```python
import torch

def _softmax(x, axis=-1):
    return torch.softmax(x, dim=axis)
def _gelu(x):
    return torch.nn.functional.gelu(x, approximate="tanh")
def _silu(x):
    return torch.nn.functional.silu(x)
def _sigmoid(x):
    return torch.sigmoid(x)
def _layernorm(x, axis=-1, eps=1e-5):
    m = x.mean(dim=axis, keepdim=True)
    v = x.var(dim=axis, keepdim=True, unbiased=False)
    return (x - m) / torch.sqrt(v + eps)
def _scatter_add(tgt, idx, src, axis=0):
    return tgt.clone().index_add_(axis, idx, src)
def _segment_sum(src, seg, n):
    out = torch.zeros((n,) + src.shape[1:], dtype=src.dtype)
    return out.index_add_(0, seg, src)
def _pad(x, pw):
    flat = tuple(v for pair in reversed(pw) for v in pair)
    return torch.nn.functional.pad(x, flat)

kernel_name = 'interleave_layers__mha_block__dense_activation_silu__prompt'

def setup_inputs():

    _w = (lambda a: (lambda t: t.to(torch.bfloat16) if t.is_floating_point() else t)(torch.as_tensor(a)))
    def _A_setup():
        B, S, D, H = 1, 2048, 512, 32
        return {
            "x": _w((lambda *s: torch.randn(*s, dtype=torch.bfloat16) * 0.05)(B, S, D)),
            "wqkv": _w((lambda *s: torch.randn(*s, dtype=torch.bfloat16) * 0.05)(D, 3 * D)),
            "wo": _w((lambda *s: torch.randn(*s, dtype=torch.bfloat16) * 0.05)(D, D)),
        }
    _A_in = _A_setup()

    def _B_setup():
        B, S, D, F = 1, 2048, 512, 1792
        return {
            "x": _w((lambda *s: torch.randn(*s, dtype=torch.bfloat16) * 0.05)(B, S, D)),
            "w1": _w((lambda *s: torch.randn(*s, dtype=torch.bfloat16) * 0.8)(D, F) * (D ** -0.5)),
            "w2": _w((lambda *s: torch.randn(*s, dtype=torch.bfloat16) * 0.2)(F, D) * (F ** -0.5)),
        }
    _B_in = _B_setup()

    return {
        "A_x": _A_in["x"],
        "A_wqkv": _A_in["wqkv"],
        "A_wo": _A_in["wo"],
        "B_x": _B_in["x"],
        "B_w1": _B_in["w1"],
        "B_w2": _B_in["w2"],
    }

def reference(A_x, A_wqkv, A_wo, B_x, B_w1, B_w2):
    def _A_ref(x, wqkv, wo):
        B, S, D = x.shape
        H = 32
        Dh = D // H
        qkv = (lambda x, *d: x.permute(*d))((x @ wqkv).reshape(B, S, 3, H, Dh), 2, 0, 3, 1, 4)
        q, k, v = qkv[0], qkv[1], qkv[2]
        scores = torch.einsum("bhqd,bhkd->bhqk", q, k) * (Dh ** -0.5)
        p = _softmax(scores, axis=-1)
        o = torch.einsum("bhqk,bhkd->bhqd", p, v)
        return (lambda x, *d: x.permute(*d))(o, 0, 2, 1, 3).reshape(B, S, D) @ wo

    def _B_ref(x, w1, w2):
        h = torch.einsum("bsd,df->bsf", x, w1)
        h = _silu(h)
        out = torch.einsum("bsf,fd->bsd", h, w2)
        return out

    x = A_x
    x = x + _A_ref(_layernorm(x, axis=-1), A_wqkv, A_wo)
    x = x + _B_ref(_layernorm(x, axis=-1), B_w1, B_w2)
    x = x + _A_ref(_layernorm(x, axis=-1), A_wqkv, A_wo)
    x = x + _B_ref(_layernorm(x, axis=-1), B_w1, B_w2)
    return x
```

```asm
; @launch grid=(256,1,1) block=(512,1,1) lds=163840
.amdgcn_target "amdgcn-amd-amdhsa--gfx950"
.text
.globl interleave_layers__mha_block__dense_activation_silu__prompt_kernel
.p2align 8
.type interleave_layers__mha_block__dense_activation_silu__prompt_kernel,@function
interleave_layers__mha_block__dense_activation_silu__prompt_kernel:
  s_cmp_ge_u32 s2, 256
  s_cbranch_scc1 L_END
  s_getpc_b64 s[54:55]
CODEPF:
  s_lshr_b32 s50, s2, 3
  s_mul_i32 s50, s50, 2560
  v_lshl_add_u32 v8, v0, 7, s50
  v_min_u32 v8, L_END-CODEPF, v8
  v_cmp_gt_u32 vcc, 20, v0
  s_load_dwordx2 s[4:5], s[0:1], 0
  s_load_dwordx2 s[8:9], s[0:1], 8
  s_and_saveexec_b64 s[56:57], vcc
  s_cbranch_execz L_NCP
  global_load_dword v247, v8, s[54:55]
L_NCP:
  s_mov_b64 exec, s[56:57]
  s_load_dwordx2 s[34:35], s[0:1], 64
  s_load_dwordx2 s[32:33], s[0:1], 56
  s_load_dwordx2 s[28:29], s[0:1], 64
  s_load_dwordx2 s[12:13], s[0:1], 16
  s_load_dwordx2 s[16:17], s[0:1], 32
  s_load_dwordx2 s[20:21], s[0:1], 40
  s_load_dwordx2 s[24:25], s[0:1], 48
  v_lshrrev_b32 v1, 6, v0
  s_and_b32 s37, s2, 7
  s_lshr_b32 s38, s2, 3
  v_readfirstlane_b32 s36, v1
  s_mov_b32 s39, 1
  s_mov_b32 s66, 1
  s_mov_b32 s91, 1
  s_mov_b32 s40, 0
  s_mov_b32 s41, 0
  s_mov_b32 s42, 0
  s_mov_b32 s60, 2097152
  s_mov_b32 s61, 10485760
  s_mov_b32 s6, 2097152
  s_mov_b32 s7, 0x20000
  s_mov_b32 s10, 1572864
  s_mov_b32 s11, 0x20000
  s_mov_b32 s14, 524288
  s_mov_b32 s15, 0x20000
  s_mov_b32 s18, 1835008
  s_mov_b32 s19, 0x20000
  s_mov_b32 s22, 1835008
  s_mov_b32 s23, 0x20000
  s_mov_b32 s26, 2097152
  s_mov_b32 s27, 0x20000
  s_mov_b32 s30, 152043520
  s_mov_b32 s31, 0x20000
  s_cmp_ge_u32 s36, 4
  s_cbranch_scc1 L_HELP
  s_mov_b32 s65, s38
  s_mov_b32 s70, s37
  s_add_u32 s42, s40, 1
  s_setprio 1
  v_mbcnt_lo_u32_b32 v212, -1, 0
  v_mbcnt_hi_u32_b32 v212, -1, v212
  s_lshr_b32 s44, s38, 4
  s_lshl_b32 s45, s37, 1
  s_add_u32 s44, s44, s45
  s_mul_i32 s71, s44, 737280
  s_lshl_b32 s44, s44, 2
  s_add_u32 s44, s44, s36
  v_lshrrev_b32 v216, 3, v212
  v_and_b32 v217, 7, v212
  v_lshrrev_b32 v219, 4, v212
  v_xor_b32 v219, v219, v217
  v_lshlrev_b32 v216, 10, v216
  v_lshl_add_u32 v221, v219, 4, v216
  v_xor_b32 v222, 64, v221
  s_lshl_b32 s45, s44, 15
  s_mul_i32 s49, s36, 12288
  s_add_u32 s49, s49, 98304
  s_waitcnt lgkmcnt(0)
  s_add_u32 s47, s38, 0
  s_and_b32 s47, s47, 7
  s_lshl_b32 s47, s47, 7
  s_add_u32 s47, s47, s45
  s_add_u32 m0, s49, 0
  s_add_u32 s46, s47, 0
  buffer_load_dwordx4 v221, s[4:7], s46 offen lds
  s_add_u32 m0, s49, 1024
  s_add_u32 s46, s47, 8192
  buffer_load_dwordx4 v222, s[4:7], s46 offen lds
  s_add_u32 m0, s49, 2048
  s_add_u32 s46, s47, 16384
  buffer_load_dwordx4 v221, s[4:7], s46 offen lds
  s_add_u32 m0, s49, 3072
  s_add_u32 s46, s47, 24576
  buffer_load_dwordx4 v222, s[4:7], s46 offen lds
  s_add_u32 s47, s38, 1
  s_and_b32 s47, s47, 7
  s_lshl_b32 s47, s47, 7
  s_add_u32 s47, s47, s45
  s_add_u32 m0, s49, 4096
  s_add_u32 s46, s47, 0
  buffer_load_dwordx4 v221, s[4:7], s46 offen lds
  s_add_u32 m0, s49, 5120
  s_add_u32 s46, s47, 8192
  buffer_load_dwordx4 v222, s[4:7], s46 offen lds
  s_add_u32 m0, s49, 6144
  s_add_u32 s46, s47, 16384
  buffer_load_dwordx4 v221, s[4:7], s46 offen lds
  s_add_u32 m0, s49, 7168
  s_add_u32 s46, s47, 24576
  buffer_load_dwordx4 v222, s[4:7], s46 offen lds
  s_add_u32 s47, s38, 2
  s_and_b32 s47, s47, 7
  s_lshl_b32 s47, s47, 7
  s_add_u32 s47, s47, s45
  s_add_u32 m0, s49, 8192
  s_add_u32 s46, s47, 0
  buffer_load_dwordx4 v221, s[4:7], s46 offen lds
  s_add_u32 m0, s49, 9216
  s_add_u32 s46, s47, 8192
  buffer_load_dwordx4 v222, s[4:7], s46 offen lds
  s_add_u32 m0, s49, 10240
  s_add_u32 s46, s47, 16384
  buffer_load_dwordx4 v221, s[4:7], s46 offen lds
  s_add_u32 m0, s49, 11264
  s_add_u32 s46, s47, 24576
  buffer_load_dwordx4 v222, s[4:7], s46 offen lds
  v_and_b32 v216, 31, v212
  v_lshrrev_b32 v217, 5, v212
  v_bfe_u32 v219, v212, 1, 3
  v_xor_b32 v217, v217, v219
  v_lshlrev_b32 v216, 7, v216
  v_add_u32 v216, s49, v216
  v_xor_b32 v219, 0, v217
  v_lshl_add_u32 v223, v219, 4, v216
  v_xor_b32 v219, 2, v217
  v_lshl_add_u32 v224, v219, 4, v216
  v_xor_b32 v219, 4, v217
  v_lshl_add_u32 v225, v219, 4, v216
  v_xor_b32 v219, 6, v217
  v_lshl_add_u32 v226, v219, 4, v216
  v_mov_b32 v228, 0
  v_mov_b32 v229, 0
  v_mov_b32 v230, 0
  v_mov_b32 v231, 0
  v_bfe_u32 v176, v212, 2, 2
  v_bfe_u32 v177, v212, 4, 1
  v_lshlrev_b32 v177, 5, v177
  v_and_b32 v178, 3, v212
  v_lshl_add_u32 v177, v178, 3, v177
  v_lshrrev_b32 v178, 5, v212
  v_lshl_add_u32 v208, v178, 3, v176
  v_add_u32 v209, 4, v208
  v_mul_u32_u24 v208, 192, v208
  v_add_u32 v208, v208, v177
  v_add_u32 v210, 49152, v208
  v_mul_u32_u24 v209, 192, v209
  v_add_u32 v209, v209, v177
  v_add_u32 v211, 49152, v209
  s_waitcnt vmcnt(8)
  ds_read_b128 v[0:3], v223 offset:0
  ds_read_b128 v[4:7], v224 offset:0
  ds_read_b128 v[8:11], v225 offset:0
  ds_read_b128 v[12:15], v226 offset:0
  s_barrier
  ds_read_b64_tr_b16 v[176:177], v208 offset:128
  ds_read_b64_tr_b16 v[178:179], v209 offset:128
  ds_read_b64_tr_b16 v[180:181], v208 offset:0
  ds_read_b64_tr_b16 v[182:183], v209 offset:0
  ds_read_b64_tr_b16 v[184:185], v208 offset:64
  ds_read_b64_tr_b16 v[186:187], v209 offset:64
  ds_read_b64_tr_b16 v[188:189], v208 offset:3200
  ds_read_b64_tr_b16 v[190:191], v209 offset:3200
  ds_read_b64_tr_b16 v[192:193], v208 offset:3072
  ds_read_b64_tr_b16 v[194:195], v209 offset:3072
  ds_read_b64_tr_b16 v[196:197], v208 offset:3136
  ds_read_b64_tr_b16 v[198:199], v209 offset:3136
  s_waitcnt lgkmcnt(15)
  v_dot2c_f32_bf16 v228, 0x3f803f80, v0
  v_dot2c_f32_bf16 v230, v0, v0
  v_dot2c_f32_bf16 v229, 0x3f803f80, v1
  v_dot2c_f32_bf16 v231, v1, v1
  v_dot2c_f32_bf16 v228, 0x3f803f80, v2
  v_dot2c_f32_bf16 v230, v2, v2
  v_dot2c_f32_bf16 v229, 0x3f803f80, v3
  v_dot2c_f32_bf16 v231, v3, v3
  s_waitcnt lgkmcnt(14)
  v_dot2c_f32_bf16 v228, 0x3f803f80, v4
  v_dot2c_f32_bf16 v230, v4, v4
  v_dot2c_f32_bf16 v229, 0x3f803f80, v5
  v_dot2c_f32_bf16 v231, v5, v5
  v_dot2c_f32_bf16 v228, 0x3f803f80, v6
  v_dot2c_f32_bf16 v230, v6, v6
  v_dot2c_f32_bf16 v229, 0x3f803f80, v7
  v_dot2c_f32_bf16 v231, v7, v7
  s_waitcnt lgkmcnt(13)
  v_dot2c_f32_bf16 v228, 0x3f803f80, v8
  v_dot2c_f32_bf16 v230, v8, v8
  v_dot2c_f32_bf16 v229, 0x3f803f80, v9
  v_dot2c_f32_bf16 v231, v9, v9
  v_dot2c_f32_bf16 v228, 0x3f803f80, v10
  v_dot2c_f32_bf16 v230, v10, v10
  v_dot2c_f32_bf16 v229, 0x3f803f80, v11
  v_dot2c_f32_bf16 v231, v11, v11
  s_waitcnt lgkmcnt(12)
  v_dot2c_f32_bf16 v228, 0x3f803f80, v12
  v_dot2c_f32_bf16 v230, v12, v12
  v_dot2c_f32_bf16 v229, 0x3f803f80, v13
  v_dot2c_f32_bf16 v231, v13, v13
  v_dot2c_f32_bf16 v228, 0x3f803f80, v14
  v_dot2c_f32_bf16 v230, v14, v14
  v_dot2c_f32_bf16 v229, 0x3f803f80, v15
  v_dot2c_f32_bf16 v231, v15, v15
  s_waitcnt lgkmcnt(10)
  v_mfma_f32_32x32x16_bf16 v[160:175], v[0:3], v[176:179], 0
  ds_read_b64_tr_b16 v[200:201], v208 offset:6272
  ds_read_b64_tr_b16 v[202:203], v209 offset:6272
  s_add_u32 s47, s38, 3
  s_and_b32 s47, s47, 7
  s_lshl_b32 s47, s47, 7
  s_add_u32 s47, s47, s45
  s_add_u32 m0, s49, 0
  s_add_u32 s46, s47, 0
  buffer_load_dwordx4 v221, s[4:7], s46 offen lds
  s_waitcnt lgkmcnt(10)
  v_mfma_f32_32x32x16_bf16 v[128:143], v[180:183], v[0:3], 0
  ds_read_b64_tr_b16 v[204:205], v208 offset:6144
  ds_read_b64_tr_b16 v[206:207], v209 offset:6144
  s_add_u32 m0, s49, 1024
  s_add_u32 s46, s47, 8192
  buffer_load_dwordx4 v222, s[4:7], s46 offen lds
  s_waitcnt lgkmcnt(10)
  v_mfma_f32_32x32x16_bf16 v[144:159], v[184:187], v[0:3], 0
  ds_read_b64_tr_b16 v[176:177], v208 offset:6208
  ds_read_b64_tr_b16 v[178:179], v209 offset:6208
  s_add_u32 m0, s49, 2048
  s_add_u32 s46, s47, 16384
  buffer_load_dwordx4 v221, s[4:7], s46 offen lds
  s_waitcnt lgkmcnt(10)
  v_mfma_f32_32x32x16_bf16 v[160:175], v[4:7], v[188:191], v[160:175]
  ds_read_b64_tr_b16 v[180:181], v208 offset:9344
  ds_read_b64_tr_b16 v[182:183], v209 offset:9344
  s_add_u32 m0, s49, 3072
  s_add_u32 s46, s47, 24576
  buffer_load_dwordx4 v222, s[4:7], s46 offen lds
  s_waitcnt lgkmcnt(10)
  v_mfma_f32_32x32x16_bf16 v[128:143], v[192:195], v[4:7], v[128:143]
  ds_read_b64_tr_b16 v[184:185], v208 offset:9216
  ds_read_b64_tr_b16 v[186:187], v209 offset:9216
  s_waitcnt vmcnt(8)
  s_waitcnt lgkmcnt(10)
  v_mfma_f32_32x32x16_bf16 v[144:159], v[196:199], v[4:7], v[144:159]
  ds_read_b64_tr_b16 v[188:189], v208 offset:9280
  ds_read_b64_tr_b16 v[190:191], v209 offset:9280
  ds_read_b128 v[16:19], v223 offset:4096
  s_waitcnt lgkmcnt(11)
  v_mfma_f32_32x32x16_bf16 v[160:175], v[8:11], v[200:203], v[160:175]
  s_barrier
  ds_read_b64_tr_b16 v[192:193], v208 offset:12416
  ds_read_b64_tr_b16 v[194:195], v209 offset:12416
  ds_read_b128 v[20:23], v224 offset:4096
  s_waitcnt lgkmcnt(12)
  v_mfma_f32_32x32x16_bf16 v[128:143], v[204:207], v[8:11], v[128:143]
  ds_read_b64_tr_b16 v[196:197], v208 offset:12288
  ds_read_b64_tr_b16 v[198:199], v209 offset:12288
  ds_read_b128 v[24:27], v225 offset:4096
  s_waitcnt lgkmcnt(13)
  v_mfma_f32_32x32x16_bf16 v[144:159], v[176:179], v[8:11], v[144:159]
  ds_read_b64_tr_b16 v[200:201], v208 offset:12352
  ds_read_b64_tr_b16 v[202:203], v209 offset:12352
  ds_read_b128 v[28:31], v226 offset:4096
  s_waitcnt lgkmcnt(14)
  v_mfma_f32_32x32x16_bf16 v[160:175], v[12:15], v[180:183], v[160:175]
  ds_read_b64_tr_b16 v[204:205], v208 offset:15488
  ds_read_b64_tr_b16 v[206:207], v209 offset:15488
  s_waitcnt lgkmcnt(14)
  v_mfma_f32_32x32x16_bf16 v[128:143], v[184:187], v[12:15], v[128:143]
  ds_read_b64_tr_b16 v[176:177], v208 offset:15360
  ds_read_b64_tr_b16 v[178:179], v209 offset:15360
  s_waitcnt lgkmcnt(14)
  v_mfma_f32_32x32x16_bf16 v[144:159], v[188:191], v[12:15], v[144:159]
  ds_read_b64_tr_b16 v[180:181], v208 offset:15424
  ds_read_b64_tr_b16 v[182:183], v209 offset:15424
  s_waitcnt lgkmcnt(15)
  v_dot2c_f32_bf16 v228, 0x3f803f80, v16
  v_dot2c_f32_bf16 v230, v16, v16
  v_dot2c_f32_bf16 v229, 0x3f803f80, v17
  v_dot2c_f32_bf16 v231, v17, v17
  v_dot2c_f32_bf16 v228, 0x3f803f80, v18
  v_dot2c_f32_bf16 v230, v18, v18
  v_dot2c_f32_bf16 v229, 0x3f803f80, v19
  v_dot2c_f32_bf16 v231, v19, v19
  s_waitcnt lgkmcnt(12)
  v_dot2c_f32_bf16 v228, 0x3f803f80, v20
  v_dot2c_f32_bf16 v230, v20, v20
  v_dot2c_f32_bf16 v229, 0x3f803f80, v21
  v_dot2c_f32_bf16 v231, v21, v21
  v_dot2c_f32_bf16 v228, 0x3f803f80, v22
  v_dot2c_f32_bf16 v230, v22, v22
  v_dot2c_f32_bf16 v229, 0x3f803f80, v23
  v_dot2c_f32_bf16 v231, v23, v23
  s_waitcnt lgkmcnt(9)
  v_dot2c_f32_bf16 v228, 0x3f803f80, v24
  v_dot2c_f32_bf16 v230, v24, v24
  v_dot2c_f32_bf16 v229, 0x3f803f80, v25
  v_dot2c_f32_bf16 v231, v25, v25
  v_dot2c_f32_bf16 v228, 0x3f803f80, v26
  v_dot2c_f32_bf16 v230, v26, v26
  v_dot2c_f32_bf16 v229, 0x3f803f80, v27
  v_dot2c_f32_bf16 v231, v27, v27
  s_waitcnt lgkmcnt(6)
  v_dot2c_f32_bf16 v228, 0x3f803f80, v28
  v_dot2c_f32_bf16 v230, v28, v28
  v_dot2c_f32_bf16 v229, 0x3f803f80, v29
  v_dot2c_f32_bf16 v231, v29, v29
  v_dot2c_f32_bf16 v228, 0x3f803f80, v30
  v_dot2c_f32_bf16 v230, v30, v30
  v_dot2c_f32_bf16 v229, 0x3f803f80, v31
  v_dot2c_f32_bf16 v231, v31, v31
  v_mfma_f32_32x32x16_bf16 v[160:175], v[16:19], v[192:195], v[160:175]
  ds_read_b64_tr_b16 v[184:185], v208 offset:18560
  ds_read_b64_tr_b16 v[186:187], v209 offset:18560
  s_add_u32 s47, s38, 4
  s_and_b32 s47, s47, 7
  s_lshl_b32 s47, s47, 7
  s_add_u32 s47, s47, s45
  s_add_u32 m0, s49, 4096
  s_add_u32 s46, s47, 0
  buffer_load_dwordx4 v221, s[4:7], s46 offen lds
  v_mfma_f32_32x32x16_bf16 v[128:143], v[196:199], v[16:19], v[128:143]
  ds_read_b64_tr_b16 v[188:189], v208 offset:18432
  ds_read_b64_tr_b16 v[190:191], v209 offset:18432
  s_add_u32 m0, s49, 5120
  s_add_u32 s46, s47, 8192
  buffer_load_dwordx4 v222, s[4:7], s46 offen lds
  v_mfma_f32_32x32x16_bf16 v[144:159], v[200:203], v[16:19], v[144:159]
  ds_read_b64_tr_b16 v[192:193], v208 offset:18496
  ds_read_b64_tr_b16 v[194:195], v209 offset:18496
  s_add_u32 m0, s49, 6144
  s_add_u32 s46, s47, 16384
  buffer_load_dwordx4 v221, s[4:7], s46 offen lds
  s_waitcnt lgkmcnt(10)
  v_mfma_f32_32x32x16_bf16 v[160:175], v[20:23], v[204:207], v[160:175]
  ds_read_b64_tr_b16 v[196:197], v208 offset:21632
  ds_read_b64_tr_b16 v[198:199], v209 offset:21632
  s_add_u32 m0, s49, 7168
  s_add_u32 s46, s47, 24576
  buffer_load_dwordx4 v222, s[4:7], s46 offen lds
  s_waitcnt lgkmcnt(10)
  v_mfma_f32_32x32x16_bf16 v[128:143], v[176:179], v[20:23], v[128:143]
  ds_read_b64_tr_b16 v[200:201], v208 offset:21504
  ds_read_b64_tr_b16 v[202:203], v209 offset:21504
  s_waitcnt vmcnt(8)
  s_waitcnt lgkmcnt(10)
  v_mfma_f32_32x32x16_bf16 v[144:159], v[180:183], v[20:23], v[144:159]
  ds_read_b64_tr_b16 v[204:205], v208 offset:21568
  ds_read_b64_tr_b16 v[206:207], v209 offset:21568
  ds_read_b128 v[32:35], v223 offset:8192
  s_waitcnt lgkmcnt(11)
  v_mfma_f32_32x32x16_bf16 v[160:175], v[24:27], v[184:187], v[160:175]
  s_barrier
  ds_read_b64_tr_b16 v[176:177], v208 offset:24704
  ds_read_b64_tr_b16 v[178:179], v209 offset:24704
  ds_read_b128 v[36:39], v224 offset:8192
  s_waitcnt lgkmcnt(12)
  v_mfma_f32_32x32x16_bf16 v[128:143], v[188:191], v[24:27], v[128:143]
  ds_read_b64_tr_b16 v[180:181], v208 offset:24576
  ds_read_b64_tr_b16 v[182:183], v209 offset:24576
  ds_read_b128 v[40:43], v225 offset:8192
  s_waitcnt lgkmcnt(13)
  v_mfma_f32_32x32x16_bf16 v[144:159], v[192:195], v[24:27], v[144:159]
  ds_read_b64_tr_b16 v[184:185], v208 offset:24640
  ds_read_b64_tr_b16 v[186:187], v209 offset:24640
  ds_read_b128 v[44:47], v226 offset:8192
  s_waitcnt lgkmcnt(14)
  v_mfma_f32_32x32x16_bf16 v[160:175], v[28:31], v[196:199], v[160:175]
  ds_read_b64_tr_b16 v[188:189], v208 offset:27776
  ds_read_b64_tr_b16 v[190:191], v209 offset:27776
  s_waitcnt lgkmcnt(14)
  v_mfma_f32_32x32x16_bf16 v[128:143], v[200:203], v[28:31], v[128:143]
  ds_read_b64_tr_b16 v[192:193], v208 offset:27648
  ds_read_b64_tr_b16 v[194:195], v209 offset:27648
  s_waitcnt lgkmcnt(14)
  v_mfma_f32_32x32x16_bf16 v[144:159], v[204:207], v[28:31], v[144:159]
  ds_read_b64_tr_b16 v[196:197], v208 offset:27712
  ds_read_b64_tr_b16 v[198:199], v209 offset:27712
  s_waitcnt lgkmcnt(15)
  v_dot2c_f32_bf16 v228, 0x3f803f80, v32
  v_dot2c_f32_bf16 v230, v32, v32
  v_dot2c_f32_bf16 v229, 0x3f803f80, v33
  v_dot2c_f32_bf16 v231, v33, v33
  v_dot2c_f32_bf16 v228, 0x3f803f80, v34
  v_dot2c_f32_bf16 v230, v34, v34
  v_dot2c_f32_bf16 v229, 0x3f803f80, v35
  v_dot2c_f32_bf16 v231, v35, v35
  s_waitcnt lgkmcnt(12)
  v_dot2c_f32_bf16 v228, 0x3f803f80, v36
  v_dot2c_f32_bf16 v230, v36, v36
  v_dot2c_f32_bf16 v229, 0x3f803f80, v37
  v_dot2c_f32_bf16 v231, v37, v37
  v_dot2c_f32_bf16 v228, 0x3f803f80, v38
  v_dot2c_f32_bf16 v230, v38, v38
  v_dot2c_f32_bf16 v229, 0x3f803f80, v39
  v_dot2c_f32_bf16 v231, v39, v39
  s_waitcnt lgkmcnt(9)
  v_dot2c_f32_bf16 v228, 0x3f803f80, v40
  v_dot2c_f32_bf16 v230, v40, v40
  v_dot2c_f32_bf16 v229, 0x3f803f80, v41
  v_dot2c_f32_bf16 v231, v41, v41
  v_dot2c_f32_bf16 v228, 0x3f803f80, v42
  v_dot2c_f32_bf16 v230, v42, v42
  v_dot2c_f32_bf16 v229, 0x3f803f80, v43
  v_dot2c_f32_bf16 v231, v43, v43
  s_waitcnt lgkmcnt(6)
  v_dot2c_f32_bf16 v228, 0x3f803f80, v44
  v_dot2c_f32_bf16 v230, v44, v44
  v_dot2c_f32_bf16 v229, 0x3f803f80, v45
  v_dot2c_f32_bf16 v231, v45, v45
  v_dot2c_f32_bf16 v228, 0x3f803f80, v46
  v_dot2c_f32_bf16 v230, v46, v46
  v_dot2c_f32_bf16 v229, 0x3f803f80, v47
  v_dot2c_f32_bf16 v231, v47, v47
  v_mfma_f32_32x32x16_bf16 v[160:175], v[32:35], v[176:179], v[160:175]
  ds_read_b64_tr_b16 v[200:201], v208 offset:30848
  ds_read_b64_tr_b16 v[202:203], v209 offset:30848
  s_add_u32 s47, s38, 5
  s_and_b32 s47, s47, 7
  s_lshl_b32 s47, s47, 7
  s_add_u32 s47, s47, s45
  s_add_u32 m0, s49, 8192
  s_add_u32 s46, s47, 0
  buffer_load_dwordx4 v221, s[4:7], s46 offen lds
  v_mfma_f32_32x32x16_bf16 v[128:143], v[180:183], v[32:35], v[128:143]
  ds_read_b64_tr_b16 v[204:205], v208 offset:30720
  ds_read_b64_tr_b16 v[206:207], v209 offset:30720
  s_add_u32 m0, s49, 9216
  s_add_u32 s46, s47, 8192
  buffer_load_dwordx4 v222, s[4:7], s46 offen lds
  v_mfma_f32_32x32x16_bf16 v[144:159], v[184:187], v[32:35], v[144:159]
  ds_read_b64_tr_b16 v[176:177], v208 offset:30784
  ds_read_b64_tr_b16 v[178:179], v209 offset:30784
  s_add_u32 m0, s49, 10240
  s_add_u32 s46, s47, 16384
  buffer_load_dwordx4 v221, s[4:7], s46 offen lds
  s_waitcnt lgkmcnt(10)
  v_mfma_f32_32x32x16_bf16 v[160:175], v[36:39], v[188:191], v[160:175]
  ds_read_b64_tr_b16 v[180:181], v208 offset:33920
  ds_read_b64_tr_b16 v[182:183], v209 offset:33920
  s_add_u32 m0, s49, 11264
  s_add_u32 s46, s47, 24576
  buffer_load_dwordx4 v222, s[4:7], s46 offen lds
  s_waitcnt lgkmcnt(10)
  v_mfma_f32_32x32x16_bf16 v[128:143], v[192:195], v[36:39], v[128:143]
  ds_read_b64_tr_b16 v[184:185], v208 offset:33792
  ds_read_b64_tr_b16 v[186:187], v209 offset:33792
  s_waitcnt vmcnt(8)
  s_waitcnt lgkmcnt(10)
  v_mfma_f32_32x32x16_bf16 v[144:159], v[196:199], v[36:39], v[144:159]
  ds_read_b64_tr_b16 v[188:189], v208 offset:33856
  ds_read_b64_tr_b16 v[190:191], v209 offset:33856
  ds_read_b128 v[48:51], v223 offset:0
  s_waitcnt lgkmcnt(11)
  v_mfma_f32_32x32x16_bf16 v[160:175], v[40:43], v[200:203], v[160:175]
  s_barrier
  ds_read_b64_tr_b16 v[192:193], v208 offset:36992
  ds_read_b64_tr_b16 v[194:195], v209 offset:36992
  ds_read_b128 v[52:55], v224 offset:0
  s_waitcnt lgkmcnt(12)
  v_mfma_f32_32x32x16_bf16 v[128:143], v[204:207], v[40:43], v[128:143]
  ds_read_b64_tr_b16 v[196:197], v208 offset:36864
  ds_read_b64_tr_b16 v[198:199], v209 offset:36864
  ds_read_b128 v[56:59], v225 offset:0
  s_waitcnt lgkmcnt(13)
  v_mfma_f32_32x32x16_bf16 v[144:159], v[176:179], v[40:43], v[144:159]
  ds_read_b64_tr_b16 v[200:201], v208 offset:36928
  ds_read_b64_tr_b16 v[202:203], v209 offset:36928
  ds_read_b128 v[60:63], v226 offset:0
  s_waitcnt lgkmcnt(14)
  v_mfma_f32_32x32x16_bf16 v[160:175], v[44:47], v[180:183], v[160:175]
  ds_read_b64_tr_b16 v[204:205], v208 offset:40064
  ds_read_b64_tr_b16 v[206:207], v209 offset:40064
  s_waitcnt lgkmcnt(14)
  v_mfma_f32_32x32x16_bf16 v[128:143], v[184:187], v[44:47], v[128:143]
  ds_read_b64_tr_b16 v[176:177], v208 offset:39936
  ds_read_b64_tr_b16 v[178:179], v209 offset:39936
  s_waitcnt lgkmcnt(14)
  v_mfma_f32_32x32x16_bf16 v[144:159], v[188:191], v[44:47], v[144:159]
  ds_read_b64_tr_b16 v[180:181], v208 offset:40000
  ds_read_b64_tr_b16 v[182:183], v209 offset:40000
  s_waitcnt lgkmcnt(15)
  v_dot2c_f32_bf16 v228, 0x3f803f80, v48
  v_dot2c_f32_bf16 v230, v48, v48
  v_dot2c_f32_bf16 v229, 0x3f803f80, v49
  v_dot2c_f32_bf16 v231, v49, v49
  v_dot2c_f32_bf16 v228, 0x3f803f80, v50
  v_dot2c_f32_bf16 v230, v50, v50
  v_dot2c_f32_bf16 v229, 0x3f803f80, v51
  v_dot2c_f32_bf16 v231, v51, v51
  s_waitcnt lgkmcnt(12)
  v_dot2c_f32_bf16 v228, 0x3f803f80, v52
  v_dot2c_f32_bf16 v230, v52, v52
  v_dot2c_f32_bf16 v229, 0x3f803f80, v53
  v_dot2c_f32_bf16 v231, v53, v53
  v_dot2c_f32_bf16 v228, 0x3f803f80, v54
  v_dot2c_f32_bf16 v230, v54, v54
  v_dot2c_f32_bf16 v229, 0x3f803f80, v55
  v_dot2c_f32_bf16 v231, v55, v55
  s_waitcnt lgkmcnt(9)
  v_dot2c_f32_bf16 v228, 0x3f803f80, v56
  v_dot2c_f32_bf16 v230, v56, v56
  v_dot2c_f32_bf16 v229, 0x3f803f80, v57
  v_dot2c_f32_bf16 v231, v57, v57
  v_dot2c_f32_bf16 v228, 0x3f803f80, v58
  v_dot2c_f32_bf16 v230, v58, v58
  v_dot2c_f32_bf16 v229, 0x3f803f80, v59
  v_dot2c_f32_bf16 v231, v59, v59
  s_waitcnt lgkmcnt(6)
  v_dot2c_f32_bf16 v228, 0x3f803f80, v60
  v_dot2c_f32_bf16 v230, v60, v60
  v_dot2c_f32_bf16 v229, 0x3f803f80, v61
  v_dot2c_f32_bf16 v231, v61, v61
  v_dot2c_f32_bf16 v228, 0x3f803f80, v62
  v_dot2c_f32_bf16 v230, v62, v62
  v_dot2c_f32_bf16 v229, 0x3f803f80, v63
  v_dot2c_f32_bf16 v231, v63, v63
  v_mfma_f32_32x32x16_bf16 v[160:175], v[48:51], v[192:195], v[160:175]
  ds_read_b64_tr_b16 v[184:185], v208 offset:43136
  ds_read_b64_tr_b16 v[186:187], v209 offset:43136
  s_add_u32 s47, s38, 6
  s_and_b32 s47, s47, 7
  s_lshl_b32 s47, s47, 7
  s_add_u32 s47, s47, s45
  s_add_u32 m0, s49, 0
  s_add_u32 s46, s47, 0
  buffer_load_dwordx4 v221, s[4:7], s46 offen lds
  v_mfma_f32_32x32x16_bf16 v[128:143], v[196:199], v[48:51], v[128:143]
  ds_read_b64_tr_b16 v[188:189], v208 offset:43008
  ds_read_b64_tr_b16 v[190:191], v209 offset:43008
  s_add_u32 m0, s49, 1024
  s_add_u32 s46, s47, 8192
  buffer_load_dwordx4 v222, s[4:7], s46 offen lds
  v_mfma_f32_32x32x16_bf16 v[144:159], v[200:203], v[48:51], v[144:159]
  ds_read_b64_tr_b16 v[192:193], v208 offset:43072
  ds_read_b64_tr_b16 v[194:195], v209 offset:43072
  s_add_u32 m0, s49, 2048
  s_add_u32 s46, s47, 16384
  buffer_load_dwordx4 v221, s[4:7], s46 offen lds
  s_waitcnt lgkmcnt(10)
  v_mfma_f32_32x32x16_bf16 v[160:175], v[52:55], v[204:207], v[160:175]
  ds_read_b64_tr_b16 v[196:197], v208 offset:46208
  ds_read_b64_tr_b16 v[198:199], v209 offset:46208
  s_add_u32 m0, s49, 3072
  s_add_u32 s46, s47, 24576
  buffer_load_dwordx4 v222, s[4:7], s46 offen lds
  s_waitcnt lgkmcnt(10)
  v_mfma_f32_32x32x16_bf16 v[128:143], v[176:179], v[52:55], v[128:143]
  ds_read_b64_tr_b16 v[200:201], v208 offset:46080
  ds_read_b64_tr_b16 v[202:203], v209 offset:46080
  s_waitcnt vmcnt(8)
  s_waitcnt lgkmcnt(10)
  v_mfma_f32_32x32x16_bf16 v[144:159], v[180:183], v[52:55], v[144:159]
  ds_read_b64_tr_b16 v[204:205], v208 offset:46144
  ds_read_b64_tr_b16 v[206:207], v209 offset:46144
  ds_read_b128 v[64:67], v223 offset:4096
  s_waitcnt lgkmcnt(11)
  v_mfma_f32_32x32x16_bf16 v[160:175], v[56:59], v[184:187], v[160:175]
  s_barrier
  ds_read_b64_tr_b16 v[176:177], v210 offset:128
  ds_read_b64_tr_b16 v[178:179], v211 offset:128
  ds_read_b128 v[68:71], v224 offset:4096
  s_waitcnt lgkmcnt(12)
  v_mfma_f32_32x32x16_bf16 v[128:143], v[188:191], v[56:59], v[128:143]
  ds_read_b64_tr_b16 v[180:181], v210 offset:0
  ds_read_b64_tr_b16 v[182:183], v211 offset:0
  ds_read_b128 v[72:75], v225 offset:4096
  s_waitcnt lgkmcnt(13)
  v_mfma_f32_32x32x16_bf16 v[144:159], v[192:195], v[56:59], v[144:159]
  ds_read_b64_tr_b16 v[184:185], v210 offset:64
  ds_read_b64_tr_b16 v[186:187], v211 offset:64
  ds_read_b128 v[76:79], v226 offset:4096
  s_waitcnt lgkmcnt(14)
  v_mfma_f32_32x32x16_bf16 v[160:175], v[60:63], v[196:199], v[160:175]
  ds_read_b64_tr_b16 v[188:189], v210 offset:3200
  ds_read_b64_tr_b16 v[190:191], v211 offset:3200
  s_waitcnt lgkmcnt(14)
  v_mfma_f32_32x32x16_bf16 v[128:143], v[200:203], v[60:63], v[128:143]
  ds_read_b64_tr_b16 v[192:193], v210 offset:3072
  ds_read_b64_tr_b16 v[194:195], v211 offset:3072
  s_waitcnt lgkmcnt(14)
  v_mfma_f32_32x32x16_bf16 v[144:159], v[204:207], v[60:63], v[144:159]
  ds_read_b64_tr_b16 v[196:197], v210 offset:3136
  ds_read_b64_tr_b16 v[198:199], v211 offset:3136
  s_waitcnt lgkmcnt(15)
  v_dot2c_f32_bf16 v228, 0x3f803f80, v64
  v_dot2c_f32_bf16 v230, v64, v64
  v_dot2c_f32_bf16 v229, 0x3f803f80, v65
  v_dot2c_f32_bf16 v231, v65, v65
  v_dot2c_f32_bf16 v228, 0x3f803f80, v66
  v_dot2c_f32_bf16 v230, v66, v66
  v_dot2c_f32_bf16 v229, 0x3f803f80, v67
  v_dot2c_f32_bf16 v231, v67, v67
  s_waitcnt lgkmcnt(12)
  v_dot2c_f32_bf16 v228, 0x3f803f80, v68
  v_dot2c_f32_bf16 v230, v68, v68
  v_dot2c_f32_bf16 v229, 0x3f803f80, v69
  v_dot2c_f32_bf16 v231, v69, v69
  v_dot2c_f32_bf16 v228, 0x3f803f80, v70
  v_dot2c_f32_bf16 v230, v70, v70
  v_dot2c_f32_bf16 v229, 0x3f803f80, v71
  v_dot2c_f32_bf16 v231, v71, v71
  s_waitcnt lgkmcnt(9)
  v_dot2c_f32_bf16 v228, 0x3f803f80, v72
  v_dot2c_f32_bf16 v230, v72, v72
  v_dot2c_f32_bf16 v229, 0x3f803f80, v73
  v_dot2c_f32_bf16 v231, v73, v73
  v_dot2c_f32_bf16 v228, 0x3f803f80, v74
  v_dot2c_f32_bf16 v230, v74, v74
  v_dot2c_f32_bf16 v229, 0x3f803f80, v75
  v_dot2c_f32_bf16 v231, v75, v75
  s_waitcnt lgkmcnt(6)
  v_dot2c_f32_bf16 v228, 0x3f803f80, v76
  v_dot2c_f32_bf16 v230, v76, v76
  v_dot2c_f32_bf16 v229, 0x3f803f80, v77
  v_dot2c_f32_bf16 v231, v77, v77
  v_dot2c_f32_bf16 v228, 0x3f803f80, v78
  v_dot2c_f32_bf16 v230, v78, v78
  v_dot2c_f32_bf16 v229, 0x3f803f80, v79
  v_dot2c_f32_bf16 v231, v79, v79
  v_mfma_f32_32x32x16_bf16 v[160:175], v[64:67], v[176:179], v[160:175]
  ds_read_b64_tr_b16 v[200:201], v210 offset:6272
  ds_read_b64_tr_b16 v[202:203], v211 offset:6272
  s_add_u32 s47, s38, 7
  s_and_b32 s47, s47, 7
  s_lshl_b32 s47, s47, 7
  s_add_u32 s47, s47, s45
  s_add_u32 m0, s49, 4096
  s_add_u32 s46, s47, 0
  buffer_load_dwordx4 v221, s[4:7], s46 offen lds
  v_mfma_f32_32x32x16_bf16 v[128:143], v[180:183], v[64:67], v[128:143]
  ds_read_b64_tr_b16 v[204:205], v210 offset:6144
  ds_read_b64_tr_b16 v[206:207], v211 offset:6144
  s_add_u32 m0, s49, 5120
  s_add_u32 s46, s47, 8192
  buffer_load_dwordx4 v222, s[4:7], s46 offen lds
  v_mfma_f32_32x32x16_bf16 v[144:159], v[184:187], v[64:67], v[144:159]
  ds_read_b64_tr_b16 v[176:177], v210 offset:6208
  ds_read_b64_tr_b16 v[178:179], v211 offset:6208
  s_add_u32 m0, s49, 6144
  s_add_u32 s46, s47, 16384
  buffer_load_dwordx4 v221, s[4:7], s46 offen lds
  s_waitcnt lgkmcnt(10)
  v_mfma_f32_32x32x16_bf16 v[160:175], v[68:71], v[188:191], v[160:175]
  ds_read_b64_tr_b16 v[180:181], v210 offset:9344
  ds_read_b64_tr_b16 v[182:183], v211 offset:9344
  s_add_u32 m0, s49, 7168
  s_add_u32 s46, s47, 24576
  buffer_load_dwordx4 v222, s[4:7], s46 offen lds
  s_waitcnt lgkmcnt(10)
  v_mfma_f32_32x32x16_bf16 v[128:143], v[192:195], v[68:71], v[128:143]
  ds_read_b64_tr_b16 v[184:185], v210 offset:9216
  ds_read_b64_tr_b16 v[186:187], v211 offset:9216
  s_waitcnt vmcnt(8)
  s_waitcnt lgkmcnt(10)
  v_mfma_f32_32x32x16_bf16 v[144:159], v[196:199], v[68:71], v[144:159]
  ds_read_b64_tr_b16 v[188:189], v210 offset:9280
  ds_read_b64_tr_b16 v[190:191], v211 offset:9280
  ds_read_b128 v[80:83], v223 offset:8192
  s_waitcnt lgkmcnt(11)
  v_mfma_f32_32x32x16_bf16 v[160:175], v[72:75], v[200:203], v[160:175]
  s_barrier
  ds_read_b64_tr_b16 v[192:193], v210 offset:12416
  ds_read_b64_tr_b16 v[194:195], v211 offset:12416
  ds_read_b128 v[84:87], v224 offset:8192
  s_waitcnt lgkmcnt(12)
  v_mfma_f32_32x32x16_bf16 v[128:143], v[204:207], v[72:75], v[128:143]
  ds_read_b64_tr_b16 v[196:197], v210 offset:12288
  ds_read_b64_tr_b16 v[198:199], v211 offset:12288
  ds_read_b128 v[88:91], v225 offset:8192
  s_waitcnt lgkmcnt(13)
  v_mfma_f32_32x32x16_bf16 v[144:159], v[176:179], v[72:75], v[144:159]
  ds_read_b64_tr_b16 v[200:201], v210 offset:12352
  ds_read_b64_tr_b16 v[202:203], v211 offset:12352
  ds_read_b128 v[92:95], v226 offset:8192
  s_waitcnt lgkmcnt(14)
  v_mfma_f32_32x32x16_bf16 v[160:175], v[76:79], v[180:183], v[160:175]
  ds_read_b64_tr_b16 v[204:205], v210 offset:15488
  ds_read_b64_tr_b16 v[206:207], v211 offset:15488
  s_waitcnt lgkmcnt(14)
  v_mfma_f32_32x32x16_bf16 v[128:143], v[184:187], v[76:79], v[128:143]
  ds_read_b64_tr_b16 v[176:177], v210 offset:15360
  ds_read_b64_tr_b16 v[178:179], v211 offset:15360
  s_waitcnt lgkmcnt(14)
  v_mfma_f32_32x32x16_bf16 v[144:159], v[188:191], v[76:79], v[144:159]
  ds_read_b64_tr_b16 v[180:181], v210 offset:15424
  ds_read_b64_tr_b16 v[182:183], v211 offset:15424
  s_waitcnt lgkmcnt(15)
  v_dot2c_f32_bf16 v228, 0x3f803f80, v80
  v_dot2c_f32_bf16 v230, v80, v80
  v_dot2c_f32_bf16 v229, 0x3f803f80, v81
  v_dot2c_f32_bf16 v231, v81, v81
  v_dot2c_f32_bf16 v228, 0x3f803f80, v82
  v_dot2c_f32_bf16 v230, v82, v82
  v_dot2c_f32_bf16 v229, 0x3f803f80, v83
  v_dot2c_f32_bf16 v231, v83, v83
  s_waitcnt lgkmcnt(12)
  v_dot2c_f32_bf16 v228, 0x3f803f80, v84
  v_dot2c_f32_bf16 v230, v84, v84
  v_dot2c_f32_bf16 v229, 0x3f803f80, v85
  v_dot2c_f32_bf16 v231, v85, v85
  v_dot2c_f32_bf16 v228, 0x3f803f80, v86
  v_dot2c_f32_bf16 v230, v86, v86
  v_dot2c_f32_bf16 v229, 0x3f803f80, v87
  v_dot2c_f32_bf16 v231, v87, v87
  s_waitcnt lgkmcnt(9)
  v_dot2c_f32_bf16 v228, 0x3f803f80, v88
  v_dot2c_f32_bf16 v230, v88, v88
  v_dot2c_f32_bf16 v229, 0x3f803f80, v89
  v_dot2c_f32_bf16 v231, v89, v89
  v_dot2c_f32_bf16 v228, 0x3f803f80, v90
  v_dot2c_f32_bf16 v230, v90, v90
  v_dot2c_f32_bf16 v229, 0x3f803f80, v91
  v_dot2c_f32_bf16 v231, v91, v91
  s_waitcnt lgkmcnt(6)
  v_dot2c_f32_bf16 v228, 0x3f803f80, v92
  v_dot2c_f32_bf16 v230, v92, v92
  v_dot2c_f32_bf16 v229, 0x3f803f80, v93
  v_dot2c_f32_bf16 v231, v93, v93
  v_dot2c_f32_bf16 v228, 0x3f803f80, v94
  v_dot2c_f32_bf16 v230, v94, v94
  v_dot2c_f32_bf16 v229, 0x3f803f80, v95
  v_dot2c_f32_bf16 v231, v95, v95
  v_mfma_f32_32x32x16_bf16 v[160:175], v[80:83], v[192:195], v[160:175]
  ds_read_b64_tr_b16 v[184:185], v210 offset:18560
  ds_read_b64_tr_b16 v[186:187], v211 offset:18560
  s_waitcnt vmcnt(4)
  s_and_b32 s49, s65, 15
  v_mfma_f32_32x32x16_bf16 v[128:143], v[196:199], v[80:83], v[128:143]
  ds_read_b64_tr_b16 v[188:189], v210 offset:18432
  ds_read_b64_tr_b16 v[190:191], v211 offset:18432
  ds_read_b128 v[96:99], v223 offset:0
  s_lshr_b32 s51, s49, 1
  v_mfma_f32_32x32x16_bf16 v[144:159], v[200:203], v[80:83], v[144:159]
  ds_read_b64_tr_b16 v[192:193], v210 offset:18496
  ds_read_b64_tr_b16 v[194:195], v211 offset:18496
  ds_read_b128 v[100:103], v224 offset:0
  s_and_b32 s49, s49, 1
  s_mul_i32 s45, s36, 114688
  s_waitcnt lgkmcnt(12)
  v_mfma_f32_32x32x16_bf16 v[160:175], v[84:87], v[204:207], v[160:175]
  ds_read_b64_tr_b16 v[196:197], v210 offset:21632
  ds_read_b64_tr_b16 v[198:199], v211 offset:21632
  ds_read_b128 v[104:107], v225 offset:0
  s_add_u32 s45, s45, s61
  s_waitcnt lgkmcnt(13)
  v_mfma_f32_32x32x16_bf16 v[128:143], v[176:179], v[84:87], v[128:143]
  ds_read_b64_tr_b16 v[200:201], v210 offset:21504
  ds_read_b64_tr_b16 v[202:203], v211 offset:21504
  ds_read_b128 v[108:111], v226 offset:0
  s_add_u32 s45, s45, s71
  s_lshl_b32 s52, s51, 12
  s_waitcnt lgkmcnt(14)
  v_mfma_f32_32x32x16_bf16 v[144:159], v[180:183], v[84:87], v[144:159]
  ds_read_b64_tr_b16 v[204:205], v210 offset:21568
  ds_read_b64_tr_b16 v[206:207], v211 offset:21568
  s_add_u32 s45, s45, s52
  s_waitcnt lgkmcnt(14)
  v_mfma_f32_32x32x16_bf16 v[160:175], v[88:91], v[184:187], v[160:175]
  s_barrier
  ds_read_b64_tr_b16 v[176:177], v210 offset:24704
  ds_read_b64_tr_b16 v[178:179], v211 offset:24704
  s_add_u32 s46, s45, 65536
  s_waitcnt lgkmcnt(14)
  v_mfma_f32_32x32x16_bf16 v[128:143], v[188:191], v[88:91], v[128:143]
  ds_read_b64_tr_b16 v[180:181], v210 offset:24576
  ds_read_b64_tr_b16 v[182:183], v211 offset:24576
  s_lshl_b32 s52, s49, 11
  s_add_u32 s46, s46, s52
  s_waitcnt lgkmcnt(13)
  v_mfma_f32_32x32x16_bf16 v[144:159], v[192:195], v[88:91], v[144:159]
  ds_read_b64_tr_b16 v[184:185], v210 offset:24640
  ds_read_b64_tr_b16 v[186:187], v211 offset:24640
  s_lshl_b32 s52, s49, 15
  s_waitcnt lgkmcnt(12)
  v_mfma_f32_32x32x16_bf16 v[160:175], v[92:95], v[196:199], v[160:175]
  ds_read_b64_tr_b16 v[188:189], v210 offset:27776
  ds_read_b64_tr_b16 v[190:191], v211 offset:27776
  s_add_u32 s45, s45, s52
  s_lshl_b32 s52, s49, 17
  s_waitcnt lgkmcnt(11)
  v_mfma_f32_32x32x16_bf16 v[128:143], v[200:203], v[92:95], v[128:143]
  ds_read_b64_tr_b16 v[192:193], v210 offset:27648
  ds_read_b64_tr_b16 v[194:195], v211 offset:27648
  s_lshl_b32 s53, s44, 10
  s_waitcnt lgkmcnt(10)
  v_mfma_f32_32x32x16_bf16 v[144:159], v[204:207], v[92:95], v[144:159]
  ds_read_b64_tr_b16 v[196:197], v210 offset:27712
  ds_read_b64_tr_b16 v[198:199], v211 offset:27712
  s_add_u32 s53, s53, s60
  s_lshl_b32 s54, s51, 18
  v_dot2c_f32_bf16 v228, 0x3f803f80, v96
  v_dot2c_f32_bf16 v230, v96, v96
  v_dot2c_f32_bf16 v229, 0x3f803f80, v97
  v_dot2c_f32_bf16 v231, v97, v97
  v_dot2c_f32_bf16 v228, 0x3f803f80, v98
  v_dot2c_f32_bf16 v230, v98, v98
  v_dot2c_f32_bf16 v229, 0x3f803f80, v99
  v_dot2c_f32_bf16 v231, v99, v99
  v_dot2c_f32_bf16 v228, 0x3f803f80, v100
  v_dot2c_f32_bf16 v230, v100, v100
  v_dot2c_f32_bf16 v229, 0x3f803f80, v101
  v_dot2c_f32_bf16 v231, v101, v101
  v_dot2c_f32_bf16 v228, 0x3f803f80, v102
  v_dot2c_f32_bf16 v230, v102, v102
  v_dot2c_f32_bf16 v229, 0x3f803f80, v103
  v_dot2c_f32_bf16 v231, v103, v103
  v_dot2c_f32_bf16 v228, 0x3f803f80, v104
  v_dot2c_f32_bf16 v230, v104, v104
  v_dot2c_f32_bf16 v229, 0x3f803f80, v105
  v_dot2c_f32_bf16 v231, v105, v105
  v_dot2c_f32_bf16 v228, 0x3f803f80, v106
  v_dot2c_f32_bf16 v230, v106, v106
  v_dot2c_f32_bf16 v229, 0x3f803f80, v107
  v_dot2c_f32_bf16 v231, v107, v107
  v_dot2c_f32_bf16 v228, 0x3f803f80, v108
  v_dot2c_f32_bf16 v230, v108, v108
  v_dot2c_f32_bf16 v229, 0x3f803f80, v109
  v_dot2c_f32_bf16 v231, v109, v109
  v_dot2c_f32_bf16 v228, 0x3f803f80, v110
  v_dot2c_f32_bf16 v230, v110, v110
  v_dot2c_f32_bf16 v229, 0x3f803f80, v111
  v_dot2c_f32_bf16 v231, v111, v111
  s_waitcnt lgkmcnt(10)
  v_mfma_f32_32x32x16_bf16 v[160:175], v[96:99], v[176:179], v[160:175]
  ds_read_b64_tr_b16 v[200:201], v210 offset:30848
  ds_read_b64_tr_b16 v[202:203], v211 offset:30848
  s_waitcnt vmcnt(0)
  s_waitcnt lgkmcnt(10)
  v_mfma_f32_32x32x16_bf16 v[128:143], v[180:183], v[96:99], v[128:143]
  ds_read_b64_tr_b16 v[204:205], v210 offset:30720
  ds_read_b64_tr_b16 v[206:207], v211 offset:30720
  ds_read_b128 v[112:115], v223 offset:4096
  s_add_u32 s53, s53, s54
  s_waitcnt lgkmcnt(11)
  v_mfma_f32_32x32x16_bf16 v[144:159], v[184:187], v[96:99], v[144:159]
  ds_read_b64_tr_b16 v[176:177], v210 offset:30784
  ds_read_b64_tr_b16 v[178:179], v211 offset:30784
  ds_read_b128 v[116:119], v224 offset:4096
  s_add_u32 s54, s53, 2097152
  s_waitcnt lgkmcnt(12)
  v_mfma_f32_32x32x16_bf16 v[160:175], v[100:103], v[188:191], v[160:175]
  ds_read_b64_tr_b16 v[180:181], v210 offset:33920
  ds_read_b64_tr_b16 v[182:183], v211 offset:33920
  ds_read_b128 v[120:123], v225 offset:4096
  s_add_u32 s54, s54, s52
  s_waitcnt lgkmcnt(13)
  v_mfma_f32_32x32x16_bf16 v[128:143], v[192:195], v[100:103], v[128:143]
  ds_read_b64_tr_b16 v[184:185], v210 offset:33792
  ds_read_b64_tr_b16 v[186:187], v211 offset:33792
  ds_read_b128 v[124:127], v226 offset:4096
  s_cmp_eq_u32 s49, 0
  s_cselect_b32 s47, 0x3eb8aa3b, 1.0
  s_cselect_b32 s48, 0, 12
  s_waitcnt lgkmcnt(14)
  v_mfma_f32_32x32x16_bf16 v[144:159], v[196:199], v[100:103], v[144:159]
  ds_read_b64_tr_b16 v[188:189], v210 offset:33856
  ds_read_b64_tr_b16 v[190:191], v211 offset:33856
  v_lshrrev_b32 v214, 1, v212
  s_waitcnt lgkmcnt(14)
  v_mfma_f32_32x32x16_bf16 v[160:175], v[104:107], v[200:203], v[160:175]
  s_barrier
  ds_read_b64_tr_b16 v[192:193], v210 offset:36992
  ds_read_b64_tr_b16 v[194:195], v211 offset:36992
  s_waitcnt lgkmcnt(14)
  v_mfma_f32_32x32x16_bf16 v[128:143], v[204:207], v[104:107], v[128:143]
  ds_read_b64_tr_b16 v[196:197], v210 offset:36864
  ds_read_b64_tr_b16 v[198:199], v211 offset:36864
  v_xor_b32 v214, v214, v212
  s_waitcnt lgkmcnt(13)
  v_mfma_f32_32x32x16_bf16 v[144:159], v[176:179], v[104:107], v[144:159]
  ds_read_b64_tr_b16 v[200:201], v210 offset:36928
  ds_read_b64_tr_b16 v[202:203], v211 offset:36928
  v_bfe_i32 v214, v214, 2, 1
  s_waitcnt lgkmcnt(12)
  v_mfma_f32_32x32x16_bf16 v[160:175], v[108:111], v[180:183], v[160:175]
  ds_read_b64_tr_b16 v[204:205], v210 offset:40064
  ds_read_b64_tr_b16 v[206:207], v211 offset:40064
  v_and_b32 v214, s48, v214
  s_waitcnt lgkmcnt(11)
  v_mfma_f32_32x32x16_bf16 v[128:143], v[184:187], v[108:111], v[128:143]
  ds_read_b64_tr_b16 v[176:177], v210 offset:39936
  ds_read_b64_tr_b16 v[178:179], v211 offset:39936
  v_xor_b32 v214, v214, v212
  s_waitcnt lgkmcnt(10)
  v_mfma_f32_32x32x16_bf16 v[144:159], v[188:191], v[108:111], v[144:159]
  ds_read_b64_tr_b16 v[180:181], v210 offset:40000
  ds_read_b64_tr_b16 v[182:183], v211 offset:40000
  v_lshlrev_b32 v214, 4, v214
  v_dot2c_f32_bf16 v228, 0x3f803f80, v112
  v_dot2c_f32_bf16 v230, v112, v112
  v_dot2c_f32_bf16 v229, 0x3f803f80, v113
  v_dot2c_f32_bf16 v231, v113, v113
  v_dot2c_f32_bf16 v228, 0x3f803f80, v114
  v_dot2c_f32_bf16 v230, v114, v114
  v_dot2c_f32_bf16 v229, 0x3f803f80, v115
  v_dot2c_f32_bf16 v231, v115, v115
  v_dot2c_f32_bf16 v228, 0x3f803f80, v116
  v_dot2c_f32_bf16 v230, v116, v116
  v_dot2c_f32_bf16 v229, 0x3f803f80, v117
  v_dot2c_f32_bf16 v231, v117, v117
  v_dot2c_f32_bf16 v228, 0x3f803f80, v118
  v_dot2c_f32_bf16 v230, v118, v118
  v_dot2c_f32_bf16 v229, 0x3f803f80, v119
  v_dot2c_f32_bf16 v231, v119, v119
  v_dot2c_f32_bf16 v228, 0x3f803f80, v120
  v_dot2c_f32_bf16 v230, v120, v120
  v_dot2c_f32_bf16 v229, 0x3f803f80, v121
  v_dot2c_f32_bf16 v231, v121, v121
  v_dot2c_f32_bf16 v228, 0x3f803f80, v122
  v_dot2c_f32_bf16 v230, v122, v122
  v_dot2c_f32_bf16 v229, 0x3f803f80, v123
  v_dot2c_f32_bf16 v231, v123, v123
  v_dot2c_f32_bf16 v228, 0x3f803f80, v124
  v_dot2c_f32_bf16 v230, v124, v124
  v_dot2c_f32_bf16 v229, 0x3f803f80, v125
  v_dot2c_f32_bf16 v231, v125, v125
  v_dot2c_f32_bf16 v228, 0x3f803f80, v126
  v_dot2c_f32_bf16 v230, v126, v126
  v_dot2c_f32_bf16 v229, 0x3f803f80, v127
  v_dot2c_f32_bf16 v231, v127, v127
  s_waitcnt lgkmcnt(10)
  v_mfma_f32_32x32x16_bf16 v[160:175], v[112:115], v[192:195], v[160:175]
  ds_read_b64_tr_b16 v[184:185], v210 offset:43136
  ds_read_b64_tr_b16 v[186:187], v211 offset:43136
  s_nop 0
  v_add_f32 v228, v228, v229
  v_add_f32 v230, v230, v231
  s_waitcnt lgkmcnt(10)
  v_mfma_f32_32x32x16_bf16 v[128:143], v[196:199], v[112:115], v[128:143]
  ds_read_b64_tr_b16 v[188:189], v210 offset:43008
  ds_read_b64_tr_b16 v[190:191], v211 offset:43008
  s_nop 1
  v_permlane32_swap_b32 v228, v230
  v_add_f32 v228, v228, v230
  s_waitcnt lgkmcnt(10)
  v_mfma_f32_32x32x16_bf16 v[144:159], v[200:203], v[112:115], v[144:159]
  ds_read_b64_tr_b16 v[192:193], v210 offset:43072
  ds_read_b64_tr_b16 v[194:195], v211 offset:43072
  v_mov_b32 v230, v228
  s_nop 1
  v_permlane32_swap_b32 v228, v230
  s_waitcnt lgkmcnt(10)
  v_mfma_f32_32x32x16_bf16 v[160:175], v[116:119], v[204:207], v[160:175]
  ds_read_b64_tr_b16 v[196:197], v210 offset:46208
  ds_read_b64_tr_b16 v[198:199], v211 offset:46208
  v_mul_f32 v228, 0xbb000000, v228
  v_mul_f32 v230, 0x3b000000, v230
  v_fma_f32 v230, -v228, v228, v230
  s_waitcnt lgkmcnt(10)
  v_mfma_f32_32x32x16_bf16 v[128:143], v[176:179], v[116:119], v[128:143]
  ds_read_b64_tr_b16 v[200:201], v210 offset:46080
  ds_read_b64_tr_b16 v[202:203], v211 offset:46080
  v_max_f32 v230, 0, v230
  v_add_f32 v230, 0x3727c5ac, v230
  v_rsq_f32 v213, v230
  s_waitcnt lgkmcnt(10)
  v_mfma_f32_32x32x16_bf16 v[144:159], v[180:183], v[116:119], v[144:159]
  ds_read_b64_tr_b16 v[204:205], v210 offset:46144
  ds_read_b64_tr_b16 v[206:207], v211 offset:46144
  v_cmp_gt_u32 vcc, 32, v212
  v_cvt_pk_bf16_f32 v232, v228, v228
  v_lshlrev_b32 v230, 16, v232
  s_waitcnt lgkmcnt(10)
  v_mfma_f32_32x32x16_bf16 v[160:175], v[120:123], v[184:187], v[160:175]
  v_sub_f32 v228, v228, v230
  v_cvt_pk_bf16_f32 v233, v228, 0
  v_cndmask_b32 v232, 0, v232, vcc
  s_waitcnt lgkmcnt(8)
  v_mfma_f32_32x32x16_bf16 v[128:143], v[188:191], v[120:123], v[128:143]
  v_cndmask_b32 v233, 0, v233, vcc
  v_mov_b32 v234, 0
  v_mov_b32 v235, 0
  s_waitcnt lgkmcnt(6)
  v_mfma_f32_32x32x16_bf16 v[144:159], v[192:195], v[120:123], v[144:159]
  v_and_b32 v231, 31, v212
  v_lshlrev_b32 v231, 2, v231
  s_lshl_b32 s50, s36, 8
  s_waitcnt lgkmcnt(4)
  v_mfma_f32_32x32x16_bf16 v[160:175], v[124:127], v[196:199], v[160:175]
  s_add_u32 s50, s50, 160768
  v_add_u32 v215, s50, v231
  ds_write_b32 v215, v213
  s_waitcnt lgkmcnt(3)
  v_mfma_f32_32x32x16_bf16 v[128:143], v[200:203], v[124:127], v[128:143]
  v_add_u32 v247, 147456, v231
  v_lshrrev_b32 v215, 5, v212
  v_lshl_add_u32 v215, v215, 4, s50
  s_waitcnt lgkmcnt(1)
  v_mfma_f32_32x32x16_bf16 v[144:159], v[204:207], v[124:127], v[144:159]
  ds_read_b128 v[216:219], v215 offset:0
  ds_read_b128 v[220:223], v215 offset:32
  ds_read_b128 v[224:227], v215 offset:64
  ds_read_b128 v[228:231], v215 offset:96
  s_barrier
  ds_read_b32 v238, v247 offset:0
  ds_read_b32 v236, v247 offset:384
  ds_read_b32 v237, v247 offset:768
  ds_read_b32 v239, v247 offset:1152
  s_waitcnt lgkmcnt(2)
  v_add_f32 v238, v238, v236
  s_waitcnt lgkmcnt(0)
  v_add_f32 v237, v237, v239
  v_add_f32 v238, v238, v237
  v_cvt_pk_bf16_f32 v237, v238, 0
  v_lshlrev_b32 v239, 16, v237
  v_sub_f32 v239, v238, v239
  v_cvt_pk_bf16_f32 v236, v238, v239
  v_mov_b32 v238, 0
  v_mov_b32 v239, 0
  ds_read_b32 v242, v247 offset:128
  ds_read_b32 v240, v247 offset:512
  ds_read_b32 v241, v247 offset:896
  ds_read_b32 v243, v247 offset:1280
  s_waitcnt lgkmcnt(2)
  v_add_f32 v242, v242, v240
  s_waitcnt lgkmcnt(0)
  v_add_f32 v241, v241, v243
  v_add_f32 v242, v242, v241
  v_cvt_pk_bf16_f32 v241, v242, 0
  v_lshlrev_b32 v243, 16, v241
  v_sub_f32 v243, v242, v243
  v_cvt_pk_bf16_f32 v240, v242, v243
  v_mov_b32 v242, 0
  v_mov_b32 v243, 0
  v_mov_b32 v215, v247
  ds_read_b32 v246, v215 offset:256
  ds_read_b32 v244, v215 offset:640
  ds_read_b32 v245, v215 offset:1024
  ds_read_b32 v247, v215 offset:1408
  s_waitcnt lgkmcnt(2)
  v_add_f32 v246, v246, v244
  s_waitcnt lgkmcnt(0)
  v_add_f32 v245, v245, v247
  v_add_f32 v246, v246, v245
  v_cvt_pk_bf16_f32 v245, v246, 0
  v_lshlrev_b32 v247, 16, v245
  v_sub_f32 v247, v246, v247
  v_cvt_pk_bf16_f32 v244, v246, v247
  v_mov_b32 v246, 0
  v_mov_b32 v247, 0
  v_mul_f32 v213, s47, v213
  s_nop 0
  v_mfma_f32_32x32x16_bf16 v[160:175], v[232:235], v[244:247], v[160:175]
  v_mfma_f32_32x32x16_bf16 v[128:143], v[236:239], v[232:235], v[128:143]
  v_mfma_f32_32x32x16_bf16 v[144:159], v[240:243], v[232:235], v[144:159]
  s_cmp_eq_u32 s49, 0
  s_cselect_b32 s45, s45, s53
  s_cselect_b32 s52, 64, 4096
  s_lshl_b32 s52, s52, 4
  v_and_b32 v244, 15, v212
  v_lshlrev_b32 v244, 4, v244
  v_lshrrev_b32 v245, 5, v212
  v_lshl_add_u32 v244, v245, 8, v244
  v_bfe_u32 v212, v212, 4, 1
  v_lshl_add_u32 v245, v212, 10, v244
  v_lshl_add_u32 v244, v212, 16, v244
  s_nop 2
  v_mul_f32 v160, v216, v160
  v_mul_f32 v161, v217, v161
  v_mul_f32 v162, v218, v162
  v_mul_f32 v163, v219, v163
  v_mul_f32 v164, v220, v164
  v_mul_f32 v165, v221, v165
  v_mul_f32 v166, v222, v166
  v_mul_f32 v167, v223, v167
  v_cvt_pk_bf16_f32 v160, v160, v161
  v_cvt_pk_bf16_f32 v161, v162, v163
  v_cvt_pk_bf16_f32 v162, v164, v165
  v_cvt_pk_bf16_f32 v163, v166, v167
  v_mul_f32 v168, v224, v168
  v_mul_f32 v169, v225, v169
  v_mul_f32 v170, v226, v170
  v_mul_f32 v171, v227, v171
  v_mul_f32 v172, v228, v172
  v_mul_f32 v173, v229, v173
  v_mul_f32 v174, v230, v174
  v_mul_f32 v175, v231, v175
  v_cvt_pk_bf16_f32 v168, v168, v169
  v_cvt_pk_bf16_f32 v169, v170, v171
  v_cvt_pk_bf16_f32 v170, v172, v173
  v_cvt_pk_bf16_f32 v171, v174, v175
  buffer_store_dwordx4 v[160:163], v244, s[28:31], s54 offen offset:0 sc1
  buffer_store_dwordx4 v[168:171], v244, s[28:31], s54 offen offset:512 sc1
  v_mul_f32 v128, v213, v128
  v_mul_f32 v129, v213, v129
  v_mul_f32 v130, v213, v130
  v_mul_f32 v131, v213, v131
  v_mul_f32 v132, v213, v132
  v_mul_f32 v133, v213, v133
  v_mul_f32 v134, v213, v134
  v_mul_f32 v135, v213, v135
  v_cvt_pk_bf16_f32 v128, v128, v129
  v_cvt_pk_bf16_f32 v129, v130, v131
  v_cvt_pk_bf16_f32 v130, v132, v133
  v_cvt_pk_bf16_f32 v131, v134, v135
  v_mul_f32 v136, v213, v136
  v_mul_f32 v137, v213, v137
  v_mul_f32 v138, v213, v138
  v_mul_f32 v139, v213, v139
  v_mul_f32 v140, v213, v140
  v_mul_f32 v141, v213, v141
  v_mul_f32 v142, v213, v142
  v_mul_f32 v143, v213, v143
  v_cvt_pk_bf16_f32 v136, v136, v137
  v_cvt_pk_bf16_f32 v137, v138, v139
  v_cvt_pk_bf16_f32 v138, v140, v141
  v_cvt_pk_bf16_f32 v139, v142, v143
  buffer_store_dwordx4 v[128:131], v214, s[28:31], s45 offen sc1
  s_add_u32 s45, s45, s52
  buffer_store_dwordx4 v[136:139], v214, s[28:31], s45 offen sc1
  s_add_u32 s45, s45, s52
  v_mul_f32 v144, v213, v144
  v_mul_f32 v145, v213, v145
  v_mul_f32 v146, v213, v146
  v_mul_f32 v147, v213, v147
  v_mul_f32 v148, v213, v148
  v_mul_f32 v149, v213, v149
  v_mul_f32 v150, v213, v150
  v_mul_f32 v151, v213, v151
  v_cvt_pk_bf16_f32 v144, v144, v145
  v_cvt_pk_bf16_f32 v145, v146, v147
  v_cvt_pk_bf16_f32 v146, v148, v149
  v_cvt_pk_bf16_f32 v147, v150, v151
  v_mul_f32 v152, v213, v152
  v_mul_f32 v153, v213, v153
  v_mul_f32 v154, v213, v154
  v_mul_f32 v155, v213, v155
  v_mul_f32 v156, v213, v156
  v_mul_f32 v157, v213, v157
  v_mul_f32 v158, v213, v158
  v_mul_f32 v159, v213, v159
  v_cvt_pk_bf16_f32 v152, v152, v153
  v_cvt_pk_bf16_f32 v153, v154, v155
  v_cvt_pk_bf16_f32 v154, v156, v157
  v_cvt_pk_bf16_f32 v155, v158, v159
  buffer_store_dwordx4 v[144:147], v214, s[28:31], s45 offen sc1
  s_add_u32 s45, s45, s52
  buffer_store_dwordx4 v[152:155], v214, s[28:31], s45 offen sc1
  s_add_u32 s45, s45, s52
  s_barrier
  v_mov_b32 v236, 163328
  ds_read_b32 v236, v236
  s_waitcnt lgkmcnt(0)
  v_readfirstlane_b32 s50, v236
  s_nop 0
  s_and_b32 s37, s50, 7
  s_bfe_u32 s38, s50, 0x50008
  s_bfe_u32 s39, s50, 0x10010
  s_bfe_u32 s66, s50, 0x10011
  s_lshl_b32 s51, s36, 7
  s_lshl_b32 s50, s37, 10
  s_add_u32 s50, s50, s51
  s_lshl_b32 s51, s38, 2
  s_add_u32 s50, s50, s51
  s_add_u32 s51, s41, 1
  v_mov_b32 v236, s50
  v_mov_b32 v237, s51
  v_mbcnt_lo_u32_b32 v238, -1, 0
  v_mbcnt_hi_u32_b32 v238, -1, v238
  s_and_b32 s50, s65, 15
  s_lshr_b32 s50, s50, 1
  s_lshl_b32 s50, s50, 9
  s_lshl_b32 s51, s70, 6
  s_add_u32 s50, s50, s51
  s_lshr_b32 s51, s65, 4
  s_lshl_b32 s51, s51, 3
  s_add_u32 s50, s50, s51
  s_and_b32 s51, s65, 1
  s_lshl_b32 s51, s51, 2
  s_add_u32 s50, s50, s51
  s_add_u32 s50, s50, 8192
  v_lshl_add_u32 v238, v238, 12, s50
  v_mov_b32 v239, 163336
  s_waitcnt vmcnt(0)
  s_mov_b64 exec, 1
  s_cmp_lg_u32 s39, 0
  s_cbranch_scc1 STS_7
  global_store_dword v236, v237, s[34:35]
STD_8:
  s_mov_b64 exec, -1
  v_mov_b32 v232, s42
  v_mov_b32 v231, 1
  s_waitcnt vmcnt(1)
  s_mov_b64 exec, 1
  ds_add_rtn_u32 v231, v239, v231
  s_waitcnt lgkmcnt(0)
  v_readfirstlane_b32 s50, v231
  s_mov_b64 exec, 3
  s_and_b32 s50, s50, 3
  s_cmp_lg_u32 s50, 3
  s_cbranch_scc1 SG_9
  global_store_dword v238, v232, s[34:35] sc1
SG_9:
  s_mov_b64 exec, -1
  s_setprio 0
L_LAYER_c:
  s_mul_i32 s50, s40, 5
  s_mul_i32 s51, s39, 11796480
  s_mul_i32 s50, s50, s51
  s_add_u32 s50, s50, 10485760
  s_add_u32 s50, s50, s51
  s_mov_b32 s62, s50
  s_add_u32 s50, s50, s51
  s_mov_b32 s63, s50
  s_add_u32 s50, s50, s51
  s_mov_b32 s64, s50
  s_add_u32 s50, s50, s51
  s_mov_b32 s69, s50
  v_mbcnt_lo_u32_b32 v96, -1, 0
  v_mbcnt_hi_u32_b32 v96, -1, v96
  v_lshlrev_b32 v95, 4, v96
  v_mov_b32 v94, 0xdddddddd
  s_lshr_b32 s51, s36, 2
  s_lshl_b32 s50, s51, 12
  s_add_u32 s50, s50, 30720
  s_mul_i32 s51, s51, 4096
  s_add_u32 s51, s51, 38912
  v_add_u32 v92, s50, v95
  v_and_b32 v4, 31, v96
  v_lshrrev_b32 v5, 5, v96
  v_lshlrev_b32 v5, 8, v5
  v_lshl_add_u32 v5, v4, 4, v5
  v_cmp_eq_u32 vcc, 16, v4
  v_add_u32 v93, s51, v5
  v_mov_b32 v5, 0x3f803f80
  v_cndmask_b32 v76, 0, v5, vcc
  v_cndmask_b32 v77, 0, v5, vcc
  v_cndmask_b32 v78, 0, v5, vcc
  v_cndmask_b32 v79, 0, v5, vcc
  v_cndmask_b32 v80, 0, v5, vcc
  v_cndmask_b32 v81, 0, v5, vcc
  v_cndmask_b32 v82, 0, v5, vcc
  v_cndmask_b32 v83, 0, v5, vcc
  s_mov_b32 s98, 0xffff
  s_mov_b32 s99, 0xffff
  v_mov_b32 v32, 0
  v_mov_b32 v33, 0
  v_mov_b32 v34, 0
  v_mov_b32 v35, 0
  v_mov_b32 v36, 0
  v_mov_b32 v37, 0
  v_mov_b32 v38, 0
  v_mov_b32 v39, 0
  v_mov_b32 v40, 0
  v_mov_b32 v41, 0
  v_mov_b32 v42, 0
  v_mov_b32 v43, 0
  v_mov_b32 v44, 0
  v_mov_b32 v45, 0
  v_mov_b32 v46, 0
  v_mov_b32 v47, 0
  v_mov_b32 v48, 0
  v_mov_b32 v49, 0
  v_mov_b32 v50, 0
  v_mov_b32 v51, 0
  v_mov_b32 v52, 0
  v_mov_b32 v53, 0
  v_mov_b32 v54, 0
  v_mov_b32 v55, 0
  v_mov_b32 v56, 0
  v_mov_b32 v57, 0
  v_mov_b32 v58, 0
  v_mov_b32 v59, 0
  v_mov_b32 v60, 0
  v_mov_b32 v61, 0
  v_mov_b32 v62, 0
  v_mov_b32 v63, 0
  s_bfe_u32 s45, s36, 0x10001
  s_lshl_b32 s46, s37, 1
  s_add_u32 s45, s45, s46
  s_mul_i32 s45, s45, 737280
  s_lshl_b32 s47, s36, 10
  s_add_u32 s67, s47, 47104
  s_and_b32 s50, s37, 1
  s_lshl_b32 s50, s50, 3
  s_lshr_b32 s51, s38, 2
  s_add_u32 s50, s50, s51
  s_lshl_b32 s50, s50, 9
  s_add_u32 s50, s50, 8192
  s_lshl_b32 s51, s66, 3
  s_or_b32 s51, s51, s37
  v_and_b32 v5, 31, v96
  v_lshrrev_b32 v4, 2, v5
  v_cmp_eq_u32 vcc, s51, v4
  v_xor_b32 v4, 4, v5
  s_nop 0
  v_cndmask_b32 v4, v5, v4, vcc
  v_and_b32 v5, 3, v4
  v_lshrrev_b32 v4, 2, v4
  v_lshl_add_u32 v5, v5, 2, s50
  v_lshl_add_u32 v99, v4, 6, v5
  v_mbcnt_lo_u32_b32 v97, -1, 0
  v_mbcnt_hi_u32_b32 v97, -1, v97
  v_lshrrev_b32 v13, 3, v97
  v_and_b32 v14, 7, v97
  v_lshlrev_b32 v15, 1, v13
  v_and_b32 v15, 4, v15
  v_xor_b32 v14, v14, v15
  v_mul_u32_u24 v13, 3584, v13
  v_lshl_add_u32 v97, v14, 4, v13
  v_mbcnt_lo_u32_b32 v98, -1, 0
  v_mbcnt_hi_u32_b32 v98, -1, v98
  v_lshrrev_b32 v13, 3, v98
  v_and_b32 v14, 7, v98
  v_lshlrev_b32 v15, 1, v13
  v_and_b32 v15, 4, v15
  v_xor_b32 v14, v14, v15
  v_mul_u32_u24 v13, 1024, v13
  v_lshl_add_u32 v98, v14, 4, v13
  s_lshl_b32 s44, s38, 16
  s_add_u32 s44, s44, s60
  s_add_u32 s44, s44, s47
  s_and_b32 s54, s38, 15
  s_min_u32 s54, s54, 13
  s_lshl_b32 s54, s54, 8
  s_and_b32 s55, s38, 7
  s_lshl_b32 s55, s55, 7
  s_mov_b32 s71, 0
  s_lshl_b32 s92, s37, 13
  s_lshl_b32 s93, s36, 10
  s_lshl_b32 s94, s36, 13
  s_add_u32 s94, s94, s55
  s_add_u32 s95, s93, 81920
  s_add_u32 s96, s36, 50
  s_mul_i32 s96, s96, 28672
  s_add_u32 s96, s96, s54
  s_add_u32 s96, s96, 128
  s_mul_i32 s97, s36, 28672
  s_add_u32 s97, s97, s54
  s_add_u32 s97, s97, 128
  s_lshr_b32 s50, s38, 3
  s_lshl_b32 s50, s50, 1
  s_lshl_b32 s51, s37, 3
  s_add_u32 s50, s50, s51
  s_and_b32 s51, s36, 1
  s_add_u32 s50, s50, s51
  s_lshl_b32 s50, s50, 15
  s_lshr_b32 s51, s36, 1
  s_lshl_b32 s51, s51, 6
  s_add_u32 s50, s50, s51
  s_add_u32 s50, s50, s55
  v_and_b32 v4, 31, v96
  v_lshrrev_b32 v5, 5, v96
  v_lshlrev_b32 v4, 10, v4
  v_lshl_add_u32 v4, v5, 3, v4
  v_add_u32 v87, s50, v4
  s_barrier
  s_and_b32 s50, s36, 3
  s_lshl_b32 s50, s50, 11
  v_add_u32 v4, s50, v95
  ds_read_b128 v[64:67], v4
  ds_read_b128 v[68:71], v4 offset:1024
  ds_read_b128 v[72:75], v92 offset:0
  s_mov_b64 exec, s[98:99]
  ds_read_b128 v[76:79], v93 offset:0
  s_mov_b64 exec, -1
  s_mov_b64 exec, s[98:99]
  ds_read_b128 v[80:83], v93 offset:512
  s_mov_b64 exec, -1
  global_load_dword v102, v99, s[34:35] sc1
  s_waitcnt lgkmcnt(2)
  v_mfma_f32_32x32x16_bf16 v[0:15], v[72:75], v[64:67], 0
  s_nop 11
  v_exp_f32 v0, v0
  v_exp_f32 v1, v1
  v_exp_f32 v2, v2
  v_exp_f32 v3, v3
  v_exp_f32 v4, v4
  v_mfma_f32_32x32x16_bf16 v[16:31], v[72:75], v[68:71], 0
  ds_read_b128 v[72:75], v92 offset:1024
  v_exp_f32 v5, v5
  v_exp_f32 v6, v6
  v_exp_f32 v7, v7
  v_exp_f32 v8, v8
  v_exp_f32 v9, v9
  s_waitcnt lgkmcnt(2)
  v_smfmac_f32_32x32x32_bf16 v[32:47], v[76:79], v[0:7], v94
  v_exp_f32 v10, v10
  v_exp_f32 v11, v11
  v_exp_f32 v12, v12
  v_exp_f32 v13, v13
  v_exp_f32 v14, v14
  v_exp_f32 v15, v15
  v_exp_f32 v16, v16
  v_exp_f32 v17, v17
  s_waitcnt lgkmcnt(1)
  v_smfmac_f32_32x32x32_bf16 v[32:47], v[80:83], v[8:15], v94
  v_exp_f32 v18, v18
  v_exp_f32 v19, v19
  v_exp_f32 v20, v20
  s_waitcnt lgkmcnt(0)
  v_mfma_f32_32x32x16_bf16 v[0:15], v[72:75], v[64:67], 0
  v_exp_f32 v21, v21
  v_exp_f32 v22, v22
  v_exp_f32 v23, v23
  v_exp_f32 v24, v24
  v_exp_f32 v25, v25
  v_smfmac_f32_32x32x32_bf16 v[48:63], v[76:79], v[16:23], v94
  s_mov_b64 exec, s[98:99]
  ds_read_b128 v[76:79], v93 offset:1024
  s_mov_b64 exec, -1
  v_exp_f32 v26, v26
  v_exp_f32 v27, v27
  v_exp_f32 v28, v28
  v_exp_f32 v29, v29
  v_exp_f32 v30, v30
  v_exp_f32 v31, v31
  v_exp_f32 v0, v0
  v_exp_f32 v1, v1
  v_smfmac_f32_32x32x32_bf16 v[48:63], v[80:83], v[24:31], v94
  s_mov_b64 exec, s[98:99]
  ds_read_b128 v[80:83], v93 offset:1536
  s_mov_b64 exec, -1
  s_cmp_lg_u32 s71, 0
  s_cbranch_scc1 APS_15
  s_waitcnt vmcnt(0)
  v_cmp_gt_u32 vcc, s42, v102
  s_nop 0
  s_cbranch_vccnz APR_16
  s_add_u32 s92, s92, 8192
  s_and_b32 s92, s92, 0xffff
  s_mov_b32 m0, s67
  s_add_u32 s48, s92, s44
  buffer_load_dwordx4 v95, s[28:31], s48 offen lds
  s_add_u32 m0, s67, 8192
  s_add_u32 s49, s48, 2097152
  buffer_load_dwordx4 v95, s[28:31], s49 offen lds
  s_add_u32 s67, s67, 16384
  s_mov_b32 s71, 1
  s_branch APS_15
APR_16:
  global_load_dword v102, v99, s[34:35] sc1
APS_15:
  v_exp_f32 v2, v2
  v_exp_f32 v3, v3
  v_exp_f32 v4, v4
  v_mfma_f32_32x32x16_bf16 v[16:31], v[72:75], v[68:71], 0
  ds_read_b128 v[72:75], v92 offset:2048
  v_exp_f32 v5, v5
  v_exp_f32 v6, v6
  v_exp_f32 v7, v7
  v_exp_f32 v8, v8
  v_exp_f32 v9, v9
  s_waitcnt lgkmcnt(2)
  v_smfmac_f32_32x32x32_bf16 v[32:47], v[76:79], v[0:7], v94
  v_exp_f32 v10, v10
  v_exp_f32 v11, v11
  v_exp_f32 v12, v12
  v_exp_f32 v13, v13
  v_exp_f32 v14, v14
  v_exp_f32 v15, v15
  v_exp_f32 v16, v16
  v_exp_f32 v17, v17
  s_waitcnt lgkmcnt(1)
  v_smfmac_f32_32x32x32_bf16 v[32:47], v[80:83], v[8:15], v94
  v_exp_f32 v18, v18
  v_exp_f32 v19, v19
  v_exp_f32 v20, v20
  s_waitcnt lgkmcnt(0)
  v_mfma_f32_32x32x16_bf16 v[0:15], v[72:75], v[64:67], 0
  v_exp_f32 v21, v21
  v_exp_f32 v22, v22
  v_exp_f32 v23, v23
  v_exp_f32 v24, v24
  v_exp_f32 v25, v25
  v_smfmac_f32_32x32x32_bf16 v[48:63], v[76:79], v[16:23], v94
  s_mov_b64 exec, s[98:99]
  ds_read_b128 v[76:79], v93 offset:2048
  s_mov_b64 exec, -1
  v_exp_f32 v26, v26
  v_exp_f32 v27, v27
  v_exp_f32 v28, v28
  v_exp_f32 v29, v29
  v_exp_f32 v30, v30
  v_exp_f32 v31, v31
  v_exp_f32 v0, v0
  v_exp_f32 v1, v1
  v_smfmac_f32_32x32x32_bf16 v[48:63], v[80:83], v[24:31], v94
  s_mov_b64 exec, s[98:99]
  ds_read_b128 v[80:83], v93 offset:2560
  s_mov_b64 exec, -1
  s_cmp_lg_u32 s71, 0
  s_cbranch_scc1 APS_17
  s_waitcnt vmcnt(0)
  v_cmp_gt_u32 vcc, s42, v102
  s_nop 0
  s_cbranch_vccnz APR_18
  s_add_u32 s92, s92, 8192
  s_and_b32 s92, s92, 0xffff
  s_mov_b32 m0, s67
  s_add_u32 s48, s92, s44
  buffer_load_dwordx4 v95, s[28:31], s48 offen lds
  s_add_u32 m0, s67, 8192
  s_add_u32 s49, s48, 2097152
  buffer_load_dwordx4 v95, s[28:31], s49 offen lds
  s_add_u32 s67, s67, 16384
  s_mov_b32 s71, 1
  s_branch APS_17
APR_18:
  global_load_dword v102, v99, s[34:35] sc1
APS_17:
  v_exp_f32 v2, v2
  v_exp_f32 v3, v3
  v_exp_f32 v4, v4
  v_mfma_f32_32x32x16_bf16 v[16:31], v[72:75], v[68:71], 0
  ds_read_b128 v[72:75], v92 offset:3072
  v_exp_f32 v5, v5
  v_exp_f32 v6, v6
  v_exp_f32 v7, v7
  v_exp_f32 v8, v8
  v_exp_f32 v9, v9
  s_waitcnt lgkmcnt(2)
  v_smfmac_f32_32x32x32_bf16 v[32:47], v[76:79], v[0:7], v94
  v_exp_f32 v10, v10
  v_exp_f32 v11, v11
  v_exp_f32 v12, v12
  v_exp_f32 v13, v13
  v_exp_f32 v14, v14
  v_exp_f32 v15, v15
  v_exp_f32 v16, v16
  v_exp_f32 v17, v17
  s_waitcnt lgkmcnt(1)
  v_smfmac_f32_32x32x32_bf16 v[32:47], v[80:83], v[8:15], v94
  v_exp_f32 v18, v18
  v_exp_f32 v19, v19
  v_exp_f32 v20, v20
  s_waitcnt lgkmcnt(0)
  v_mfma_f32_32x32x16_bf16 v[0:15], v[72:75], v[64:67], 0
  v_exp_f32 v21, v21
  v_exp_f32 v22, v22
  v_exp_f32 v23, v23
  v_exp_f32 v24, v24
  v_exp_f32 v25, v25
  v_smfmac_f32_32x32x32_bf16 v[48:63], v[76:79], v[16:23], v94
  s_mov_b64 exec, s[98:99]
  ds_read_b128 v[76:79], v93 offset:3072
  s_mov_b64 exec, -1
  v_exp_f32 v26, v26
  v_exp_f32 v27, v27
  v_exp_f32 v28, v28
  v_exp_f32 v29, v29
  v_exp_f32 v30, v30
  v_exp_f32 v31, v31
  v_exp_f32 v0, v0
  v_exp_f32 v1, v1
  v_smfmac_f32_32x32x32_bf16 v[48:63], v[80:83], v[24:31], v94
  s_mov_b64 exec, s[98:99]
  ds_read_b128 v[80:83], v93 offset:3584
  s_mov_b64 exec, -1
  s_barrier
  s_cmp_lg_u32 s71, 0
  s_cbranch_scc1 APS_19
  s_add_u32 s92, s92, 8192
  s_and_b32 s92, s92, 0xffff
  s_mov_b32 m0, s67
  s_add_u32 s48, s92, s44
  buffer_load_dwordx4 v95, s[28:31], s48 offen lds
  s_add_u32 m0, s67, 8192
  s_add_u32 s49, s48, 2097152
  buffer_load_dwordx4 v95, s[28:31], s49 offen lds
  s_add_u32 s67, s67, 16384
  s_mov_b32 s71, 1
APS_19:
  s_add_u32 s92, s92, 8192
  s_and_b32 s92, s92, 0xffff
  s_mov_b32 m0, s67
  s_add_u32 s48, s92, s44
  buffer_load_dwordx4 v95, s[28:31], s48 offen lds
  s_add_u32 m0, s67, 8192
  s_add_u32 s49, s48, 2097152
  buffer_load_dwordx4 v95, s[28:31], s49 offen lds
  s_add_u32 s67, s67, 16384
  v_exp_f32 v2, v2
  v_exp_f32 v3, v3
  v_exp_f32 v4, v4
  v_mfma_f32_32x32x16_bf16 v[16:31], v[72:75], v[68:71], 0
  v_exp_f32 v5, v5
  v_exp_f32 v6, v6
  v_exp_f32 v7, v7
  v_exp_f32 v8, v8
  v_exp_f32 v9, v9
  s_waitcnt lgkmcnt(1)
  v_smfmac_f32_32x32x32_bf16 v[32:47], v[76:79], v[0:7], v94
  v_exp_f32 v10, v10
  v_exp_f32 v11, v11
  v_exp_f32 v12, v12
  v_exp_f32 v13, v13
  v_exp_f32 v14, v14
  v_exp_f32 v15, v15
  v_exp_f32 v16, v16
  v_exp_f32 v17, v17
  s_waitcnt lgkmcnt(0)
  v_smfmac_f32_32x32x32_bf16 v[32:47], v[80:83], v[8:15], v94
  s_waitcnt vmcnt(2)
  s_barrier
  ds_read_b128 v[72:75], v92 offset:16384
  s_add_u32 s92, s92, 8192
  s_and_b32 s92, s92, 0xffff
  s_mov_b32 m0, s67
  s_add_u32 s48, s92, s44
  buffer_load_dwordx4 v95, s[28:31], s48 offen lds
  s_add_u32 m0, s67, 8192
  s_add_u32 s49, s48, 2097152
  buffer_load_dwordx4 v95, s[28:31], s49 offen lds
  s_add_u32 s67, s67, 16384
  v_exp_f32 v18, v18
  v_exp_f32 v19, v19
  v_exp_f32 v20, v20
  s_waitcnt lgkmcnt(0)
  v_mfma_f32_32x32x16_bf16 v[0:15], v[72:75], v[64:67], 0
  v_exp_f32 v21, v21
  v_exp_f32 v22, v22
  v_exp_f32 v23, v23
  v_exp_f32 v24, v24
  v_exp_f32 v25, v25
  v_smfmac_f32_32x32x32_bf16 v[48:63], v[76:79], v[16:23], v94
  s_mov_b64 exec, s[98:99]
  ds_read_b128 v[76:79], v93 offset:16384
  s_mov_b64 exec, -1
  v_exp_f32 v26, v26
  v_exp_f32 v27, v27
  v_exp_f32 v28, v28
  v_exp_f32 v29, v29
  v_exp_f32 v30, v30
  v_exp_f32 v31, v31
  v_exp_f32 v0, v0
  v_exp_f32 v1, v1
  v_smfmac_f32_32x32x32_bf16 v[48:63], v[80:83], v[24:31], v94
  s_mov_b64 exec, s[98:99]
  ds_read_b128 v[80:83], v93 offset:16896
  s_mov_b64 exec, -1
  v_exp_f32 v2, v2
  v_exp_f32 v3, v3
  v_exp_f32 v4, v4
  v_mfma_f32_32x32x16_bf16 v[16:31], v[72:75], v[68:71], 0
  ds_read_b128 v[72:75], v92 offset:17408
  v_exp_f32 v5, v5
  v_exp_f32 v6, v6
  v_exp_f32 v7, v7
  v_exp_f32 v8, v8
  v_exp_f32 v9, v9
  s_waitcnt lgkmcnt(2)
  v_smfmac_f32_32x32x32_bf16 v[32:47], v[76:79], v[0:7], v94
  v_exp_f32 v10, v10
  v_exp_f32 v11, v11
  v_exp_f32 v12, v12
  v_exp_f32 v13, v13
  v_exp_f32 v14, v14
  v_exp_f32 v15, v15
  v_exp_f32 v16, v16
  v_exp_f32 v17, v17
  s_waitcnt lgkmcnt(1)
  v_smfmac_f32_32x32x32_bf16 v[32:47], v[80:83], v[8:15], v94
  v_exp_f32 v18, v18
  v_exp_f32 v19, v19
  v_exp_f32 v20, v20
  s_waitcnt lgkmcnt(0)
  v_mfma_f32_32x32x16_bf16 v[0:15], v[72:75], v[64:67], 0
  v_exp_f32 v21, v21
  v_exp_f32 v22, v22
  v_exp_f32 v23, v23
  v_exp_f32 v24, v24
  v_exp_f32 v25, v25
  v_smfmac_f32_32x32x32_bf16 v[48:63], v[76:79], v[16:23], v94
  s_mov_b64 exec, s[98:99]
  ds_read_b128 v[76:79], v93 offset:17408
  s_mov_b64 exec, -1
  v_exp_f32 v26, v26
  v_exp_f32 v27, v27
  v_exp_f32 v28, v28
  v_exp_f32 v29, v29
  v_exp_f32 v30, v30
  v_exp_f32 v31, v31
  v_exp_f32 v0, v0
  v_exp_f32 v1, v1
  v_smfmac_f32_32x32x32_bf16 v[48:63], v[80:83], v[24:31], v94
  s_mov_b64 exec, s[98:99]
  ds_read_b128 v[80:83], v93 offset:17920
  s_mov_b64 exec, -1
  v_exp_f32 v2, v2
  v_exp_f32 v3, v3
  v_exp_f32 v4, v4
  v_mfma_f32_32x32x16_bf16 v[16:31], v[72:75], v[68:71], 0
  ds_read_b128 v[72:75], v92 offset:18432
  v_exp_f32 v5, v5
  v_exp_f32 v6, v6
  v_exp_f32 v7, v7
  v_exp_f32 v8, v8
  v_exp_f32 v9, v9
  s_waitcnt lgkmcnt(2)
  v_smfmac_f32_32x32x32_bf16 v[32:47], v[76:79], v[0:7], v94
  v_exp_f32 v10, v10
  v_exp_f32 v11, v11
  v_exp_f32 v12, v12
  v_exp_f32 v13, v13
  v_exp_f32 v14, v14
  v_exp_f32 v15, v15
  v_exp_f32 v16, v16
  v_exp_f32 v17, v17
  s_waitcnt lgkmcnt(1)
  v_smfmac_f32_32x32x32_bf16 v[32:47], v[80:83], v[8:15], v94
  v_exp_f32 v18, v18
  v_exp_f32 v19, v19
  v_exp_f32 v20, v20
  s_waitcnt lgkmcnt(0)
  v_mfma_f32_32x32x16_bf16 v[0:15], v[72:75], v[64:67], 0
  v_exp_f32 v21, v21
  v_exp_f32 v22, v22
  v_exp_f32 v23, v23
  v_exp_f32 v24, v24
  v_exp_f32 v25, v25
  v_smfmac_f32_32x32x32_bf16 v[48:63], v[76:79], v[16:23], v94
  s_mov_b64 exec, s[98:99]
  ds_read_b128 v[76:79], v93 offset:18432
  s_mov_b64 exec, -1
  v_exp_f32 v26, v26
  v_exp_f32 v27, v27
  v_exp_f32 v28, v28
  v_exp_f32 v29, v29
  v_exp_f32 v30, v30
  v_exp_f32 v31, v31
  v_exp_f32 v0, v0
  v_exp_f32 v1, v1
  v_smfmac_f32_32x32x32_bf16 v[48:63], v[80:83], v[24:31], v94
  s_mov_b64 exec, s[98:99]
  ds_read_b128 v[80:83], v93 offset:18944
  s_mov_b64 exec, -1
  v_exp_f32 v2, v2
  v_exp_f32 v3, v3
  v_exp_f32 v4, v4
  v_mfma_f32_32x32x16_bf16 v[16:31], v[72:75], v[68:71], 0
  ds_read_b128 v[72:75], v92 offset:19456
  v_exp_f32 v5, v5
  v_exp_f32 v6, v6
  v_exp_f32 v7, v7
  v_exp_f32 v8, v8
  v_exp_f32 v9, v9
  s_waitcnt lgkmcnt(2)
  v_smfmac_f32_32x32x32_bf16 v[32:47], v[76:79], v[0:7], v94
  v_exp_f32 v10, v10
  v_exp_f32 v11, v11
  v_exp_f32 v12, v12
  v_exp_f32 v13, v13
  v_exp_f32 v14, v14
  v_exp_f32 v15, v15
  v_exp_f32 v16, v16
  v_exp_f32 v17, v17
  s_waitcnt lgkmcnt(1)
  v_smfmac_f32_32x32x32_bf16 v[32:47], v[80:83], v[8:15], v94
  v_exp_f32 v18, v18
  v_exp_f32 v19, v19
  v_exp_f32 v20, v20
  s_waitcnt lgkmcnt(0)
  v_mfma_f32_32x32x16_bf16 v[0:15], v[72:75], v[64:67], 0
  v_exp_f32 v21, v21
  v_exp_f32 v22, v22
  v_exp_f32 v23, v23
  v_exp_f32 v24, v24
  v_exp_f32 v25, v25
  v_smfmac_f32_32x32x32_bf16 v[48:63], v[76:79], v[16:23], v94
  s_mov_b64 exec, s[98:99]
  ds_read_b128 v[76:79], v93 offset:19456
  s_mov_b64 exec, -1
  v_exp_f32 v26, v26
  v_exp_f32 v27, v27
  v_exp_f32 v28, v28
  v_exp_f32 v29, v29
  v_exp_f32 v30, v30
  v_exp_f32 v31, v31
  v_exp_f32 v0, v0
  v_exp_f32 v1, v1
  v_smfmac_f32_32x32x32_bf16 v[48:63], v[80:83], v[24:31], v94
  s_mov_b64 exec, s[98:99]
  ds_read_b128 v[80:83], v93 offset:19968
  s_mov_b64 exec, -1
  s_waitcnt vmcnt(2)
  s_barrier
  v_exp_f32 v2, v2
  v_exp_f32 v3, v3
  v_exp_f32 v4, v4
  v_mfma_f32_32x32x16_bf16 v[16:31], v[72:75], v[68:71], 0
  ds_read_b128 v[72:75], v92 offset:32768
  buffer_load_dwordx4 v[104:107], v97, s[16:19], s97 offen
  s_add_u32 s97, s97, 114688
  v_exp_f32 v5, v5
  v_exp_f32 v6, v6
  v_exp_f32 v7, v7
  v_exp_f32 v8, v8
  v_exp_f32 v9, v9
  s_waitcnt lgkmcnt(2)
  v_smfmac_f32_32x32x32_bf16 v[32:47], v[76:79], v[0:7], v94
  v_exp_f32 v10, v10
  v_exp_f32 v11, v11
  v_exp_f32 v12, v12
  v_exp_f32 v13, v13
  v_exp_f32 v14, v14
  v_exp_f32 v15, v15
  v_exp_f32 v16, v16
  v_exp_f32 v17, v17
  s_waitcnt lgkmcnt(1)
  v_smfmac_f32_32x32x32_bf16 v[32:47], v[80:83], v[8:15], v94
  s_add_u32 s92, s92, 8192
  s_and_b32 s92, s92, 0xffff
  s_mov_b32 m0, s67
  s_add_u32 s48, s92, s44
  buffer_load_dwordx4 v95, s[28:31], s48 offen lds
  s_add_u32 m0, s67, 8192
  s_add_u32 s49, s48, 2097152
  buffer_load_dwordx4 v95, s[28:31], s49 offen lds
  s_add_u32 s67, s67, 16384
  v_exp_f32 v18, v18
  v_exp_f32 v19, v19
  v_exp_f32 v20, v20
  s_waitcnt lgkmcnt(0)
  v_mfma_f32_32x32x16_bf16 v[0:15], v[72:75], v[64:67], 0
  v_exp_f32 v21, v21
  v_exp_f32 v22, v22
  v_exp_f32 v23, v23
  v_exp_f32 v24, v24
  v_exp_f32 v25, v25
  v_smfmac_f32_32x32x32_bf16 v[48:63], v[76:79], v[16:23], v94
  s_mov_b64 exec, s[98:99]
  ds_read_b128 v[76:79], v93 offset:32768
  s_mov_b64 exec, -1
  v_exp_f32 v26, v26
  v_exp_f32 v27, v27
  v_exp_f32 v28, v28
  v_exp_f32 v29, v29
  v_exp_f32 v30, v30
  v_exp_f32 v31, v31
  v_exp_f32 v0, v0
  v_exp_f32 v1, v1
  v_smfmac_f32_32x32x32_bf16 v[48:63], v[80:83], v[24:31], v94
  s_mov_b64 exec, s[98:99]
  ds_read_b128 v[80:83], v93 offset:33280
  s_mov_b64 exec, -1
  v_exp_f32 v2, v2
  v_exp_f32 v3, v3
  v_exp_f32 v4, v4
  v_mfma_f32_32x32x16_bf16 v[16:31], v[72:75], v[68:71], 0
  ds_read_b128 v[72:75], v92 offset:33792
  v_exp_f32 v5, v5
  v_exp_f32 v6, v6
  v_exp_f32 v7, v7
  v_exp_f32 v8, v8
  v_exp_f32 v9, v9
  s_waitcnt lgkmcnt(2)
  v_smfmac_f32_32x32x32_bf16 v[32:47], v[76:79], v[0:7], v94
  v_exp_f32 v10, v10
  v_exp_f32 v11, v11
  v_exp_f32 v12, v12
  v_exp_f32 v13, v13
  v_exp_f32 v14, v14
  v_exp_f32 v15, v15
  v_exp_f32 v16, v16
  v_exp_f32 v17, v17
  s_waitcnt lgkmcnt(1)
  v_smfmac_f32_32x32x32_bf16 v[32:47], v[80:83], v[8:15], v94
  v_exp_f32 v18, v18
  v_exp_f32 v19, v19
  v_exp_f32 v20, v20
  s_waitcnt lgkmcnt(0)
  v_mfma_f32_32x32x16_bf16 v[0:15], v[72:75], v[64:67], 0
  buffer_load_dwordx4 v[108:111], v97, s[16:19], s97 offen
  s_add_u32 s97, s97, 114688
  v_exp_f32 v21, v21
  v_exp_f32 v22, v22
  v_exp_f32 v23, v23
  v_exp_f32 v24, v24
  v_exp_f32 v25, v25
  v_smfmac_f32_32x32x32_bf16 v[48:63], v[76:79], v[16:23], v94
  s_mov_b64 exec, s[98:99]
  ds_read_b128 v[76:79], v93 offset:33792
  s_mov_b64 exec, -1
  v_exp_f32 v26, v26
  v_exp_f32 v27, v27
  v_exp_f32 v28, v28
  v_exp_f32 v29, v29
  v_exp_f32 v30, v30
  v_exp_f32 v31, v31
  v_exp_f32 v0, v0
  v_exp_f32 v1, v1
  v_smfmac_f32_32x32x32_bf16 v[48:63], v[80:83], v[24:31], v94
  s_mov_b64 exec, s[98:99]
  ds_read_b128 v[80:83], v93 offset:34304
  s_mov_b64 exec, -1
  v_exp_f32 v2, v2
  v_exp_f32 v3, v3
  v_exp_f32 v4, v4
  v_mfma_f32_32x32x16_bf16 v[16:31], v[72:75], v[68:71], 0
  ds_read_b128 v[72:75], v92 offset:34816
  v_exp_f32 v5, v5
  v_exp_f32 v6, v6
  v_exp_f32 v7, v7
  v_exp_f32 v8, v8
  v_exp_f32 v9, v9
  s_waitcnt lgkmcnt(2)
  v_smfmac_f32_32x32x32_bf16 v[32:47], v[76:79], v[0:7], v94
  v_exp_f32 v10, v10
  v_exp_f32 v11, v11
  v_exp_f32 v12, v12
  v_exp_f32 v13, v13
  v_exp_f32 v14, v14
  v_exp_f32 v15, v15
  v_exp_f32 v16, v16
  v_exp_f32 v17, v17
  s_waitcnt lgkmcnt(1)
  v_smfmac_f32_32x32x32_bf16 v[32:47], v[80:83], v[8:15], v94
  v_exp_f32 v18, v18
  v_exp_f32 v19, v19
  v_exp_f32 v20, v20
  s_waitcnt lgkmcnt(0)
  v_mfma_f32_32x32x16_bf16 v[0:15], v[72:75], v[64:67], 0
  v_exp_f32 v21, v21
  v_exp_f32 v22, v22
  v_exp_f32 v23, v23
  v_exp_f32 v24, v24
  v_exp_f32 v25, v25
  v_smfmac_f32_32x32x32_bf16 v[48:63], v[76:79], v[16:23], v94
  s_mov_b64 exec, s[98:99]
  ds_read_b128 v[76:79], v93 offset:34816
  s_mov_b64 exec, -1
  v_exp_f32 v26, v26
  v_exp_f32 v27, v27
  v_exp_f32 v28, v28
  v_exp_f32 v29, v29
  v_exp_f32 v30, v30
  v_exp_f32 v31, v31
  v_exp_f32 v0, v0
  v_exp_f32 v1, v1
  v_smfmac_f32_32x32x32_bf16 v[48:63], v[80:83], v[24:31], v94
  s_mov_b64 exec, s[98:99]
  ds_read_b128 v[80:83], v93 offset:35328
  s_mov_b64 exec, -1
  v_exp_f32 v2, v2
  v_exp_f32 v3, v3
  v_exp_f32 v4, v4
  v_mfma_f32_32x32x16_bf16 v[16:31], v[72:75], v[68:71], 0
  ds_read_b128 v[72:75], v92 offset:35840
  buffer_load_dwordx4 v[112:115], v97, s[16:19], s97 offen
  s_add_u32 s97, s97, 114688
  v_exp_f32 v5, v5
  v_exp_f32 v6, v6
  v_exp_f32 v7, v7
  v_exp_f32 v8, v8
  v_exp_f32 v9, v9
  s_waitcnt lgkmcnt(2)
  v_smfmac_f32_32x32x32_bf16 v[32:47], v[76:79], v[0:7], v94
  v_exp_f32 v10, v10
  v_exp_f32 v11, v11
  v_exp_f32 v12, v12
  v_exp_f32 v13, v13
  v_exp_f32 v14, v14
  v_exp_f32 v15, v15
  v_exp_f32 v16, v16
  v_exp_f32 v17, v17
  s_waitcnt lgkmcnt(1)
  v_smfmac_f32_32x32x32_bf16 v[32:47], v[80:83], v[8:15], v94
  v_exp_f32 v18, v18
  v_exp_f32 v19, v19
  v_exp_f32 v20, v20
  s_waitcnt lgkmcnt(0)
  v_mfma_f32_32x32x16_bf16 v[0:15], v[72:75], v[64:67], 0
  v_exp_f32 v21, v21
  v_exp_f32 v22, v22
  v_exp_f32 v23, v23
  v_exp_f32 v24, v24
  v_exp_f32 v25, v25
  v_smfmac_f32_32x32x32_bf16 v[48:63], v[76:79], v[16:23], v94
  s_mov_b64 exec, s[98:99]
  ds_read_b128 v[76:79], v93 offset:35840
  s_mov_b64 exec, -1
  v_exp_f32 v26, v26
  v_exp_f32 v27, v27
  v_exp_f32 v28, v28
  v_exp_f32 v29, v29
  v_exp_f32 v30, v30
  v_exp_f32 v31, v31
  v_exp_f32 v0, v0
  v_exp_f32 v1, v1
  v_smfmac_f32_32x32x32_bf16 v[48:63], v[80:83], v[24:31], v94
  s_mov_b64 exec, s[98:99]
  ds_read_b128 v[80:83], v93 offset:36352
  s_mov_b64 exec, -1
  s_waitcnt vmcnt(5)
  s_barrier
  v_exp_f32 v2, v2
  v_exp_f32 v3, v3
  v_exp_f32 v4, v4
  v_mfma_f32_32x32x16_bf16 v[16:31], v[72:75], v[68:71], 0
  ds_read_b128 v[72:75], v92 offset:49152
  v_exp_f32 v5, v5
  v_exp_f32 v6, v6
  v_exp_f32 v7, v7
  v_exp_f32 v8, v8
  v_exp_f32 v9, v9
  s_waitcnt lgkmcnt(2)
  v_smfmac_f32_32x32x32_bf16 v[32:47], v[76:79], v[0:7], v94
  v_exp_f32 v10, v10
  v_exp_f32 v11, v11
  v_exp_f32 v12, v12
  v_exp_f32 v13, v13
  v_exp_f32 v14, v14
  v_exp_f32 v15, v15
  v_exp_f32 v16, v16
  v_exp_f32 v17, v17
  s_waitcnt lgkmcnt(1)
  v_smfmac_f32_32x32x32_bf16 v[32:47], v[80:83], v[8:15], v94
  s_add_u32 s92, s92, 8192
  s_and_b32 s92, s92, 0xffff
  s_mov_b32 m0, s67
  s_add_u32 s48, s92, s44
  buffer_load_dwordx4 v95, s[28:31], s48 offen lds
  s_add_u32 m0, s67, 8192
  s_add_u32 s49, s48, 2097152
  buffer_load_dwordx4 v95, s[28:31], s49 offen lds
  s_add_u32 s67, s67, 16384
  v_exp_f32 v18, v18
  v_exp_f32 v19, v19
  v_exp_f32 v20, v20
  s_waitcnt lgkmcnt(0)
  v_mfma_f32_32x32x16_bf16 v[0:15], v[72:75], v[64:67], 0
  buffer_load_dwordx4 v[116:119], v97, s[16:19], s97 offen
  s_add_u32 s97, s97, 114688
  v_exp_f32 v21, v21
  v_exp_f32 v22, v22
  v_exp_f32 v23, v23
  v_exp_f32 v24, v24
  v_exp_f32 v25, v25
  v_smfmac_f32_32x32x32_bf16 v[48:63], v[76:79], v[16:23], v94
  s_mov_b64 exec, s[98:99]
  ds_read_b128 v[76:79], v93 offset:49152
  s_mov_b64 exec, -1
  v_exp_f32 v26, v26
  v_exp_f32 v27, v27
  v_exp_f32 v28, v28
  v_exp_f32 v29, v29
  v_exp_f32 v30, v30
  v_exp_f32 v31, v31
  v_exp_f32 v0, v0
  v_exp_f32 v1, v1
  v_smfmac_f32_32x32x32_bf16 v[48:63], v[80:83], v[24:31], v94
  s_mov_b64 exec, s[98:99]
  ds_read_b128 v[80:83], v93 offset:49664
  s_mov_b64 exec, -1
  v_exp_f32 v2, v2
  v_exp_f32 v3, v3
  v_exp_f32 v4, v4
  v_mfma_f32_32x32x16_bf16 v[16:31], v[72:75], v[68:71], 0
  ds_read_b128 v[72:75], v92 offset:50176
  v_exp_f32 v5, v5
  v_exp_f32 v6, v6
  v_exp_f32 v7, v7
  v_exp_f32 v8, v8
  v_exp_f32 v9, v9
  s_waitcnt lgkmcnt(2)
  v_smfmac_f32_32x32x32_bf16 v[32:47], v[76:79], v[0:7], v94
  v_exp_f32 v10, v10
  v_exp_f32 v11, v11
  v_exp_f32 v12, v12
  v_exp_f32 v13, v13
  v_exp_f32 v14, v14
  v_exp_f32 v15, v15
  v_exp_f32 v16, v16
  v_exp_f32 v17, v17
  s_waitcnt lgkmcnt(1)
  v_smfmac_f32_32x32x32_bf16 v[32:47], v[80:83], v[8:15], v94
  v_exp_f32 v18, v18
  v_exp_f32 v19, v19
  v_exp_f32 v20, v20
  s_waitcnt lgkmcnt(0)
  v_mfma_f32_32x32x16_bf16 v[0:15], v[72:75], v[64:67], 0
  v_exp_f32 v21, v21
  v_exp_f32 v22, v22
  v_exp_f32 v23, v23
  v_exp_f32 v24, v24
  v_exp_f32 v25, v25
  v_smfmac_f32_32x32x32_bf16 v[48:63], v[76:79], v[16:23], v94
  s_mov_b64 exec, s[98:99]
  ds_read_b128 v[76:79], v93 offset:50176
  s_mov_b64 exec, -1
  v_exp_f32 v26, v26
  v_exp_f32 v27, v27
  v_exp_f32 v28, v28
  v_exp_f32 v29, v29
  v_exp_f32 v30, v30
  v_exp_f32 v31, v31
  v_exp_f32 v0, v0
  v_exp_f32 v1, v1
  v_smfmac_f32_32x32x32_bf16 v[48:63], v[80:83], v[24:31], v94
  s_mov_b64 exec, s[98:99]
  ds_read_b128 v[80:83], v93 offset:50688
  s_mov_b64 exec, -1
  v_exp_f32 v2, v2
  v_exp_f32 v3, v3
  v_exp_f32 v4, v4
  v_mfma_f32_32x32x16_bf16 v[16:31], v[72:75], v[68:71], 0
  ds_read_b128 v[72:75], v92 offset:51200
  buffer_load_dwordx4 v[120:123], v97, s[16:19], s97 offen
  s_add_u32 s97, s97, 114688
  v_exp_f32 v5, v5
  v_exp_f32 v6, v6
  v_exp_f32 v7, v7
  v_exp_f32 v8, v8
  v_exp_f32 v9, v9
  s_waitcnt lgkmcnt(2)
  v_smfmac_f32_32x32x32_bf16 v[32:47], v[76:79], v[0:7], v94
  v_exp_f32 v10, v10
  v_exp_f32 v11, v11
  v_exp_f32 v12, v12
  v_exp_f32 v13, v13
  v_exp_f32 v14, v14
  v_exp_f32 v15, v15
  v_exp_f32 v16, v16
  v_exp_f32 v17, v17
  s_waitcnt lgkmcnt(1)
  v_smfmac_f32_32x32x32_bf16 v[32:47], v[80:83], v[8:15], v94
  v_exp_f32 v18, v18
  v_exp_f32 v19, v19
  v_exp_f32 v20, v20
  s_waitcnt lgkmcnt(0)
  v_mfma_f32_32x32x16_bf16 v[0:15], v[72:75], v[64:67], 0
  v_exp_f32 v21, v21
  v_exp_f32 v22, v22
  v_exp_f32 v23, v23
  v_exp_f32 v24, v24
  v_exp_f32 v25, v25
  v_smfmac_f32_32x32x32_bf16 v[48:63], v[76:79], v[16:23], v94
  s_mov_b64 exec, s[98:99]
  ds_read_b128 v[76:79], v93 offset:51200
  s_mov_b64 exec, -1
  v_exp_f32 v26, v26
  v_exp_f32 v27, v27
  v_exp_f32 v28, v28
  v_exp_f32 v29, v29
  v_exp_f32 v30, v30
  v_exp_f32 v31, v31
  v_exp_f32 v0, v0
  v_exp_f32 v1, v1
  v_smfmac_f32_32x32x32_bf16 v[48:63], v[80:83], v[24:31], v94
  s_mov_b64 exec, s[98:99]
  ds_read_b128 v[80:83], v93 offset:51712
  s_mov_b64 exec, -1
  v_exp_f32 v2, v2
  v_exp_f32 v3, v3
  v_exp_f32 v4, v4
  v_mfma_f32_32x32x16_bf16 v[16:31], v[72:75], v[68:71], 0
  ds_read_b128 v[72:75], v92 offset:52224
  v_exp_f32 v5, v5
  v_exp_f32 v6, v6
  v_exp_f32 v7, v7
  v_exp_f32 v8, v8
  v_exp_f32 v9, v9
  s_waitcnt lgkmcnt(2)
  v_smfmac_f32_32x32x32_bf16 v[32:47], v[76:79], v[0:7], v94
  v_exp_f32 v10, v10
  v_exp_f32 v11, v11
  v_exp_f32 v12, v12
  v_exp_f32 v13, v13
  v_exp_f32 v14, v14
  v_exp_f32 v15, v15
  v_exp_f32 v16, v16
  v_exp_f32 v17, v17
  s_waitcnt lgkmcnt(1)
  v_smfmac_f32_32x32x32_bf16 v[32:47], v[80:83], v[8:15], v94
  v_exp_f32 v18, v18
  v_exp_f32 v19, v19
  v_exp_f32 v20, v20
  s_waitcnt lgkmcnt(0)
  v_mfma_f32_32x32x16_bf16 v[0:15], v[72:75], v[64:67], 0
  buffer_load_dwordx4 v[124:127], v97, s[16:19], s97 offen
  s_add_u32 s97, s97, 114688
  v_exp_f32 v21, v21
  v_exp_f32 v22, v22
  v_exp_f32 v23, v23
  v_exp_f32 v24, v24
  v_exp_f32 v25, v25
  v_smfmac_f32_32x32x32_bf16 v[48:63], v[76:79], v[16:23], v94
  s_mov_b64 exec, s[98:99]
  ds_read_b128 v[76:79], v93 offset:52224
  s_mov_b64 exec, -1
  v_exp_f32 v26, v26
  v_exp_f32 v27, v27
  v_exp_f32 v28, v28
  v_exp_f32 v29, v29
  v_exp_f32 v30, v30
  v_exp_f32 v31, v31
  v_exp_f32 v0, v0
  v_exp_f32 v1, v1
  v_smfmac_f32_32x32x32_bf16 v[48:63], v[80:83], v[24:31], v94
  s_mov_b64 exec, s[98:99]
  ds_read_b128 v[80:83], v93 offset:52736
  s_mov_b64 exec, -1
  s_waitcnt vmcnt(7)
  s_barrier
  v_exp_f32 v2, v2
  v_exp_f32 v3, v3
  v_exp_f32 v4, v4
  v_mfma_f32_32x32x16_bf16 v[16:31], v[72:75], v[68:71], 0
  v_add_u32 v92, 65536, v92
  ds_read_b128 v[72:75], v92 offset:0
  s_mov_b32 m0, s93
  s_add_u32 s93, s93, 8192
  buffer_load_dwordx4 v98, s[12:15], s94 offen lds
  s_add_u32 s94, s94, 65536
  v_exp_f32 v5, v5
  v_exp_f32 v6, v6
  v_exp_f32 v7, v7
  v_exp_f32 v8, v8
  v_exp_f32 v9, v9
  s_waitcnt lgkmcnt(2)
  v_smfmac_f32_32x32x32_bf16 v[32:47], v[76:79], v[0:7], v94
  v_exp_f32 v10, v10
  v_exp_f32 v11, v11
  v_exp_f32 v12, v12
  v_exp_f32 v13, v13
  v_exp_f32 v14, v14
  v_exp_f32 v15, v15
  v_exp_f32 v16, v16
  v_exp_f32 v17, v17
  s_waitcnt lgkmcnt(1)
  v_smfmac_f32_32x32x32_bf16 v[32:47], v[80:83], v[8:15], v94
  s_add_u32 s92, s92, 8192
  s_and_b32 s92, s92, 0xffff
  s_mov_b32 m0, s67
  s_add_u32 s48, s92, s44
  buffer_load_dwordx4 v95, s[28:31], s48 offen lds
  s_add_u32 m0, s67, 8192
  s_add_u32 s49, s48, 2097152
  buffer_load_dwordx4 v95, s[28:31], s49 offen lds
  s_add_u32 s67, s67, 16384
  v_exp_f32 v18, v18
  v_exp_f32 v19, v19
  v_exp_f32 v20, v20
  s_waitcnt lgkmcnt(0)
  v_mfma_f32_32x32x16_bf16 v[0:15], v[72:75], v[64:67], 0
  v_exp_f32 v21, v21
  v_exp_f32 v22, v22
  v_exp_f32 v23, v23
  v_exp_f32 v24, v24
  v_exp_f32 v25, v25
  v_smfmac_f32_32x32x32_bf16 v[48:63], v[76:79], v[16:23], v94
  v_add_u32 v93, 65536, v93
  s_mov_b64 exec, s[98:99]
  ds_read_b128 v[76:79], v93 offset:0
  s_mov_b64 exec, -1
  v_exp_f32 v26, v26
  v_exp_f32 v27, v27
  v_exp_f32 v28, v28
  v_exp_f32 v29, v29
  v_exp_f32 v30, v30
  v_exp_f32 v31, v31
  v_exp_f32 v0, v0
  v_exp_f32 v1, v1
  v_smfmac_f32_32x32x32_bf16 v[48:63], v[80:83], v[24:31], v94
  s_mov_b64 exec, s[98:99]
  ds_read_b128 v[80:83], v93 offset:512
  s_mov_b64 exec, -1
  v_exp_f32 v2, v2
  v_exp_f32 v3, v3
  v_exp_f32 v4, v4
  v_mfma_f32_32x32x16_bf16 v[16:31], v[72:75], v[68:71], 0
  ds_read_b128 v[72:75], v92 offset:1024
  s_mov_b32 m0, s93
  s_add_u32 s93, s93, 8192
  buffer_load_dwordx4 v98, s[12:15], s94 offen lds
  s_add_u32 s94, s94, 65536
  buffer_load_dwordx4 v[160:163], v97, s[16:19], s97 offen
  s_add_u32 s97, s97, 114688
  v_exp_f32 v5, v5
  v_exp_f32 v6, v6
  v_exp_f32 v7, v7
  v_exp_f32 v8, v8
  v_exp_f32 v9, v9
  s_waitcnt lgkmcnt(2)
  v_smfmac_f32_32x32x32_bf16 v[32:47], v[76:79], v[0:7], v94
  v_exp_f32 v10, v10
  v_exp_f32 v11, v11
  v_exp_f32 v12, v12
  v_exp_f32 v13, v13
  v_exp_f32 v14, v14
  v_exp_f32 v15, v15
  v_exp_f32 v16, v16
  v_exp_f32 v17, v17
  s_waitcnt lgkmcnt(1)
  v_smfmac_f32_32x32x32_bf16 v[32:47], v[80:83], v[8:15], v94
  v_exp_f32 v18, v18
  v_exp_f32 v19, v19
  v_exp_f32 v20, v20
  s_waitcnt lgkmcnt(0)
  v_mfma_f32_32x32x16_bf16 v[0:15], v[72:75], v[64:67], 0
  v_exp_f32 v21, v21
  v_exp_f32 v22, v22
  v_exp_f32 v23, v23
  v_exp_f32 v24, v24
  v_exp_f32 v25, v25
  v_smfmac_f32_32x32x32_bf16 v[48:63], v[76:79], v[16:23], v94
  s_mov_b64 exec, s[98:99]
  ds_read_b128 v[76:79], v93 offset:1024
  s_mov_b64 exec, -1
  v_exp_f32 v26, v26
  v_exp_f32 v27, v27
  v_exp_f32 v28, v28
  v_exp_f32 v29, v29
  v_exp_f32 v30, v30
  v_exp_f32 v31, v31
  v_exp_f32 v0, v0
  v_exp_f32 v1, v1
  v_smfmac_f32_32x32x32_bf16 v[48:63], v[80:83], v[24:31], v94
  s_mov_b64 exec, s[98:99]
  ds_read_b128 v[80:83], v93 offset:1536
  s_mov_b64 exec, -1
  v_exp_f32 v2, v2
  v_exp_f32 v3, v3
  v_exp_f32 v4, v4
  v_mfma_f32_32x32x16_bf16 v[16:31], v[72:75], v[68:71], 0
  ds_read_b128 v[72:75], v92 offset:2048
  s_mov_b32 m0, s93
  s_add_u32 s93, s93, 8192
  buffer_load_dwordx4 v98, s[12:15], s94 offen lds
  s_add_u32 s94, s94, 65536
  v_exp_f32 v5, v5
  v_exp_f32 v6, v6
  v_exp_f32 v7, v7
  v_exp_f32 v8, v8
  v_exp_f32 v9, v9
  s_waitcnt lgkmcnt(2)
  v_smfmac_f32_32x32x32_bf16 v[32:47], v[76:79], v[0:7], v94
  v_exp_f32 v10, v10
  v_exp_f32 v11, v11
  v_exp_f32 v12, v12
  v_exp_f32 v13, v13
  v_exp_f32 v14, v14
  v_exp_f32 v15, v15
  v_exp_f32 v16, v16
  v_exp_f32 v17, v17
  s_waitcnt lgkmcnt(1)
  v_smfmac_f32_32x32x32_bf16 v[32:47], v[80:83], v[8:15], v94
  v_exp_f32 v18, v18
  v_exp_f32 v19, v19
  v_exp_f32 v20, v20
  s_waitcnt lgkmcnt(0)
  v_mfma_f32_32x32x16_bf16 v[0:15], v[72:75], v[64:67], 0
  buffer_load_dwordx4 v[164:167], v97, s[16:19], s97 offen
  s_add_u32 s97, s97, 114688
  v_exp_f32 v21, v21
  v_exp_f32 v22, v22
  v_exp_f32 v23, v23
  v_exp_f32 v24, v24
  v_exp_f32 v25, v25
  v_smfmac_f32_32x32x32_bf16 v[48:63], v[76:79], v[16:23], v94
  s_mov_b64 exec, s[98:99]
  ds_read_b128 v[76:79], v93 offset:2048
  s_mov_b64 exec, -1
  v_exp_f32 v26, v26
  v_exp_f32 v27, v27
  v_exp_f32 v28, v28
  v_exp_f32 v29, v29
  v_exp_f32 v30, v30
  v_exp_f32 v31, v31
  v_exp_f32 v0, v0
  v_exp_f32 v1, v1
  v_smfmac_f32_32x32x32_bf16 v[48:63], v[80:83], v[24:31], v94
  s_mov_b64 exec, s[98:99]
  ds_read_b128 v[80:83], v93 offset:2560
  s_mov_b64 exec, -1
  v_exp_f32 v2, v2
  v_exp_f32 v3, v3
  v_exp_f32 v4, v4
  v_mfma_f32_32x32x16_bf16 v[16:31], v[72:75], v[68:71], 0
  ds_read_b128 v[72:75], v92 offset:3072
  s_mov_b32 m0, s93
  s_add_u32 s93, s93, 8192
  buffer_load_dwordx4 v98, s[12:15], s94 offen lds
  s_add_u32 s94, s94, 65536
  v_exp_f32 v5, v5
  v_exp_f32 v6, v6
  v_exp_f32 v7, v7
  v_exp_f32 v8, v8
  v_exp_f32 v9, v9
  s_waitcnt lgkmcnt(2)
  v_smfmac_f32_32x32x32_bf16 v[32:47], v[76:79], v[0:7], v94
  v_exp_f32 v10, v10
  v_exp_f32 v11, v11
  v_exp_f32 v12, v12
  v_exp_f32 v13, v13
  v_exp_f32 v14, v14
  v_exp_f32 v15, v15
  v_exp_f32 v16, v16
  v_exp_f32 v17, v17
  s_waitcnt lgkmcnt(1)
  v_smfmac_f32_32x32x32_bf16 v[32:47], v[80:83], v[8:15], v94
  v_exp_f32 v18, v18
  v_exp_f32 v19, v19
  v_exp_f32 v20, v20
  s_waitcnt lgkmcnt(0)
  v_mfma_f32_32x32x16_bf16 v[0:15], v[72:75], v[64:67], 0
  v_exp_f32 v21, v21
  v_exp_f32 v22, v22
  v_exp_f32 v23, v23
  v_exp_f32 v24, v24
  v_exp_f32 v25, v25
  v_smfmac_f32_32x32x32_bf16 v[48:63], v[76:79], v[16:23], v94
  s_mov_b64 exec, s[98:99]
  ds_read_b128 v[76:79], v93 offset:3072
  s_mov_b64 exec, -1
  v_exp_f32 v26, v26
  v_exp_f32 v27, v27
  v_exp_f32 v28, v28
  v_exp_f32 v29, v29
  v_exp_f32 v30, v30
  v_exp_f32 v31, v31
  v_exp_f32 v0, v0
  v_exp_f32 v1, v1
  v_smfmac_f32_32x32x32_bf16 v[48:63], v[80:83], v[24:31], v94
  s_mov_b64 exec, s[98:99]
  ds_read_b128 v[80:83], v93 offset:3584
  s_mov_b64 exec, -1
  s_waitcnt vmcnt(11)
  s_barrier
  v_exp_f32 v2, v2
  v_exp_f32 v3, v3
  v_exp_f32 v4, v4
  v_mfma_f32_32x32x16_bf16 v[16:31], v[72:75], v[68:71], 0
  ds_read_b128 v[72:75], v92 offset:16384
  s_mov_b32 m0, s93
  s_add_u32 s93, s93, 8192
  buffer_load_dwordx4 v98, s[12:15], s94 offen lds
  s_add_u32 s94, s94, 65536
  s_mov_b32 m0, s95
  s_add_u32 s95, s95, 8192
  buffer_load_dwordx4 v97, s[16:19], s96 offen lds
  s_add_u32 s96, s96, 229376
  buffer_load_dwordx4 v[168:171], v97, s[16:19], s97 offen
  s_add_u32 s97, s97, 114688
  v_exp_f32 v5, v5
  v_exp_f32 v6, v6
  v_exp_f32 v7, v7
  v_exp_f32 v8, v8
  v_exp_f32 v9, v9
  s_waitcnt lgkmcnt(2)
  v_smfmac_f32_32x32x32_bf16 v[32:47], v[76:79], v[0:7], v94
  v_exp_f32 v10, v10
  v_exp_f32 v11, v11
  v_exp_f32 v12, v12
  v_exp_f32 v13, v13
  v_exp_f32 v14, v14
  v_exp_f32 v15, v15
  v_exp_f32 v16, v16
  v_exp_f32 v17, v17
  s_waitcnt lgkmcnt(1)
  v_smfmac_f32_32x32x32_bf16 v[32:47], v[80:83], v[8:15], v94
  s_add_u32 s92, s92, 8192
  s_and_b32 s92, s92, 0xffff
  s_mov_b32 m0, s67
  s_add_u32 s48, s92, s44
  buffer_load_dwordx4 v95, s[28:31], s48 offen lds
  s_add_u32 m0, s67, 8192
  s_add_u32 s49, s48, 2097152
  buffer_load_dwordx4 v95, s[28:31], s49 offen lds
  s_add_u32 s67, s67, 16384
  v_exp_f32 v18, v18
  v_exp_f32 v19, v19
  v_exp_f32 v20, v20
  s_waitcnt lgkmcnt(0)
  v_mfma_f32_32x32x16_bf16 v[0:15], v[72:75], v[64:67], 0
  v_exp_f32 v21, v21
  v_exp_f32 v22, v22
  v_exp_f32 v23, v23
  v_exp_f32 v24, v24
  v_exp_f32 v25, v25
  v_smfmac_f32_32x32x32_bf16 v[48:63], v[76:79], v[16:23], v94
  s_mov_b64 exec, s[98:99]
  ds_read_b128 v[76:79], v93 offset:16384
  s_mov_b64 exec, -1
  v_exp_f32 v26, v26
  v_exp_f32 v27, v27
  v_exp_f32 v28, v28
  v_exp_f32 v29, v29
  v_exp_f32 v30, v30
  v_exp_f32 v31, v31
  v_exp_f32 v0, v0
  v_exp_f32 v1, v1
  v_smfmac_f32_32x32x32_bf16 v[48:63], v[80:83], v[24:31], v94
  s_mov_b64 exec, s[98:99]
  ds_read_b128 v[80:83], v93 offset:16896
  s_mov_b64 exec, -1
  v_exp_f32 v2, v2
  v_exp_f32 v3, v3
  v_exp_f32 v4, v4
  v_mfma_f32_32x32x16_bf16 v[16:31], v[72:75], v[68:71], 0
  ds_read_b128 v[72:75], v92 offset:17408
  s_mov_b32 m0, s93
  s_add_u32 s93, s93, 8192
  buffer_load_dwordx4 v98, s[12:15], s94 offen lds
  s_add_u32 s94, s94, 65536
  v_exp_f32 v5, v5
  v_exp_f32 v6, v6
  v_exp_f32 v7, v7
  v_exp_f32 v8, v8
  v_exp_f32 v9, v9
  s_waitcnt lgkmcnt(2)
  v_smfmac_f32_32x32x32_bf16 v[32:47], v[76:79], v[0:7], v94
  v_exp_f32 v10, v10
  v_exp_f32 v11, v11
  v_exp_f32 v12, v12
  v_exp_f32 v13, v13
  v_exp_f32 v14, v14
  v_exp_f32 v15, v15
  v_exp_f32 v16, v16
  v_exp_f32 v17, v17
  s_waitcnt lgkmcnt(1)
  v_smfmac_f32_32x32x32_bf16 v[32:47], v[80:83], v[8:15], v94
  v_exp_f32 v18, v18
  v_exp_f32 v19, v19
  v_exp_f32 v20, v20
  s_waitcnt lgkmcnt(0)
  v_mfma_f32_32x32x16_bf16 v[0:15], v[72:75], v[64:67], 0
  buffer_load_dwordx4 v[172:175], v97, s[16:19], s97 offen
  s_add_u32 s97, s97, 114688
  v_exp_f32 v21, v21
  v_exp_f32 v22, v22
  v_exp_f32 v23, v23
  v_exp_f32 v24, v24
  v_exp_f32 v25, v25
  v_smfmac_f32_32x32x32_bf16 v[48:63], v[76:79], v[16:23], v94
  s_mov_b64 exec, s[98:99]
  ds_read_b128 v[76:79], v93 offset:17408
  s_mov_b64 exec, -1
  v_exp_f32 v26, v26
  v_exp_f32 v27, v27
  v_exp_f32 v28, v28
  v_exp_f32 v29, v29
  v_exp_f32 v30, v30
  v_exp_f32 v31, v31
  v_exp_f32 v0, v0
  v_exp_f32 v1, v1
  v_smfmac_f32_32x32x32_bf16 v[48:63], v[80:83], v[24:31], v94
  s_mov_b64 exec, s[98:99]
  ds_read_b128 v[80:83], v93 offset:17920
  s_mov_b64 exec, -1
  v_exp_f32 v2, v2
  v_exp_f32 v3, v3
  v_exp_f32 v4, v4
  v_mfma_f32_32x32x16_bf16 v[16:31], v[72:75], v[68:71], 0
  ds_read_b128 v[72:75], v92 offset:18432
  s_mov_b32 m0, s93
  s_add_u32 s93, s93, 8192
  buffer_load_dwordx4 v98, s[12:15], s94 offen lds
  s_add_u32 s94, s94, 65536
  v_exp_f32 v5, v5
  v_exp_f32 v6, v6
  v_exp_f32 v7, v7
  v_exp_f32 v8, v8
  v_exp_f32 v9, v9
  s_waitcnt lgkmcnt(2)
  v_smfmac_f32_32x32x32_bf16 v[32:47], v[76:79], v[0:7], v94
  v_exp_f32 v10, v10
  v_exp_f32 v11, v11
  v_exp_f32 v12, v12
  v_exp_f32 v13, v13
  v_exp_f32 v14, v14
  v_exp_f32 v15, v15
  v_exp_f32 v16, v16
  v_exp_f32 v17, v17
  s_waitcnt lgkmcnt(1)
  v_smfmac_f32_32x32x32_bf16 v[32:47], v[80:83], v[8:15], v94
  v_exp_f32 v18, v18
  v_exp_f32 v19, v19
  v_exp_f32 v20, v20
  s_waitcnt lgkmcnt(0)
  v_mfma_f32_32x32x16_bf16 v[0:15], v[72:75], v[64:67], 0
  v_exp_f32 v21, v21
  v_exp_f32 v22, v22
  v_exp_f32 v23, v23
  v_exp_f32 v24, v24
  v_exp_f32 v25, v25
  v_smfmac_f32_32x32x32_bf16 v[48:63], v[76:79], v[16:23], v94
  s_mov_b64 exec, s[98:99]
  ds_read_b128 v[76:79], v93 offset:18432
  s_mov_b64 exec, -1
  v_exp_f32 v26, v26
  v_exp_f32 v27, v27
  v_exp_f32 v28, v28
  v_exp_f32 v29, v29
  v_exp_f32 v30, v30
  v_exp_f32 v31, v31
  v_exp_f32 v0, v0
  v_exp_f32 v1, v1
  v_smfmac_f32_32x32x32_bf16 v[48:63], v[80:83], v[24:31], v94
  s_mov_b64 exec, s[98:99]
  ds_read_b128 v[80:83], v93 offset:18944
  s_mov_b64 exec, -1
  v_exp_f32 v2, v2
  v_exp_f32 v3, v3
  v_exp_f32 v4, v4
  v_mfma_f32_32x32x16_bf16 v[16:31], v[72:75], v[68:71], 0
  ds_read_b128 v[72:75], v92 offset:19456
  s_mov_b32 m0, s93
  s_add_u32 s93, s93, 8192
  buffer_load_dwordx4 v98, s[12:15], s94 offen lds
  s_add_u32 s94, s94, 65536
  buffer_load_dwordx4 v[232:235], v97, s[16:19], s97 offen
  s_add_u32 s97, s97, 114688
  v_exp_f32 v5, v5
  v_exp_f32 v6, v6
  v_exp_f32 v7, v7
  v_exp_f32 v8, v8
  v_exp_f32 v9, v9
  s_waitcnt lgkmcnt(2)
  v_smfmac_f32_32x32x32_bf16 v[32:47], v[76:79], v[0:7], v94
  v_exp_f32 v10, v10
  v_exp_f32 v11, v11
  v_exp_f32 v12, v12
  v_exp_f32 v13, v13
  v_exp_f32 v14, v14
  v_exp_f32 v15, v15
  v_exp_f32 v16, v16
  v_exp_f32 v17, v17
  s_waitcnt lgkmcnt(1)
  v_smfmac_f32_32x32x32_bf16 v[32:47], v[80:83], v[8:15], v94
  v_exp_f32 v18, v18
  v_exp_f32 v19, v19
  v_exp_f32 v20, v20
  s_waitcnt lgkmcnt(0)
  v_mfma_f32_32x32x16_bf16 v[0:15], v[72:75], v[64:67], 0
  v_exp_f32 v21, v21
  v_exp_f32 v22, v22
  v_exp_f32 v23, v23
  v_exp_f32 v24, v24
  v_exp_f32 v25, v25
  v_smfmac_f32_32x32x32_bf16 v[48:63], v[76:79], v[16:23], v94
  s_mov_b64 exec, s[98:99]
  ds_read_b128 v[76:79], v93 offset:19456
  s_mov_b64 exec, -1
  v_exp_f32 v26, v26
  v_exp_f32 v27, v27
  v_exp_f32 v28, v28
  v_exp_f32 v29, v29
  v_exp_f32 v30, v30
  v_exp_f32 v31, v31
  v_exp_f32 v0, v0
  v_exp_f32 v1, v1
  v_smfmac_f32_32x32x32_bf16 v[48:63], v[80:83], v[24:31], v94
  s_mov_b64 exec, s[98:99]
  ds_read_b128 v[80:83], v93 offset:19968
  s_mov_b64 exec, -1
  s_waitcnt vmcnt(15)
  s_barrier
  v_exp_f32 v2, v2
  v_exp_f32 v3, v3
  v_exp_f32 v4, v4
  v_mfma_f32_32x32x16_bf16 v[16:31], v[72:75], v[68:71], 0
  ds_read_b128 v[72:75], v92 offset:32768
  s_mov_b32 m0, s95
  s_add_u32 s95, s95, 8192
  buffer_load_dwordx4 v97, s[16:19], s96 offen lds
  s_add_u32 s96, s96, 229376
  s_mov_b32 m0, s95
  s_add_u32 s95, s95, 8192
  s_cmp_lt_u32 s36, 6
  s_cselect_b32 s50, 1835136, 0
  s_sub_u32 s96, s96, s50
  buffer_load_dwordx4 v97, s[16:19], s96 offen lds
  s_add_u32 s96, s96, 229376
  v_exp_f32 v5, v5
  v_exp_f32 v6, v6
  v_exp_f32 v7, v7
  v_exp_f32 v8, v8
  v_exp_f32 v9, v9
  s_waitcnt lgkmcnt(2)
  v_smfmac_f32_32x32x32_bf16 v[32:47], v[76:79], v[0:7], v94
  v_exp_f32 v10, v10
  v_exp_f32 v11, v11
  v_exp_f32 v12, v12
  v_exp_f32 v13, v13
  v_exp_f32 v14, v14
  v_exp_f32 v15, v15
  v_exp_f32 v16, v16
  v_exp_f32 v17, v17
  s_waitcnt lgkmcnt(1)
  v_smfmac_f32_32x32x32_bf16 v[32:47], v[80:83], v[8:15], v94
  v_exp_f32 v18, v18
  v_exp_f32 v19, v19
  v_exp_f32 v20, v20
  s_waitcnt lgkmcnt(0)
  v_mfma_f32_32x32x16_bf16 v[0:15], v[72:75], v[64:67], 0
  buffer_load_dwordx4 v[236:239], v97, s[16:19], s97 offen
  s_add_u32 s97, s97, 114688
  v_exp_f32 v21, v21
  v_exp_f32 v22, v22
  v_exp_f32 v23, v23
  v_exp_f32 v24, v24
  v_exp_f32 v25, v25
  v_smfmac_f32_32x32x32_bf16 v[48:63], v[76:79], v[16:23], v94
  s_mov_b64 exec, s[98:99]
  ds_read_b128 v[76:79], v93 offset:32768
  s_mov_b64 exec, -1
  v_exp_f32 v26, v26
  v_exp_f32 v27, v27
  v_exp_f32 v28, v28
  v_exp_f32 v29, v29
  v_exp_f32 v30, v30
  v_exp_f32 v31, v31
  v_exp_f32 v0, v0
  v_exp_f32 v1, v1
  v_smfmac_f32_32x32x32_bf16 v[48:63], v[80:83], v[24:31], v94
  s_mov_b64 exec, s[98:99]
  ds_read_b128 v[80:83], v93 offset:33280
  s_mov_b64 exec, -1
  v_exp_f32 v2, v2
  v_exp_f32 v3, v3
  v_exp_f32 v4, v4
  v_mfma_f32_32x32x16_bf16 v[16:31], v[72:75], v[68:71], 0
  ds_read_b128 v[72:75], v92 offset:33792
  v_exp_f32 v5, v5
  v_exp_f32 v6, v6
  v_exp_f32 v7, v7
  v_exp_f32 v8, v8
  v_exp_f32 v9, v9
  s_waitcnt lgkmcnt(2)
  v_smfmac_f32_32x32x32_bf16 v[32:47], v[76:79], v[0:7], v94
  v_exp_f32 v10, v10
  v_exp_f32 v11, v11
  v_exp_f32 v12, v12
  v_exp_f32 v13, v13
  v_exp_f32 v14, v14
  v_exp_f32 v15, v15
  v_exp_f32 v16, v16
  v_exp_f32 v17, v17
  s_waitcnt lgkmcnt(1)
  v_smfmac_f32_32x32x32_bf16 v[32:47], v[80:83], v[8:15], v94
  v_exp_f32 v18, v18
  v_exp_f32 v19, v19
  v_exp_f32 v20, v20
  s_waitcnt lgkmcnt(0)
  v_mfma_f32_32x32x16_bf16 v[0:15], v[72:75], v[64:67], 0
  v_exp_f32 v21, v21
  v_exp_f32 v22, v22
  v_exp_f32 v23, v23
  v_exp_f32 v24, v24
  v_exp_f32 v25, v25
  v_smfmac_f32_32x32x32_bf16 v[48:63], v[76:79], v[16:23], v94
  s_mov_b64 exec, s[98:99]
  ds_read_b128 v[76:79], v93 offset:33792
  s_mov_b64 exec, -1
  v_exp_f32 v26, v26
  v_exp_f32 v27, v27
  v_exp_f32 v28, v28
  v_exp_f32 v29, v29
  v_exp_f32 v30, v30
  v_exp_f32 v31, v31
  v_exp_f32 v0, v0
  v_exp_f32 v1, v1
  v_smfmac_f32_32x32x32_bf16 v[48:63], v[80:83], v[24:31], v94
  s_mov_b64 exec, s[98:99]
  ds_read_b128 v[80:83], v93 offset:34304
  s_mov_b64 exec, -1
  v_exp_f32 v2, v2
  v_exp_f32 v3, v3
  v_exp_f32 v4, v4
  v_mfma_f32_32x32x16_bf16 v[16:31], v[72:75], v[68:71], 0
  ds_read_b128 v[72:75], v92 offset:34816
  buffer_load_dwordx4 v[240:243], v97, s[16:19], s97 offen
  s_add_u32 s97, s97, 114688
  v_exp_f32 v5, v5
  v_exp_f32 v6, v6
  v_exp_f32 v7, v7
  v_exp_f32 v8, v8
  v_exp_f32 v9, v9
  s_waitcnt lgkmcnt(2)
  v_smfmac_f32_32x32x32_bf16 v[32:47], v[76:79], v[0:7], v94
  v_exp_f32 v10, v10
  v_exp_f32 v11, v11
  v_exp_f32 v12, v12
  v_exp_f32 v13, v13
  v_exp_f32 v14, v14
  v_exp_f32 v15, v15
  v_exp_f32 v16, v16
  v_exp_f32 v17, v17
  s_waitcnt lgkmcnt(1)
  v_smfmac_f32_32x32x32_bf16 v[32:47], v[80:83], v[8:15], v94
  v_exp_f32 v18, v18
  v_exp_f32 v19, v19
  v_exp_f32 v20, v20
  s_waitcnt lgkmcnt(0)
  v_mfma_f32_32x32x16_bf16 v[0:15], v[72:75], v[64:67], 0
  v_exp_f32 v21, v21
  v_exp_f32 v22, v22
  v_exp_f32 v23, v23
  v_exp_f32 v24, v24
  v_exp_f32 v25, v25
  v_smfmac_f32_32x32x32_bf16 v[48:63], v[76:79], v[16:23], v94
  s_mov_b64 exec, s[98:99]
  ds_read_b128 v[76:79], v93 offset:34816
  s_mov_b64 exec, -1
  v_exp_f32 v26, v26
  v_exp_f32 v27, v27
  v_exp_f32 v28, v28
  v_exp_f32 v29, v29
  v_exp_f32 v30, v30
  v_exp_f32 v31, v31
  v_exp_f32 v0, v0
  v_exp_f32 v1, v1
  v_smfmac_f32_32x32x32_bf16 v[48:63], v[80:83], v[24:31], v94
  s_mov_b64 exec, s[98:99]
  ds_read_b128 v[80:83], v93 offset:35328
  s_mov_b64 exec, -1
  v_exp_f32 v2, v2
  v_exp_f32 v3, v3
  v_exp_f32 v4, v4
  v_mfma_f32_32x32x16_bf16 v[16:31], v[72:75], v[68:71], 0
  ds_read_b128 v[72:75], v92 offset:35840
  v_exp_f32 v5, v5
  v_exp_f32 v6, v6
  v_exp_f32 v7, v7
  v_exp_f32 v8, v8
  v_exp_f32 v9, v9
  s_waitcnt lgkmcnt(2)
  v_smfmac_f32_32x32x32_bf16 v[32:47], v[76:79], v[0:7], v94
  v_exp_f32 v10, v10
  v_exp_f32 v11, v11
  v_exp_f32 v12, v12
  v_exp_f32 v13, v13
  v_exp_f32 v14, v14
  v_exp_f32 v15, v15
  v_exp_f32 v16, v16
  v_exp_f32 v17, v17
  s_waitcnt lgkmcnt(1)
  v_smfmac_f32_32x32x32_bf16 v[32:47], v[80:83], v[8:15], v94
  v_exp_f32 v18, v18
  v_exp_f32 v19, v19
  v_exp_f32 v20, v20
  s_waitcnt lgkmcnt(0)
  v_mfma_f32_32x32x16_bf16 v[0:15], v[72:75], v[64:67], 0
  s_cmp_lg_u32 s40, 0
  s_cbranch_scc1 AL0_21
  buffer_load_dwordx2 v[248:249], v87, s[4:7], 0 offen offset:0
  buffer_load_dwordx2 v[250:251], v87, s[4:7], 0 offen offset:16
  buffer_load_dwordx2 v[252:253], v87, s[4:7], 0 offen offset:32
  buffer_load_dwordx2 v[254:255], v87, s[4:7], 0 offen offset:48
AL0_21:
  v_exp_f32 v21, v21
  v_exp_f32 v22, v22
  v_exp_f32 v23, v23
  v_exp_f32 v24, v24
  v_exp_f32 v25, v25
  v_smfmac_f32_32x32x32_bf16 v[48:63], v[76:79], v[16:23], v94
  s_mov_b64 exec, s[98:99]
  ds_read_b128 v[76:79], v93 offset:35840
  s_mov_b64 exec, -1
  v_exp_f32 v26, v26
  v_exp_f32 v27, v27
  v_exp_f32 v28, v28
  v_exp_f32 v29, v29
  v_exp_f32 v30, v30
  v_exp_f32 v31, v31
  v_exp_f32 v0, v0
  v_exp_f32 v1, v1
  v_smfmac_f32_32x32x32_bf16 v[48:63], v[80:83], v[24:31], v94
  s_mov_b64 exec, s[98:99]
  ds_read_b128 v[80:83], v93 offset:36352
  s_mov_b64 exec, -1
  s_waitcnt vmcnt(9)
  s_barrier
  v_exp_f32 v2, v2
  v_exp_f32 v3, v3
  v_exp_f32 v4, v4
  v_mfma_f32_32x32x16_bf16 v[16:31], v[72:75], v[68:71], 0
  ds_read_b128 v[72:75], v92 offset:49152
  s_mov_b32 m0, s95
  s_add_u32 s95, s95, 8192
  buffer_load_dwordx4 v97, s[16:19], s96 offen lds
  s_add_u32 s96, s96, 229376
  s_mov_b32 m0, s95
  s_add_u32 s95, s95, 8192
  buffer_load_dwordx4 v97, s[16:19], s96 offen lds
  s_add_u32 s96, s96, 229376
  v_exp_f32 v5, v5
  v_exp_f32 v6, v6
  v_exp_f32 v7, v7
  v_exp_f32 v8, v8
  v_exp_f32 v9, v9
  s_waitcnt lgkmcnt(2)
  v_smfmac_f32_32x32x32_bf16 v[32:47], v[76:79], v[0:7], v94
  v_exp_f32 v10, v10
  v_exp_f32 v11, v11
  v_exp_f32 v12, v12
  v_exp_f32 v13, v13
  v_exp_f32 v14, v14
  v_exp_f32 v15, v15
  v_exp_f32 v16, v16
  v_exp_f32 v17, v17
  s_waitcnt lgkmcnt(1)
  v_smfmac_f32_32x32x32_bf16 v[32:47], v[80:83], v[8:15], v94
  v_exp_f32 v18, v18
  v_exp_f32 v19, v19
  v_exp_f32 v20, v20
  s_waitcnt lgkmcnt(0)
  v_mfma_f32_32x32x16_bf16 v[0:15], v[72:75], v[64:67], 0
  v_exp_f32 v21, v21
  v_exp_f32 v22, v22
  v_exp_f32 v23, v23
  v_exp_f32 v24, v24
  v_exp_f32 v25, v25
  v_smfmac_f32_32x32x32_bf16 v[48:63], v[76:79], v[16:23], v94
  s_mov_b64 exec, s[98:99]
  ds_read_b128 v[76:79], v93 offset:49152
  s_mov_b64 exec, -1
  v_exp_f32 v26, v26
  v_exp_f32 v27, v27
  v_exp_f32 v28, v28
  v_exp_f32 v29, v29
  v_exp_f32 v30, v30
  v_exp_f32 v31, v31
  v_exp_f32 v0, v0
  v_exp_f32 v1, v1
  v_smfmac_f32_32x32x32_bf16 v[48:63], v[80:83], v[24:31], v94
  s_mov_b64 exec, s[98:99]
  ds_read_b128 v[80:83], v93 offset:49664
  s_mov_b64 exec, -1
  v_exp_f32 v2, v2
  v_exp_f32 v3, v3
  v_exp_f32 v4, v4
  v_mfma_f32_32x32x16_bf16 v[16:31], v[72:75], v[68:71], 0
  ds_read_b128 v[72:75], v92 offset:50176
  v_exp_f32 v5, v5
  v_exp_f32 v6, v6
  v_exp_f32 v7, v7
  v_exp_f32 v8, v8
  v_exp_f32 v9, v9
  s_waitcnt lgkmcnt(2)
  v_smfmac_f32_32x32x32_bf16 v[32:47], v[76:79], v[0:7], v94
  v_exp_f32 v10, v10
  v_exp_f32 v11, v11
  v_exp_f32 v12, v12
  v_exp_f32 v13, v13
  v_exp_f32 v14, v14
  v_exp_f32 v15, v15
  v_exp_f32 v16, v16
  v_exp_f32 v17, v17
  s_waitcnt lgkmcnt(1)
  v_smfmac_f32_32x32x32_bf16 v[32:47], v[80:83], v[8:15], v94
  v_exp_f32 v18, v18
  v_exp_f32 v19, v19
  v_exp_f32 v20, v20
  s_waitcnt lgkmcnt(0)
  v_mfma_f32_32x32x16_bf16 v[0:15], v[72:75], v[64:67], 0
  v_exp_f32 v21, v21
  v_exp_f32 v22, v22
  v_exp_f32 v23, v23
  v_exp_f32 v24, v24
  v_exp_f32 v25, v25
  v_smfmac_f32_32x32x32_bf16 v[48:63], v[76:79], v[16:23], v94
  s_mov_b64 exec, s[98:99]
  ds_read_b128 v[76:79], v93 offset:50176
  s_mov_b64 exec, -1
  v_exp_f32 v26, v26
  v_exp_f32 v27, v27
  v_exp_f32 v28, v28
  v_exp_f32 v29, v29
  v_exp_f32 v30, v30
  v_exp_f32 v31, v31
  v_exp_f32 v0, v0
  v_exp_f32 v1, v1
  v_smfmac_f32_32x32x32_bf16 v[48:63], v[80:83], v[24:31], v94
  s_mov_b64 exec, s[98:99]
  ds_read_b128 v[80:83], v93 offset:50688
  s_mov_b64 exec, -1
  s_barrier
  v_exp_f32 v2, v2
  v_exp_f32 v3, v3
  v_exp_f32 v4, v4
  v_mfma_f32_32x32x16_bf16 v[16:31], v[72:75], v[68:71], 0
  ds_read_b128 v[72:75], v92 offset:51200
  s_mov_b32 m0, s95
  s_add_u32 s95, s95, 8192
  buffer_load_dwordx4 v97, s[16:19], s96 offen lds
  s_add_u32 s96, s96, 229376
  s_mov_b32 m0, s95
  s_add_u32 s95, s95, 8192
  buffer_load_dwordx4 v97, s[16:19], s96 offen lds
  s_add_u32 s96, s96, 229376
  v_exp_f32 v5, v5
  v_exp_f32 v6, v6
  v_exp_f32 v7, v7
  v_exp_f32 v8, v8
  v_exp_f32 v9, v9
  s_waitcnt lgkmcnt(2)
  v_smfmac_f32_32x32x32_bf16 v[32:47], v[76:79], v[0:7], v94
  v_exp_f32 v10, v10
  v_exp_f32 v11, v11
  v_exp_f32 v12, v12
  v_exp_f32 v13, v13
  v_exp_f32 v14, v14
  v_exp_f32 v15, v15
  v_exp_f32 v16, v16
  v_exp_f32 v17, v17
  s_waitcnt lgkmcnt(1)
  v_smfmac_f32_32x32x32_bf16 v[32:47], v[80:83], v[8:15], v94
  v_exp_f32 v18, v18
  v_exp_f32 v19, v19
  v_exp_f32 v20, v20
  s_waitcnt lgkmcnt(0)
  v_mfma_f32_32x32x16_bf16 v[0:15], v[72:75], v[64:67], 0
  v_exp_f32 v21, v21
  v_exp_f32 v22, v22
  v_exp_f32 v23, v23
  v_exp_f32 v24, v24
  v_exp_f32 v25, v25
  v_smfmac_f32_32x32x32_bf16 v[48:63], v[76:79], v[16:23], v94
  s_mov_b64 exec, s[98:99]
  ds_read_b128 v[76:79], v93 offset:51200
  s_mov_b64 exec, -1
  v_exp_f32 v26, v26
  v_exp_f32 v27, v27
  v_exp_f32 v28, v28
  v_exp_f32 v29, v29
  v_exp_f32 v30, v30
  v_exp_f32 v31, v31
  v_exp_f32 v0, v0
  v_exp_f32 v1, v1
  v_smfmac_f32_32x32x32_bf16 v[48:63], v[80:83], v[24:31], v94
  s_mov_b64 exec, s[98:99]
  ds_read_b128 v[80:83], v93 offset:51712
  s_mov_b64 exec, -1
  v_exp_f32 v2, v2
  v_exp_f32 v3, v3
  v_exp_f32 v4, v4
  v_mfma_f32_32x32x16_bf16 v[16:31], v[72:75], v[68:71], 0
  ds_read_b128 v[72:75], v92 offset:52224
  v_exp_f32 v5, v5
  v_exp_f32 v6, v6
  v_exp_f32 v7, v7
  v_exp_f32 v8, v8
  v_exp_f32 v9, v9
  s_waitcnt lgkmcnt(2)
  v_smfmac_f32_32x32x32_bf16 v[32:47], v[76:79], v[0:7], v94
  v_exp_f32 v10, v10
  v_exp_f32 v11, v11
  v_exp_f32 v12, v12
  v_exp_f32 v13, v13
  v_exp_f32 v14, v14
  v_exp_f32 v15, v15
  v_exp_f32 v16, v16
  v_exp_f32 v17, v17
  s_waitcnt lgkmcnt(1)
  v_smfmac_f32_32x32x32_bf16 v[32:47], v[80:83], v[8:15], v94
  v_exp_f32 v18, v18
  v_exp_f32 v19, v19
  v_exp_f32 v20, v20
  s_waitcnt lgkmcnt(0)
  v_mfma_f32_32x32x16_bf16 v[0:15], v[72:75], v[64:67], 0
  s_lshl_b32 s50, s36, 11
  s_add_u32 s50, s50, 65536
  v_add_u32 v84, s50, v95
  s_xor_b32 s50, s50, 8192
  v_add_u32 v85, s50, v95
  s_lshl_b32 s50, s36, 8
  s_add_u32 s50, s50, 139264
  v_lshl_add_u32 v86, v96, 2, s50
  s_xor_b32 s50, s50, 1024
  v_lshl_add_u32 v87, v96, 2, s50
  s_and_b32 s46, s36, 1
  s_lshl_b32 s46, s46, 1
  s_lshr_b32 s47, s36, 2
  s_add_u32 s46, s46, s47
  s_lshl_b32 s46, s46, 15
  s_lshl_b32 s47, s38, 10
  s_add_u32 s46, s46, s47
  s_add_u32 s46, s46, s45
  s_add_u32 s46, s46, s62
  s_add_u32 s46, s46, 458752
  v_mov_b32 v88, 0x30800000
  v_mov_b32 v89, 0x5f800000
  v_mov_b32 v101, 0x207
  s_and_b32 s51, s36, 3
  s_lshl_b32 s51, s51, 1
  s_lshr_b32 s50, s36, 2
  s_add_u32 s51, s51, s50
  s_lshl_b32 s51, s51, 7
  s_lshl_b32 s50, s37, 10
  s_add_u32 s50, s50, s51
  s_lshl_b32 s51, s38, 2
  s_add_u32 s50, s50, s51
  s_add_u32 s51, s41, 2
  v_mov_b32 v90, s50
  v_mov_b32 v91, s51
  v_exp_f32 v21, v21
  v_exp_f32 v22, v22
  v_exp_f32 v23, v23
  v_exp_f32 v24, v24
  v_exp_f32 v25, v25
  v_smfmac_f32_32x32x32_bf16 v[48:63], v[76:79], v[16:23], v94
  s_mov_b64 exec, s[98:99]
  ds_read_b128 v[76:79], v93 offset:52224
  s_mov_b64 exec, -1
  v_exp_f32 v26, v26
  v_exp_f32 v27, v27
  v_exp_f32 v28, v28
  v_exp_f32 v29, v29
  v_exp_f32 v30, v30
  v_exp_f32 v31, v31
  v_exp_f32 v0, v0
  v_exp_f32 v1, v1
  v_smfmac_f32_32x32x32_bf16 v[48:63], v[80:83], v[24:31], v94
  s_mov_b64 exec, s[98:99]
  ds_read_b128 v[80:83], v93 offset:52736
  s_mov_b64 exec, -1
  v_exp_f32 v2, v2
  v_exp_f32 v3, v3
  v_exp_f32 v4, v4
  v_mfma_f32_32x32x16_bf16 v[16:31], v[72:75], v[68:71], 0
  v_exp_f32 v5, v5
  v_exp_f32 v6, v6
  v_exp_f32 v7, v7
  v_exp_f32 v8, v8
  v_exp_f32 v9, v9
  s_waitcnt lgkmcnt(1)
  v_smfmac_f32_32x32x32_bf16 v[32:47], v[76:79], v[0:7], v94
  v_exp_f32 v10, v10
  v_exp_f32 v11, v11
  v_exp_f32 v12, v12
  v_exp_f32 v13, v13
  v_exp_f32 v14, v14
  v_exp_f32 v15, v15
  v_exp_f32 v16, v16
  v_exp_f32 v17, v17
  s_waitcnt lgkmcnt(0)
  v_smfmac_f32_32x32x32_bf16 v[32:47], v[80:83], v[8:15], v94
  v_exp_f32 v18, v18
  v_exp_f32 v19, v19
  v_exp_f32 v20, v20
  v_exp_f32 v21, v21
  v_exp_f32 v22, v22
  v_exp_f32 v23, v23
  v_exp_f32 v24, v24
  v_exp_f32 v25, v25
  v_smfmac_f32_32x32x32_bf16 v[48:63], v[76:79], v[16:23], v94
  v_exp_f32 v26, v26
  v_exp_f32 v27, v27
  v_exp_f32 v28, v28
  v_exp_f32 v29, v29
  v_exp_f32 v30, v30
  v_exp_f32 v31, v31
  s_nop 1
  v_smfmac_f32_32x32x32_bf16 v[48:63], v[80:83], v[24:31], v94
  s_nop 11
  ds_write_b128 v84, v[48:51]
  ds_write_b128 v84, v[52:55] offset:1024
  ds_write_b32 v86, v56
  s_waitcnt lgkmcnt(0)
  s_barrier
  ds_read_b128 v[4:7], v85
  ds_read_b128 v[8:11], v85 offset:1024
  ds_read_b32 v12, v87
  s_waitcnt lgkmcnt(2)
  v_add_f32 v32, v32, v4
  v_add_f32 v33, v33, v5
  v_add_f32 v34, v34, v6
  v_add_f32 v35, v35, v7
  s_waitcnt lgkmcnt(1)
  v_add_f32 v36, v36, v8
  v_add_f32 v37, v37, v9
  v_add_f32 v38, v38, v10
  v_add_f32 v39, v39, v11
  s_waitcnt lgkmcnt(0)
  v_add_f32 v40, v40, v12
  v_mov_b32 v41, v40
  s_nop 1
  v_permlane32_swap_b32 v40, v41
  v_cmp_nle_f32 s[50:51], v88, v40
  v_cmp_nge_f32 vcc, v89, v40
  s_nop 0
  s_or_b64 s[50:51], s[50:51], vcc
  v_add_f32 v4, abs(v32), abs(v33)
  v_add_f32 v5, abs(v34), abs(v35)
  v_add_f32 v6, abs(v36), abs(v37)
  v_add_f32 v7, abs(v38), abs(v39)
  v_add_f32 v4, v4, v5
  v_add_f32 v6, v6, v7
  v_add_f32 v4, v4, v6
  v_cmp_class_f32 vcc, v4, v101
  s_nop 0
  s_or_b64 s[50:51], s[50:51], vcc
  s_cmp_lg_u64 s[50:51], 0
  s_cbranch_scc1 ASLW_25
ANRM_24:
  v_rcp_f32 v0, v40
  s_nop 0
  v_mul_f32 v32, v0, v32
  v_mul_f32 v33, v0, v33
  v_mul_f32 v34, v0, v34
  v_mul_f32 v35, v0, v35
  v_mul_f32 v36, v0, v36
  v_mul_f32 v37, v0, v37
  v_mul_f32 v38, v0, v38
  v_mul_f32 v39, v0, v39
  v_cvt_pk_bf16_f32 v32, v32, v33
  v_cvt_pk_bf16_f32 v33, v34, v35
  v_cvt_pk_bf16_f32 v34, v36, v37
  v_cvt_pk_bf16_f32 v35, v38, v39
  s_cmp_lg_u32 s39, 0
  s_cbranch_scc1 STS_26
  buffer_store_dwordx4 v[32:35], v95, s[28:31], s46 offen
STD_27:
  v_mbcnt_lo_u32_b32 v214, -1, 0
  v_mbcnt_hi_u32_b32 v214, -1, v214
  s_lshr_b32 s44, s38, 3
  s_lshl_b32 s44, s44, 1
  s_lshl_b32 s45, s37, 3
  s_add_u32 s44, s44, s45
  s_and_b32 s45, s36, 1
  s_add_u32 s44, s44, s45
  s_lshr_b32 s45, s36, 1
  s_and_b32 s47, s38, 7
  s_lshl_b32 s47, s47, 1
  s_add_u32 s47, s47, s45
  v_lshlrev_b32 v216, 4, v214
  s_lshr_b32 s71, s44, 2
  s_mul_i32 s71, s71, 737280
  s_and_b32 s53, s44, 3
  s_lshl_b32 s46, s53, 15
  s_lshl_b32 s48, s45, 14
  s_add_u32 s46, s46, s48
  s_add_u32 s46, s46, s62
  s_add_u32 s46, s46, 458752
  s_add_u32 s46, s46, s71
  v_mbcnt_lo_u32_b32 v224, -1, 0
  v_mbcnt_hi_u32_b32 v224, -1, v224
  s_lshl_b32 s50, s37, 10
  s_lshr_b32 s51, s38, 3
  s_lshl_b32 s51, s51, 1
  s_and_b32 s52, s36, 1
  s_add_u32 s51, s51, s52
  s_lshl_b32 s51, s51, 7
  s_add_u32 s50, s50, s51
  s_lshr_b32 s51, s36, 1
  s_lshl_b32 s51, s51, 6
  s_add_u32 s50, s50, s51
  v_and_b32 v224, 15, v224
  v_lshl_add_u32 v224, v224, 2, s50
  s_waitcnt vmcnt(0)
  s_mov_b64 exec, 1
  s_cmp_lg_u32 s39, 0
  s_cbranch_scc1 STS_28
  global_store_dword v90, v91, s[34:35]
STD_29:
  s_mov_b64 exec, -1
  s_setprio 1
  global_load_dword v225, v224, s[34:35] sc1
  s_barrier
  v_lshlrev_b32 v128, 16, v248
  v_and_b32 v129, 0xffff0000, v248
  v_lshlrev_b32 v130, 16, v249
  v_and_b32 v131, 0xffff0000, v249
  v_lshlrev_b32 v132, 16, v250
  v_and_b32 v133, 0xffff0000, v250
  v_lshlrev_b32 v134, 16, v251
  v_and_b32 v135, 0xffff0000, v251
  v_lshlrev_b32 v136, 16, v252
  v_and_b32 v137, 0xffff0000, v252
  v_lshlrev_b32 v138, 16, v253
  v_and_b32 v139, 0xffff0000, v253
  v_lshlrev_b32 v140, 16, v254
  v_and_b32 v141, 0xffff0000, v254
  v_lshlrev_b32 v142, 16, v255
  v_and_b32 v143, 0xffff0000, v255
  v_bfe_u32 v220, v214, 2, 2
  v_bfe_u32 v221, v214, 4, 1
  v_lshlrev_b32 v221, 5, v221
  v_and_b32 v222, 3, v214
  v_lshl_add_u32 v221, v222, 3, v221
  v_lshrrev_b32 v222, 5, v214
  v_lshl_add_u32 v208, v222, 2, v220
  v_lshlrev_b32 v208, 7, v208
  v_add_u32 v208, v208, v221
  v_lshrrev_b32 v209, 1, v220
  v_xor_b32 v209, s45, v209
  v_lshl_add_u32 v208, v209, 6, v208
  v_xor_b32 v209, 64, v208
  s_lshl_b32 s48, s45, 15
  v_add_u32 v208, s48, v208
  v_add_u32 v209, s48, v209
  s_lshl_b32 s48, s36, 12
  s_add_u32 s48, s48, 65536
  v_add_u32 v217, s48, v216
  s_xor_b32 s48, s48, 8192
  v_add_u32 v218, s48, v216
  s_add_u32 s51, s41, 2
  s_mov_b32 s50, 0x20000
POLL_35:
  global_load_dword v226, v224, s[34:35] sc1
  s_waitcnt vmcnt(1)
  v_cmp_gt_u32 vcc, s51, v225
  s_nop 0
  s_cbranch_vccz POLLX_36
  global_load_dword v225, v224, s[34:35] sc1
  s_waitcnt vmcnt(1)
  v_cmp_gt_u32 vcc, s51, v226
  s_nop 0
  s_cbranch_vccz POLLX_36
  s_sub_u32 s50, s50, 1
  s_cmp_lg_u32 s50, 0
  s_cbranch_scc1 POLL_35
POLLX_36:
  buffer_load_dwordx4 v[0:3], v216, s[28:31], s46 offen offset:0 sc1
  buffer_load_dwordx4 v[4:7], v216, s[28:31], s46 offen offset:1024 sc1
  buffer_load_dwordx4 v[8:11], v216, s[28:31], s46 offen offset:2048 sc1
  buffer_load_dwordx4 v[12:15], v216, s[28:31], s46 offen offset:3072 sc1
  s_add_u32 s46, s46, 4096
  buffer_load_dwordx4 v[16:19], v216, s[28:31], s46 offen offset:0 sc1
  buffer_load_dwordx4 v[20:23], v216, s[28:31], s46 offen offset:1024 sc1
  buffer_load_dwordx4 v[24:27], v216, s[28:31], s46 offen offset:2048 sc1
  buffer_load_dwordx4 v[28:31], v216, s[28:31], s46 offen offset:3072 sc1
  s_add_u32 s46, s46, 4096
  buffer_load_dwordx4 v[32:35], v216, s[28:31], s46 offen offset:0 sc1
  buffer_load_dwordx4 v[36:39], v216, s[28:31], s46 offen offset:1024 sc1
  ds_read_b64_tr_b16 v[176:177], v208 offset:0
  ds_read_b64_tr_b16 v[178:179], v208 offset:1024
  ds_read_b64_tr_b16 v[180:181], v209 offset:0
  ds_read_b64_tr_b16 v[182:183], v209 offset:1024
  ds_read_b64_tr_b16 v[184:185], v208 offset:2048
  ds_read_b64_tr_b16 v[186:187], v208 offset:3072
  ds_read_b64_tr_b16 v[188:189], v209 offset:2048
  ds_read_b64_tr_b16 v[190:191], v209 offset:3072
  ds_read_b64_tr_b16 v[192:193], v208 offset:4096
  ds_read_b64_tr_b16 v[194:195], v208 offset:5120
  ds_read_b64_tr_b16 v[196:197], v209 offset:4096
  ds_read_b64_tr_b16 v[198:199], v209 offset:5120
  s_waitcnt vmcnt(9) lgkmcnt(10)
  v_mfma_f32_32x32x16_bf16 v[128:143], v[176:179], v[0:3], v[128:143]
  ds_read_b64_tr_b16 v[200:201], v208 offset:6144
  ds_read_b64_tr_b16 v[202:203], v208 offset:7168
  s_waitcnt lgkmcnt(10)
  v_mfma_f32_32x32x16_bf16 v[144:159], v[180:183], v[0:3], 0
  ds_read_b64_tr_b16 v[204:205], v209 offset:6144
  ds_read_b64_tr_b16 v[206:207], v209 offset:7168
  buffer_load_dwordx4 v[40:43], v216, s[28:31], s46 offen offset:2048 sc1
  s_waitcnt vmcnt(9) lgkmcnt(10)
  v_mfma_f32_32x32x16_bf16 v[128:143], v[184:187], v[4:7], v[128:143]
  ds_read_b64_tr_b16 v[176:177], v208 offset:8192
  ds_read_b64_tr_b16 v[178:179], v208 offset:9216
  s_waitcnt lgkmcnt(10)
  v_mfma_f32_32x32x16_bf16 v[144:159], v[188:191], v[4:7], v[144:159]
  ds_read_b64_tr_b16 v[180:181], v209 offset:8192
  ds_read_b64_tr_b16 v[182:183], v209 offset:9216
  buffer_load_dwordx4 v[44:47], v216, s[28:31], s46 offen offset:3072 sc1
  s_waitcnt vmcnt(9) lgkmcnt(10)
  v_mfma_f32_32x32x16_bf16 v[128:143], v[192:195], v[8:11], v[128:143]
  ds_read_b64_tr_b16 v[184:185], v208 offset:10240
  ds_read_b64_tr_b16 v[186:187], v208 offset:11264
  s_waitcnt lgkmcnt(10)
  v_mfma_f32_32x32x16_bf16 v[144:159], v[196:199], v[8:11], v[144:159]
  ds_read_b64_tr_b16 v[188:189], v209 offset:10240
  ds_read_b64_tr_b16 v[190:191], v209 offset:11264
  s_add_u32 s46, s46, 4096
  buffer_load_dwordx4 v[48:51], v216, s[28:31], s46 offen offset:0 sc1
  s_waitcnt vmcnt(9) lgkmcnt(10)
  v_mfma_f32_32x32x16_bf16 v[128:143], v[200:203], v[12:15], v[128:143]
  ds_read_b64_tr_b16 v[192:193], v208 offset:12288
  ds_read_b64_tr_b16 v[194:195], v208 offset:13312
  s_waitcnt lgkmcnt(10)
  v_mfma_f32_32x32x16_bf16 v[144:159], v[204:207], v[12:15], v[144:159]
  ds_read_b64_tr_b16 v[196:197], v209 offset:12288
  ds_read_b64_tr_b16 v[198:199], v209 offset:13312
  buffer_load_dwordx4 v[52:55], v216, s[28:31], s46 offen offset:1024 sc1
  s_waitcnt vmcnt(9) lgkmcnt(10)
  v_mfma_f32_32x32x16_bf16 v[128:143], v[176:179], v[16:19], v[128:143]
  ds_read_b64_tr_b16 v[200:201], v208 offset:14336
  ds_read_b64_tr_b16 v[202:203], v208 offset:15360
  s_waitcnt lgkmcnt(10)
  v_mfma_f32_32x32x16_bf16 v[144:159], v[180:183], v[16:19], v[144:159]
  ds_read_b64_tr_b16 v[204:205], v209 offset:14336
  ds_read_b64_tr_b16 v[206:207], v209 offset:15360
  buffer_load_dwordx4 v[56:59], v216, s[28:31], s46 offen offset:2048 sc1
  s_waitcnt vmcnt(9) lgkmcnt(10)
  v_mfma_f32_32x32x16_bf16 v[128:143], v[184:187], v[20:23], v[128:143]
  ds_read_b64_tr_b16 v[176:177], v208 offset:16384
  ds_read_b64_tr_b16 v[178:179], v208 offset:17408
  s_waitcnt lgkmcnt(10)
  v_mfma_f32_32x32x16_bf16 v[144:159], v[188:191], v[20:23], v[144:159]
  ds_read_b64_tr_b16 v[180:181], v209 offset:16384
  ds_read_b64_tr_b16 v[182:183], v209 offset:17408
  buffer_load_dwordx4 v[60:63], v216, s[28:31], s46 offen offset:3072 sc1
  s_barrier
  s_waitcnt vmcnt(9) lgkmcnt(10)
  v_mfma_f32_32x32x16_bf16 v[128:143], v[192:195], v[24:27], v[128:143]
  ds_read_b64_tr_b16 v[184:185], v208 offset:18432
  ds_read_b64_tr_b16 v[186:187], v208 offset:19456
  s_waitcnt lgkmcnt(10)
  v_mfma_f32_32x32x16_bf16 v[144:159], v[196:199], v[24:27], v[144:159]
  ds_read_b64_tr_b16 v[188:189], v209 offset:18432
  ds_read_b64_tr_b16 v[190:191], v209 offset:19456
  s_waitcnt vmcnt(8) lgkmcnt(10)
  v_mfma_f32_32x32x16_bf16 v[128:143], v[200:203], v[28:31], v[128:143]
  ds_read_b64_tr_b16 v[192:193], v209 offset:20480
  ds_read_b64_tr_b16 v[194:195], v209 offset:21504
  s_waitcnt lgkmcnt(10)
  v_mfma_f32_32x32x16_bf16 v[144:159], v[204:207], v[28:31], v[144:159]
  ds_read_b64_tr_b16 v[196:197], v209 offset:22528
  ds_read_b64_tr_b16 v[198:199], v209 offset:23552
  s_waitcnt vmcnt(7) lgkmcnt(10)
  v_mfma_f32_32x32x16_bf16 v[128:143], v[176:179], v[32:35], v[128:143]
  ds_read_b64_tr_b16 v[200:201], v209 offset:24576
  ds_read_b64_tr_b16 v[202:203], v209 offset:25600
  s_waitcnt lgkmcnt(10)
  v_mfma_f32_32x32x16_bf16 v[144:159], v[180:183], v[32:35], v[144:159]
  ds_read_b64_tr_b16 v[204:205], v209 offset:26624
  ds_read_b64_tr_b16 v[206:207], v209 offset:27648
  s_waitcnt vmcnt(6) lgkmcnt(10)
  v_mfma_f32_32x32x16_bf16 v[128:143], v[184:187], v[36:39], v[128:143]
  ds_read_b64_tr_b16 v[176:177], v209 offset:28672
  ds_read_b64_tr_b16 v[178:179], v209 offset:29696
  s_waitcnt lgkmcnt(10)
  v_mfma_f32_32x32x16_bf16 v[144:159], v[188:191], v[36:39], v[144:159]
  ds_read_b64_tr_b16 v[180:181], v209 offset:30720
  ds_read_b64_tr_b16 v[182:183], v209 offset:31744
  s_waitcnt vmcnt(5) lgkmcnt(10)
  v_mfma_f32_32x32x16_bf16 v[144:159], v[192:195], v[40:43], v[144:159]
  ds_read_b64_tr_b16 v[184:185], v208 offset:20480
  ds_read_b64_tr_b16 v[186:187], v208 offset:21504
  s_waitcnt vmcnt(4) lgkmcnt(10)
  v_mfma_f32_32x32x16_bf16 v[144:159], v[196:199], v[44:47], v[144:159]
  ds_read_b64_tr_b16 v[188:189], v208 offset:22528
  ds_read_b64_tr_b16 v[190:191], v208 offset:23552
  s_waitcnt vmcnt(3) lgkmcnt(10)
  v_mfma_f32_32x32x16_bf16 v[144:159], v[200:203], v[48:51], v[144:159]
  ds_read_b64_tr_b16 v[192:193], v208 offset:24576
  ds_read_b64_tr_b16 v[194:195], v208 offset:25600
  s_waitcnt vmcnt(2) lgkmcnt(10)
  v_mfma_f32_32x32x16_bf16 v[144:159], v[204:207], v[52:55], v[144:159]
  ds_read_b64_tr_b16 v[196:197], v208 offset:26624
  ds_read_b64_tr_b16 v[198:199], v208 offset:27648
  s_waitcnt vmcnt(1) lgkmcnt(10)
  v_mfma_f32_32x32x16_bf16 v[144:159], v[176:179], v[56:59], v[144:159]
  ds_read_b64_tr_b16 v[200:201], v208 offset:28672
  ds_read_b64_tr_b16 v[202:203], v208 offset:29696
  s_waitcnt vmcnt(0) lgkmcnt(10)
  v_mfma_f32_32x32x16_bf16 v[144:159], v[180:183], v[60:63], v[144:159]
  ds_read_b64_tr_b16 v[204:205], v208 offset:30720
  ds_read_b64_tr_b16 v[206:207], v208 offset:31744
  s_waitcnt lgkmcnt(10)
  v_mfma_f32_32x32x16_bf16 v[128:143], v[184:187], v[40:43], v[128:143]
  s_add_u32 s71, s71, s63
  s_lshl_b32 s46, s53, 15
  s_lshl_b32 s48, s47, 11
  s_add_u32 s46, s46, s48
  s_add_u32 s46, s46, s71
  s_add_u32 s46, s46, 589824
  s_lshl_b32 s49, s53, 12
  s_lshr_b32 s48, s47, 2
  s_lshl_b32 s48, s48, 10
  s_add_u32 s49, s49, s48
  s_and_b32 s48, s47, 3
  s_lshl_b32 s48, s48, 2
  s_add_u32 s49, s49, s48
  s_add_u32 s49, s49, s71
  s_add_u32 s49, s49, 720896
  s_waitcnt lgkmcnt(8)
  v_mfma_f32_32x32x16_bf16 v[128:143], v[188:191], v[44:47], v[128:143]
  ds_write_b128 v217, v[144:147] offset:0
  ds_write_b128 v217, v[148:151] offset:1024
  s_waitcnt lgkmcnt(8)
  v_mfma_f32_32x32x16_bf16 v[128:143], v[192:195], v[48:51], v[128:143]
  ds_write_b128 v217, v[152:155] offset:2048
  ds_write_b128 v217, v[156:159] offset:3072
  v_mov_b32 v224, 0
  v_mov_b32 v225, 0
  v_mov_b32 v226, 0
  v_mov_b32 v227, 0
  s_waitcnt lgkmcnt(8)
  v_mfma_f32_32x32x16_bf16 v[128:143], v[196:199], v[52:55], v[128:143]
  s_waitcnt lgkmcnt(0)
  s_barrier
  ds_read_b128 v[144:147], v218 offset:0
  ds_read_b128 v[148:151], v218 offset:1024
  ds_read_b128 v[152:155], v218 offset:2048
  ds_read_b128 v[156:159], v218 offset:3072
  v_mfma_f32_32x32x16_bf16 v[128:143], v[200:203], v[56:59], v[128:143]
  v_mfma_f32_32x32x16_bf16 v[128:143], v[204:207], v[60:63], v[128:143]
  s_nop 11
  s_waitcnt lgkmcnt(3)
  v_add_f32 v128, v128, v144
  v_add_f32 v129, v129, v145
  v_add_f32 v130, v130, v146
  v_add_f32 v131, v131, v147
  v_cvt_pk_bf16_f32 v248, v128, v129
  v_cvt_pk_bf16_f32 v249, v130, v131
  s_waitcnt lgkmcnt(2)
  v_add_f32 v132, v132, v148
  v_add_f32 v133, v133, v149
  v_add_f32 v134, v134, v150
  v_add_f32 v135, v135, v151
  v_cvt_pk_bf16_f32 v250, v132, v133
  v_cvt_pk_bf16_f32 v251, v134, v135
  s_waitcnt lgkmcnt(1)
  v_add_f32 v136, v136, v152
  v_add_f32 v137, v137, v153
  v_add_f32 v138, v138, v154
  v_add_f32 v139, v139, v155
  v_cvt_pk_bf16_f32 v252, v136, v137
  v_cvt_pk_bf16_f32 v253, v138, v139
  s_waitcnt lgkmcnt(0)
  v_add_f32 v140, v140, v156
  v_add_f32 v141, v141, v157
  v_add_f32 v142, v142, v158
  v_add_f32 v143, v143, v159
  v_cvt_pk_bf16_f32 v254, v140, v141
  v_cvt_pk_bf16_f32 v255, v142, v143
  s_cmp_lg_u32 s39, 0
  s_cbranch_scc1 STS_37
  buffer_store_dwordx4 v[248:251], v216, s[28:31], s46 offen
  buffer_store_dwordx4 v[252:255], v216, s[28:31], s46 offen offset:1024
STD_38:
  v_dot2c_f32_bf16 v224, 0x3f803f80, v248
  v_dot2c_f32_bf16 v226, v248, v248
  v_dot2c_f32_bf16 v225, 0x3f803f80, v249
  v_dot2c_f32_bf16 v227, v249, v249
  v_dot2c_f32_bf16 v224, 0x3f803f80, v250
  v_dot2c_f32_bf16 v226, v250, v250
  v_dot2c_f32_bf16 v225, 0x3f803f80, v251
  v_dot2c_f32_bf16 v227, v251, v251
  v_dot2c_f32_bf16 v224, 0x3f803f80, v252
  v_dot2c_f32_bf16 v226, v252, v252
  v_dot2c_f32_bf16 v225, 0x3f803f80, v253
  v_dot2c_f32_bf16 v227, v253, v253
  v_dot2c_f32_bf16 v224, 0x3f803f80, v254
  v_dot2c_f32_bf16 v226, v254, v254
  v_dot2c_f32_bf16 v225, 0x3f803f80, v255
  v_dot2c_f32_bf16 v227, v255, v255
  s_nop 2
  v_add_f32 v224, v224, v225
  v_add_f32 v226, v226, v227
  s_nop 1
  v_permlane32_swap_b32 v224, v226
  v_add_f32 v224, v224, v226
  s_cmp_lg_u32 s39, 0
  s_cbranch_scc1 STS_39
  buffer_store_dword v224, v216, s[28:31], s49 offen
STD_40:
  s_setprio 0
  s_lshl_b32 s48, s36, 10
  s_add_u32 s48, s48, 30720
  v_add_u32 v219, s48, v216
  s_lshl_b32 s51, s36, 7
  s_lshl_b32 s50, s37, 10
  s_add_u32 s50, s50, s51
  s_lshl_b32 s51, s38, 2
  s_add_u32 s50, s50, s51
  s_add_u32 s51, s41, 3
  v_mov_b32 v226, s50
  v_mov_b32 v227, s51
  v_mbcnt_lo_u32_b32 v245, -1, 0
  v_mbcnt_hi_u32_b32 v245, -1, v245
  s_lshr_b32 s44, s38, 4
  s_lshl_b32 s45, s37, 1
  s_add_u32 s44, s44, s45
  s_mul_i32 s44, s44, 737280
  v_lshlrev_b32 v245, 4, v245
  s_add_u32 s55, s44, s63
  s_lshl_b32 s45, s36, 12
  s_add_u32 s45, s45, s55
  s_add_u32 s45, s45, 720896
  s_lshl_b32 s48, s36, 15
  s_add_u32 s55, s55, s48
  s_add_u32 s55, s55, 589824
  v_mbcnt_lo_u32_b32 v228, -1, 0
  v_mbcnt_hi_u32_b32 v228, -1, v228
  s_lshl_b32 s50, s37, 10
  s_and_b32 s51, s36, 1
  s_lshl_b32 s51, s51, 7
  s_add_u32 s50, s50, s51
  s_lshr_b32 s51, s38, 4
  s_lshl_b32 s51, s51, 1
  s_lshr_b32 s52, s36, 1
  s_add_u32 s51, s51, s52
  s_lshl_b32 s51, s51, 5
  s_add_u32 s50, s50, s51
  v_bfe_u32 v229, v228, 3, 1
  v_and_b32 v228, 7, v228
  v_lshl_add_u32 v228, v228, 2, s50
  v_lshl_add_u32 v228, v229, 8, v228
  s_waitcnt vmcnt(0)
  s_mov_b64 exec, 1
  s_cmp_lg_u32 s39, 0
  s_cbranch_scc1 STS_43
  global_store_dword v226, v227, s[34:35]
STD_44:
  s_mov_b64 exec, -1
  global_load_dword v229, v228, s[34:35] sc1
  ds_write_b128 v219, v[104:107] offset:0
  ds_write_b128 v219, v[108:111] offset:4096
  ds_write_b128 v219, v[112:115] offset:8192
  ds_write_b128 v219, v[116:119] offset:12288
  ds_write_b128 v219, v[120:123] offset:16384
  ds_write_b128 v219, v[124:127] offset:20480
  ds_write_b128 v219, v[160:163] offset:24576
  ds_write_b128 v219, v[164:167] offset:28672
  s_barrier
  ds_write_b128 v219, v[168:171] offset:32768
  ds_write_b128 v219, v[172:175] offset:36864
  ds_write_b128 v219, v[232:235] offset:40960
  ds_write_b128 v219, v[236:239] offset:45056
  s_cmp_ge_u32 s36, 2
  s_cbranch_scc1 WRX_53
  ds_write_b128 v219, v[240:243] offset:49152
WRX_53:
  v_mbcnt_lo_u32_b32 v224, -1, 0
  v_mbcnt_hi_u32_b32 v224, -1, v224
  s_waitcnt lgkmcnt(0)
  s_barrier
  s_and_b32 s47, s38, 15
  s_cmp_ge_u32 s47, 14
  s_cbranch_scc1 W1I_50
  s_add_u32 s51, s41, 3
  s_mov_b32 s50, 0x20000
POLL_54:
  global_load_dword v230, v228, s[34:35] sc1
  s_waitcnt vmcnt(1)
  v_cmp_gt_u32 vcc, s51, v229
  s_nop 0
  s_cbranch_vccz POLLX_55
  global_load_dword v229, v228, s[34:35] sc1
  s_waitcnt vmcnt(1)
  v_cmp_gt_u32 vcc, s51, v230
  s_nop 0
  s_cbranch_vccz POLLX_55
  s_sub_u32 s50, s50, 1
  s_cmp_lg_u32 s50, 0
  s_cbranch_scc1 POLL_54
POLLX_55:
  buffer_load_dwordx4 v[0:3], v245, s[28:31], s55 offen offset:0 sc1
  buffer_load_dwordx4 v[4:7], v245, s[28:31], s55 offen offset:1024 sc1
  buffer_load_dwordx4 v[8:11], v245, s[28:31], s55 offen offset:2048 sc1
  buffer_load_dwordx4 v[12:15], v245, s[28:31], s55 offen offset:3072 sc1
  buffer_load_dwordx4 v[160:163], v245, s[28:31], s45 offen offset:0 sc1
  buffer_load_dwordx4 v[164:167], v245, s[28:31], s45 offen offset:1024 sc1
  buffer_load_dwordx4 v[168:171], v245, s[28:31], s45 offen offset:2048 sc1
  buffer_load_dwordx4 v[172:175], v245, s[28:31], s45 offen offset:3072 sc1
  s_add_u32 s55, s55, 4096
  buffer_load_dwordx4 v[16:19], v245, s[28:31], s55 offen offset:0 sc1
  buffer_load_dwordx4 v[20:23], v245, s[28:31], s55 offen offset:1024 sc1
  buffer_load_dwordx4 v[24:27], v245, s[28:31], s55 offen offset:2048 sc1
  buffer_load_dwordx4 v[28:31], v245, s[28:31], s55 offen offset:3072 sc1
  s_add_u32 s55, s55, 4096
  buffer_load_dwordx4 v[32:35], v245, s[28:31], s55 offen offset:0 sc1
  buffer_load_dwordx4 v[36:39], v245, s[28:31], s55 offen offset:1024 sc1
  v_bfe_u32 v232, v224, 2, 2
  v_bfe_u32 v233, v224, 4, 1
  v_lshlrev_b32 v233, 5, v233
  v_and_b32 v234, 3, v224
  v_lshl_add_u32 v233, v234, 3, v233
  v_lshrrev_b32 v234, 5, v224
  v_lshl_add_u32 v216, v234, 2, v232
  v_lshlrev_b32 v216, 7, v216
  v_add_u32 v216, v216, v233
  v_lshrrev_b32 v217, 1, v232
  v_xor_b32 v217, 0, v217
  v_lshl_add_u32 v216, v217, 6, v216
  v_xor_b32 v217, 64, v216
  v_add_u32 v218, 30720, v216
  v_add_u32 v222, 63488, v216
  v_add_u32 v220, 129024, v216
  v_add_u32 v216, 96256, v216
  v_add_u32 v219, 30720, v217
  v_add_u32 v223, 63488, v217
  v_add_u32 v221, 129024, v217
  v_add_u32 v217, 96256, v217
  v_and_b32 v227, 31, v224
  v_lshlrev_b32 v227, 2, v227
  v_add_u32 v227, 162304, v227
  s_mul_i32 s46, s36, 114688
  s_lshl_b32 s48, s47, 13
  s_add_u32 s46, s46, s48
  s_add_u32 s46, s46, s44
  s_add_u32 s46, s46, s64
  s_add_u32 s48, s46, 4096
  ds_read_b64_tr_b16 v[192:193], v216 offset:0
  ds_read_b64_tr_b16 v[194:195], v216 offset:1024
  ds_read_b64_tr_b16 v[196:197], v217 offset:0
  ds_read_b64_tr_b16 v[198:199], v217 offset:1024
  ds_read_b64_tr_b16 v[200:201], v216 offset:2048
  ds_read_b64_tr_b16 v[202:203], v216 offset:3072
  ds_read_b64_tr_b16 v[204:205], v217 offset:2048
  ds_read_b64_tr_b16 v[206:207], v217 offset:3072
  ds_read_b64_tr_b16 v[208:209], v216 offset:4096
  ds_read_b64_tr_b16 v[210:211], v216 offset:5120
  s_waitcnt vmcnt(13) lgkmcnt(8)
  v_mfma_f32_32x32x16_bf16 v[128:143], v[192:195], v[0:3], 0
  ds_read_b64_tr_b16 v[212:213], v217 offset:4096
  ds_read_b64_tr_b16 v[214:215], v217 offset:5120
  s_waitcnt lgkmcnt(8)
  v_mfma_f32_32x32x16_bf16 v[144:159], v[196:199], v[0:3], 0
  ds_read_b64_tr_b16 v[192:193], v216 offset:6144
  ds_read_b64_tr_b16 v[194:195], v216 offset:7168
  buffer_load_dwordx4 v[40:43], v245, s[28:31], s55 offen offset:2048 sc1
  s_waitcnt vmcnt(13) lgkmcnt(8)
  v_mfma_f32_32x32x16_bf16 v[128:143], v[200:203], v[4:7], v[128:143]
  ds_read_b64_tr_b16 v[196:197], v217 offset:6144
  ds_read_b64_tr_b16 v[198:199], v217 offset:7168
  s_waitcnt lgkmcnt(8)
  v_mfma_f32_32x32x16_bf16 v[144:159], v[204:207], v[4:7], v[144:159]
  ds_read_b64_tr_b16 v[200:201], v216 offset:8192
  ds_read_b64_tr_b16 v[202:203], v216 offset:9216
  buffer_load_dwordx4 v[44:47], v245, s[28:31], s55 offen offset:3072 sc1
  s_waitcnt vmcnt(13) lgkmcnt(8)
  v_mfma_f32_32x32x16_bf16 v[128:143], v[208:211], v[8:11], v[128:143]
  ds_read_b64_tr_b16 v[204:205], v217 offset:8192
  ds_read_b64_tr_b16 v[206:207], v217 offset:9216
  s_waitcnt lgkmcnt(8)
  v_mfma_f32_32x32x16_bf16 v[144:159], v[212:215], v[8:11], v[144:159]
  ds_read_b64_tr_b16 v[208:209], v216 offset:10240
  ds_read_b64_tr_b16 v[210:211], v216 offset:11264
  s_add_u32 s55, s55, 4096
  buffer_load_dwordx4 v[48:51], v245, s[28:31], s55 offen offset:0 sc1
  s_waitcnt vmcnt(13) lgkmcnt(8)
  v_mfma_f32_32x32x16_bf16 v[128:143], v[192:195], v[12:15], v[128:143]
  ds_read_b64_tr_b16 v[212:213], v217 offset:10240
  ds_read_b64_tr_b16 v[214:215], v217 offset:11264
  s_waitcnt lgkmcnt(8)
  v_mfma_f32_32x32x16_bf16 v[144:159], v[196:199], v[12:15], v[144:159]
  ds_read_b64_tr_b16 v[192:193], v216 offset:12288
  ds_read_b64_tr_b16 v[194:195], v216 offset:13312
  buffer_load_dwordx4 v[52:55], v245, s[28:31], s55 offen offset:1024 sc1
  s_waitcnt vmcnt(9) lgkmcnt(8)
  v_mfma_f32_32x32x16_bf16 v[128:143], v[200:203], v[16:19], v[128:143]
  ds_read_b64_tr_b16 v[196:197], v217 offset:12288
  ds_read_b64_tr_b16 v[198:199], v217 offset:13312
  v_add_f32 v160, v160, v168
  v_add_f32 v161, v161, v169
  s_waitcnt lgkmcnt(8)
  v_mfma_f32_32x32x16_bf16 v[144:159], v[204:207], v[16:19], v[144:159]
  ds_read_b64_tr_b16 v[200:201], v216 offset:14336
  ds_read_b64_tr_b16 v[202:203], v216 offset:15360
  buffer_load_dwordx4 v[56:59], v245, s[28:31], s55 offen offset:2048 sc1
  v_add_f32 v162, v162, v170
  v_add_f32 v163, v163, v171
  s_waitcnt vmcnt(9) lgkmcnt(8)
  v_mfma_f32_32x32x16_bf16 v[128:143], v[208:211], v[20:23], v[128:143]
  ds_read_b64_tr_b16 v[204:205], v217 offset:14336
  ds_read_b64_tr_b16 v[206:207], v217 offset:15360
  v_add_f32 v164, v164, v172
  v_add_f32 v165, v165, v173
  s_waitcnt lgkmcnt(8)
  v_mfma_f32_32x32x16_bf16 v[144:159], v[212:215], v[20:23], v[144:159]
  ds_read_b64_tr_b16 v[208:209], v216 offset:16384
  ds_read_b64_tr_b16 v[210:211], v216 offset:17408
  buffer_load_dwordx4 v[60:63], v245, s[28:31], s55 offen offset:3072 sc1
  v_add_f32 v166, v166, v174
  v_add_f32 v167, v167, v175
  s_waitcnt vmcnt(9) lgkmcnt(8)
  v_mfma_f32_32x32x16_bf16 v[128:143], v[192:195], v[24:27], v[128:143]
  ds_read_b64_tr_b16 v[212:213], v217 offset:16384
  ds_read_b64_tr_b16 v[214:215], v217 offset:17408
  v_add_f32 v160, v160, v164
  v_add_f32 v161, v161, v165
  s_waitcnt lgkmcnt(8)
  v_mfma_f32_32x32x16_bf16 v[144:159], v[196:199], v[24:27], v[144:159]
  ds_read_b64_tr_b16 v[192:193], v216 offset:18432
  ds_read_b64_tr_b16 v[194:195], v216 offset:19456
  s_add_u32 s55, s55, 4096
  buffer_load_dwordx4 v[64:67], v245, s[28:31], s55 offen offset:0 sc1
  v_add_f32 v162, v162, v166
  v_add_f32 v163, v163, v167
  s_waitcnt vmcnt(9) lgkmcnt(8)
  v_mfma_f32_32x32x16_bf16 v[128:143], v[200:203], v[28:31], v[128:143]
  ds_read_b64_tr_b16 v[196:197], v217 offset:18432
  ds_read_b64_tr_b16 v[198:199], v217 offset:19456
  v_add_f32 v160, v160, v162
  v_add_f32 v161, v161, v163
  s_waitcnt lgkmcnt(8)
  v_mfma_f32_32x32x16_bf16 v[144:159], v[204:207], v[28:31], v[144:159]
  ds_read_b64_tr_b16 v[200:201], v216 offset:20480
  ds_read_b64_tr_b16 v[202:203], v216 offset:21504
  buffer_load_dwordx4 v[68:71], v245, s[28:31], s55 offen offset:1024 sc1
  v_add_f32 v160, v160, v161
  v_mov_b32 v228, v160
  s_waitcnt vmcnt(9) lgkmcnt(8)
  v_mfma_f32_32x32x16_bf16 v[128:143], v[208:211], v[32:35], v[128:143]
  ds_read_b64_tr_b16 v[204:205], v217 offset:20480
  ds_read_b64_tr_b16 v[206:207], v217 offset:21504
  v_mov_b32 v229, v160
  s_nop 1
  s_waitcnt lgkmcnt(8)
  v_mfma_f32_32x32x16_bf16 v[144:159], v[212:215], v[32:35], v[144:159]
  ds_read_b64_tr_b16 v[208:209], v216 offset:22528
  ds_read_b64_tr_b16 v[210:211], v216 offset:23552
  buffer_load_dwordx4 v[72:75], v245, s[28:31], s55 offen offset:2048 sc1
  v_permlane32_swap_b32 v228, v229
  v_mul_f32 v228, 0xbb000000, v228
  s_waitcnt vmcnt(9) lgkmcnt(8)
  v_mfma_f32_32x32x16_bf16 v[128:143], v[192:195], v[36:39], v[128:143]
  ds_read_b64_tr_b16 v[212:213], v217 offset:22528
  ds_read_b64_tr_b16 v[214:215], v217 offset:23552
  v_mul_f32 v229, 0x3b000000, v229
  v_fma_f32 v229, -v228, v228, v229
  s_waitcnt lgkmcnt(8)
  v_mfma_f32_32x32x16_bf16 v[144:159], v[196:199], v[36:39], v[144:159]
  ds_read_b64_tr_b16 v[192:193], v216 offset:24576
  ds_read_b64_tr_b16 v[194:195], v216 offset:25600
  buffer_load_dwordx4 v[76:79], v245, s[28:31], s55 offen offset:3072 sc1
  v_max_f32 v229, 0, v229
  v_add_f32 v229, 0x3727c5ac, v229
  s_waitcnt vmcnt(9) lgkmcnt(8)
  v_mfma_f32_32x32x16_bf16 v[128:143], v[200:203], v[40:43], v[128:143]
  ds_read_b64_tr_b16 v[196:197], v217 offset:24576
  ds_read_b64_tr_b16 v[198:199], v217 offset:25600
  v_rsq_f32 v225, v229
  v_cmp_gt_u32 vcc, 32, v224
  s_waitcnt lgkmcnt(8)
  v_mfma_f32_32x32x16_bf16 v[144:159], v[204:207], v[40:43], v[144:159]
  ds_read_b64_tr_b16 v[200:201], v216 offset:26624
  ds_read_b64_tr_b16 v[202:203], v216 offset:27648
  s_add_u32 s55, s55, 4096
  buffer_load_dwordx4 v[80:83], v245, s[28:31], s55 offen offset:0 sc1
  v_cvt_pk_bf16_f32 v232, v228, v228
  v_lshlrev_b32 v229, 16, v232
  s_waitcnt vmcnt(9) lgkmcnt(8)
  v_mfma_f32_32x32x16_bf16 v[128:143], v[208:211], v[44:47], v[128:143]
  ds_read_b64_tr_b16 v[204:205], v217 offset:26624
  ds_read_b64_tr_b16 v[206:207], v217 offset:27648
  v_sub_f32 v228, v228, v229
  v_cvt_pk_bf16_f32 v233, v228, 0
  s_waitcnt lgkmcnt(8)
  v_mfma_f32_32x32x16_bf16 v[144:159], v[212:215], v[44:47], v[144:159]
  ds_read_b64_tr_b16 v[208:209], v216 offset:28672
  ds_read_b64_tr_b16 v[210:211], v216 offset:29696
  buffer_load_dwordx4 v[84:87], v245, s[28:31], s55 offen offset:1024 sc1
  v_cndmask_b32 v232, 0, v232, vcc
  v_cndmask_b32 v233, 0, v233, vcc
  s_waitcnt vmcnt(9) lgkmcnt(8)
  v_mfma_f32_32x32x16_bf16 v[128:143], v[192:195], v[48:51], v[128:143]
  ds_read_b64_tr_b16 v[212:213], v217 offset:28672
  ds_read_b64_tr_b16 v[214:215], v217 offset:29696
  v_mov_b32 v234, 0
  v_mov_b32 v235, 0
  s_waitcnt lgkmcnt(8)
  v_mfma_f32_32x32x16_bf16 v[144:159], v[196:199], v[48:51], v[144:159]
  ds_read_b64_tr_b16 v[192:193], v216 offset:30720
  ds_read_b64_tr_b16 v[194:195], v216 offset:31744
  buffer_load_dwordx4 v[88:91], v245, s[28:31], s55 offen offset:2048 sc1
  v_mul_f32 v226, 0xbfb8aa3b, v225
  v_rcp_f32 v225, v225
  s_waitcnt vmcnt(9) lgkmcnt(8)
  v_mfma_f32_32x32x16_bf16 v[128:143], v[200:203], v[52:55], v[128:143]
  ds_read_b64_tr_b16 v[196:197], v217 offset:30720
  ds_read_b64_tr_b16 v[198:199], v217 offset:31744
  v_mbcnt_lo_u32_b32 v244, -1, 0
  v_mbcnt_hi_u32_b32 v244, -1, v244
  v_lshrrev_b32 v176, 3, v244
  v_and_b32 v177, 7, v244
  v_lshlrev_b32 v178, 1, v176
  v_and_b32 v178, 4, v178
  v_xor_b32 v177, v177, v178
  v_mul_u32_u24 v176, 1024, v176
  v_lshl_add_u32 v244, v177, 4, v176
  s_and_b32 s52, s36, 1
  s_mul_i32 s53, s52, 14336
  s_mul_i32 s52, s52, 917504
  s_lshr_b32 s54, s36, 1
  s_lshl_b32 s49, s54, 10
  s_add_u32 s53, s53, s49
  s_lshl_b32 s54, s54, 13
  s_add_u32 s52, s52, s54
  s_and_b32 s54, s38, 7
  s_lshl_b32 s54, s54, 7
  s_add_u32 s52, s52, s54
  s_waitcnt lgkmcnt(8)
  v_mfma_f32_32x32x16_bf16 v[144:159], v[204:207], v[52:55], v[144:159]
  ds_read_b64_tr_b16 v[200:201], v220 offset:0
  ds_read_b64_tr_b16 v[202:203], v220 offset:1024
  buffer_load_dwordx4 v[92:95], v245, s[28:31], s55 offen offset:3072 sc1
  s_waitcnt vmcnt(9) lgkmcnt(8)
  v_mfma_f32_32x32x16_bf16 v[128:143], v[208:211], v[56:59], v[128:143]
  ds_read_b64_tr_b16 v[204:205], v221 offset:0
  ds_read_b64_tr_b16 v[206:207], v221 offset:1024
  s_waitcnt lgkmcnt(8)
  v_mfma_f32_32x32x16_bf16 v[144:159], v[212:215], v[56:59], v[144:159]
  ds_read_b64_tr_b16 v[208:209], v220 offset:2048
  ds_read_b64_tr_b16 v[210:211], v220 offset:3072
  s_add_u32 s55, s55, 4096
  buffer_load_dwordx4 v[96:99], v245, s[28:31], s55 offen offset:0 sc1
  s_waitcnt vmcnt(9) lgkmcnt(8)
  v_mfma_f32_32x32x16_bf16 v[128:143], v[192:195], v[60:63], v[128:143]
  ds_read_b64_tr_b16 v[212:213], v221 offset:2048
  ds_read_b64_tr_b16 v[214:215], v221 offset:3072
  s_waitcnt lgkmcnt(8)
  v_mfma_f32_32x32x16_bf16 v[144:159], v[196:199], v[60:63], v[144:159]
  ds_read_b64_tr_b16 v[192:193], v220 offset:4096
  ds_read_b64_tr_b16 v[194:195], v220 offset:5120
  buffer_load_dwordx4 v[100:103], v245, s[28:31], s55 offen offset:1024 sc1
  s_waitcnt vmcnt(9) lgkmcnt(8)
  v_mfma_f32_32x32x16_bf16 v[128:143], v[200:203], v[64:67], v[128:143]
  ds_read_b64_tr_b16 v[196:197], v221 offset:4096
  ds_read_b64_tr_b16 v[198:199], v221 offset:5120
  s_waitcnt lgkmcnt(8)
  v_mfma_f32_32x32x16_bf16 v[144:159], v[204:207], v[64:67], v[144:159]
  ds_read_b64_tr_b16 v[200:201], v220 offset:6144
  ds_read_b64_tr_b16 v[202:203], v220 offset:7168
  buffer_load_dwordx4 v[104:107], v245, s[28:31], s55 offen offset:2048 sc1
  s_waitcnt vmcnt(9) lgkmcnt(8)
  v_mfma_f32_32x32x16_bf16 v[128:143], v[208:211], v[68:71], v[128:143]
  ds_read_b64_tr_b16 v[204:205], v221 offset:6144
  ds_read_b64_tr_b16 v[206:207], v221 offset:7168
  s_waitcnt lgkmcnt(8)
  v_mfma_f32_32x32x16_bf16 v[144:159], v[212:215], v[68:71], v[144:159]
  ds_read_b64_tr_b16 v[208:209], v220 offset:8192
  ds_read_b64_tr_b16 v[210:211], v220 offset:9216
  buffer_load_dwordx4 v[108:111], v245, s[28:31], s55 offen offset:3072 sc1
  s_waitcnt vmcnt(9) lgkmcnt(8)
  v_mfma_f32_32x32x16_bf16 v[128:143], v[192:195], v[72:75], v[128:143]
  ds_read_b64_tr_b16 v[212:213], v221 offset:8192
  ds_read_b64_tr_b16 v[214:215], v221 offset:9216
  s_waitcnt lgkmcnt(8)
  v_mfma_f32_32x32x16_bf16 v[144:159], v[196:199], v[72:75], v[144:159]
  ds_read_b64_tr_b16 v[192:193], v220 offset:10240
  ds_read_b64_tr_b16 v[194:195], v220 offset:11264
  s_add_u32 s55, s55, 4096
  buffer_load_dwordx4 v[112:115], v245, s[28:31], s55 offen offset:0 sc1
  s_waitcnt vmcnt(9) lgkmcnt(8)
  v_mfma_f32_32x32x16_bf16 v[128:143], v[200:203], v[76:79], v[128:143]
  ds_read_b64_tr_b16 v[196:197], v221 offset:10240
  ds_read_b64_tr_b16 v[198:199], v221 offset:11264
  s_waitcnt lgkmcnt(8)
  v_mfma_f32_32x32x16_bf16 v[144:159], v[204:207], v[76:79], v[144:159]
  ds_read_b64_tr_b16 v[200:201], v220 offset:12288
  ds_read_b64_tr_b16 v[202:203], v220 offset:13312
  buffer_load_dwordx4 v[116:119], v245, s[28:31], s55 offen offset:1024 sc1
  s_waitcnt vmcnt(9) lgkmcnt(8)
  v_mfma_f32_32x32x16_bf16 v[128:143], v[208:211], v[80:83], v[128:143]
  ds_read_b64_tr_b16 v[204:205], v221 offset:12288
  ds_read_b64_tr_b16 v[206:207], v221 offset:13312
  s_waitcnt lgkmcnt(8)
  v_mfma_f32_32x32x16_bf16 v[144:159], v[212:215], v[80:83], v[144:159]
  ds_read_b64_tr_b16 v[208:209], v220 offset:14336
  ds_read_b64_tr_b16 v[210:211], v220 offset:15360
  buffer_load_dwordx4 v[120:123], v245, s[28:31], s55 offen offset:2048 sc1
  s_waitcnt vmcnt(9) lgkmcnt(8)
  v_mfma_f32_32x32x16_bf16 v[128:143], v[192:195], v[84:87], v[128:143]
  ds_read_b64_tr_b16 v[212:213], v221 offset:14336
  ds_read_b64_tr_b16 v[214:215], v221 offset:15360
  s_waitcnt lgkmcnt(8)
  v_mfma_f32_32x32x16_bf16 v[144:159], v[196:199], v[84:87], v[144:159]
  ds_read_b64_tr_b16 v[192:193], v220 offset:16384
  ds_read_b64_tr_b16 v[194:195], v220 offset:17408
  buffer_load_dwordx4 v[124:127], v245, s[28:31], s55 offen offset:3072 sc1
  s_waitcnt vmcnt(9) lgkmcnt(8)
  v_mfma_f32_32x32x16_bf16 v[128:143], v[200:203], v[88:91], v[128:143]
  ds_read_b64_tr_b16 v[196:197], v221 offset:16384
  ds_read_b64_tr_b16 v[198:199], v221 offset:17408
  s_waitcnt lgkmcnt(8)
  v_mfma_f32_32x32x16_bf16 v[144:159], v[204:207], v[88:91], v[144:159]
  ds_read_b64_tr_b16 v[200:201], v220 offset:18432
  ds_read_b64_tr_b16 v[202:203], v220 offset:19456
  s_add_u32 m0, s53, 0
  s_add_u32 s54, s52, 0
  buffer_load_dwordx4 v244, s[20:23], s54 offen lds
  s_waitcnt vmcnt(9) lgkmcnt(8)
  v_mfma_f32_32x32x16_bf16 v[128:143], v[208:211], v[92:95], v[128:143]
  ds_read_b64_tr_b16 v[204:205], v221 offset:18432
  ds_read_b64_tr_b16 v[206:207], v221 offset:19456
  s_waitcnt lgkmcnt(8)
  v_mfma_f32_32x32x16_bf16 v[144:159], v[212:215], v[92:95], v[144:159]
  ds_read_b64_tr_b16 v[208:209], v220 offset:20480
  ds_read_b64_tr_b16 v[210:211], v220 offset:21504
  s_add_u32 m0, s53, 2048
  s_add_u32 s54, s52, 16384
  buffer_load_dwordx4 v244, s[20:23], s54 offen lds
  s_waitcnt vmcnt(9) lgkmcnt(8)
  v_mfma_f32_32x32x16_bf16 v[128:143], v[192:195], v[96:99], v[128:143]
  ds_read_b64_tr_b16 v[212:213], v221 offset:20480
  ds_read_b64_tr_b16 v[214:215], v221 offset:21504
  s_waitcnt lgkmcnt(8)
  v_mfma_f32_32x32x16_bf16 v[144:159], v[196:199], v[96:99], v[144:159]
  ds_read_b64_tr_b16 v[192:193], v220 offset:22528
  ds_read_b64_tr_b16 v[194:195], v220 offset:23552
  s_add_u32 m0, s53, 4096
  s_add_u32 s54, s52, 32768
  buffer_load_dwordx4 v244, s[20:23], s54 offen lds
  s_waitcnt vmcnt(9) lgkmcnt(8)
  v_mfma_f32_32x32x16_bf16 v[128:143], v[200:203], v[100:103], v[128:143]
  ds_read_b64_tr_b16 v[196:197], v221 offset:22528
  ds_read_b64_tr_b16 v[198:199], v221 offset:23552
  s_waitcnt lgkmcnt(8)
  v_mfma_f32_32x32x16_bf16 v[144:159], v[204:207], v[100:103], v[144:159]
  ds_read_b64_tr_b16 v[200:201], v220 offset:24576
  ds_read_b64_tr_b16 v[202:203], v220 offset:25600
  s_add_u32 m0, s53, 6144
  s_add_u32 s54, s52, 49152
  buffer_load_dwordx4 v244, s[20:23], s54 offen lds
  s_waitcnt vmcnt(9) lgkmcnt(8)
  v_mfma_f32_32x32x16_bf16 v[128:143], v[208:211], v[104:107], v[128:143]
  ds_read_b64_tr_b16 v[204:205], v221 offset:24576
  ds_read_b64_tr_b16 v[206:207], v221 offset:25600
  s_waitcnt lgkmcnt(8)
  v_mfma_f32_32x32x16_bf16 v[144:159], v[212:215], v[104:107], v[144:159]
  ds_read_b64_tr_b16 v[208:209], v220 offset:26624
  ds_read_b64_tr_b16 v[210:211], v220 offset:27648
  s_add_u32 m0, s53, 8192
  s_add_u32 s54, s52, 131072
  buffer_load_dwordx4 v244, s[20:23], s54 offen lds
  s_waitcnt vmcnt(9) lgkmcnt(8)
  v_mfma_f32_32x32x16_bf16 v[128:143], v[192:195], v[108:111], v[128:143]
  ds_read_b64_tr_b16 v[212:213], v221 offset:26624
  ds_read_b64_tr_b16 v[214:215], v221 offset:27648
  s_waitcnt lgkmcnt(8)
  v_mfma_f32_32x32x16_bf16 v[144:159], v[196:199], v[108:111], v[144:159]
  ds_read_b64_tr_b16 v[192:193], v220 offset:28672
  ds_read_b64_tr_b16 v[194:195], v220 offset:29696
  s_add_u32 m0, s53, 10240
  s_add_u32 s54, s52, 147456
  buffer_load_dwordx4 v244, s[20:23], s54 offen lds
  s_waitcnt vmcnt(9) lgkmcnt(8)
  v_mfma_f32_32x32x16_bf16 v[128:143], v[200:203], v[112:115], v[128:143]
  ds_read_b64_tr_b16 v[196:197], v221 offset:28672
  ds_read_b64_tr_b16 v[198:199], v221 offset:29696
  s_waitcnt lgkmcnt(8)
  v_mfma_f32_32x32x16_bf16 v[144:159], v[204:207], v[112:115], v[144:159]
  ds_read_b64_tr_b16 v[200:201], v220 offset:30720
  ds_read_b64_tr_b16 v[202:203], v220 offset:31744
  s_add_u32 m0, s53, 12288
  s_add_u32 s54, s52, 163840
  buffer_load_dwordx4 v244, s[20:23], s54 offen lds
  s_waitcnt vmcnt(9) lgkmcnt(8)
  v_mfma_f32_32x32x16_bf16 v[128:143], v[208:211], v[116:119], v[128:143]
  ds_read_b64_tr_b16 v[204:205], v221 offset:30720
  ds_read_b64_tr_b16 v[206:207], v221 offset:31744
  s_waitcnt lgkmcnt(8)
  v_mfma_f32_32x32x16_bf16 v[144:159], v[212:215], v[116:119], v[144:159]
  s_waitcnt lgkmcnt(0)
  s_barrier
  ds_read_b32 v238, v227
  ds_read_b32 v242, v227 offset:128
  ds_read_b64_tr_b16 v[208:209], v218 offset:0
  ds_read_b64_tr_b16 v[210:211], v218 offset:1024
  s_waitcnt vmcnt(8)
  v_mfma_f32_32x32x16_bf16 v[128:143], v[192:195], v[120:123], v[128:143]
  ds_read_b64_tr_b16 v[212:213], v218 offset:2048
  ds_read_b64_tr_b16 v[214:215], v218 offset:3072
  v_mfma_f32_32x32x16_bf16 v[144:159], v[196:199], v[120:123], v[144:159]
  ds_read_b64_tr_b16 v[192:193], v218 offset:4096
  ds_read_b64_tr_b16 v[194:195], v218 offset:5120
  s_waitcnt lgkmcnt(7)
  v_cvt_pk_bf16_f32 v237, v238, 0
  v_lshlrev_b32 v239, 16, v237
  v_sub_f32 v239, v238, v239
  v_cvt_pk_bf16_f32 v236, v238, v239
  s_waitcnt vmcnt(7)
  v_mfma_f32_32x32x16_bf16 v[128:143], v[200:203], v[124:127], v[128:143]
  ds_read_b64_tr_b16 v[196:197], v218 offset:6144
  ds_read_b64_tr_b16 v[198:199], v218 offset:7168
  v_mov_b32 v238, 0
  v_mov_b32 v239, 0
  s_waitcnt lgkmcnt(8)
  v_cvt_pk_bf16_f32 v241, v242, 0
  v_lshlrev_b32 v243, 16, v241
  v_mfma_f32_32x32x16_bf16 v[144:159], v[204:207], v[124:127], v[144:159]
  ds_read_b64_tr_b16 v[200:201], v218 offset:8192
  ds_read_b64_tr_b16 v[202:203], v218 offset:9216
  v_sub_f32 v243, v242, v243
  v_cvt_pk_bf16_f32 v240, v242, v243
  v_mov_b32 v242, 0
  v_mov_b32 v243, 0
  s_nop 0
  v_mfma_f32_32x32x16_bf16 v[128:143], v[236:239], v[232:235], v[128:143]
  v_mfma_f32_32x32x16_bf16 v[144:159], v[240:243], v[232:235], v[144:159]
  s_waitcnt lgkmcnt(8)
  v_mfma_f32_32x32x16_bf16 v[160:175], v[208:211], v[0:3], 0
  ds_read_b64_tr_b16 v[204:205], v218 offset:10240
  ds_read_b64_tr_b16 v[206:207], v218 offset:11264
  ds_read_b32 v238, v227 offset:256
  s_waitcnt lgkmcnt(0)
  v_cvt_pk_bf16_f32 v237, v238, 0
  v_lshlrev_b32 v239, 16, v237
  v_sub_f32 v239, v238, v239
  v_mfma_f32_32x32x16_bf16 v[160:175], v[212:215], v[4:7], v[160:175]
  ds_read_b64_tr_b16 v[208:209], v218 offset:12288
  ds_read_b64_tr_b16 v[210:211], v218 offset:13312
  v_cvt_pk_bf16_f32 v236, v238, v239
  v_mov_b32 v238, 0
  v_mov_b32 v239, 0
  ds_read_b32 v242, v227 offset:384
  v_mfma_f32_32x32x16_bf16 v[160:175], v[192:195], v[8:11], v[160:175]
  ds_read_b64_tr_b16 v[212:213], v218 offset:14336
  ds_read_b64_tr_b16 v[214:215], v218 offset:15360
  s_waitcnt lgkmcnt(2)
  v_cvt_pk_bf16_f32 v241, v242, 0
  v_lshlrev_b32 v243, 16, v241
  v_sub_f32 v243, v242, v243
  v_cvt_pk_bf16_f32 v240, v242, v243
  v_mov_b32 v242, 0
  v_mfma_f32_32x32x16_bf16 v[160:175], v[196:199], v[12:15], v[160:175]
  ds_read_b64_tr_b16 v[192:193], v218 offset:16384
  ds_read_b64_tr_b16 v[194:195], v218 offset:17408
  v_mov_b32 v243, 0
  v_mul_f32 v228, v226, v128
  v_mul_f32 v229, v226, v129
  v_mul_f32 v230, v226, v130
  v_mfma_f32_32x32x16_bf16 v[160:175], v[200:203], v[16:19], v[160:175]
  ds_read_b64_tr_b16 v[196:197], v218 offset:18432
  ds_read_b64_tr_b16 v[198:199], v218 offset:19456
  v_mul_f32 v231, v226, v131
  v_exp_f32 v228, v228
  v_exp_f32 v229, v229
  v_exp_f32 v230, v230
  v_mfma_f32_32x32x16_bf16 v[160:175], v[204:207], v[20:23], v[160:175]
  ds_read_b64_tr_b16 v[200:201], v218 offset:20480
  ds_read_b64_tr_b16 v[202:203], v218 offset:21504
  v_exp_f32 v231, v231
  v_fma_f32 v228, v228, v225, v225
  v_fma_f32 v229, v229, v225, v225
  v_fma_f32 v230, v230, v225, v225
  v_fma_f32 v231, v231, v225, v225
  v_mfma_f32_32x32x16_bf16 v[160:175], v[208:211], v[24:27], v[160:175]
  ds_read_b64_tr_b16 v[204:205], v218 offset:22528
  ds_read_b64_tr_b16 v[206:207], v218 offset:23552
  v_rcp_f32 v228, v228
  v_rcp_f32 v229, v229
  v_rcp_f32 v230, v230
  v_rcp_f32 v231, v231
  s_waitcnt lgkmcnt(8)
  v_mfma_f32_32x32x16_bf16 v[160:175], v[212:215], v[28:31], v[160:175]
  ds_read_b64_tr_b16 v[208:209], v218 offset:24576
  ds_read_b64_tr_b16 v[210:211], v218 offset:25600
  v_mul_f32 v128, v128, v228
  v_mul_f32 v129, v129, v229
  v_mul_f32 v130, v130, v230
  v_mul_f32 v131, v131, v231
  v_mul_f32 v228, v226, v132
  s_waitcnt lgkmcnt(8)
  v_mfma_f32_32x32x16_bf16 v[160:175], v[192:195], v[32:35], v[160:175]
  ds_read_b64_tr_b16 v[212:213], v218 offset:26624
  ds_read_b64_tr_b16 v[214:215], v218 offset:27648
  v_mul_f32 v229, v226, v133
  v_mul_f32 v230, v226, v134
  v_mul_f32 v231, v226, v135
  v_exp_f32 v228, v228
  s_waitcnt lgkmcnt(8)
  v_mfma_f32_32x32x16_bf16 v[160:175], v[196:199], v[36:39], v[160:175]
  ds_read_b64_tr_b16 v[192:193], v218 offset:28672
  ds_read_b64_tr_b16 v[194:195], v218 offset:29696
  v_exp_f32 v229, v229
  v_exp_f32 v230, v230
  v_exp_f32 v231, v231
  v_fma_f32 v228, v228, v225, v225
  s_waitcnt lgkmcnt(8)
  v_mfma_f32_32x32x16_bf16 v[160:175], v[200:203], v[40:43], v[160:175]
  ds_read_b64_tr_b16 v[196:197], v218 offset:30720
  ds_read_b64_tr_b16 v[198:199], v218 offset:31744
  v_fma_f32 v229, v229, v225, v225
  v_fma_f32 v230, v230, v225, v225
  v_fma_f32 v231, v231, v225, v225
  v_rcp_f32 v228, v228
  v_rcp_f32 v229, v229
  s_waitcnt lgkmcnt(8)
  v_mfma_f32_32x32x16_bf16 v[160:175], v[204:207], v[44:47], v[160:175]
  ds_read_b64_tr_b16 v[200:201], v222 offset:0
  ds_read_b64_tr_b16 v[202:203], v222 offset:1024
  v_rcp_f32 v230, v230
  v_rcp_f32 v231, v231
  v_mul_f32 v132, v132, v228
  v_mul_f32 v133, v133, v229
  s_waitcnt lgkmcnt(8)
  v_mfma_f32_32x32x16_bf16 v[160:175], v[208:211], v[48:51], v[160:175]
  ds_read_b64_tr_b16 v[204:205], v222 offset:2048
  ds_read_b64_tr_b16 v[206:207], v222 offset:3072
  v_mul_f32 v134, v134, v230
  v_mul_f32 v135, v135, v231
  v_cvt_pk_bf16_f32 v128, v128, v129
  v_cvt_pk_bf16_f32 v129, v130, v131
  s_waitcnt lgkmcnt(8)
  v_mfma_f32_32x32x16_bf16 v[160:175], v[212:215], v[52:55], v[160:175]
  ds_read_b64_tr_b16 v[208:209], v222 offset:4096
  ds_read_b64_tr_b16 v[210:211], v222 offset:5120
  v_cvt_pk_bf16_f32 v130, v132, v133
  v_cvt_pk_bf16_f32 v131, v134, v135
  v_mul_f32 v228, v226, v136
  v_mul_f32 v229, v226, v137
  v_mul_f32 v230, v226, v138
  s_waitcnt lgkmcnt(8)
  v_mfma_f32_32x32x16_bf16 v[160:175], v[192:195], v[56:59], v[160:175]
  ds_read_b64_tr_b16 v[212:213], v222 offset:6144
  ds_read_b64_tr_b16 v[214:215], v222 offset:7168
  v_mul_f32 v231, v226, v139
  v_exp_f32 v228, v228
  v_exp_f32 v229, v229
  v_exp_f32 v230, v230
  s_waitcnt lgkmcnt(8)
  v_mfma_f32_32x32x16_bf16 v[160:175], v[196:199], v[60:63], v[160:175]
  ds_read_b64_tr_b16 v[192:193], v222 offset:8192
  ds_read_b64_tr_b16 v[194:195], v222 offset:9216
  v_exp_f32 v231, v231
  v_fma_f32 v228, v228, v225, v225
  v_fma_f32 v229, v229, v225, v225
  v_fma_f32 v230, v230, v225, v225
  v_fma_f32 v231, v231, v225, v225
  s_waitcnt lgkmcnt(8)
  v_mfma_f32_32x32x16_bf16 v[160:175], v[200:203], v[64:67], v[160:175]
  ds_read_b64_tr_b16 v[196:197], v222 offset:10240
  ds_read_b64_tr_b16 v[198:199], v222 offset:11264
  v_rcp_f32 v228, v228
  v_rcp_f32 v229, v229
  v_rcp_f32 v230, v230
  v_rcp_f32 v231, v231
  s_waitcnt lgkmcnt(8)
  v_mfma_f32_32x32x16_bf16 v[160:175], v[204:207], v[68:71], v[160:175]
  ds_read_b64_tr_b16 v[200:201], v222 offset:12288
  ds_read_b64_tr_b16 v[202:203], v222 offset:13312
  v_mul_f32 v136, v136, v228
  v_mul_f32 v137, v137, v229
  v_mul_f32 v138, v138, v230
  v_mul_f32 v139, v139, v231
  s_waitcnt lgkmcnt(8)
  v_mfma_f32_32x32x16_bf16 v[160:175], v[208:211], v[72:75], v[160:175]
  ds_read_b64_tr_b16 v[204:205], v222 offset:14336
  ds_read_b64_tr_b16 v[206:207], v222 offset:15360
  v_mul_f32 v228, v226, v140
  v_mul_f32 v229, v226, v141
  v_mul_f32 v230, v226, v142
  v_mul_f32 v231, v226, v143
  v_exp_f32 v228, v228
  s_waitcnt lgkmcnt(8)
  v_mfma_f32_32x32x16_bf16 v[160:175], v[212:215], v[76:79], v[160:175]
  ds_read_b64_tr_b16 v[208:209], v222 offset:16384
  ds_read_b64_tr_b16 v[210:211], v222 offset:17408
  v_exp_f32 v229, v229
  v_exp_f32 v230, v230
  v_exp_f32 v231, v231
  v_fma_f32 v228, v228, v225, v225
  s_waitcnt lgkmcnt(8)
  v_mfma_f32_32x32x16_bf16 v[160:175], v[192:195], v[80:83], v[160:175]
  ds_read_b64_tr_b16 v[212:213], v222 offset:18432
  ds_read_b64_tr_b16 v[214:215], v222 offset:19456
  v_fma_f32 v229, v229, v225, v225
  v_fma_f32 v230, v230, v225, v225
  v_fma_f32 v231, v231, v225, v225
  v_rcp_f32 v228, v228
  s_waitcnt lgkmcnt(8)
  v_mfma_f32_32x32x16_bf16 v[160:175], v[196:199], v[84:87], v[160:175]
  ds_read_b64_tr_b16 v[192:193], v222 offset:20480
  ds_read_b64_tr_b16 v[194:195], v222 offset:21504
  v_rcp_f32 v229, v229
  v_rcp_f32 v230, v230
  v_rcp_f32 v231, v231
  v_mul_f32 v140, v140, v228
  v_mul_f32 v141, v141, v229
  s_waitcnt lgkmcnt(8)
  v_mfma_f32_32x32x16_bf16 v[160:175], v[200:203], v[88:91], v[160:175]
  ds_read_b64_tr_b16 v[196:197], v222 offset:22528
  ds_read_b64_tr_b16 v[198:199], v222 offset:23552
  v_mul_f32 v142, v142, v230
  v_mul_f32 v143, v143, v231
  v_cvt_pk_bf16_f32 v136, v136, v137
  v_cvt_pk_bf16_f32 v137, v138, v139
  s_waitcnt lgkmcnt(8)
  v_mfma_f32_32x32x16_bf16 v[160:175], v[204:207], v[92:95], v[160:175]
  ds_read_b64_tr_b16 v[200:201], v222 offset:24576
  ds_read_b64_tr_b16 v[202:203], v222 offset:25600
  v_cvt_pk_bf16_f32 v138, v140, v141
  v_cvt_pk_bf16_f32 v139, v142, v143
  s_cmp_lg_u32 s39, 0
  s_cbranch_scc1 STS_56
  buffer_store_dwordx4 v[128:131], v245, s[28:31], s46 offen offset:0
  buffer_store_dwordx4 v[136:139], v245, s[28:31], s46 offen offset:1024
STD_57:
  v_mul_f32 v228, v226, v144
  v_mul_f32 v229, v226, v145
  s_waitcnt lgkmcnt(8)
  v_mfma_f32_32x32x16_bf16 v[160:175], v[208:211], v[96:99], v[160:175]
  ds_read_b64_tr_b16 v[204:205], v222 offset:26624
  ds_read_b64_tr_b16 v[206:207], v222 offset:27648
  v_mul_f32 v230, v226, v146
  v_mul_f32 v231, v226, v147
  v_exp_f32 v228, v228
  v_exp_f32 v229, v229
  s_waitcnt lgkmcnt(8)
  v_mfma_f32_32x32x16_bf16 v[160:175], v[212:215], v[100:103], v[160:175]
  ds_read_b64_tr_b16 v[208:209], v222 offset:28672
  ds_read_b64_tr_b16 v[210:211], v222 offset:29696
  v_exp_f32 v230, v230
  v_exp_f32 v231, v231
  v_fma_f32 v228, v228, v225, v225
  v_fma_f32 v229, v229, v225, v225
  s_waitcnt lgkmcnt(8)
  v_mfma_f32_32x32x16_bf16 v[160:175], v[192:195], v[104:107], v[160:175]
  ds_read_b64_tr_b16 v[212:213], v222 offset:30720
  ds_read_b64_tr_b16 v[214:215], v222 offset:31744
  v_fma_f32 v230, v230, v225, v225
  v_fma_f32 v231, v231, v225, v225
  v_rcp_f32 v228, v228
  v_rcp_f32 v229, v229
  v_rcp_f32 v230, v230
  s_waitcnt lgkmcnt(8)
  v_mfma_f32_32x32x16_bf16 v[160:175], v[196:199], v[108:111], v[160:175]
  ds_read_b64_tr_b16 v[192:193], v219 offset:0
  ds_read_b64_tr_b16 v[194:195], v219 offset:1024
  v_rcp_f32 v231, v231
  v_mul_f32 v144, v144, v228
  v_mul_f32 v145, v145, v229
  v_mul_f32 v146, v146, v230
  s_waitcnt lgkmcnt(8)
  v_mfma_f32_32x32x16_bf16 v[160:175], v[200:203], v[112:115], v[160:175]
  ds_read_b64_tr_b16 v[196:197], v219 offset:2048
  ds_read_b64_tr_b16 v[198:199], v219 offset:3072
  v_mul_f32 v147, v147, v231
  v_mul_f32 v228, v226, v148
  v_mul_f32 v229, v226, v149
  v_mul_f32 v230, v226, v150
  s_waitcnt lgkmcnt(8)
  v_mfma_f32_32x32x16_bf16 v[160:175], v[204:207], v[116:119], v[160:175]
  ds_read_b64_tr_b16 v[200:201], v219 offset:4096
  ds_read_b64_tr_b16 v[202:203], v219 offset:5120
  v_mul_f32 v231, v226, v151
  v_exp_f32 v228, v228
  v_exp_f32 v229, v229
  v_exp_f32 v230, v230
  v_exp_f32 v231, v231
  s_waitcnt lgkmcnt(8)
  v_mfma_f32_32x32x16_bf16 v[160:175], v[208:211], v[120:123], v[160:175]
  ds_read_b64_tr_b16 v[204:205], v219 offset:6144
  ds_read_b64_tr_b16 v[206:207], v219 offset:7168
  v_fma_f32 v228, v228, v225, v225
  v_fma_f32 v229, v229, v225, v225
  v_fma_f32 v230, v230, v225, v225
  v_fma_f32 v231, v231, v225, v225
  s_waitcnt lgkmcnt(8)
  v_mfma_f32_32x32x16_bf16 v[160:175], v[212:215], v[124:127], v[160:175]
  ds_read_b64_tr_b16 v[208:209], v219 offset:8192
  ds_read_b64_tr_b16 v[210:211], v219 offset:9216
  v_rcp_f32 v228, v228
  v_rcp_f32 v229, v229
  v_rcp_f32 v230, v230
  v_rcp_f32 v231, v231
  v_mul_f32 v148, v148, v228
  v_mfma_f32_32x32x16_bf16 v[160:175], v[236:239], v[232:235], v[160:175]
  s_waitcnt lgkmcnt(8)
  v_mfma_f32_32x32x16_bf16 v[176:191], v[192:195], v[0:3], 0
  ds_read_b64_tr_b16 v[212:213], v219 offset:10240
  ds_read_b64_tr_b16 v[214:215], v219 offset:11264
  v_mul_f32 v149, v149, v229
  v_mul_f32 v150, v150, v230
  v_mul_f32 v151, v151, v231
  v_cvt_pk_bf16_f32 v144, v144, v145
  s_waitcnt lgkmcnt(8)
  v_mfma_f32_32x32x16_bf16 v[176:191], v[196:199], v[4:7], v[176:191]
  ds_read_b64_tr_b16 v[192:193], v219 offset:12288
  ds_read_b64_tr_b16 v[194:195], v219 offset:13312
  v_cvt_pk_bf16_f32 v145, v146, v147
  v_cvt_pk_bf16_f32 v146, v148, v149
  v_cvt_pk_bf16_f32 v147, v150, v151
  v_mul_f32 v228, v226, v152
  s_waitcnt lgkmcnt(8)
  v_mfma_f32_32x32x16_bf16 v[176:191], v[200:203], v[8:11], v[176:191]
  ds_read_b64_tr_b16 v[196:197], v219 offset:14336
  ds_read_b64_tr_b16 v[198:199], v219 offset:15360
  v_mul_f32 v229, v226, v153
  v_mul_f32 v230, v226, v154
  v_mul_f32 v231, v226, v155
  v_exp_f32 v228, v228
  v_exp_f32 v229, v229
  s_waitcnt lgkmcnt(8)
  v_mfma_f32_32x32x16_bf16 v[176:191], v[204:207], v[12:15], v[176:191]
  ds_read_b64_tr_b16 v[200:201], v219 offset:16384
  ds_read_b64_tr_b16 v[202:203], v219 offset:17408
  v_exp_f32 v230, v230
  v_exp_f32 v231, v231
  v_fma_f32 v228, v228, v225, v225
  v_fma_f32 v229, v229, v225, v225
  s_waitcnt lgkmcnt(8)
  v_mfma_f32_32x32x16_bf16 v[176:191], v[208:211], v[16:19], v[176:191]
  ds_read_b64_tr_b16 v[204:205], v219 offset:18432
  ds_read_b64_tr_b16 v[206:207], v219 offset:19456
  v_fma_f32 v230, v230, v225, v225
  v_fma_f32 v231, v231, v225, v225
  v_rcp_f32 v228, v228
  v_rcp_f32 v229, v229
  v_rcp_f32 v230, v230
  s_waitcnt lgkmcnt(8)
  v_mfma_f32_32x32x16_bf16 v[176:191], v[212:215], v[20:23], v[176:191]
  ds_read_b64_tr_b16 v[208:209], v219 offset:20480
  ds_read_b64_tr_b16 v[210:211], v219 offset:21504
  v_rcp_f32 v231, v231
  v_mul_f32 v152, v152, v228
  v_mul_f32 v153, v153, v229
  v_mul_f32 v154, v154, v230
  s_waitcnt lgkmcnt(8)
  v_mfma_f32_32x32x16_bf16 v[176:191], v[192:195], v[24:27], v[176:191]
  ds_read_b64_tr_b16 v[212:213], v219 offset:22528
  ds_read_b64_tr_b16 v[214:215], v219 offset:23552
  v_mul_f32 v155, v155, v231
  v_mul_f32 v228, v226, v156
  v_mul_f32 v229, v226, v157
  v_mul_f32 v230, v226, v158
  s_waitcnt lgkmcnt(8)
  v_mfma_f32_32x32x16_bf16 v[176:191], v[196:199], v[28:31], v[176:191]
  ds_read_b64_tr_b16 v[192:193], v219 offset:24576
  ds_read_b64_tr_b16 v[194:195], v219 offset:25600
  v_mul_f32 v231, v226, v159
  v_exp_f32 v228, v228
  v_exp_f32 v229, v229
  v_exp_f32 v230, v230
  v_exp_f32 v231, v231
  s_waitcnt lgkmcnt(8)
  v_mfma_f32_32x32x16_bf16 v[176:191], v[200:203], v[32:35], v[176:191]
  ds_read_b64_tr_b16 v[196:197], v219 offset:26624
  ds_read_b64_tr_b16 v[198:199], v219 offset:27648
  v_fma_f32 v228, v228, v225, v225
  v_fma_f32 v229, v229, v225, v225
  v_fma_f32 v230, v230, v225, v225
  v_fma_f32 v231, v231, v225, v225
  s_waitcnt lgkmcnt(8)
  v_mfma_f32_32x32x16_bf16 v[176:191], v[204:207], v[36:39], v[176:191]
  ds_read_b64_tr_b16 v[200:201], v219 offset:28672
  ds_read_b64_tr_b16 v[202:203], v219 offset:29696
  v_rcp_f32 v228, v228
  v_rcp_f32 v229, v229
  v_rcp_f32 v230, v230
  v_rcp_f32 v231, v231
  v_mul_f32 v156, v156, v228
  s_waitcnt lgkmcnt(8)
  v_mfma_f32_32x32x16_bf16 v[176:191], v[208:211], v[40:43], v[176:191]
  ds_read_b64_tr_b16 v[204:205], v219 offset:30720
  ds_read_b64_tr_b16 v[206:207], v219 offset:31744
  v_mul_f32 v157, v157, v229
  v_mul_f32 v158, v158, v230
  v_mul_f32 v159, v159, v231
  v_cvt_pk_bf16_f32 v152, v152, v153
  s_waitcnt lgkmcnt(8)
  v_mfma_f32_32x32x16_bf16 v[176:191], v[212:215], v[44:47], v[176:191]
  ds_read_b64_tr_b16 v[208:209], v223 offset:0
  ds_read_b64_tr_b16 v[210:211], v223 offset:1024
  v_cvt_pk_bf16_f32 v153, v154, v155
  v_cvt_pk_bf16_f32 v154, v156, v157
  v_cvt_pk_bf16_f32 v155, v158, v159
  s_cmp_lg_u32 s39, 0
  s_cbranch_scc1 STS_58
  buffer_store_dwordx4 v[144:147], v245, s[28:31], s46 offen offset:2048
  buffer_store_dwordx4 v[152:155], v245, s[28:31], s46 offen offset:3072
STD_59:
  s_waitcnt lgkmcnt(8)
  v_mfma_f32_32x32x16_bf16 v[176:191], v[192:195], v[48:51], v[176:191]
  ds_read_b64_tr_b16 v[212:213], v223 offset:2048
  ds_read_b64_tr_b16 v[214:215], v223 offset:3072
  v_mul_f32 v228, v226, v160
  v_mul_f32 v229, v226, v161
  v_mul_f32 v230, v226, v162
  v_mul_f32 v231, v226, v163
  v_exp_f32 v228, v228
  s_waitcnt lgkmcnt(8)
  v_mfma_f32_32x32x16_bf16 v[176:191], v[196:199], v[52:55], v[176:191]
  ds_read_b64_tr_b16 v[192:193], v223 offset:4096
  ds_read_b64_tr_b16 v[194:195], v223 offset:5120
  v_exp_f32 v229, v229
  v_exp_f32 v230, v230
  v_exp_f32 v231, v231
  v_fma_f32 v228, v228, v225, v225
  s_waitcnt lgkmcnt(8)
  v_mfma_f32_32x32x16_bf16 v[176:191], v[200:203], v[56:59], v[176:191]
  ds_read_b64_tr_b16 v[196:197], v223 offset:6144
  ds_read_b64_tr_b16 v[198:199], v223 offset:7168
  v_fma_f32 v229, v229, v225, v225
  v_fma_f32 v230, v230, v225, v225
  v_fma_f32 v231, v231, v225, v225
  v_rcp_f32 v228, v228
  v_rcp_f32 v229, v229
  s_waitcnt lgkmcnt(8)
  v_mfma_f32_32x32x16_bf16 v[176:191], v[204:207], v[60:63], v[176:191]
  ds_read_b64_tr_b16 v[200:201], v223 offset:8192
  ds_read_b64_tr_b16 v[202:203], v223 offset:9216
  v_rcp_f32 v230, v230
  v_rcp_f32 v231, v231
  v_mul_f32 v160, v160, v228
  v_mul_f32 v161, v161, v229
  s_waitcnt lgkmcnt(8)
  v_mfma_f32_32x32x16_bf16 v[176:191], v[208:211], v[64:67], v[176:191]
  ds_read_b64_tr_b16 v[204:205], v223 offset:10240
  ds_read_b64_tr_b16 v[206:207], v223 offset:11264
  v_mul_f32 v162, v162, v230
  v_mul_f32 v163, v163, v231
  v_mul_f32 v228, v226, v164
  v_mul_f32 v229, v226, v165
  s_waitcnt lgkmcnt(8)
  v_mfma_f32_32x32x16_bf16 v[176:191], v[212:215], v[68:71], v[176:191]
  ds_read_b64_tr_b16 v[208:209], v223 offset:12288
  ds_read_b64_tr_b16 v[210:211], v223 offset:13312
  v_mul_f32 v230, v226, v166
  v_mul_f32 v231, v226, v167
  v_exp_f32 v228, v228
  v_exp_f32 v229, v229
  v_exp_f32 v230, v230
  s_waitcnt lgkmcnt(8)
  v_mfma_f32_32x32x16_bf16 v[176:191], v[192:195], v[72:75], v[176:191]
  ds_read_b64_tr_b16 v[212:213], v223 offset:14336
  ds_read_b64_tr_b16 v[214:215], v223 offset:15360
  v_exp_f32 v231, v231
  v_fma_f32 v228, v228, v225, v225
  v_fma_f32 v229, v229, v225, v225
  v_fma_f32 v230, v230, v225, v225
  s_waitcnt lgkmcnt(8)
  v_mfma_f32_32x32x16_bf16 v[176:191], v[196:199], v[76:79], v[176:191]
  ds_read_b64_tr_b16 v[192:193], v223 offset:16384
  ds_read_b64_tr_b16 v[194:195], v223 offset:17408
  v_fma_f32 v231, v231, v225, v225
  v_rcp_f32 v228, v228
  v_rcp_f32 v229, v229
  v_rcp_f32 v230, v230
  v_rcp_f32 v231, v231
  s_waitcnt lgkmcnt(8)
  v_mfma_f32_32x32x16_bf16 v[176:191], v[200:203], v[80:83], v[176:191]
  ds_read_b64_tr_b16 v[196:197], v223 offset:18432
  ds_read_b64_tr_b16 v[198:199], v223 offset:19456
  v_mul_f32 v164, v164, v228
  v_mul_f32 v165, v165, v229
  v_mul_f32 v166, v166, v230
  v_mul_f32 v167, v167, v231
  s_waitcnt lgkmcnt(8)
  v_mfma_f32_32x32x16_bf16 v[176:191], v[204:207], v[84:87], v[176:191]
  ds_read_b64_tr_b16 v[200:201], v223 offset:20480
  ds_read_b64_tr_b16 v[202:203], v223 offset:21504
  v_cvt_pk_bf16_f32 v160, v160, v161
  v_cvt_pk_bf16_f32 v161, v162, v163
  v_cvt_pk_bf16_f32 v162, v164, v165
  v_cvt_pk_bf16_f32 v163, v166, v167
  s_waitcnt lgkmcnt(8)
  v_mfma_f32_32x32x16_bf16 v[176:191], v[208:211], v[88:91], v[176:191]
  ds_read_b64_tr_b16 v[204:205], v223 offset:22528
  ds_read_b64_tr_b16 v[206:207], v223 offset:23552
  v_mul_f32 v228, v226, v168
  v_mul_f32 v229, v226, v169
  v_mul_f32 v230, v226, v170
  v_mul_f32 v231, v226, v171
  v_exp_f32 v228, v228
  s_waitcnt lgkmcnt(8)
  v_mfma_f32_32x32x16_bf16 v[176:191], v[212:215], v[92:95], v[176:191]
  ds_read_b64_tr_b16 v[208:209], v223 offset:24576
  ds_read_b64_tr_b16 v[210:211], v223 offset:25600
  v_exp_f32 v229, v229
  v_exp_f32 v230, v230
  v_exp_f32 v231, v231
  v_fma_f32 v228, v228, v225, v225
  s_waitcnt lgkmcnt(8)
  v_mfma_f32_32x32x16_bf16 v[176:191], v[192:195], v[96:99], v[176:191]
  ds_read_b64_tr_b16 v[212:213], v223 offset:26624
  ds_read_b64_tr_b16 v[214:215], v223 offset:27648
  v_fma_f32 v229, v229, v225, v225
  v_fma_f32 v230, v230, v225, v225
  v_fma_f32 v231, v231, v225, v225
  v_rcp_f32 v228, v228
  v_rcp_f32 v229, v229
  s_waitcnt lgkmcnt(8)
  v_mfma_f32_32x32x16_bf16 v[176:191], v[196:199], v[100:103], v[176:191]
  ds_read_b64_tr_b16 v[192:193], v223 offset:28672
  ds_read_b64_tr_b16 v[194:195], v223 offset:29696
  v_rcp_f32 v230, v230
  v_rcp_f32 v231, v231
  v_mul_f32 v168, v168, v228
  v_mul_f32 v169, v169, v229
  s_waitcnt lgkmcnt(8)
  v_mfma_f32_32x32x16_bf16 v[176:191], v[200:203], v[104:107], v[176:191]
  ds_read_b64_tr_b16 v[196:197], v223 offset:30720
  ds_read_b64_tr_b16 v[198:199], v223 offset:31744
  v_mul_f32 v170, v170, v230
  v_mul_f32 v171, v171, v231
  v_mul_f32 v228, v226, v172
  v_mul_f32 v229, v226, v173
  s_waitcnt lgkmcnt(8)
  v_mfma_f32_32x32x16_bf16 v[176:191], v[204:207], v[108:111], v[176:191]
  v_mul_f32 v230, v226, v174
  v_mul_f32 v231, v226, v175
  v_exp_f32 v228, v228
  v_exp_f32 v229, v229
  v_exp_f32 v230, v230
  s_waitcnt lgkmcnt(6)
  v_mfma_f32_32x32x16_bf16 v[176:191], v[208:211], v[112:115], v[176:191]
  v_exp_f32 v231, v231
  v_fma_f32 v228, v228, v225, v225
  v_fma_f32 v229, v229, v225, v225
  v_fma_f32 v230, v230, v225, v225
  s_waitcnt lgkmcnt(4)
  v_mfma_f32_32x32x16_bf16 v[176:191], v[212:215], v[116:119], v[176:191]
  v_fma_f32 v231, v231, v225, v225
  v_rcp_f32 v228, v228
  v_rcp_f32 v229, v229
  v_rcp_f32 v230, v230
  v_rcp_f32 v231, v231
  s_waitcnt lgkmcnt(2)
  v_mfma_f32_32x32x16_bf16 v[176:191], v[192:195], v[120:123], v[176:191]
  v_mul_f32 v172, v172, v228
  v_mul_f32 v173, v173, v229
  v_mul_f32 v174, v174, v230
  v_mul_f32 v175, v175, v231
  s_waitcnt lgkmcnt(0)
  v_mfma_f32_32x32x16_bf16 v[176:191], v[196:199], v[124:127], v[176:191]
  v_cvt_pk_bf16_f32 v168, v168, v169
  v_cvt_pk_bf16_f32 v169, v170, v171
  v_cvt_pk_bf16_f32 v170, v172, v173
  v_cvt_pk_bf16_f32 v171, v174, v175
  s_cmp_lg_u32 s39, 0
  s_cbranch_scc1 STS_60
  buffer_store_dwordx4 v[160:163], v245, s[28:31], s48 offen offset:0
  buffer_store_dwordx4 v[168:171], v245, s[28:31], s48 offen offset:1024
STD_61:
  v_mfma_f32_32x32x16_bf16 v[176:191], v[240:243], v[232:235], v[176:191]
  s_barrier
  s_lshl_b32 s51, s36, 7
  s_lshl_b32 s50, s37, 10
  s_add_u32 s50, s50, s51
  s_lshl_b32 s51, s38, 2
  s_add_u32 s50, s50, s51
  s_add_u32 s51, s41, 4
  v_mov_b32 v192, s50
  v_mov_b32 v193, s51
  s_waitcnt vmcnt(2)
  s_mov_b64 exec, 1
  s_cmp_lg_u32 s39, 0
  s_cbranch_scc1 STS_64
  global_store_dword v192, v193, s[34:35]
STD_65:
  s_mov_b64 exec, -1
  v_mbcnt_lo_u32_b32 v240, -1, 0
  v_mbcnt_hi_u32_b32 v240, -1, v240
  s_lshl_b32 s50, s37, 10
  s_bfe_u32 s51, s38, 0x10003
  s_lshl_b32 s51, s51, 1
  s_and_b32 s52, s36, 1
  s_add_u32 s51, s51, s52
  s_lshl_b32 s51, s51, 7
  s_add_u32 s50, s50, s51
  s_and_b32 s51, s38, 16
  s_lshl_b32 s51, s51, 2
  s_add_u32 s50, s50, s51
  s_lshr_b32 s51, s36, 1
  s_mul_i32 s51, s51, 28
  s_add_u32 s50, s50, s51
  v_and_b32 v240, 7, v240
  v_min_u32 v240, 6, v240
  v_lshl_add_u32 v240, v240, 2, s50
  v_mul_f32 v228, v226, v176
  v_mul_f32 v229, v226, v177
  v_mul_f32 v230, v226, v178
  v_mul_f32 v231, v226, v179
  v_exp_f32 v228, v228
  v_exp_f32 v229, v229
  v_exp_f32 v230, v230
  v_exp_f32 v231, v231
  v_fma_f32 v228, v228, v225, v225
  v_fma_f32 v229, v229, v225, v225
  v_fma_f32 v230, v230, v225, v225
  v_fma_f32 v231, v231, v225, v225
  v_rcp_f32 v228, v228
  v_rcp_f32 v229, v229
  v_rcp_f32 v230, v230
  v_rcp_f32 v231, v231
  v_mul_f32 v176, v176, v228
  v_mul_f32 v177, v177, v229
  v_mul_f32 v178, v178, v230
  v_mul_f32 v179, v179, v231
  v_mul_f32 v228, v226, v180
  v_mul_f32 v229, v226, v181
  v_mul_f32 v230, v226, v182
  v_mul_f32 v231, v226, v183
  v_exp_f32 v228, v228
  v_exp_f32 v229, v229
  v_exp_f32 v230, v230
  v_exp_f32 v231, v231
  v_fma_f32 v228, v228, v225, v225
  v_fma_f32 v229, v229, v225, v225
  v_fma_f32 v230, v230, v225, v225
  v_fma_f32 v231, v231, v225, v225
  v_rcp_f32 v228, v228
  v_rcp_f32 v229, v229
  v_rcp_f32 v230, v230
  v_rcp_f32 v231, v231
  v_mul_f32 v180, v180, v228
  v_mul_f32 v181, v181, v229
  v_mul_f32 v182, v182, v230
  v_mul_f32 v183, v183, v231
  v_cvt_pk_bf16_f32 v176, v176, v177
  v_cvt_pk_bf16_f32 v177, v178, v179
  v_cvt_pk_bf16_f32 v178, v180, v181
  v_cvt_pk_bf16_f32 v179, v182, v183
  v_mul_f32 v228, v226, v184
  v_mul_f32 v229, v226, v185
  v_mul_f32 v230, v226, v186
  v_mul_f32 v231, v226, v187
  v_exp_f32 v228, v228
  v_exp_f32 v229, v229
  v_exp_f32 v230, v230
  v_exp_f32 v231, v231
  v_fma_f32 v228, v228, v225, v225
  v_fma_f32 v229, v229, v225, v225
  v_fma_f32 v230, v230, v225, v225
  v_fma_f32 v231, v231, v225, v225
  v_rcp_f32 v228, v228
  v_rcp_f32 v229, v229
  v_rcp_f32 v230, v230
  v_rcp_f32 v231, v231
  v_mul_f32 v184, v184, v228
  v_mul_f32 v185, v185, v229
  v_mul_f32 v186, v186, v230
  v_mul_f32 v187, v187, v231
  v_mul_f32 v228, v226, v188
  v_mul_f32 v229, v226, v189
  v_mul_f32 v230, v226, v190
  v_mul_f32 v231, v226, v191
  v_exp_f32 v228, v228
  v_exp_f32 v229, v229
  v_exp_f32 v230, v230
  v_exp_f32 v231, v231
  v_fma_f32 v228, v228, v225, v225
  v_fma_f32 v229, v229, v225, v225
  v_fma_f32 v230, v230, v225, v225
  global_load_dword v241, v240, s[34:35] sc1
  v_fma_f32 v231, v231, v225, v225
  v_rcp_f32 v228, v228
  v_rcp_f32 v229, v229
  v_rcp_f32 v230, v230
  v_rcp_f32 v231, v231
  v_mul_f32 v188, v188, v228
  v_mul_f32 v189, v189, v229
  v_mul_f32 v190, v190, v230
  v_mul_f32 v191, v191, v231
  v_cvt_pk_bf16_f32 v184, v184, v185
  v_cvt_pk_bf16_f32 v185, v186, v187
  v_cvt_pk_bf16_f32 v186, v188, v189
  v_cvt_pk_bf16_f32 v187, v190, v191
  s_cmp_lg_u32 s39, 0
  s_cbranch_scc1 STS_66
  buffer_store_dwordx4 v[176:179], v245, s[28:31], s48 offen offset:2048
  buffer_store_dwordx4 v[184:187], v245, s[28:31], s48 offen offset:3072
STD_67:
  s_branch W1E_51
W1I_50:
  s_waitcnt vmcnt(0)
  v_mbcnt_lo_u32_b32 v240, -1, 0
  v_mbcnt_hi_u32_b32 v240, -1, v240
  s_lshl_b32 s50, s37, 10
  s_bfe_u32 s51, s38, 0x10003
  s_lshl_b32 s51, s51, 1
  s_and_b32 s52, s36, 1
  s_add_u32 s51, s51, s52
  s_lshl_b32 s51, s51, 7
  s_add_u32 s50, s50, s51
  s_and_b32 s51, s38, 16
  s_lshl_b32 s51, s51, 2
  s_add_u32 s50, s50, s51
  s_lshr_b32 s51, s36, 1
  s_mul_i32 s51, s51, 28
  s_add_u32 s50, s50, s51
  v_and_b32 v240, 7, v240
  v_min_u32 v240, 6, v240
  v_lshl_add_u32 v240, v240, 2, s50
  v_mov_b32 v241, 0
  s_barrier
  s_barrier
W1E_51:
  s_setprio 1
  v_mbcnt_lo_u32_b32 v214, -1, 0
  v_mbcnt_hi_u32_b32 v214, -1, v214
  s_lshr_b32 s44, s38, 3
  s_lshl_b32 s44, s44, 1
  s_lshl_b32 s45, s37, 3
  s_add_u32 s44, s44, s45
  s_and_b32 s45, s36, 1
  s_add_u32 s44, s44, s45
  s_lshr_b32 s45, s36, 1
  s_and_b32 s47, s38, 7
  s_lshl_b32 s47, s47, 1
  s_add_u32 s47, s47, s45
  v_lshlrev_b32 v216, 4, v214
  s_lshr_b32 s71, s44, 2
  s_mul_i32 s71, s71, 737280
  s_and_b32 s53, s44, 3
  s_mul_i32 s46, s53, 114688
  s_mul_i32 s48, s45, 57344
  s_add_u32 s46, s46, s48
  s_add_u32 s46, s46, s64
  s_add_u32 s46, s46, s71
  s_waitcnt vmcnt(2)
  s_add_u32 s51, s41, 4
  v_cmp_gt_u32 vcc, s51, v241
  s_nop 0
  s_cbranch_vccz W2K_73
  s_add_u32 s51, s41, 4
  s_mov_b32 s50, 0x20000
  global_load_dword v241, v240, s[34:35] sc1
POLL_74:
  global_load_dword v242, v240, s[34:35] sc1
  s_waitcnt vmcnt(1)
  v_cmp_gt_u32 vcc, s51, v241
  s_nop 0
  s_cbranch_vccz POLLX_75
  global_load_dword v241, v240, s[34:35] sc1
  s_waitcnt vmcnt(1)
  v_cmp_gt_u32 vcc, s51, v242
  s_nop 0
  s_cbranch_vccz POLLX_75
  s_sub_u32 s50, s50, 1
  s_cmp_lg_u32 s50, 0
  s_cbranch_scc1 POLL_74
POLLX_75:
  s_waitcnt vmcnt(0)
W2K_73:
  buffer_load_dwordx4 v[0:3], v216, s[28:31], s46 offen offset:0 sc1
  buffer_load_dwordx4 v[4:7], v216, s[28:31], s46 offen offset:1024 sc1
  buffer_load_dwordx4 v[8:11], v216, s[28:31], s46 offen offset:2048 sc1
  buffer_load_dwordx4 v[12:15], v216, s[28:31], s46 offen offset:3072 sc1
  s_add_u32 s46, s46, 8192
  buffer_load_dwordx4 v[16:19], v216, s[28:31], s46 offen offset:0 sc1
  buffer_load_dwordx4 v[20:23], v216, s[28:31], s46 offen offset:1024 sc1
  buffer_load_dwordx4 v[24:27], v216, s[28:31], s46 offen offset:2048 sc1
  buffer_load_dwordx4 v[28:31], v216, s[28:31], s46 offen offset:3072 sc1
  s_lshl_b32 s51, s36, 7
  s_lshl_b32 s50, s37, 10
  s_add_u32 s50, s50, s51
  s_lshl_b32 s51, s38, 2
  s_add_u32 s50, s50, s51
  s_add_u32 s51, s41, 5
  v_mov_b32 v224, s50
  v_mov_b32 v225, s51
  v_lshlrev_b32 v128, 16, v248
  v_and_b32 v129, 0xffff0000, v248
  v_lshlrev_b32 v130, 16, v249
  v_and_b32 v131, 0xffff0000, v249
  v_lshlrev_b32 v132, 16, v250
  v_and_b32 v133, 0xffff0000, v250
  v_lshlrev_b32 v134, 16, v251
  v_and_b32 v135, 0xffff0000, v251
  v_lshlrev_b32 v136, 16, v252
  v_and_b32 v137, 0xffff0000, v252
  v_lshlrev_b32 v138, 16, v253
  v_and_b32 v139, 0xffff0000, v253
  v_lshlrev_b32 v140, 16, v254
  v_and_b32 v141, 0xffff0000, v254
  v_lshlrev_b32 v142, 16, v255
  v_and_b32 v143, 0xffff0000, v255
  v_bfe_u32 v220, v214, 2, 2
  v_bfe_u32 v221, v214, 4, 1
  v_lshlrev_b32 v221, 5, v221
  v_and_b32 v222, 3, v214
  v_lshl_add_u32 v221, v222, 3, v221
  v_lshrrev_b32 v222, 5, v214
  v_lshl_add_u32 v208, v222, 2, v220
  v_lshlrev_b32 v208, 7, v208
  v_add_u32 v208, v208, v221
  v_lshrrev_b32 v209, 1, v220
  v_xor_b32 v209, s45, v209
  v_lshl_add_u32 v208, v209, 6, v208
  v_xor_b32 v209, 64, v208
  s_lshl_b32 s48, s45, 15
  s_add_u32 s49, s48, 96256
  v_add_u32 v210, s49, v208
  v_add_u32 v211, s49, v209
  s_add_u32 s49, s48, 30720
  v_add_u32 v212, s49, v208
  v_add_u32 v213, s49, v209
  s_mul_i32 s48, s45, 14336
  v_add_u32 v208, s48, v208
  v_add_u32 v209, s48, v209
  s_lshl_b32 s48, s36, 12
  s_add_u32 s48, s48, 65536
  v_add_u32 v217, s48, v216
  s_xor_b32 s48, s48, 8192
  v_add_u32 v218, s48, v216
  s_barrier
  ds_read_b64_tr_b16 v[176:177], v208 offset:0
  ds_read_b64_tr_b16 v[178:179], v208 offset:1024
  ds_read_b64_tr_b16 v[180:181], v209 offset:0
  ds_read_b64_tr_b16 v[182:183], v209 offset:1024
  ds_read_b64_tr_b16 v[184:185], v208 offset:2048
  ds_read_b64_tr_b16 v[186:187], v208 offset:3072
  ds_read_b64_tr_b16 v[188:189], v209 offset:2048
  ds_read_b64_tr_b16 v[190:191], v209 offset:3072
  ds_read_b64_tr_b16 v[192:193], v208 offset:4096
  ds_read_b64_tr_b16 v[194:195], v208 offset:5120
  ds_read_b64_tr_b16 v[196:197], v209 offset:4096
  ds_read_b64_tr_b16 v[198:199], v209 offset:5120
  s_waitcnt vmcnt(7) lgkmcnt(10)
  v_mfma_f32_32x32x16_bf16 v[128:143], v[176:179], v[0:3], v[128:143]
  ds_read_b64_tr_b16 v[200:201], v208 offset:6144
  ds_read_b64_tr_b16 v[202:203], v208 offset:7168
  s_mov_b64 exec, 1
  s_cmp_lg_u32 s39, 0
  s_cbranch_scc1 STS_78
  global_store_dword v224, v225, s[34:35]
STD_79:
  s_mov_b64 exec, -1
  s_waitcnt lgkmcnt(10)
  v_mfma_f32_32x32x16_bf16 v[144:159], v[180:183], v[0:3], 0
  ds_read_b64_tr_b16 v[204:205], v209 offset:6144
  ds_read_b64_tr_b16 v[206:207], v209 offset:7168
  s_add_u32 s46, s46, 8192
  buffer_load_dwordx4 v[32:35], v216, s[28:31], s46 offen offset:0 sc1
  s_waitcnt vmcnt(8) lgkmcnt(10)
  v_mfma_f32_32x32x16_bf16 v[128:143], v[184:187], v[4:7], v[128:143]
  ds_read_b64_tr_b16 v[176:177], v208 offset:8192
  ds_read_b64_tr_b16 v[178:179], v208 offset:9216
  s_waitcnt lgkmcnt(10)
  v_mfma_f32_32x32x16_bf16 v[144:159], v[188:191], v[4:7], v[144:159]
  ds_read_b64_tr_b16 v[180:181], v209 offset:8192
  ds_read_b64_tr_b16 v[182:183], v209 offset:9216
  buffer_load_dwordx4 v[36:39], v216, s[28:31], s46 offen offset:1024 sc1
  s_waitcnt vmcnt(8) lgkmcnt(10)
  v_mfma_f32_32x32x16_bf16 v[128:143], v[192:195], v[8:11], v[128:143]
  ds_read_b64_tr_b16 v[184:185], v208 offset:10240
  ds_read_b64_tr_b16 v[186:187], v208 offset:11264
  s_waitcnt lgkmcnt(10)
  v_mfma_f32_32x32x16_bf16 v[144:159], v[196:199], v[8:11], v[144:159]
  ds_read_b64_tr_b16 v[188:189], v209 offset:10240
  ds_read_b64_tr_b16 v[190:191], v209 offset:11264
  buffer_load_dwordx4 v[40:43], v216, s[28:31], s46 offen offset:2048 sc1
  s_waitcnt vmcnt(8) lgkmcnt(10)
  v_mfma_f32_32x32x16_bf16 v[128:143], v[200:203], v[12:15], v[128:143]
  ds_read_b64_tr_b16 v[192:193], v208 offset:12288
  ds_read_b64_tr_b16 v[194:195], v208 offset:13312
  s_waitcnt lgkmcnt(10)
  v_mfma_f32_32x32x16_bf16 v[144:159], v[204:207], v[12:15], v[144:159]
  ds_read_b64_tr_b16 v[196:197], v209 offset:12288
  ds_read_b64_tr_b16 v[198:199], v209 offset:13312
  buffer_load_dwordx4 v[44:47], v216, s[28:31], s46 offen offset:3072 sc1
  s_waitcnt vmcnt(8) lgkmcnt(10)
  v_mfma_f32_32x32x16_bf16 v[128:143], v[176:179], v[16:19], v[128:143]
  ds_read_b64_tr_b16 v[200:201], v210 offset:0
  ds_read_b64_tr_b16 v[202:203], v210 offset:1024
  s_waitcnt lgkmcnt(10)
  v_mfma_f32_32x32x16_bf16 v[144:159], v[180:183], v[16:19], v[144:159]
  ds_read_b64_tr_b16 v[204:205], v211 offset:0
  ds_read_b64_tr_b16 v[206:207], v211 offset:1024
  s_add_u32 s46, s46, 8192
  buffer_load_dwordx4 v[48:51], v216, s[28:31], s46 offen offset:0 sc1
  s_waitcnt vmcnt(8) lgkmcnt(10)
  v_mfma_f32_32x32x16_bf16 v[128:143], v[184:187], v[20:23], v[128:143]
  ds_read_b64_tr_b16 v[176:177], v210 offset:2048
  ds_read_b64_tr_b16 v[178:179], v210 offset:3072
  s_waitcnt lgkmcnt(10)
  v_mfma_f32_32x32x16_bf16 v[144:159], v[188:191], v[20:23], v[144:159]
  ds_read_b64_tr_b16 v[180:181], v211 offset:2048
  ds_read_b64_tr_b16 v[182:183], v211 offset:3072
  buffer_load_dwordx4 v[52:55], v216, s[28:31], s46 offen offset:1024 sc1
  s_waitcnt vmcnt(8) lgkmcnt(10)
  v_mfma_f32_32x32x16_bf16 v[128:143], v[192:195], v[24:27], v[128:143]
  ds_read_b64_tr_b16 v[184:185], v210 offset:4096
  ds_read_b64_tr_b16 v[186:187], v210 offset:5120
  s_waitcnt lgkmcnt(10)
  v_mfma_f32_32x32x16_bf16 v[144:159], v[196:199], v[24:27], v[144:159]
  ds_read_b64_tr_b16 v[188:189], v211 offset:4096
  ds_read_b64_tr_b16 v[190:191], v211 offset:5120
  buffer_load_dwordx4 v[56:59], v216, s[28:31], s46 offen offset:2048 sc1
  s_waitcnt vmcnt(8) lgkmcnt(10)
  v_mfma_f32_32x32x16_bf16 v[128:143], v[200:203], v[28:31], v[128:143]
  ds_read_b64_tr_b16 v[192:193], v210 offset:6144
  ds_read_b64_tr_b16 v[194:195], v210 offset:7168
  s_waitcnt lgkmcnt(10)
  v_mfma_f32_32x32x16_bf16 v[144:159], v[204:207], v[28:31], v[144:159]
  ds_read_b64_tr_b16 v[196:197], v211 offset:6144
  ds_read_b64_tr_b16 v[198:199], v211 offset:7168
  buffer_load_dwordx4 v[60:63], v216, s[28:31], s46 offen offset:3072 sc1
  s_waitcnt vmcnt(7) lgkmcnt(10)
  v_mfma_f32_32x32x16_bf16 v[128:143], v[176:179], v[32:35], v[128:143]
  ds_read_b64_tr_b16 v[200:201], v210 offset:8192
  ds_read_b64_tr_b16 v[202:203], v210 offset:9216
  s_waitcnt lgkmcnt(10)
  v_mfma_f32_32x32x16_bf16 v[144:159], v[180:183], v[32:35], v[144:159]
  ds_read_b64_tr_b16 v[204:205], v211 offset:8192
  ds_read_b64_tr_b16 v[206:207], v211 offset:9216
  s_add_u32 s46, s46, 8192
  buffer_load_dwordx4 v[64:67], v216, s[28:31], s46 offen offset:0 sc1
  s_waitcnt vmcnt(7) lgkmcnt(10)
  v_mfma_f32_32x32x16_bf16 v[128:143], v[184:187], v[36:39], v[128:143]
  ds_read_b64_tr_b16 v[176:177], v210 offset:10240
  ds_read_b64_tr_b16 v[178:179], v210 offset:11264
  s_waitcnt lgkmcnt(10)
  v_mfma_f32_32x32x16_bf16 v[144:159], v[188:191], v[36:39], v[144:159]
  ds_read_b64_tr_b16 v[180:181], v211 offset:10240
  ds_read_b64_tr_b16 v[182:183], v211 offset:11264
  buffer_load_dwordx4 v[68:71], v216, s[28:31], s46 offen offset:1024 sc1
  s_waitcnt vmcnt(7) lgkmcnt(10)
  v_mfma_f32_32x32x16_bf16 v[128:143], v[192:195], v[40:43], v[128:143]
  ds_read_b64_tr_b16 v[184:185], v210 offset:12288
  ds_read_b64_tr_b16 v[186:187], v210 offset:13312
  s_waitcnt lgkmcnt(10)
  v_mfma_f32_32x32x16_bf16 v[144:159], v[196:199], v[40:43], v[144:159]
  ds_read_b64_tr_b16 v[188:189], v211 offset:12288
  ds_read_b64_tr_b16 v[190:191], v211 offset:13312
  buffer_load_dwordx4 v[72:75], v216, s[28:31], s46 offen offset:2048 sc1
  s_waitcnt vmcnt(7) lgkmcnt(10)
  v_mfma_f32_32x32x16_bf16 v[128:143], v[200:203], v[44:47], v[128:143]
  ds_read_b64_tr_b16 v[192:193], v210 offset:14336
  ds_read_b64_tr_b16 v[194:195], v210 offset:15360
  s_waitcnt lgkmcnt(10)
  v_mfma_f32_32x32x16_bf16 v[144:159], v[204:207], v[44:47], v[144:159]
  ds_read_b64_tr_b16 v[196:197], v211 offset:14336
  ds_read_b64_tr_b16 v[198:199], v211 offset:15360
  buffer_load_dwordx4 v[76:79], v216, s[28:31], s46 offen offset:3072 sc1
  s_waitcnt vmcnt(7) lgkmcnt(10)
  v_mfma_f32_32x32x16_bf16 v[128:143], v[176:179], v[48:51], v[128:143]
  ds_read_b64_tr_b16 v[200:201], v210 offset:16384
  ds_read_b64_tr_b16 v[202:203], v210 offset:17408
  s_waitcnt lgkmcnt(10)
  v_mfma_f32_32x32x16_bf16 v[144:159], v[180:183], v[48:51], v[144:159]
  ds_read_b64_tr_b16 v[204:205], v211 offset:16384
  ds_read_b64_tr_b16 v[206:207], v211 offset:17408
  s_add_u32 s46, s46, 8192
  buffer_load_dwordx4 v[80:83], v216, s[28:31], s46 offen offset:0 sc1
  s_waitcnt vmcnt(7) lgkmcnt(10)
  v_mfma_f32_32x32x16_bf16 v[128:143], v[184:187], v[52:55], v[128:143]
  ds_read_b64_tr_b16 v[176:177], v210 offset:18432
  ds_read_b64_tr_b16 v[178:179], v210 offset:19456
  global_load_dword v241, v240, s[34:35] sc1
  s_waitcnt lgkmcnt(10)
  v_mfma_f32_32x32x16_bf16 v[144:159], v[188:191], v[52:55], v[144:159]
  ds_read_b64_tr_b16 v[180:181], v211 offset:18432
  ds_read_b64_tr_b16 v[182:183], v211 offset:19456
  buffer_load_dwordx4 v[84:87], v216, s[28:31], s46 offen offset:1024 sc1
  s_waitcnt vmcnt(8) lgkmcnt(10)
  v_mfma_f32_32x32x16_bf16 v[128:143], v[192:195], v[56:59], v[128:143]
  s_waitcnt lgkmcnt(0)
  s_barrier
  ds_read_b64_tr_b16 v[184:185], v210 offset:20480
  ds_read_b64_tr_b16 v[186:187], v210 offset:21504
  v_mfma_f32_32x32x16_bf16 v[144:159], v[196:199], v[56:59], v[144:159]
  ds_read_b64_tr_b16 v[188:189], v211 offset:20480
  ds_read_b64_tr_b16 v[190:191], v211 offset:21504
  buffer_load_dwordx4 v[88:91], v216, s[28:31], s46 offen offset:2048 sc1
  s_waitcnt vmcnt(8)
  v_mfma_f32_32x32x16_bf16 v[128:143], v[200:203], v[60:63], v[128:143]
  ds_read_b64_tr_b16 v[192:193], v210 offset:22528
  ds_read_b64_tr_b16 v[194:195], v210 offset:23552
  v_mfma_f32_32x32x16_bf16 v[144:159], v[204:207], v[60:63], v[144:159]
  ds_read_b64_tr_b16 v[196:197], v211 offset:22528
  ds_read_b64_tr_b16 v[198:199], v211 offset:23552
  buffer_load_dwordx4 v[92:95], v216, s[28:31], s46 offen offset:3072 sc1
  s_waitcnt vmcnt(8)
  v_mfma_f32_32x32x16_bf16 v[128:143], v[176:179], v[64:67], v[128:143]
  ds_read_b64_tr_b16 v[200:201], v210 offset:24576
  ds_read_b64_tr_b16 v[202:203], v210 offset:25600
  v_mfma_f32_32x32x16_bf16 v[144:159], v[180:183], v[64:67], v[144:159]
  ds_read_b64_tr_b16 v[204:205], v211 offset:24576
  ds_read_b64_tr_b16 v[206:207], v211 offset:25600
  s_add_u32 s46, s46, 8192
  buffer_load_dwordx4 v[96:99], v216, s[28:31], s46 offen offset:0 sc1
  s_waitcnt vmcnt(8) lgkmcnt(10)
  v_mfma_f32_32x32x16_bf16 v[128:143], v[184:187], v[68:71], v[128:143]
  ds_read_b64_tr_b16 v[176:177], v210 offset:26624
  ds_read_b64_tr_b16 v[178:179], v210 offset:27648
  s_waitcnt lgkmcnt(10)
  v_mfma_f32_32x32x16_bf16 v[144:159], v[188:191], v[68:71], v[144:159]
  ds_read_b64_tr_b16 v[180:181], v211 offset:26624
  ds_read_b64_tr_b16 v[182:183], v211 offset:27648
  buffer_load_dwordx4 v[100:103], v216, s[28:31], s46 offen offset:1024 sc1
  s_waitcnt vmcnt(8) lgkmcnt(10)
  v_mfma_f32_32x32x16_bf16 v[128:143], v[192:195], v[72:75], v[128:143]
  ds_read_b64_tr_b16 v[184:185], v210 offset:28672
  ds_read_b64_tr_b16 v[186:187], v210 offset:29696
  s_waitcnt lgkmcnt(10)
  v_mfma_f32_32x32x16_bf16 v[144:159], v[196:199], v[72:75], v[144:159]
  ds_read_b64_tr_b16 v[188:189], v211 offset:28672
  ds_read_b64_tr_b16 v[190:191], v211 offset:29696
  buffer_load_dwordx4 v[104:107], v216, s[28:31], s46 offen offset:2048 sc1
  s_waitcnt vmcnt(8) lgkmcnt(10)
  v_mfma_f32_32x32x16_bf16 v[128:143], v[200:203], v[76:79], v[128:143]
  ds_read_b64_tr_b16 v[192:193], v210 offset:30720
  ds_read_b64_tr_b16 v[194:195], v210 offset:31744
  s_waitcnt lgkmcnt(10)
  v_mfma_f32_32x32x16_bf16 v[144:159], v[204:207], v[76:79], v[144:159]
  ds_read_b64_tr_b16 v[196:197], v211 offset:30720
  ds_read_b64_tr_b16 v[198:199], v211 offset:31744
  buffer_load_dwordx4 v[108:111], v216, s[28:31], s46 offen offset:3072 sc1
  s_waitcnt vmcnt(8) lgkmcnt(10)
  v_mfma_f32_32x32x16_bf16 v[128:143], v[176:179], v[80:83], v[128:143]
  ds_read_b64_tr_b16 v[200:201], v212 offset:0
  ds_read_b64_tr_b16 v[202:203], v212 offset:1024
  s_waitcnt lgkmcnt(10)
  v_mfma_f32_32x32x16_bf16 v[144:159], v[180:183], v[80:83], v[144:159]
  ds_read_b64_tr_b16 v[204:205], v213 offset:0
  ds_read_b64_tr_b16 v[206:207], v213 offset:1024
  s_add_u32 s51, s41, 5
  s_waitcnt vmcnt(7)
  v_cmp_gt_u32 vcc, s51, v241
  s_nop 0
  s_cbranch_vccz W2L_80
  s_add_u32 s51, s41, 5
  s_mov_b32 s50, 0x20000
  global_load_dword v241, v240, s[34:35] sc1
POLL_81:
  global_load_dword v242, v240, s[34:35] sc1
  s_waitcnt vmcnt(1)
  v_cmp_gt_u32 vcc, s51, v241
  s_nop 0
  s_cbranch_vccz POLLX_82
  global_load_dword v241, v240, s[34:35] sc1
  s_waitcnt vmcnt(1)
  v_cmp_gt_u32 vcc, s51, v242
  s_nop 0
  s_cbranch_vccz POLLX_82
  s_sub_u32 s50, s50, 1
  s_cmp_lg_u32 s50, 0
  s_cbranch_scc1 POLL_81
POLLX_82:
  s_waitcnt vmcnt(0)
W2L_80:
  s_add_u32 s46, s46, 4294922240
  buffer_load_dwordx4 v[112:115], v216, s[28:31], s46 offen offset:0 sc1
  s_waitcnt vmcnt(7) lgkmcnt(10)
  v_mfma_f32_32x32x16_bf16 v[128:143], v[184:187], v[84:87], v[128:143]
  ds_read_b64_tr_b16 v[176:177], v212 offset:2048
  ds_read_b64_tr_b16 v[178:179], v212 offset:3072
  s_waitcnt lgkmcnt(10)
  v_mfma_f32_32x32x16_bf16 v[144:159], v[188:191], v[84:87], v[144:159]
  ds_read_b64_tr_b16 v[180:181], v213 offset:2048
  ds_read_b64_tr_b16 v[182:183], v213 offset:3072
  buffer_load_dwordx4 v[116:119], v216, s[28:31], s46 offen offset:1024 sc1
  s_waitcnt vmcnt(7) lgkmcnt(10)
  v_mfma_f32_32x32x16_bf16 v[128:143], v[192:195], v[88:91], v[128:143]
  ds_read_b64_tr_b16 v[184:185], v212 offset:4096
  ds_read_b64_tr_b16 v[186:187], v212 offset:5120
  s_waitcnt lgkmcnt(10)
  v_mfma_f32_32x32x16_bf16 v[144:159], v[196:199], v[88:91], v[144:159]
  ds_read_b64_tr_b16 v[188:189], v213 offset:4096
  ds_read_b64_tr_b16 v[190:191], v213 offset:5120
  buffer_load_dwordx4 v[120:123], v216, s[28:31], s46 offen offset:2048 sc1
  s_waitcnt vmcnt(7) lgkmcnt(10)
  v_mfma_f32_32x32x16_bf16 v[128:143], v[200:203], v[92:95], v[128:143]
  ds_read_b64_tr_b16 v[192:193], v212 offset:6144
  ds_read_b64_tr_b16 v[194:195], v212 offset:7168
  s_waitcnt lgkmcnt(10)
  v_mfma_f32_32x32x16_bf16 v[144:159], v[204:207], v[92:95], v[144:159]
  ds_read_b64_tr_b16 v[196:197], v213 offset:6144
  ds_read_b64_tr_b16 v[198:199], v213 offset:7168
  buffer_load_dwordx4 v[124:127], v216, s[28:31], s46 offen offset:3072 sc1
  s_waitcnt vmcnt(7) lgkmcnt(10)
  v_mfma_f32_32x32x16_bf16 v[128:143], v[176:179], v[96:99], v[128:143]
  ds_read_b64_tr_b16 v[200:201], v212 offset:8192
  ds_read_b64_tr_b16 v[202:203], v212 offset:9216
  s_waitcnt lgkmcnt(10)
  v_mfma_f32_32x32x16_bf16 v[144:159], v[180:183], v[96:99], v[144:159]
  ds_read_b64_tr_b16 v[204:205], v213 offset:8192
  ds_read_b64_tr_b16 v[206:207], v213 offset:9216
  s_add_u32 s46, s46, 8192
  buffer_load_dwordx4 v[0:3], v216, s[28:31], s46 offen offset:0 sc1
  s_waitcnt vmcnt(7) lgkmcnt(10)
  v_mfma_f32_32x32x16_bf16 v[128:143], v[184:187], v[100:103], v[128:143]
  ds_read_b64_tr_b16 v[176:177], v212 offset:10240
  ds_read_b64_tr_b16 v[178:179], v212 offset:11264
  s_waitcnt lgkmcnt(10)
  v_mfma_f32_32x32x16_bf16 v[144:159], v[188:191], v[100:103], v[144:159]
  ds_read_b64_tr_b16 v[180:181], v213 offset:10240
  ds_read_b64_tr_b16 v[182:183], v213 offset:11264
  buffer_load_dwordx4 v[4:7], v216, s[28:31], s46 offen offset:1024 sc1
  s_waitcnt vmcnt(7) lgkmcnt(10)
  v_mfma_f32_32x32x16_bf16 v[128:143], v[192:195], v[104:107], v[128:143]
  ds_read_b64_tr_b16 v[184:185], v212 offset:12288
  ds_read_b64_tr_b16 v[186:187], v212 offset:13312
  s_waitcnt lgkmcnt(10)
  v_mfma_f32_32x32x16_bf16 v[144:159], v[196:199], v[104:107], v[144:159]
  ds_read_b64_tr_b16 v[188:189], v213 offset:12288
  ds_read_b64_tr_b16 v[190:191], v213 offset:13312
  buffer_load_dwordx4 v[8:11], v216, s[28:31], s46 offen offset:2048 sc1
  s_waitcnt vmcnt(7) lgkmcnt(10)
  v_mfma_f32_32x32x16_bf16 v[128:143], v[200:203], v[108:111], v[128:143]
  ds_read_b64_tr_b16 v[192:193], v212 offset:14336
  ds_read_b64_tr_b16 v[194:195], v212 offset:15360
  s_waitcnt lgkmcnt(10)
  v_mfma_f32_32x32x16_bf16 v[144:159], v[204:207], v[108:111], v[144:159]
  ds_read_b64_tr_b16 v[196:197], v213 offset:14336
  ds_read_b64_tr_b16 v[198:199], v213 offset:15360
  buffer_load_dwordx4 v[12:15], v216, s[28:31], s46 offen offset:3072 sc1
  s_waitcnt vmcnt(7) lgkmcnt(10)
  v_mfma_f32_32x32x16_bf16 v[128:143], v[176:179], v[112:115], v[128:143]
  ds_read_b64_tr_b16 v[200:201], v212 offset:16384
  ds_read_b64_tr_b16 v[202:203], v212 offset:17408
  s_waitcnt lgkmcnt(10)
  v_mfma_f32_32x32x16_bf16 v[144:159], v[180:183], v[112:115], v[144:159]
  ds_read_b64_tr_b16 v[204:205], v213 offset:16384
  ds_read_b64_tr_b16 v[206:207], v213 offset:17408
  s_add_u32 s46, s46, 8192
  buffer_load_dwordx4 v[16:19], v216, s[28:31], s46 offen offset:0 sc1
  s_waitcnt vmcnt(7) lgkmcnt(10)
  v_mfma_f32_32x32x16_bf16 v[128:143], v[184:187], v[116:119], v[128:143]
  ds_read_b64_tr_b16 v[176:177], v212 offset:18432
  ds_read_b64_tr_b16 v[178:179], v212 offset:19456
  s_waitcnt lgkmcnt(10)
  v_mfma_f32_32x32x16_bf16 v[144:159], v[188:191], v[116:119], v[144:159]
  ds_read_b64_tr_b16 v[180:181], v213 offset:18432
  ds_read_b64_tr_b16 v[182:183], v213 offset:19456
  buffer_load_dwordx4 v[20:23], v216, s[28:31], s46 offen offset:1024 sc1
  s_waitcnt vmcnt(7) lgkmcnt(10)
  v_mfma_f32_32x32x16_bf16 v[128:143], v[192:195], v[120:123], v[128:143]
  ds_read_b64_tr_b16 v[184:185], v212 offset:20480
  ds_read_b64_tr_b16 v[186:187], v212 offset:21504
  s_waitcnt lgkmcnt(10)
  v_mfma_f32_32x32x16_bf16 v[144:159], v[196:199], v[120:123], v[144:159]
  ds_read_b64_tr_b16 v[188:189], v213 offset:20480
  ds_read_b64_tr_b16 v[190:191], v213 offset:21504
  buffer_load_dwordx4 v[24:27], v216, s[28:31], s46 offen offset:2048 sc1
  s_waitcnt vmcnt(7) lgkmcnt(10)
  v_mfma_f32_32x32x16_bf16 v[128:143], v[200:203], v[124:127], v[128:143]
  ds_read_b64_tr_b16 v[192:193], v212 offset:22528
  ds_read_b64_tr_b16 v[194:195], v212 offset:23552
  s_waitcnt lgkmcnt(10)
  v_mfma_f32_32x32x16_bf16 v[144:159], v[204:207], v[124:127], v[144:159]
  ds_read_b64_tr_b16 v[196:197], v213 offset:22528
  ds_read_b64_tr_b16 v[198:199], v213 offset:23552
  buffer_load_dwordx4 v[28:31], v216, s[28:31], s46 offen offset:3072 sc1
  s_waitcnt vmcnt(7) lgkmcnt(10)
  v_mfma_f32_32x32x16_bf16 v[128:143], v[176:179], v[0:3], v[128:143]
  ds_read_b64_tr_b16 v[200:201], v212 offset:24576
  ds_read_b64_tr_b16 v[202:203], v212 offset:25600
  s_waitcnt lgkmcnt(10)
  v_mfma_f32_32x32x16_bf16 v[144:159], v[180:183], v[0:3], v[144:159]
  ds_read_b64_tr_b16 v[204:205], v213 offset:24576
  ds_read_b64_tr_b16 v[206:207], v213 offset:25600
  s_add_u32 s46, s46, 8192
  buffer_load_dwordx4 v[32:35], v216, s[28:31], s46 offen offset:0 sc1
  s_waitcnt vmcnt(7) lgkmcnt(10)
  v_mfma_f32_32x32x16_bf16 v[128:143], v[184:187], v[4:7], v[128:143]
  ds_read_b64_tr_b16 v[176:177], v212 offset:26624
  ds_read_b64_tr_b16 v[178:179], v212 offset:27648
  s_waitcnt lgkmcnt(10)
  v_mfma_f32_32x32x16_bf16 v[144:159], v[188:191], v[4:7], v[144:159]
  ds_read_b64_tr_b16 v[180:181], v213 offset:26624
  ds_read_b64_tr_b16 v[182:183], v213 offset:27648
  buffer_load_dwordx4 v[36:39], v216, s[28:31], s46 offen offset:1024 sc1
  s_waitcnt vmcnt(7) lgkmcnt(10)
  v_mfma_f32_32x32x16_bf16 v[128:143], v[192:195], v[8:11], v[128:143]
  ds_read_b64_tr_b16 v[184:185], v212 offset:28672
  ds_read_b64_tr_b16 v[186:187], v212 offset:29696
  s_waitcnt lgkmcnt(10)
  v_mfma_f32_32x32x16_bf16 v[144:159], v[196:199], v[8:11], v[144:159]
  ds_read_b64_tr_b16 v[188:189], v213 offset:28672
  ds_read_b64_tr_b16 v[190:191], v213 offset:29696
  buffer_load_dwordx4 v[40:43], v216, s[28:31], s46 offen offset:2048 sc1
  s_waitcnt vmcnt(7) lgkmcnt(10)
  v_mfma_f32_32x32x16_bf16 v[128:143], v[200:203], v[12:15], v[128:143]
  ds_read_b64_tr_b16 v[192:193], v212 offset:30720
  ds_read_b64_tr_b16 v[194:195], v212 offset:31744
  s_waitcnt lgkmcnt(10)
  v_mfma_f32_32x32x16_bf16 v[144:159], v[204:207], v[12:15], v[144:159]
  ds_read_b64_tr_b16 v[196:197], v213 offset:30720
  ds_read_b64_tr_b16 v[198:199], v213 offset:31744
  buffer_load_dwordx4 v[44:47], v216, s[28:31], s46 offen offset:3072 sc1
  s_waitcnt vmcnt(7) lgkmcnt(10)
  v_mfma_f32_32x32x16_bf16 v[128:143], v[176:179], v[16:19], v[128:143]
  s_waitcnt lgkmcnt(0)
  s_barrier
  ds_read_b64_tr_b16 v[200:201], v208 offset:0
  ds_read_b64_tr_b16 v[202:203], v208 offset:1024
  v_mfma_f32_32x32x16_bf16 v[144:159], v[180:183], v[16:19], v[144:159]
  ds_read_b64_tr_b16 v[204:205], v209 offset:0
  ds_read_b64_tr_b16 v[206:207], v209 offset:1024
  s_add_u32 s46, s46, 8192
  buffer_load_dwordx4 v[48:51], v216, s[28:31], s46 offen offset:0 sc1
  s_waitcnt vmcnt(7)
  v_mfma_f32_32x32x16_bf16 v[128:143], v[184:187], v[20:23], v[128:143]
  ds_read_b64_tr_b16 v[176:177], v208 offset:2048
  ds_read_b64_tr_b16 v[178:179], v208 offset:3072
  v_mfma_f32_32x32x16_bf16 v[144:159], v[188:191], v[20:23], v[144:159]
  ds_read_b64_tr_b16 v[180:181], v209 offset:2048
  ds_read_b64_tr_b16 v[182:183], v209 offset:3072
  buffer_load_dwordx4 v[52:55], v216, s[28:31], s46 offen offset:1024 sc1
  s_waitcnt vmcnt(7)
  v_mfma_f32_32x32x16_bf16 v[128:143], v[192:195], v[24:27], v[128:143]
  ds_read_b64_tr_b16 v[184:185], v208 offset:4096
  ds_read_b64_tr_b16 v[186:187], v208 offset:5120
  v_mfma_f32_32x32x16_bf16 v[144:159], v[196:199], v[24:27], v[144:159]
  ds_read_b64_tr_b16 v[188:189], v209 offset:4096
  ds_read_b64_tr_b16 v[190:191], v209 offset:5120
  buffer_load_dwordx4 v[56:59], v216, s[28:31], s46 offen offset:2048 sc1
  s_waitcnt vmcnt(7) lgkmcnt(10)
  v_mfma_f32_32x32x16_bf16 v[128:143], v[200:203], v[28:31], v[128:143]
  ds_read_b64_tr_b16 v[192:193], v208 offset:6144
  ds_read_b64_tr_b16 v[194:195], v208 offset:7168
  s_waitcnt lgkmcnt(10)
  v_mfma_f32_32x32x16_bf16 v[144:159], v[204:207], v[28:31], v[144:159]
  ds_read_b64_tr_b16 v[196:197], v209 offset:6144
  ds_read_b64_tr_b16 v[198:199], v209 offset:7168
  buffer_load_dwordx4 v[60:63], v216, s[28:31], s46 offen offset:3072 sc1
  s_waitcnt vmcnt(7) lgkmcnt(10)
  v_mfma_f32_32x32x16_bf16 v[128:143], v[176:179], v[32:35], v[128:143]
  ds_read_b64_tr_b16 v[200:201], v208 offset:8192
  ds_read_b64_tr_b16 v[202:203], v208 offset:9216
  s_waitcnt lgkmcnt(10)
  v_mfma_f32_32x32x16_bf16 v[144:159], v[180:183], v[32:35], v[144:159]
  ds_read_b64_tr_b16 v[204:205], v209 offset:8192
  ds_read_b64_tr_b16 v[206:207], v209 offset:9216
  s_add_u32 s46, s46, 8192
  buffer_load_dwordx4 v[64:67], v216, s[28:31], s46 offen offset:0 sc1
  s_waitcnt vmcnt(7) lgkmcnt(10)
  v_mfma_f32_32x32x16_bf16 v[128:143], v[184:187], v[36:39], v[128:143]
  ds_read_b64_tr_b16 v[176:177], v208 offset:10240
  ds_read_b64_tr_b16 v[178:179], v208 offset:11264
  s_waitcnt lgkmcnt(10)
  v_mfma_f32_32x32x16_bf16 v[144:159], v[188:191], v[36:39], v[144:159]
  ds_read_b64_tr_b16 v[180:181], v209 offset:10240
  ds_read_b64_tr_b16 v[182:183], v209 offset:11264
  buffer_load_dwordx4 v[68:71], v216, s[28:31], s46 offen offset:1024 sc1
  s_waitcnt vmcnt(7) lgkmcnt(10)
  v_mfma_f32_32x32x16_bf16 v[128:143], v[192:195], v[40:43], v[128:143]
  ds_read_b64_tr_b16 v[184:185], v208 offset:12288
  ds_read_b64_tr_b16 v[186:187], v208 offset:13312
  s_waitcnt lgkmcnt(10)
  v_mfma_f32_32x32x16_bf16 v[144:159], v[196:199], v[40:43], v[144:159]
  ds_read_b64_tr_b16 v[188:189], v209 offset:12288
  ds_read_b64_tr_b16 v[190:191], v209 offset:13312
  buffer_load_dwordx4 v[72:75], v216, s[28:31], s46 offen offset:2048 sc1
  s_waitcnt vmcnt(7) lgkmcnt(10)
  v_mfma_f32_32x32x16_bf16 v[128:143], v[200:203], v[44:47], v[128:143]
  ds_read_b64_tr_b16 v[192:193], v210 offset:0
  ds_read_b64_tr_b16 v[194:195], v210 offset:1024
  s_waitcnt lgkmcnt(10)
  v_mfma_f32_32x32x16_bf16 v[144:159], v[204:207], v[44:47], v[144:159]
  ds_read_b64_tr_b16 v[196:197], v211 offset:0
  ds_read_b64_tr_b16 v[198:199], v211 offset:1024
  buffer_load_dwordx4 v[76:79], v216, s[28:31], s46 offen offset:3072 sc1
  s_waitcnt vmcnt(7) lgkmcnt(10)
  v_mfma_f32_32x32x16_bf16 v[128:143], v[176:179], v[48:51], v[128:143]
  ds_read_b64_tr_b16 v[200:201], v210 offset:2048
  ds_read_b64_tr_b16 v[202:203], v210 offset:3072
  s_waitcnt lgkmcnt(10)
  v_mfma_f32_32x32x16_bf16 v[144:159], v[180:183], v[48:51], v[144:159]
  ds_read_b64_tr_b16 v[204:205], v211 offset:2048
  ds_read_b64_tr_b16 v[206:207], v211 offset:3072
  s_add_u32 s46, s46, 8192
  buffer_load_dwordx4 v[80:83], v216, s[28:31], s46 offen offset:0 sc1
  s_waitcnt vmcnt(7) lgkmcnt(10)
  v_mfma_f32_32x32x16_bf16 v[128:143], v[184:187], v[52:55], v[128:143]
  ds_read_b64_tr_b16 v[176:177], v210 offset:4096
  ds_read_b64_tr_b16 v[178:179], v210 offset:5120
  s_waitcnt lgkmcnt(10)
  v_mfma_f32_32x32x16_bf16 v[144:159], v[188:191], v[52:55], v[144:159]
  ds_read_b64_tr_b16 v[180:181], v211 offset:4096
  ds_read_b64_tr_b16 v[182:183], v211 offset:5120
  buffer_load_dwordx4 v[84:87], v216, s[28:31], s46 offen offset:1024 sc1
  s_waitcnt vmcnt(7) lgkmcnt(10)
  v_mfma_f32_32x32x16_bf16 v[128:143], v[192:195], v[56:59], v[128:143]
  ds_read_b64_tr_b16 v[184:185], v210 offset:6144
  ds_read_b64_tr_b16 v[186:187], v210 offset:7168
  s_waitcnt lgkmcnt(10)
  v_mfma_f32_32x32x16_bf16 v[144:159], v[196:199], v[56:59], v[144:159]
  ds_read_b64_tr_b16 v[188:189], v211 offset:6144
  ds_read_b64_tr_b16 v[190:191], v211 offset:7168
  buffer_load_dwordx4 v[88:91], v216, s[28:31], s46 offen offset:2048 sc1
  s_waitcnt vmcnt(7) lgkmcnt(10)
  v_mfma_f32_32x32x16_bf16 v[128:143], v[200:203], v[60:63], v[128:143]
  ds_read_b64_tr_b16 v[192:193], v211 offset:8192
  ds_read_b64_tr_b16 v[194:195], v211 offset:9216
  s_waitcnt lgkmcnt(10)
  v_mfma_f32_32x32x16_bf16 v[144:159], v[204:207], v[60:63], v[144:159]
  ds_read_b64_tr_b16 v[196:197], v211 offset:10240
  ds_read_b64_tr_b16 v[198:199], v211 offset:11264
  buffer_load_dwordx4 v[92:95], v216, s[28:31], s46 offen offset:3072 sc1
  s_barrier
  s_waitcnt vmcnt(7) lgkmcnt(10)
  v_mfma_f32_32x32x16_bf16 v[128:143], v[176:179], v[64:67], v[128:143]
  ds_read_b64_tr_b16 v[200:201], v211 offset:12288
  ds_read_b64_tr_b16 v[202:203], v211 offset:13312
  s_waitcnt lgkmcnt(10)
  v_mfma_f32_32x32x16_bf16 v[144:159], v[180:183], v[64:67], v[144:159]
  ds_read_b64_tr_b16 v[204:205], v211 offset:14336
  ds_read_b64_tr_b16 v[206:207], v211 offset:15360
  s_waitcnt vmcnt(6) lgkmcnt(10)
  v_mfma_f32_32x32x16_bf16 v[128:143], v[184:187], v[68:71], v[128:143]
  ds_read_b64_tr_b16 v[176:177], v211 offset:16384
  ds_read_b64_tr_b16 v[178:179], v211 offset:17408
  s_waitcnt lgkmcnt(10)
  v_mfma_f32_32x32x16_bf16 v[144:159], v[188:191], v[68:71], v[144:159]
  ds_read_b64_tr_b16 v[180:181], v211 offset:18432
  ds_read_b64_tr_b16 v[182:183], v211 offset:19456
  s_waitcnt vmcnt(5) lgkmcnt(10)
  v_mfma_f32_32x32x16_bf16 v[144:159], v[192:195], v[72:75], v[144:159]
  ds_read_b64_tr_b16 v[184:185], v210 offset:8192
  ds_read_b64_tr_b16 v[186:187], v210 offset:9216
  s_waitcnt vmcnt(4) lgkmcnt(10)
  v_mfma_f32_32x32x16_bf16 v[144:159], v[196:199], v[76:79], v[144:159]
  ds_read_b64_tr_b16 v[188:189], v210 offset:10240
  ds_read_b64_tr_b16 v[190:191], v210 offset:11264
  s_waitcnt vmcnt(3) lgkmcnt(10)
  v_mfma_f32_32x32x16_bf16 v[144:159], v[200:203], v[80:83], v[144:159]
  ds_read_b64_tr_b16 v[192:193], v210 offset:12288
  ds_read_b64_tr_b16 v[194:195], v210 offset:13312
  s_waitcnt vmcnt(2) lgkmcnt(10)
  v_mfma_f32_32x32x16_bf16 v[144:159], v[204:207], v[84:87], v[144:159]
  ds_read_b64_tr_b16 v[196:197], v210 offset:14336
  ds_read_b64_tr_b16 v[198:199], v210 offset:15360
  s_waitcnt vmcnt(1) lgkmcnt(10)
  v_mfma_f32_32x32x16_bf16 v[144:159], v[176:179], v[88:91], v[144:159]
  ds_read_b64_tr_b16 v[200:201], v210 offset:16384
  ds_read_b64_tr_b16 v[202:203], v210 offset:17408
  s_waitcnt vmcnt(0) lgkmcnt(10)
  v_mfma_f32_32x32x16_bf16 v[144:159], v[180:183], v[92:95], v[144:159]
  ds_read_b64_tr_b16 v[204:205], v210 offset:18432
  ds_read_b64_tr_b16 v[206:207], v210 offset:19456
  s_waitcnt lgkmcnt(10)
  v_mfma_f32_32x32x16_bf16 v[128:143], v[184:187], v[72:75], v[128:143]
  s_add_u32 s71, s71, s69
  s_lshl_b32 s46, s53, 15
  s_lshl_b32 s48, s47, 11
  s_add_u32 s46, s46, s48
  s_add_u32 s46, s46, s71
  s_add_u32 s46, s46, 589824
  s_lshl_b32 s49, s53, 12
  s_lshr_b32 s48, s47, 2
  s_lshl_b32 s48, s48, 10
  s_add_u32 s49, s49, s48
  s_and_b32 s48, s47, 3
  s_lshl_b32 s48, s48, 2
  s_add_u32 s49, s49, s48
  s_add_u32 s49, s49, s71
  s_add_u32 s49, s49, 720896
  s_waitcnt lgkmcnt(8)
  v_mfma_f32_32x32x16_bf16 v[128:143], v[188:191], v[76:79], v[128:143]
  ds_write_b128 v217, v[144:147] offset:0
  ds_write_b128 v217, v[148:151] offset:1024
  s_waitcnt lgkmcnt(8)
  v_mfma_f32_32x32x16_bf16 v[128:143], v[192:195], v[80:83], v[128:143]
  ds_write_b128 v217, v[152:155] offset:2048
  ds_write_b128 v217, v[156:159] offset:3072
  v_mov_b32 v224, 0
  v_mov_b32 v225, 0
  v_mov_b32 v226, 0
  v_mov_b32 v227, 0
  v_and_b32 v217, 31, v214
  v_lshlrev_b32 v217, 10, v217
  v_lshl_add_u32 v217, v222, 4, v217
  s_lshl_b32 s52, s44, 15
  s_lshl_b32 s48, s47, 6
  s_add_u32 s52, s52, s48
  s_waitcnt lgkmcnt(8)
  v_mfma_f32_32x32x16_bf16 v[128:143], v[196:199], v[84:87], v[128:143]
  s_waitcnt lgkmcnt(0)
  s_barrier
  ds_read_b128 v[144:147], v218 offset:0
  ds_read_b128 v[148:151], v218 offset:1024
  ds_read_b128 v[152:155], v218 offset:2048
  ds_read_b128 v[156:159], v218 offset:3072
  v_mfma_f32_32x32x16_bf16 v[128:143], v[200:203], v[88:91], v[128:143]
  v_mfma_f32_32x32x16_bf16 v[128:143], v[204:207], v[92:95], v[128:143]
  s_nop 11
  s_waitcnt lgkmcnt(3)
  v_add_f32 v128, v128, v144
  v_add_f32 v129, v129, v145
  v_add_f32 v130, v130, v146
  v_add_f32 v131, v131, v147
  v_cvt_pk_bf16_f32 v248, v128, v129
  v_cvt_pk_bf16_f32 v249, v130, v131
  s_waitcnt lgkmcnt(2)
  v_add_f32 v132, v132, v148
  v_add_f32 v133, v133, v149
  v_add_f32 v134, v134, v150
  v_add_f32 v135, v135, v151
  v_cvt_pk_bf16_f32 v250, v132, v133
  v_cvt_pk_bf16_f32 v251, v134, v135
  s_waitcnt lgkmcnt(1)
  v_add_f32 v136, v136, v152
  v_add_f32 v137, v137, v153
  v_add_f32 v138, v138, v154
  v_add_f32 v139, v139, v155
  v_cvt_pk_bf16_f32 v252, v136, v137
  v_cvt_pk_bf16_f32 v253, v138, v139
  s_waitcnt lgkmcnt(0)
  v_add_f32 v140, v140, v156
  v_add_f32 v141, v141, v157
  v_add_f32 v142, v142, v158
  v_add_f32 v143, v143, v159
  v_cvt_pk_bf16_f32 v254, v140, v141
  v_cvt_pk_bf16_f32 v255, v142, v143
  s_cmp_lg_u32 s40, 0
  s_cbranch_scc1 W2F_83
  s_cmp_lg_u32 s39, 0
  s_cbranch_scc1 STS_85
  buffer_store_dwordx4 v[248:251], v216, s[28:31], s46 offen
  buffer_store_dwordx4 v[252:255], v216, s[28:31], s46 offen offset:1024
STD_86:
  v_dot2c_f32_bf16 v224, 0x3f803f80, v248
  v_dot2c_f32_bf16 v226, v248, v248
  v_dot2c_f32_bf16 v225, 0x3f803f80, v249
  v_dot2c_f32_bf16 v227, v249, v249
  v_dot2c_f32_bf16 v224, 0x3f803f80, v250
  v_dot2c_f32_bf16 v226, v250, v250
  v_dot2c_f32_bf16 v225, 0x3f803f80, v251
  v_dot2c_f32_bf16 v227, v251, v251
  v_dot2c_f32_bf16 v224, 0x3f803f80, v252
  v_dot2c_f32_bf16 v226, v252, v252
  v_dot2c_f32_bf16 v225, 0x3f803f80, v253
  v_dot2c_f32_bf16 v227, v253, v253
  v_dot2c_f32_bf16 v224, 0x3f803f80, v254
  v_dot2c_f32_bf16 v226, v254, v254
  v_dot2c_f32_bf16 v225, 0x3f803f80, v255
  v_dot2c_f32_bf16 v227, v255, v255
  s_nop 2
  v_add_f32 v224, v224, v225
  v_add_f32 v226, v226, v227
  s_nop 1
  v_permlane32_swap_b32 v224, v226
  v_add_f32 v224, v224, v226
  s_cmp_lg_u32 s39, 0
  s_cbranch_scc1 STS_87
  buffer_store_dword v224, v216, s[28:31], s49 offen
STD_88:
  s_branch W2D_84
W2F_83:
  s_nop 0
  v_permlane32_swap_b32 v248, v250
  v_permlane32_swap_b32 v249, v251
  v_permlane32_swap_b32 v252, v254
  v_permlane32_swap_b32 v253, v255
  buffer_store_dwordx4 v[248:251], v217, s[24:27], s52 offen
  buffer_store_dwordx4 v[252:255], v217, s[24:27], s52 offen offset:32
  s_endpgm
W2D_84:
  s_setprio 0
  s_lshl_b32 s51, s36, 7
  s_lshl_b32 s50, s37, 10
  s_add_u32 s50, s50, s51
  s_lshl_b32 s51, s38, 2
  s_add_u32 s50, s50, s51
  s_add_u32 s51, s41, 6
  v_mov_b32 v226, s50
  v_mov_b32 v227, s51
  v_mbcnt_lo_u32_b32 v159, -1, 0
  v_mbcnt_hi_u32_b32 v159, -1, v159
  s_lshr_b32 s44, s38, 4
  s_lshl_b32 s45, s37, 1
  s_add_u32 s44, s44, s45
  s_mul_i32 s44, s44, 737280
  v_lshlrev_b32 v159, 4, v159
  s_add_u32 s55, s44, s69
  s_lshl_b32 s45, s36, 12
  s_add_u32 s45, s45, s55
  s_add_u32 s45, s45, 720896
  s_lshl_b32 s48, s36, 15
  s_add_u32 s55, s55, s48
  s_add_u32 s55, s55, 589824
  v_mbcnt_lo_u32_b32 v232, -1, 0
  v_mbcnt_hi_u32_b32 v232, -1, v232
  s_lshl_b32 s50, s37, 10
  s_and_b32 s51, s36, 1
  s_lshl_b32 s51, s51, 7
  s_add_u32 s50, s50, s51
  s_lshr_b32 s51, s38, 4
  s_lshl_b32 s51, s51, 1
  s_lshr_b32 s52, s36, 1
  s_add_u32 s51, s51, s52
  s_lshl_b32 s51, s51, 5
  s_add_u32 s50, s50, s51
  v_bfe_u32 v233, v232, 3, 1
  v_and_b32 v232, 7, v232
  v_lshl_add_u32 v232, v232, 2, s50
  v_lshl_add_u32 v232, v233, 8, v232
  s_waitcnt vmcnt(0)
  s_mov_b64 exec, 1
  s_cmp_lg_u32 s39, 0
  s_cbranch_scc1 STS_91
  global_store_dword v226, v227, s[34:35]
STD_92:
  s_mov_b64 exec, -1
  s_cmp_lg_u32 s40, 0
  s_cbranch_scc1 L_END
  s_mov_b32 s41, 6
  s_mov_b32 s40, 1
  s_andn2_b32 s90, s66, s39
  s_mov_b32 s66, s39
  s_mov_b32 s91, s39
  s_mov_b32 s60, 6291456
  s_mul_i32 s61, s39, 58982400
  s_add_u32 s61, s61, 10485760
  s_mov_b32 s65, s38
  s_mov_b32 s70, s37
  s_add_u32 s42, s40, 1
  s_setprio 1
  global_load_dword v233, v232, s[34:35] sc1
  s_barrier
  s_add_u32 s51, s41, 0
  s_mov_b32 s50, 0x20000
POLL_97:
  global_load_dword v234, v232, s[34:35] sc1
  s_waitcnt vmcnt(1)
  v_cmp_gt_u32 vcc, s51, v233
  s_nop 0
  s_cbranch_vccz POLLX_98
  global_load_dword v233, v232, s[34:35] sc1
  s_waitcnt vmcnt(1)
  v_cmp_gt_u32 vcc, s51, v234
  s_nop 0
  s_cbranch_vccz POLLX_98
  s_sub_u32 s50, s50, 1
  s_cmp_lg_u32 s50, 0
  s_cbranch_scc1 POLL_97
POLLX_98:
  buffer_load_dwordx4 v[0:3], v159, s[28:31], s55 offen offset:0 sc1
  buffer_load_dwordx4 v[4:7], v159, s[28:31], s55 offen offset:1024 sc1
  buffer_load_dwordx4 v[8:11], v159, s[28:31], s55 offen offset:2048 sc1
  buffer_load_dwordx4 v[12:15], v159, s[28:31], s55 offen offset:3072 sc1
  buffer_load_dwordx4 v[216:219], v159, s[28:31], s45 offen offset:0 sc1
  buffer_load_dwordx4 v[220:223], v159, s[28:31], s45 offen offset:1024 sc1
  buffer_load_dwordx4 v[224:227], v159, s[28:31], s45 offen offset:2048 sc1
  buffer_load_dwordx4 v[228:231], v159, s[28:31], s45 offen offset:3072 sc1
  s_add_u32 s55, s55, 4096
  buffer_load_dwordx4 v[16:19], v159, s[28:31], s55 offen offset:0 sc1
  buffer_load_dwordx4 v[20:23], v159, s[28:31], s55 offen offset:1024 sc1
  buffer_load_dwordx4 v[24:27], v159, s[28:31], s55 offen offset:2048 sc1
  buffer_load_dwordx4 v[28:31], v159, s[28:31], s55 offen offset:3072 sc1
  s_add_u32 s55, s55, 4096
  buffer_load_dwordx4 v[32:35], v159, s[28:31], s55 offen offset:0 sc1
  buffer_load_dwordx4 v[36:39], v159, s[28:31], s55 offen offset:1024 sc1
  v_mbcnt_lo_u32_b32 v212, -1, 0
  v_mbcnt_hi_u32_b32 v212, -1, v212
  s_lshr_b32 s44, s38, 4
  s_lshl_b32 s45, s37, 1
  s_add_u32 s44, s44, s45
  s_mul_i32 s71, s44, 737280
  s_lshl_b32 s44, s44, 2
  s_add_u32 s44, s44, s36
  v_bfe_u32 v176, v212, 2, 2
  v_bfe_u32 v177, v212, 4, 1
  v_lshlrev_b32 v177, 5, v177
  v_and_b32 v178, 3, v212
  v_lshl_add_u32 v177, v178, 3, v177
  v_lshrrev_b32 v178, 5, v212
  v_lshl_add_u32 v208, v178, 2, v176
  v_add_u32 v209, 8, v208
  v_mul_u32_u24 v208, 192, v208
  v_add_u32 v208, v208, v177
  v_add_u32 v210, 49152, v208
  v_mul_u32_u24 v209, 192, v209
  v_add_u32 v209, v209, v177
  v_add_u32 v211, 49152, v209
  s_barrier
  s_cmp_eq_u32 s90, 0
  s_cbranch_scc1 DYN_99
  s_barrier
DYN_99:
  ds_read_b64_tr_b16 v[176:177], v208 offset:128
  ds_read_b64_tr_b16 v[178:179], v209 offset:128
  ds_read_b64_tr_b16 v[180:181], v208 offset:0
  ds_read_b64_tr_b16 v[182:183], v209 offset:0
  ds_read_b64_tr_b16 v[184:185], v208 offset:3200
  ds_read_b64_tr_b16 v[186:187], v209 offset:3200
  ds_read_b64_tr_b16 v[188:189], v208 offset:3072
  ds_read_b64_tr_b16 v[190:191], v209 offset:3072
  ds_read_b64_tr_b16 v[192:193], v208 offset:6272
  ds_read_b64_tr_b16 v[194:195], v209 offset:6272
  ds_read_b64_tr_b16 v[196:197], v208 offset:6144
  ds_read_b64_tr_b16 v[198:199], v209 offset:6144
  s_waitcnt vmcnt(13) lgkmcnt(10)
  v_mfma_f32_32x32x16_bf16 v[160:175], v[0:3], v[176:179], 0
  ds_read_b64_tr_b16 v[200:201], v208 offset:9344
  ds_read_b64_tr_b16 v[202:203], v209 offset:9344
  s_waitcnt lgkmcnt(10)
  v_mfma_f32_32x32x16_bf16 v[128:143], v[180:183], v[0:3], 0
  ds_read_b64_tr_b16 v[204:205], v208 offset:9216
  ds_read_b64_tr_b16 v[206:207], v209 offset:9216
  buffer_load_dwordx4 v[40:43], v159, s[28:31], s55 offen offset:2048 sc1
  s_waitcnt vmcnt(13) lgkmcnt(10)
  v_mfma_f32_32x32x16_bf16 v[160:175], v[4:7], v[184:187], v[160:175]
  ds_read_b64_tr_b16 v[176:177], v208 offset:12416
  ds_read_b64_tr_b16 v[178:179], v209 offset:12416
  s_waitcnt lgkmcnt(10)
  v_mfma_f32_32x32x16_bf16 v[128:143], v[188:191], v[4:7], v[128:143]
  ds_read_b64_tr_b16 v[180:181], v208 offset:12288
  ds_read_b64_tr_b16 v[182:183], v209 offset:12288
  buffer_load_dwordx4 v[44:47], v159, s[28:31], s55 offen offset:3072 sc1
  s_waitcnt vmcnt(13) lgkmcnt(10)
  v_mfma_f32_32x32x16_bf16 v[160:175], v[8:11], v[192:195], v[160:175]
  ds_read_b64_tr_b16 v[184:185], v208 offset:15488
  ds_read_b64_tr_b16 v[186:187], v209 offset:15488
  s_waitcnt lgkmcnt(10)
  v_mfma_f32_32x32x16_bf16 v[128:143], v[196:199], v[8:11], v[128:143]
  ds_read_b64_tr_b16 v[188:189], v208 offset:15360
  ds_read_b64_tr_b16 v[190:191], v209 offset:15360
  s_add_u32 s55, s55, 4096
  buffer_load_dwordx4 v[48:51], v159, s[28:31], s55 offen offset:0 sc1
  s_waitcnt vmcnt(13) lgkmcnt(10)
  v_mfma_f32_32x32x16_bf16 v[160:175], v[12:15], v[200:203], v[160:175]
  ds_read_b64_tr_b16 v[192:193], v208 offset:18560
  ds_read_b64_tr_b16 v[194:195], v209 offset:18560
  s_waitcnt lgkmcnt(10)
  v_mfma_f32_32x32x16_bf16 v[128:143], v[204:207], v[12:15], v[128:143]
  ds_read_b64_tr_b16 v[196:197], v208 offset:18432
  ds_read_b64_tr_b16 v[198:199], v209 offset:18432
  buffer_load_dwordx4 v[52:55], v159, s[28:31], s55 offen offset:1024 sc1
  s_waitcnt vmcnt(9) lgkmcnt(10)
  v_mfma_f32_32x32x16_bf16 v[160:175], v[16:19], v[176:179], v[160:175]
  ds_read_b64_tr_b16 v[200:201], v208 offset:21632
  ds_read_b64_tr_b16 v[202:203], v209 offset:21632
  v_add_f32 v216, v216, v224
  v_add_f32 v217, v217, v225
  s_waitcnt lgkmcnt(10)
  v_mfma_f32_32x32x16_bf16 v[128:143], v[180:183], v[16:19], v[128:143]
  ds_read_b64_tr_b16 v[204:205], v208 offset:21504
  ds_read_b64_tr_b16 v[206:207], v209 offset:21504
  buffer_load_dwordx4 v[56:59], v159, s[28:31], s55 offen offset:2048 sc1
  v_add_f32 v218, v218, v226
  v_add_f32 v219, v219, v227
  s_waitcnt vmcnt(9) lgkmcnt(10)
  v_mfma_f32_32x32x16_bf16 v[160:175], v[20:23], v[184:187], v[160:175]
  ds_read_b64_tr_b16 v[176:177], v208 offset:24704
  ds_read_b64_tr_b16 v[178:179], v209 offset:24704
  v_add_f32 v220, v220, v228
  v_add_f32 v221, v221, v229
  s_waitcnt lgkmcnt(10)
  v_mfma_f32_32x32x16_bf16 v[128:143], v[188:191], v[20:23], v[128:143]
  ds_read_b64_tr_b16 v[180:181], v208 offset:24576
  ds_read_b64_tr_b16 v[182:183], v209 offset:24576
  buffer_load_dwordx4 v[60:63], v159, s[28:31], s55 offen offset:3072 sc1
  v_add_f32 v222, v222, v230
  v_add_f32 v223, v223, v231
  s_waitcnt vmcnt(9) lgkmcnt(10)
  v_mfma_f32_32x32x16_bf16 v[160:175], v[24:27], v[192:195], v[160:175]
  ds_read_b64_tr_b16 v[184:185], v208 offset:27776
  ds_read_b64_tr_b16 v[186:187], v209 offset:27776
  v_add_f32 v216, v216, v220
  v_add_f32 v217, v217, v221
  s_waitcnt lgkmcnt(10)
  v_mfma_f32_32x32x16_bf16 v[128:143], v[196:199], v[24:27], v[128:143]
  ds_read_b64_tr_b16 v[188:189], v208 offset:27648
  ds_read_b64_tr_b16 v[190:191], v209 offset:27648
  s_add_u32 s55, s55, 4096
  buffer_load_dwordx4 v[64:67], v159, s[28:31], s55 offen offset:0 sc1
  v_add_f32 v218, v218, v222
  v_add_f32 v219, v219, v223
  s_waitcnt vmcnt(9) lgkmcnt(10)
  v_mfma_f32_32x32x16_bf16 v[160:175], v[28:31], v[200:203], v[160:175]
  ds_read_b64_tr_b16 v[192:193], v208 offset:30848
  ds_read_b64_tr_b16 v[194:195], v209 offset:30848
  v_add_f32 v216, v216, v218
  v_add_f32 v217, v217, v219
  s_waitcnt lgkmcnt(10)
  v_mfma_f32_32x32x16_bf16 v[128:143], v[204:207], v[28:31], v[128:143]
  ds_read_b64_tr_b16 v[196:197], v208 offset:30720
  ds_read_b64_tr_b16 v[198:199], v209 offset:30720
  buffer_load_dwordx4 v[68:71], v159, s[28:31], s55 offen offset:1024 sc1
  v_add_f32 v216, v216, v217
  v_mov_b32 v236, v216
  s_waitcnt vmcnt(9) lgkmcnt(10)
  v_mfma_f32_32x32x16_bf16 v[160:175], v[32:35], v[176:179], v[160:175]
  ds_read_b64_tr_b16 v[200:201], v208 offset:33920
  ds_read_b64_tr_b16 v[202:203], v209 offset:33920
  v_mov_b32 v237, v216
  s_nop 1
  s_waitcnt lgkmcnt(10)
  v_mfma_f32_32x32x16_bf16 v[128:143], v[180:183], v[32:35], v[128:143]
  ds_read_b64_tr_b16 v[204:205], v208 offset:33792
  ds_read_b64_tr_b16 v[206:207], v209 offset:33792
  buffer_load_dwordx4 v[72:75], v159, s[28:31], s55 offen offset:2048 sc1
  v_permlane32_swap_b32 v236, v237
  v_mul_f32 v236, 0xbb000000, v236
  s_waitcnt vmcnt(9) lgkmcnt(10)
  v_mfma_f32_32x32x16_bf16 v[160:175], v[36:39], v[184:187], v[160:175]
  ds_read_b64_tr_b16 v[176:177], v208 offset:36992
  ds_read_b64_tr_b16 v[178:179], v209 offset:36992
  v_mul_f32 v237, 0x3b000000, v237
  v_fma_f32 v237, -v236, v236, v237
  s_waitcnt lgkmcnt(10)
  v_mfma_f32_32x32x16_bf16 v[128:143], v[188:191], v[36:39], v[128:143]
  ds_read_b64_tr_b16 v[180:181], v208 offset:36864
  ds_read_b64_tr_b16 v[182:183], v209 offset:36864
  buffer_load_dwordx4 v[76:79], v159, s[28:31], s55 offen offset:3072 sc1
  v_max_f32 v237, 0, v237
  v_add_f32 v237, 0x3727c5ac, v237
  s_waitcnt vmcnt(9) lgkmcnt(10)
  v_mfma_f32_32x32x16_bf16 v[160:175], v[40:43], v[192:195], v[160:175]
  ds_read_b64_tr_b16 v[184:185], v208 offset:40064
  ds_read_b64_tr_b16 v[186:187], v209 offset:40064
  v_rsq_f32 v213, v237
  v_cmp_gt_u32 vcc, 32, v212
  s_waitcnt lgkmcnt(10)
  v_mfma_f32_32x32x16_bf16 v[128:143], v[196:199], v[40:43], v[128:143]
  ds_read_b64_tr_b16 v[188:189], v208 offset:39936
  ds_read_b64_tr_b16 v[190:191], v209 offset:39936
  s_add_u32 s55, s55, 4096
  buffer_load_dwordx4 v[80:83], v159, s[28:31], s55 offen offset:0 sc1
  v_cvt_pk_bf16_f32 v232, v236, v236
  v_lshlrev_b32 v237, 16, v232
  s_waitcnt vmcnt(9) lgkmcnt(10)
  v_mfma_f32_32x32x16_bf16 v[160:175], v[44:47], v[200:203], v[160:175]
  ds_read_b64_tr_b16 v[192:193], v208 offset:43136
  ds_read_b64_tr_b16 v[194:195], v209 offset:43136
  v_sub_f32 v236, v236, v237
  v_cvt_pk_bf16_f32 v233, v236, 0
  s_waitcnt lgkmcnt(10)
  v_mfma_f32_32x32x16_bf16 v[128:143], v[204:207], v[44:47], v[128:143]
  ds_read_b64_tr_b16 v[196:197], v208 offset:43008
  ds_read_b64_tr_b16 v[198:199], v209 offset:43008
  buffer_load_dwordx4 v[84:87], v159, s[28:31], s55 offen offset:1024 sc1
  v_cndmask_b32 v232, 0, v232, vcc
  v_cndmask_b32 v233, 0, v233, vcc
  s_waitcnt vmcnt(9) lgkmcnt(10)
  v_mfma_f32_32x32x16_bf16 v[160:175], v[48:51], v[176:179], v[160:175]
  ds_read_b64_tr_b16 v[200:201], v208 offset:46208
  ds_read_b64_tr_b16 v[202:203], v209 offset:46208
  v_mov_b32 v234, 0
  v_mov_b32 v235, 0
  s_waitcnt lgkmcnt(10)
  v_mfma_f32_32x32x16_bf16 v[128:143], v[180:183], v[48:51], v[128:143]
  ds_read_b64_tr_b16 v[204:205], v208 offset:46080
  ds_read_b64_tr_b16 v[206:207], v209 offset:46080
  buffer_load_dwordx4 v[88:91], v159, s[28:31], s55 offen offset:2048 sc1
  v_and_b32 v231, 31, v212
  v_lshlrev_b32 v231, 2, v231
  s_waitcnt vmcnt(9) lgkmcnt(10)
  v_mfma_f32_32x32x16_bf16 v[160:175], v[52:55], v[184:187], v[160:175]
  ds_read_b64_tr_b16 v[176:177], v210 offset:128
  ds_read_b64_tr_b16 v[178:179], v211 offset:128
  s_lshl_b32 s50, s36, 8
  s_add_u32 s50, s50, 160768
  s_waitcnt lgkmcnt(10)
  v_mfma_f32_32x32x16_bf16 v[128:143], v[188:191], v[52:55], v[128:143]
  ds_read_b64_tr_b16 v[180:181], v210 offset:0
  ds_read_b64_tr_b16 v[182:183], v211 offset:0
  buffer_load_dwordx4 v[92:95], v159, s[28:31], s55 offen offset:3072 sc1
  v_add_u32 v214, s50, v231
  ds_write_b32 v214, v213
  s_waitcnt vmcnt(9) lgkmcnt(11)
  v_mfma_f32_32x32x16_bf16 v[160:175], v[56:59], v[192:195], v[160:175]
  ds_read_b64_tr_b16 v[184:185], v210 offset:3200
  ds_read_b64_tr_b16 v[186:187], v211 offset:3200
  v_add_u32 v247, 161792, v231
  v_lshrrev_b32 v214, 5, v212
  s_waitcnt lgkmcnt(11)
  v_mfma_f32_32x32x16_bf16 v[128:143], v[196:199], v[56:59], v[128:143]
  ds_read_b64_tr_b16 v[188:189], v210 offset:3072
  ds_read_b64_tr_b16 v[190:191], v211 offset:3072
  s_add_u32 s55, s55, 4096
  buffer_load_dwordx4 v[96:99], v159, s[28:31], s55 offen offset:0 sc1
  v_lshl_add_u32 v214, v214, 4, s50
  ds_read_b128 v[216:219], v214 offset:0
  s_waitcnt vmcnt(9) lgkmcnt(12)
  v_mfma_f32_32x32x16_bf16 v[160:175], v[60:63], v[200:203], v[160:175]
  ds_read_b64_tr_b16 v[192:193], v210 offset:6272
  ds_read_b64_tr_b16 v[194:195], v211 offset:6272
  ds_read_b128 v[220:223], v214 offset:32
  ds_read_b128 v[224:227], v214 offset:64
  s_waitcnt lgkmcnt(14)
  v_mfma_f32_32x32x16_bf16 v[128:143], v[204:207], v[60:63], v[128:143]
  ds_read_b64_tr_b16 v[196:197], v210 offset:6144
  ds_read_b64_tr_b16 v[198:199], v211 offset:6144
  buffer_load_dwordx4 v[100:103], v159, s[28:31], s55 offen offset:1024 sc1
  ds_read_b128 v[228:231], v214 offset:96
  ds_read_b32 v238, v247 offset:0
  s_waitcnt vmcnt(9) lgkmcnt(15)
  v_mfma_f32_32x32x16_bf16 v[160:175], v[64:67], v[176:179], v[160:175]
  ds_read_b64_tr_b16 v[200:201], v210 offset:9344
  ds_read_b64_tr_b16 v[202:203], v211 offset:9344
  s_waitcnt lgkmcnt(2)
  v_cvt_pk_bf16_f32 v237, v238, 0
  v_lshlrev_b32 v239, 16, v237
  v_mfma_f32_32x32x16_bf16 v[128:143], v[180:183], v[64:67], v[128:143]
  ds_read_b64_tr_b16 v[204:205], v210 offset:9216
  ds_read_b64_tr_b16 v[206:207], v211 offset:9216
  buffer_load_dwordx4 v[104:107], v159, s[28:31], s55 offen offset:2048 sc1
  v_sub_f32 v239, v238, v239
  v_cvt_pk_bf16_f32 v236, v238, v239
  s_waitcnt vmcnt(9)
  v_mfma_f32_32x32x16_bf16 v[160:175], v[68:71], v[184:187], v[160:175]
  ds_read_b64_tr_b16 v[176:177], v210 offset:12416
  ds_read_b64_tr_b16 v[178:179], v211 offset:12416
  v_mov_b32 v238, 0
  v_mov_b32 v239, 0
  v_mfma_f32_32x32x16_bf16 v[128:143], v[188:191], v[68:71], v[128:143]
  ds_read_b64_tr_b16 v[180:181], v210 offset:12288
  ds_read_b64_tr_b16 v[182:183], v211 offset:12288
  buffer_load_dwordx4 v[108:111], v159, s[28:31], s55 offen offset:3072 sc1
  ds_read_b32 v242, v247 offset:128
  s_waitcnt lgkmcnt(0)
  v_cvt_pk_bf16_f32 v241, v242, 0
  s_waitcnt vmcnt(9)
  v_mfma_f32_32x32x16_bf16 v[160:175], v[72:75], v[192:195], v[160:175]
  ds_read_b64_tr_b16 v[184:185], v210 offset:15488
  ds_read_b64_tr_b16 v[186:187], v211 offset:15488
  v_lshlrev_b32 v243, 16, v241
  v_sub_f32 v243, v242, v243
  v_mfma_f32_32x32x16_bf16 v[128:143], v[196:199], v[72:75], v[128:143]
  ds_read_b64_tr_b16 v[188:189], v210 offset:15360
  ds_read_b64_tr_b16 v[190:191], v211 offset:15360
  s_add_u32 s55, s55, 4096
  buffer_load_dwordx4 v[112:115], v159, s[28:31], s55 offen offset:0 sc1
  v_cvt_pk_bf16_f32 v240, v242, v243
  v_mov_b32 v242, 0
  s_waitcnt vmcnt(9)
  v_mfma_f32_32x32x16_bf16 v[160:175], v[76:79], v[200:203], v[160:175]
  ds_read_b64_tr_b16 v[192:193], v210 offset:18560
  ds_read_b64_tr_b16 v[194:195], v211 offset:18560
  v_mov_b32 v243, 0
  v_mov_b32 v214, v247
  v_mfma_f32_32x32x16_bf16 v[128:143], v[204:207], v[76:79], v[128:143]
  ds_read_b64_tr_b16 v[196:197], v210 offset:18432
  ds_read_b64_tr_b16 v[198:199], v211 offset:18432
  buffer_load_dwordx4 v[116:119], v159, s[28:31], s55 offen offset:1024 sc1
  ds_read_b32 v246, v214 offset:256
  s_waitcnt lgkmcnt(0)
  v_cvt_pk_bf16_f32 v245, v246, 0
  s_waitcnt vmcnt(9)
  v_mfma_f32_32x32x16_bf16 v[160:175], v[80:83], v[176:179], v[160:175]
  ds_read_b64_tr_b16 v[200:201], v210 offset:21632
  ds_read_b64_tr_b16 v[202:203], v211 offset:21632
  v_lshlrev_b32 v247, 16, v245
  v_sub_f32 v247, v246, v247
  v_mfma_f32_32x32x16_bf16 v[128:143], v[180:183], v[80:83], v[128:143]
  ds_read_b64_tr_b16 v[204:205], v210 offset:21504
  ds_read_b64_tr_b16 v[206:207], v211 offset:21504
  buffer_load_dwordx4 v[120:123], v159, s[28:31], s55 offen offset:2048 sc1
  v_cvt_pk_bf16_f32 v244, v246, v247
  v_mov_b32 v246, 0
  s_waitcnt vmcnt(9)
  v_mfma_f32_32x32x16_bf16 v[160:175], v[84:87], v[184:187], v[160:175]
  ds_read_b64_tr_b16 v[176:177], v210 offset:24704
  ds_read_b64_tr_b16 v[178:179], v211 offset:24704
  v_mov_b32 v247, 0
  s_and_b32 s49, s65, 15
  v_mfma_f32_32x32x16_bf16 v[128:143], v[188:191], v[84:87], v[128:143]
  ds_read_b64_tr_b16 v[180:181], v210 offset:24576
  ds_read_b64_tr_b16 v[182:183], v211 offset:24576
  buffer_load_dwordx4 v[124:127], v159, s[28:31], s55 offen offset:3072 sc1
  s_lshr_b32 s51, s49, 1
  s_and_b32 s49, s49, 1
  s_waitcnt vmcnt(9)
  v_mfma_f32_32x32x16_bf16 v[160:175], v[88:91], v[192:195], v[160:175]
  ds_read_b64_tr_b16 v[184:185], v210 offset:27776
  ds_read_b64_tr_b16 v[186:187], v211 offset:27776
  s_mul_i32 s45, s36, 114688
  s_add_u32 s45, s45, s61
  v_mfma_f32_32x32x16_bf16 v[128:143], v[196:199], v[88:91], v[128:143]
  ds_read_b64_tr_b16 v[188:189], v210 offset:27648
  ds_read_b64_tr_b16 v[190:191], v211 offset:27648
  s_add_u32 s45, s45, s71
  s_lshl_b32 s52, s51, 12
  s_waitcnt vmcnt(8) lgkmcnt(10)
  v_mfma_f32_32x32x16_bf16 v[160:175], v[92:95], v[200:203], v[160:175]
  ds_read_b64_tr_b16 v[192:193], v210 offset:30848
  ds_read_b64_tr_b16 v[194:195], v211 offset:30848
  s_add_u32 s45, s45, s52
  s_add_u32 s46, s45, 65536
  s_waitcnt lgkmcnt(10)
  v_mfma_f32_32x32x16_bf16 v[128:143], v[204:207], v[92:95], v[128:143]
  ds_read_b64_tr_b16 v[196:197], v210 offset:30720
  ds_read_b64_tr_b16 v[198:199], v211 offset:30720
  s_lshl_b32 s52, s49, 11
  s_add_u32 s46, s46, s52
  s_waitcnt vmcnt(7) lgkmcnt(10)
  v_mfma_f32_32x32x16_bf16 v[160:175], v[96:99], v[176:179], v[160:175]
  ds_read_b64_tr_b16 v[200:201], v210 offset:33920
  ds_read_b64_tr_b16 v[202:203], v211 offset:33920
  s_lshl_b32 s52, s49, 15
  s_add_u32 s45, s45, s52
  s_waitcnt lgkmcnt(10)
  v_mfma_f32_32x32x16_bf16 v[128:143], v[180:183], v[96:99], v[128:143]
  ds_read_b64_tr_b16 v[204:205], v210 offset:33792
  ds_read_b64_tr_b16 v[206:207], v211 offset:33792
  s_lshl_b32 s52, s49, 17
  s_lshl_b32 s53, s44, 10
  s_waitcnt vmcnt(6) lgkmcnt(10)
  v_mfma_f32_32x32x16_bf16 v[160:175], v[100:103], v[184:187], v[160:175]
  ds_read_b64_tr_b16 v[176:177], v210 offset:36992
  ds_read_b64_tr_b16 v[178:179], v211 offset:36992
  s_add_u32 s53, s53, s60
  s_lshl_b32 s54, s51, 18
  s_waitcnt lgkmcnt(10)
  v_mfma_f32_32x32x16_bf16 v[128:143], v[188:191], v[100:103], v[128:143]
  ds_read_b64_tr_b16 v[180:181], v210 offset:36864
  ds_read_b64_tr_b16 v[182:183], v211 offset:36864
  s_add_u32 s53, s53, s54
  s_add_u32 s54, s53, 2097152
  s_waitcnt vmcnt(5) lgkmcnt(10)
  v_mfma_f32_32x32x16_bf16 v[160:175], v[104:107], v[192:195], v[160:175]
  ds_read_b64_tr_b16 v[184:185], v210 offset:40064
  ds_read_b64_tr_b16 v[186:187], v211 offset:40064
  s_add_u32 s54, s54, s52
  s_cmp_eq_u32 s49, 0
  s_cselect_b32 s47, 0x3eb8aa3b, 1.0
  s_cselect_b32 s48, 0, 12
  s_waitcnt lgkmcnt(10)
  v_mfma_f32_32x32x16_bf16 v[128:143], v[196:199], v[104:107], v[128:143]
  ds_read_b64_tr_b16 v[188:189], v210 offset:39936
  ds_read_b64_tr_b16 v[190:191], v211 offset:39936
  v_lshrrev_b32 v214, 1, v212
  v_xor_b32 v214, v214, v212
  s_waitcnt vmcnt(4) lgkmcnt(10)
  v_mfma_f32_32x32x16_bf16 v[160:175], v[108:111], v[200:203], v[160:175]
  ds_read_b64_tr_b16 v[192:193], v210 offset:43136
  ds_read_b64_tr_b16 v[194:195], v211 offset:43136
  v_bfe_i32 v214, v214, 2, 1
  v_and_b32 v214, s48, v214
  s_waitcnt lgkmcnt(10)
  v_mfma_f32_32x32x16_bf16 v[128:143], v[204:207], v[108:111], v[128:143]
  ds_read_b64_tr_b16 v[196:197], v210 offset:43008
  ds_read_b64_tr_b16 v[198:199], v211 offset:43008
  v_xor_b32 v214, v214, v212
  v_lshlrev_b32 v214, 4, v214
  s_waitcnt vmcnt(3) lgkmcnt(10)
  v_mfma_f32_32x32x16_bf16 v[160:175], v[112:115], v[176:179], v[160:175]
  ds_read_b64_tr_b16 v[200:201], v210 offset:46208
  ds_read_b64_tr_b16 v[202:203], v211 offset:46208
  v_mul_f32 v213, s47, v213
  s_waitcnt lgkmcnt(10)
  v_mfma_f32_32x32x16_bf16 v[128:143], v[180:183], v[112:115], v[128:143]
  ds_read_b64_tr_b16 v[204:205], v210 offset:46080
  ds_read_b64_tr_b16 v[206:207], v211 offset:46080
  s_waitcnt vmcnt(2) lgkmcnt(10)
  v_mfma_f32_32x32x16_bf16 v[160:175], v[116:119], v[184:187], v[160:175]
  ds_read_b64_tr_b16 v[176:177], v208 offset:64
  ds_read_b64_tr_b16 v[178:179], v209 offset:64
  s_waitcnt lgkmcnt(10)
  v_mfma_f32_32x32x16_bf16 v[128:143], v[188:191], v[116:119], v[128:143]
  ds_read_b64_tr_b16 v[180:181], v208 offset:3136
  ds_read_b64_tr_b16 v[182:183], v209 offset:3136
  s_waitcnt vmcnt(1) lgkmcnt(10)
  v_mfma_f32_32x32x16_bf16 v[160:175], v[120:123], v[192:195], v[160:175]
  ds_read_b64_tr_b16 v[184:185], v208 offset:6208
  ds_read_b64_tr_b16 v[186:187], v209 offset:6208
  s_waitcnt lgkmcnt(10)
  v_mfma_f32_32x32x16_bf16 v[128:143], v[196:199], v[120:123], v[128:143]
  ds_read_b64_tr_b16 v[188:189], v208 offset:9280
  ds_read_b64_tr_b16 v[190:191], v209 offset:9280
  s_waitcnt vmcnt(0) lgkmcnt(10)
  v_mfma_f32_32x32x16_bf16 v[160:175], v[124:127], v[200:203], v[160:175]
  ds_read_b64_tr_b16 v[192:193], v208 offset:12352
  ds_read_b64_tr_b16 v[194:195], v209 offset:12352
  s_waitcnt lgkmcnt(10)
  v_mfma_f32_32x32x16_bf16 v[128:143], v[204:207], v[124:127], v[128:143]
  ds_read_b64_tr_b16 v[196:197], v208 offset:15424
  ds_read_b64_tr_b16 v[198:199], v209 offset:15424
  v_mfma_f32_32x32x16_bf16 v[160:175], v[232:235], v[244:247], v[160:175]
  v_mfma_f32_32x32x16_bf16 v[128:143], v[236:239], v[232:235], v[128:143]
  s_waitcnt lgkmcnt(10)
  v_mfma_f32_32x32x16_bf16 v[144:159], v[176:179], v[0:3], 0
  ds_read_b64_tr_b16 v[200:201], v208 offset:18496
  ds_read_b64_tr_b16 v[202:203], v209 offset:18496
  v_and_b32 v244, 15, v212
  v_lshlrev_b32 v244, 4, v244
  v_lshrrev_b32 v245, 5, v212
  s_waitcnt lgkmcnt(10)
  v_mfma_f32_32x32x16_bf16 v[144:159], v[180:183], v[4:7], v[144:159]
  ds_read_b64_tr_b16 v[204:205], v208 offset:21568
  ds_read_b64_tr_b16 v[206:207], v209 offset:21568
  v_lshl_add_u32 v244, v245, 8, v244
  v_bfe_u32 v212, v212, 4, 1
  v_lshl_add_u32 v245, v212, 10, v244
  s_waitcnt lgkmcnt(10)
  v_mfma_f32_32x32x16_bf16 v[144:159], v[184:187], v[8:11], v[144:159]
  ds_read_b64_tr_b16 v[176:177], v208 offset:24640
  ds_read_b64_tr_b16 v[178:179], v209 offset:24640
  v_lshl_add_u32 v244, v212, 16, v244
  v_mul_f32 v160, v216, v160
  v_mul_f32 v161, v217, v161
  s_waitcnt lgkmcnt(10)
  v_mfma_f32_32x32x16_bf16 v[144:159], v[188:191], v[12:15], v[144:159]
  ds_read_b64_tr_b16 v[180:181], v208 offset:27712
  ds_read_b64_tr_b16 v[182:183], v209 offset:27712
  v_mul_f32 v162, v218, v162
  v_mul_f32 v163, v219, v163
  v_mul_f32 v164, v220, v164
  s_waitcnt lgkmcnt(10)
  v_mfma_f32_32x32x16_bf16 v[144:159], v[192:195], v[16:19], v[144:159]
  ds_read_b64_tr_b16 v[184:185], v208 offset:30784
  ds_read_b64_tr_b16 v[186:187], v209 offset:30784
  v_mul_f32 v165, v221, v165
  v_mul_f32 v166, v222, v166
  v_mul_f32 v167, v223, v167
  s_waitcnt lgkmcnt(10)
  v_mfma_f32_32x32x16_bf16 v[144:159], v[196:199], v[20:23], v[144:159]
  ds_read_b64_tr_b16 v[188:189], v208 offset:33856
  ds_read_b64_tr_b16 v[190:191], v209 offset:33856
  v_cvt_pk_bf16_f32 v160, v160, v161
  v_cvt_pk_bf16_f32 v161, v162, v163
  v_cvt_pk_bf16_f32 v162, v164, v165
  s_waitcnt lgkmcnt(10)
  v_mfma_f32_32x32x16_bf16 v[144:159], v[200:203], v[24:27], v[144:159]
  ds_read_b64_tr_b16 v[192:193], v208 offset:36928
  ds_read_b64_tr_b16 v[194:195], v209 offset:36928
  v_cvt_pk_bf16_f32 v163, v166, v167
  v_mul_f32 v168, v224, v168
  v_mul_f32 v169, v225, v169
  s_waitcnt lgkmcnt(10)
  v_mfma_f32_32x32x16_bf16 v[144:159], v[204:207], v[28:31], v[144:159]
  ds_read_b64_tr_b16 v[196:197], v208 offset:40000
  ds_read_b64_tr_b16 v[198:199], v209 offset:40000
  v_mul_f32 v170, v226, v170
  v_mul_f32 v171, v227, v171
  v_mul_f32 v172, v228, v172
  s_waitcnt lgkmcnt(10)
  v_mfma_f32_32x32x16_bf16 v[144:159], v[176:179], v[32:35], v[144:159]
  ds_read_b64_tr_b16 v[200:201], v208 offset:43072
  ds_read_b64_tr_b16 v[202:203], v209 offset:43072
  v_mul_f32 v173, v229, v173
  v_mul_f32 v174, v230, v174
  v_mul_f32 v175, v231, v175
  s_waitcnt lgkmcnt(10)
  v_mfma_f32_32x32x16_bf16 v[144:159], v[180:183], v[36:39], v[144:159]
  ds_read_b64_tr_b16 v[204:205], v208 offset:46144
  ds_read_b64_tr_b16 v[206:207], v209 offset:46144
  v_cvt_pk_bf16_f32 v168, v168, v169
  v_cvt_pk_bf16_f32 v169, v170, v171
  v_cvt_pk_bf16_f32 v170, v172, v173
  s_waitcnt lgkmcnt(10)
  v_mfma_f32_32x32x16_bf16 v[144:159], v[184:187], v[40:43], v[144:159]
  ds_read_b64_tr_b16 v[176:177], v210 offset:64
  ds_read_b64_tr_b16 v[178:179], v211 offset:64
  v_cvt_pk_bf16_f32 v171, v174, v175
  buffer_store_dwordx4 v[160:163], v244, s[28:31], s54 offen offset:0 sc1
  buffer_store_dwordx4 v[168:171], v244, s[28:31], s54 offen offset:512 sc1
  s_waitcnt lgkmcnt(10)
  v_mfma_f32_32x32x16_bf16 v[144:159], v[188:191], v[44:47], v[144:159]
  ds_read_b64_tr_b16 v[180:181], v210 offset:3136
  ds_read_b64_tr_b16 v[182:183], v211 offset:3136
  s_cmp_lg_u32 s91, 0
  s_cbranch_scc1 STS_100
  buffer_store_dwordx4 v[160:163], v245, s[28:31], s46 offen offset:0
  buffer_store_dwordx4 v[168:171], v245, s[28:31], s46 offen offset:512
STD_101:
  v_mul_f32 v128, v213, v128
  v_mul_f32 v129, v213, v129
  s_waitcnt lgkmcnt(10)
  v_mfma_f32_32x32x16_bf16 v[144:159], v[192:195], v[48:51], v[144:159]
  ds_read_b64_tr_b16 v[184:185], v210 offset:6208
  ds_read_b64_tr_b16 v[186:187], v211 offset:6208
  v_mul_f32 v130, v213, v130
  v_mul_f32 v131, v213, v131
  v_mul_f32 v132, v213, v132
  s_waitcnt lgkmcnt(10)
  v_mfma_f32_32x32x16_bf16 v[144:159], v[196:199], v[52:55], v[144:159]
  ds_read_b64_tr_b16 v[188:189], v210 offset:9280
  ds_read_b64_tr_b16 v[190:191], v211 offset:9280
  v_mul_f32 v133, v213, v133
  v_mul_f32 v134, v213, v134
  v_mul_f32 v135, v213, v135
  s_waitcnt lgkmcnt(10)
  v_mfma_f32_32x32x16_bf16 v[144:159], v[200:203], v[56:59], v[144:159]
  ds_read_b64_tr_b16 v[192:193], v210 offset:12352
  ds_read_b64_tr_b16 v[194:195], v211 offset:12352
  v_cvt_pk_bf16_f32 v128, v128, v129
  v_cvt_pk_bf16_f32 v129, v130, v131
  v_cvt_pk_bf16_f32 v130, v132, v133
  s_waitcnt lgkmcnt(10)
  v_mfma_f32_32x32x16_bf16 v[144:159], v[204:207], v[60:63], v[144:159]
  ds_read_b64_tr_b16 v[196:197], v210 offset:15424
  ds_read_b64_tr_b16 v[198:199], v211 offset:15424
  v_cvt_pk_bf16_f32 v131, v134, v135
  v_mul_f32 v136, v213, v136
  v_mul_f32 v137, v213, v137
  s_waitcnt lgkmcnt(10)
  v_mfma_f32_32x32x16_bf16 v[144:159], v[176:179], v[64:67], v[144:159]
  ds_read_b64_tr_b16 v[200:201], v210 offset:18496
  ds_read_b64_tr_b16 v[202:203], v211 offset:18496
  v_mul_f32 v138, v213, v138
  v_mul_f32 v139, v213, v139
  v_mul_f32 v140, v213, v140
  s_waitcnt lgkmcnt(10)
  v_mfma_f32_32x32x16_bf16 v[144:159], v[180:183], v[68:71], v[144:159]
  ds_read_b64_tr_b16 v[204:205], v210 offset:21568
  ds_read_b64_tr_b16 v[206:207], v211 offset:21568
  v_mul_f32 v141, v213, v141
  v_mul_f32 v142, v213, v142
  v_mul_f32 v143, v213, v143
  s_waitcnt lgkmcnt(10)
  v_mfma_f32_32x32x16_bf16 v[144:159], v[184:187], v[72:75], v[144:159]
  ds_read_b64_tr_b16 v[176:177], v210 offset:24640
  ds_read_b64_tr_b16 v[178:179], v211 offset:24640
  v_cvt_pk_bf16_f32 v136, v136, v137
  v_cvt_pk_bf16_f32 v137, v138, v139
  v_cvt_pk_bf16_f32 v138, v140, v141
  s_waitcnt lgkmcnt(10)
  v_mfma_f32_32x32x16_bf16 v[144:159], v[188:191], v[76:79], v[144:159]
  ds_read_b64_tr_b16 v[180:181], v210 offset:27712
  ds_read_b64_tr_b16 v[182:183], v211 offset:27712
  v_cvt_pk_bf16_f32 v139, v142, v143
  s_cmp_lg_u32 s91, 0
  s_cbranch_scc1 STS_102
  buffer_store_dwordx4 v[128:131], v214, s[28:31], s45 offen offset:0
  buffer_store_dwordx4 v[136:139], v214, s[28:31], s45 offen offset:1024
STD_103:
  s_cmp_eq_u32 s49, 0
  s_cbranch_scc1 QK0_104
  buffer_store_dwordx4 v[128:131], v214, s[28:31], s53 offen sc1
  s_add_u32 s53, s53, 65536
  buffer_store_dwordx4 v[136:139], v214, s[28:31], s53 offen sc1
  s_add_u32 s53, s53, 65536
QK0_104:
  s_waitcnt lgkmcnt(10)
  v_mfma_f32_32x32x16_bf16 v[144:159], v[192:195], v[80:83], v[144:159]
  ds_read_b64_tr_b16 v[184:185], v210 offset:30784
  ds_read_b64_tr_b16 v[186:187], v211 offset:30784
  s_lshl_b32 s51, s36, 7
  s_lshl_b32 s50, s37, 10
  s_add_u32 s50, s50, s51
  s_lshl_b32 s51, s38, 2
  s_add_u32 s50, s50, s51
  s_add_u32 s51, s41, 1
  v_mov_b32 v236, s50
  v_mov_b32 v237, s51
  v_mbcnt_lo_u32_b32 v238, -1, 0
  v_mbcnt_hi_u32_b32 v238, -1, v238
  s_and_b32 s50, s65, 15
  s_lshr_b32 s50, s50, 1
  s_lshl_b32 s50, s50, 9
  s_lshl_b32 s51, s70, 6
  s_add_u32 s50, s50, s51
  s_lshr_b32 s51, s65, 4
  s_lshl_b32 s51, s51, 3
  s_add_u32 s50, s50, s51
  s_and_b32 s51, s65, 1
  s_lshl_b32 s51, s51, 2
  s_add_u32 s50, s50, s51
  s_add_u32 s50, s50, 8192
  v_lshl_add_u32 v238, v238, 12, s50
  v_mov_b32 v239, 163336
  s_waitcnt lgkmcnt(10)
  v_mfma_f32_32x32x16_bf16 v[144:159], v[196:199], v[84:87], v[144:159]
  ds_read_b64_tr_b16 v[188:189], v210 offset:33856
  ds_read_b64_tr_b16 v[190:191], v211 offset:33856
  s_waitcnt lgkmcnt(10)
  v_mfma_f32_32x32x16_bf16 v[144:159], v[200:203], v[88:91], v[144:159]
  ds_read_b64_tr_b16 v[192:193], v210 offset:36928
  ds_read_b64_tr_b16 v[194:195], v211 offset:36928
  s_waitcnt lgkmcnt(10)
  v_mfma_f32_32x32x16_bf16 v[144:159], v[204:207], v[92:95], v[144:159]
  ds_read_b64_tr_b16 v[196:197], v210 offset:40000
  ds_read_b64_tr_b16 v[198:199], v211 offset:40000
  s_waitcnt lgkmcnt(10)
  v_mfma_f32_32x32x16_bf16 v[144:159], v[176:179], v[96:99], v[144:159]
  ds_read_b64_tr_b16 v[200:201], v210 offset:43072
  ds_read_b64_tr_b16 v[202:203], v211 offset:43072
  s_waitcnt lgkmcnt(10)
  v_mfma_f32_32x32x16_bf16 v[144:159], v[180:183], v[100:103], v[144:159]
  ds_read_b64_tr_b16 v[204:205], v210 offset:46144
  ds_read_b64_tr_b16 v[206:207], v211 offset:46144
  s_waitcnt lgkmcnt(10)
  v_mfma_f32_32x32x16_bf16 v[144:159], v[184:187], v[104:107], v[144:159]
  s_waitcnt lgkmcnt(8)
  v_mfma_f32_32x32x16_bf16 v[144:159], v[188:191], v[108:111], v[144:159]
  s_waitcnt lgkmcnt(6)
  v_mfma_f32_32x32x16_bf16 v[144:159], v[192:195], v[112:115], v[144:159]
  s_waitcnt lgkmcnt(4)
  v_mfma_f32_32x32x16_bf16 v[144:159], v[196:199], v[116:119], v[144:159]
  s_waitcnt lgkmcnt(2)
  v_mfma_f32_32x32x16_bf16 v[144:159], v[200:203], v[120:123], v[144:159]
  s_waitcnt lgkmcnt(0)
  v_mfma_f32_32x32x16_bf16 v[144:159], v[204:207], v[124:127], v[144:159]
  v_mfma_f32_32x32x16_bf16 v[144:159], v[240:243], v[232:235], v[144:159]
  s_barrier
  s_nop 10
  v_mul_f32 v144, v213, v144
  v_mul_f32 v145, v213, v145
  v_mul_f32 v146, v213, v146
  v_mul_f32 v147, v213, v147
  v_mul_f32 v148, v213, v148
  v_mul_f32 v149, v213, v149
  v_mul_f32 v150, v213, v150
  v_mul_f32 v151, v213, v151
  v_cvt_pk_bf16_f32 v144, v144, v145
  v_cvt_pk_bf16_f32 v145, v146, v147
  v_cvt_pk_bf16_f32 v146, v148, v149
  v_cvt_pk_bf16_f32 v147, v150, v151
  v_mul_f32 v152, v213, v152
  v_mul_f32 v153, v213, v153
  v_mul_f32 v154, v213, v154
  v_mul_f32 v155, v213, v155
  v_mul_f32 v156, v213, v156
  v_mul_f32 v157, v213, v157
  v_mul_f32 v158, v213, v158
  v_mul_f32 v159, v213, v159
  v_cvt_pk_bf16_f32 v152, v152, v153
  v_cvt_pk_bf16_f32 v153, v154, v155
  v_cvt_pk_bf16_f32 v154, v156, v157
  v_cvt_pk_bf16_f32 v155, v158, v159
  s_cmp_lg_u32 s91, 0
  s_cbranch_scc1 STS_107
  buffer_store_dwordx4 v[144:147], v214, s[28:31], s45 offen offset:2048
  buffer_store_dwordx4 v[152:155], v214, s[28:31], s45 offen offset:3072
STD_108:
  s_waitcnt vmcnt(0)
  s_mov_b64 exec, 1
  s_cmp_lg_u32 s39, 0
  s_cbranch_scc1 STS_109
  global_store_dword v236, v237, s[34:35]
STD_110:
  s_mov_b64 exec, -1
  s_cmp_eq_u32 s49, 0
  s_cbranch_scc1 QKE_111
  buffer_store_dwordx4 v[144:147], v214, s[28:31], s53 offen sc1
  s_add_u32 s53, s53, 65536
  buffer_store_dwordx4 v[152:155], v214, s[28:31], s53 offen sc1
  s_add_u32 s53, s53, 65536
QKE_111:
  v_mov_b32 v232, s42
  v_mov_b32 v231, 1
  s_waitcnt vmcnt(0)
  s_mov_b64 exec, 1
  ds_add_rtn_u32 v231, v239, v231
  s_waitcnt lgkmcnt(0)
  v_readfirstlane_b32 s50, v231
  s_mov_b64 exec, 3
  s_and_b32 s50, s50, 3
  s_cmp_lg_u32 s50, 3
  s_cbranch_scc1 SG_112
  global_store_dword v238, v232, s[34:35] sc1
SG_112:
  s_mov_b64 exec, -1
  s_setprio 0
  s_branch L_LAYER_c
L_HELP:
  s_mov_b32 s65, s38
  s_mov_b32 s70, s37
  s_add_u32 s42, s40, 1
  s_setprio 3
  v_mbcnt_lo_u32_b32 v9, -1, 0
  v_mbcnt_hi_u32_b32 v9, -1, v9
  s_and_b32 s50, s38, 15
  s_lshr_b32 s51, s50, 1
  s_and_b32 s50, s50, 1
  s_lshl_b32 s53, s50, 10
  s_lshl_b32 s54, s51, 7
  s_add_u32 s53, s53, s54
  s_lshl_b32 s55, s50, 6
  s_add_u32 s54, s54, s55
  s_add_u32 s54, s54, 2048
  s_sub_u32 s54, s54, 128
  v_add_u32 v13, 0, v9
  v_mul_u32_u24 v14, 171, v13
  v_lshrrev_b32 v14, 11, v14
  v_mul_u32_u24 v15, 12, v14
  v_sub_u32 v15, v13, v15
  v_mov_b32 v16, s53
  v_mov_b32 v17, s54
  v_cmp_gt_u32 vcc, 8, v15
  s_nop 1
  v_cndmask_b32 v16, v17, v16, vcc
  v_lshl_add_u32 v16, v15, 4, v16
  v_mul_u32_u24 v14, 3072, v14
  v_add_u32 v10, v14, v16
  v_add_u32 v13, 64, v9
  v_mul_u32_u24 v14, 171, v13
  v_lshrrev_b32 v14, 11, v14
  v_mul_u32_u24 v15, 12, v14
  v_sub_u32 v15, v13, v15
  v_mov_b32 v16, s53
  v_mov_b32 v17, s54
  v_cmp_gt_u32 vcc, 8, v15
  s_nop 1
  v_cndmask_b32 v16, v17, v16, vcc
  v_lshl_add_u32 v16, v15, 4, v16
  v_mul_u32_u24 v14, 3072, v14
  v_add_u32 v11, v14, v16
  v_add_u32 v13, 128, v9
  v_mul_u32_u24 v14, 171, v13
  v_lshrrev_b32 v14, 11, v14
  v_mul_u32_u24 v15, 12, v14
  v_sub_u32 v15, v13, v15
  v_mov_b32 v16, s53
  v_mov_b32 v17, s54
  v_cmp_gt_u32 vcc, 8, v15
  s_nop 1
  v_cndmask_b32 v16, v17, v16, vcc
  v_lshl_add_u32 v16, v15, 4, v16
  v_mul_u32_u24 v14, 3072, v14
  v_add_u32 v12, v14, v16
  s_waitcnt lgkmcnt(0)
  s_cmp_lg_u32 s36, 4
  s_cbranch_scc1 QRS_117
  s_getreg_b32 s43, hwreg(HW_REG_XCC_ID)
  s_and_b32 s43, s43, 15
  s_lshl_b32 s50, s2, 5
  s_lshl_b32 s51, s2, 7
  s_add_u32 s51, s51, 8192
  v_mbcnt_lo_u32_b32 v2, -1, 0
  v_mbcnt_hi_u32_b32 v2, -1, v2
  v_lshl_add_u32 v1, v2, 2, s50
  v_lshl_add_u32 v2, v2, 2, s51
  v_mov_b32 v3, 0
  v_mov_b32 v4, 163336
  ds_write_b32 v4, v3
  s_mov_b32 exec_hi, 0
  global_store_dword v2, v3, s[34:35] sc1
  s_mov_b64 exec, 0xff
  global_store_dword v1, v3, s[34:35] offset:0 sc1
  s_mov_b64 exec, -1
QRS_117:
  s_sub_u32 s52, s36, 4
  s_lshl_b32 s54, s38, 2
  s_add_u32 s54, s54, s52
  s_and_b32 s54, s54, 31
  s_mul_i32 s54, s54, 49152
  s_mul_i32 s53, s52, 3072
  s_add_u32 m0, s53, 0
  s_nop 0
  buffer_load_dwordx4 v10, s[8:11], s54 offen lds
  s_add_u32 m0, s53, 1024
  s_nop 0
  buffer_load_dwordx4 v11, s[8:11], s54 offen lds
  s_add_u32 m0, s53, 2048
  s_nop 0
  buffer_load_dwordx4 v12, s[8:11], s54 offen lds
  s_add_u32 s52, s52, 4
  s_lshl_b32 s54, s38, 2
  s_add_u32 s54, s54, s52
  s_and_b32 s54, s54, 31
  s_mul_i32 s54, s54, 49152
  s_mul_i32 s53, s52, 3072
  s_add_u32 m0, s53, 0
  s_nop 0
  buffer_load_dwordx4 v10, s[8:11], s54 offen lds
  s_add_u32 m0, s53, 1024
  s_nop 0
  buffer_load_dwordx4 v11, s[8:11], s54 offen lds
  s_add_u32 m0, s53, 2048
  s_nop 0
  buffer_load_dwordx4 v12, s[8:11], s54 offen lds
  s_add_u32 s52, s52, 4
  s_lshl_b32 s54, s38, 2
  s_add_u32 s54, s54, s52
  s_and_b32 s54, s54, 31
  s_mul_i32 s54, s54, 49152
  s_mul_i32 s53, s52, 3072
  s_add_u32 m0, s53, 0
  s_nop 0
  buffer_load_dwordx4 v10, s[8:11], s54 offen lds
  s_add_u32 m0, s53, 1024
  s_nop 0
  buffer_load_dwordx4 v11, s[8:11], s54 offen lds
  s_add_u32 m0, s53, 2048
  s_nop 0
  buffer_load_dwordx4 v12, s[8:11], s54 offen lds
  s_add_u32 s52, s52, 4
  v_bfe_u32 v13, v9, 2, 2
  v_bfe_u32 v14, v9, 4, 1
  v_lshlrev_b32 v14, 5, v14
  v_and_b32 v15, 3, v9
  v_lshl_add_u32 v14, v15, 3, v14
  v_lshrrev_b32 v15, 5, v9
  v_lshl_add_u32 v16, v15, 2, v13
  v_mul_u32_u24 v16, 192, v16
  v_add_u32 v16, v16, v14
  s_sub_u32 s50, s36, 4
  s_mul_i32 s50, s50, 3072
  v_add_u32 v16, s50, v16
  v_add_u32 v17, 49152, v16
  v_mov_b32 v44, 0
  v_mov_b32 v45, 0
  v_mov_b32 v46, 0
  v_mov_b32 v47, 0
  v_mov_b32 v48, 0
  v_mov_b32 v49, 0
  v_mov_b32 v50, 0
  v_mov_b32 v51, 0
  v_mov_b32 v52, 0
  v_mov_b32 v53, 0
  v_mov_b32 v54, 0
  v_mov_b32 v55, 0
  v_mov_b32 v159, 0
  v_mov_b32 v215, 0
  v_mov_b32 v216, 0
  v_mov_b32 v224, 0
  v_mov_b32 v228, 0
  v_mov_b32 v232, 0
  v_mov_b32 v240, 0
  v_mov_b32 v244, 0
  v_mov_b32 v245, 0
  s_cmp_lg_u32 s36, 4
  s_cbranch_scc1 QRP_118
  s_waitcnt vmcnt(9)
  s_mov_b64 exec, 1
  s_and_b32 s50, s2, 3
  s_lshl_b32 s50, s50, 3
  s_add_u32 s51, s43, 1
  s_lshl_b32 s51, s51, s50
  s_and_b32 s50, s2, 0xfc
  v_mov_b32 v1, s50
  v_mov_b32 v2, s51
  global_atomic_or v1, v2, s[32:33] sc1
  s_mov_b64 exec, -1
QRP_118:
  s_setprio 0
  s_lshl_b32 s54, s38, 2
  s_add_u32 s54, s54, s52
  s_and_b32 s54, s54, 31
  s_mul_i32 s54, s54, 49152
  s_mul_i32 s53, s52, 3072
  s_add_u32 m0, s53, 0
  s_nop 0
  buffer_load_dwordx4 v10, s[8:11], s54 offen lds
  s_add_u32 m0, s53, 1024
  s_nop 0
  buffer_load_dwordx4 v11, s[8:11], s54 offen lds
  s_add_u32 m0, s53, 2048
  s_nop 0
  buffer_load_dwordx4 v12, s[8:11], s54 offen lds
  s_add_u32 s52, s52, 4
  s_waitcnt vmcnt(9)
  s_barrier
  ds_read_b64_tr_b16 v[20:21], v16 offset:0
  ds_read_b64_tr_b16 v[22:23], v16 offset:1536
  ds_read_b64_tr_b16 v[24:25], v16 offset:64
  ds_read_b64_tr_b16 v[26:27], v16 offset:1600
  ds_read_b64_tr_b16 v[28:29], v16 offset:128
  ds_read_b64_tr_b16 v[30:31], v16 offset:1664
  s_waitcnt lgkmcnt(5)
  v_lshlrev_b32 v32, 16, v20
  v_and_b32 v36, 0xffff0000, v20
  v_lshlrev_b32 v33, 16, v21
  v_and_b32 v37, 0xffff0000, v21
  s_waitcnt lgkmcnt(4)
  v_lshlrev_b32 v34, 16, v22
  v_and_b32 v38, 0xffff0000, v22
  v_lshlrev_b32 v35, 16, v23
  v_and_b32 v39, 0xffff0000, v23
  v_add_f32 v44, v44, v32
  v_add_f32 v45, v45, v33
  v_add_f32 v46, v46, v34
  v_add_f32 v47, v47, v35
  v_add_f32 v44, v44, v36
  v_add_f32 v45, v45, v37
  v_add_f32 v46, v46, v38
  v_add_f32 v47, v47, v39
  s_waitcnt lgkmcnt(3)
  v_lshlrev_b32 v32, 16, v24
  v_and_b32 v36, 0xffff0000, v24
  v_lshlrev_b32 v33, 16, v25
  v_and_b32 v37, 0xffff0000, v25
  s_waitcnt lgkmcnt(2)
  v_lshlrev_b32 v34, 16, v26
  v_and_b32 v38, 0xffff0000, v26
  v_lshlrev_b32 v35, 16, v27
  v_and_b32 v39, 0xffff0000, v27
  v_add_f32 v48, v48, v32
  v_add_f32 v49, v49, v33
  v_add_f32 v50, v50, v34
  v_add_f32 v51, v51, v35
  v_add_f32 v48, v48, v36
  v_add_f32 v49, v49, v37
  v_add_f32 v50, v50, v38
  v_add_f32 v51, v51, v39
  s_waitcnt lgkmcnt(1)
  v_lshlrev_b32 v32, 16, v28
  v_and_b32 v36, 0xffff0000, v28
  v_lshlrev_b32 v33, 16, v29
  v_and_b32 v37, 0xffff0000, v29
  s_waitcnt lgkmcnt(0)
  v_lshlrev_b32 v34, 16, v30
  v_and_b32 v38, 0xffff0000, v30
  v_lshlrev_b32 v35, 16, v31
  v_and_b32 v39, 0xffff0000, v31
  v_add_f32 v52, v52, v32
  v_add_f32 v53, v53, v33
  v_add_f32 v54, v54, v34
  v_add_f32 v55, v55, v35
  v_add_f32 v52, v52, v36
  v_add_f32 v53, v53, v37
  v_add_f32 v54, v54, v38
  v_add_f32 v55, v55, v39
  s_lshl_b32 s54, s38, 2
  s_add_u32 s54, s54, s52
  s_and_b32 s54, s54, 31
  s_mul_i32 s54, s54, 49152
  s_mul_i32 s53, s52, 3072
  s_add_u32 m0, s53, 0
  s_nop 0
  buffer_load_dwordx4 v10, s[8:11], s54 offen lds
  s_add_u32 m0, s53, 1024
  s_nop 0
  buffer_load_dwordx4 v11, s[8:11], s54 offen lds
  s_add_u32 m0, s53, 2048
  s_nop 0
  buffer_load_dwordx4 v12, s[8:11], s54 offen lds
  s_add_u32 s52, s52, 4
  s_waitcnt vmcnt(9)
  s_barrier
  ds_read_b64_tr_b16 v[20:21], v16 offset:12288
  ds_read_b64_tr_b16 v[22:23], v16 offset:13824
  ds_read_b64_tr_b16 v[24:25], v16 offset:12352
  ds_read_b64_tr_b16 v[26:27], v16 offset:13888
  ds_read_b64_tr_b16 v[28:29], v16 offset:12416
  ds_read_b64_tr_b16 v[30:31], v16 offset:13952
  s_waitcnt lgkmcnt(5)
  v_lshlrev_b32 v32, 16, v20
  v_and_b32 v36, 0xffff0000, v20
  v_lshlrev_b32 v33, 16, v21
  v_and_b32 v37, 0xffff0000, v21
  s_waitcnt lgkmcnt(4)
  v_lshlrev_b32 v34, 16, v22
  v_and_b32 v38, 0xffff0000, v22
  v_lshlrev_b32 v35, 16, v23
  v_and_b32 v39, 0xffff0000, v23
  v_add_f32 v44, v44, v32
  v_add_f32 v45, v45, v33
  v_add_f32 v46, v46, v34
  v_add_f32 v47, v47, v35
  v_add_f32 v44, v44, v36
  v_add_f32 v45, v45, v37
  v_add_f32 v46, v46, v38
  v_add_f32 v47, v47, v39
  s_waitcnt lgkmcnt(3)
  v_lshlrev_b32 v32, 16, v24
  v_and_b32 v36, 0xffff0000, v24
  v_lshlrev_b32 v33, 16, v25
  v_and_b32 v37, 0xffff0000, v25
  s_waitcnt lgkmcnt(2)
  v_lshlrev_b32 v34, 16, v26
  v_and_b32 v38, 0xffff0000, v26
  v_lshlrev_b32 v35, 16, v27
  v_and_b32 v39, 0xffff0000, v27
  v_add_f32 v48, v48, v32
  v_add_f32 v49, v49, v33
  v_add_f32 v50, v50, v34
  v_add_f32 v51, v51, v35
  v_add_f32 v48, v48, v36
  v_add_f32 v49, v49, v37
  v_add_f32 v50, v50, v38
  v_add_f32 v51, v51, v39
  s_waitcnt lgkmcnt(1)
  v_lshlrev_b32 v32, 16, v28
  v_and_b32 v36, 0xffff0000, v28
  v_lshlrev_b32 v33, 16, v29
  v_and_b32 v37, 0xffff0000, v29
  s_waitcnt lgkmcnt(0)
  v_lshlrev_b32 v34, 16, v30
  v_and_b32 v38, 0xffff0000, v30
  v_lshlrev_b32 v35, 16, v31
  v_and_b32 v39, 0xffff0000, v31
  v_add_f32 v52, v52, v32
  v_add_f32 v53, v53, v33
  v_add_f32 v54, v54, v34
  v_add_f32 v55, v55, v35
  v_add_f32 v52, v52, v36
  v_add_f32 v53, v53, v37
  v_add_f32 v54, v54, v38
  v_add_f32 v55, v55, v39
  s_lshl_b32 s54, s38, 2
  s_add_u32 s54, s54, s52
  s_and_b32 s54, s54, 31
  s_mul_i32 s54, s54, 49152
  s_mul_i32 s53, s52, 3072
  s_add_u32 m0, s53, 0
  s_nop 0
  buffer_load_dwordx4 v10, s[8:11], s54 offen lds
  s_add_u32 m0, s53, 1024
  s_nop 0
  buffer_load_dwordx4 v11, s[8:11], s54 offen lds
  s_add_u32 m0, s53, 2048
  s_nop 0
  buffer_load_dwordx4 v12, s[8:11], s54 offen lds
  s_add_u32 s52, s52, 4
  s_waitcnt vmcnt(9)
  s_barrier
  ds_read_b64_tr_b16 v[20:21], v16 offset:24576
  ds_read_b64_tr_b16 v[22:23], v16 offset:26112
  ds_read_b64_tr_b16 v[24:25], v16 offset:24640
  ds_read_b64_tr_b16 v[26:27], v16 offset:26176
  ds_read_b64_tr_b16 v[28:29], v16 offset:24704
  ds_read_b64_tr_b16 v[30:31], v16 offset:26240
  s_waitcnt lgkmcnt(5)
  v_lshlrev_b32 v32, 16, v20
  v_and_b32 v36, 0xffff0000, v20
  v_lshlrev_b32 v33, 16, v21
  v_and_b32 v37, 0xffff0000, v21
  s_waitcnt lgkmcnt(4)
  v_lshlrev_b32 v34, 16, v22
  v_and_b32 v38, 0xffff0000, v22
  v_lshlrev_b32 v35, 16, v23
  v_and_b32 v39, 0xffff0000, v23
  v_add_f32 v44, v44, v32
  v_add_f32 v45, v45, v33
  v_add_f32 v46, v46, v34
  v_add_f32 v47, v47, v35
  v_add_f32 v44, v44, v36
  v_add_f32 v45, v45, v37
  v_add_f32 v46, v46, v38
  v_add_f32 v47, v47, v39
  s_waitcnt lgkmcnt(3)
  v_lshlrev_b32 v32, 16, v24
  v_and_b32 v36, 0xffff0000, v24
  v_lshlrev_b32 v33, 16, v25
  v_and_b32 v37, 0xffff0000, v25
  s_waitcnt lgkmcnt(2)
  v_lshlrev_b32 v34, 16, v26
  v_and_b32 v38, 0xffff0000, v26
  v_lshlrev_b32 v35, 16, v27
  v_and_b32 v39, 0xffff0000, v27
  v_add_f32 v48, v48, v32
  v_add_f32 v49, v49, v33
  v_add_f32 v50, v50, v34
  v_add_f32 v51, v51, v35
  v_add_f32 v48, v48, v36
  v_add_f32 v49, v49, v37
  v_add_f32 v50, v50, v38
  v_add_f32 v51, v51, v39
  s_waitcnt lgkmcnt(1)
  v_lshlrev_b32 v32, 16, v28
  v_and_b32 v36, 0xffff0000, v28
  v_lshlrev_b32 v33, 16, v29
  v_and_b32 v37, 0xffff0000, v29
  s_waitcnt lgkmcnt(0)
  v_lshlrev_b32 v34, 16, v30
  v_and_b32 v38, 0xffff0000, v30
  v_lshlrev_b32 v35, 16, v31
  v_and_b32 v39, 0xffff0000, v31
  v_add_f32 v52, v52, v32
  v_add_f32 v53, v53, v33
  v_add_f32 v54, v54, v34
  v_add_f32 v55, v55, v35
  v_add_f32 v52, v52, v36
  v_add_f32 v53, v53, v37
  v_add_f32 v54, v54, v38
  v_add_f32 v55, v55, v39
  s_lshl_b32 s54, s38, 2
  s_add_u32 s54, s54, s52
  s_and_b32 s54, s54, 31
  s_mul_i32 s54, s54, 49152
  s_mul_i32 s53, s52, 3072
  s_add_u32 m0, s53, 0
  s_nop 0
  buffer_load_dwordx4 v10, s[8:11], s54 offen lds
  s_add_u32 m0, s53, 1024
  s_nop 0
  buffer_load_dwordx4 v11, s[8:11], s54 offen lds
  s_add_u32 m0, s53, 2048
  s_nop 0
  buffer_load_dwordx4 v12, s[8:11], s54 offen lds
  s_add_u32 s52, s52, 4
  s_waitcnt vmcnt(9)
  s_barrier
  ds_read_b64_tr_b16 v[20:21], v16 offset:36864
  ds_read_b64_tr_b16 v[22:23], v16 offset:38400
  ds_read_b64_tr_b16 v[24:25], v16 offset:36928
  ds_read_b64_tr_b16 v[26:27], v16 offset:38464
  ds_read_b64_tr_b16 v[28:29], v16 offset:36992
  ds_read_b64_tr_b16 v[30:31], v16 offset:38528
  s_waitcnt lgkmcnt(5)
  v_lshlrev_b32 v32, 16, v20
  v_and_b32 v36, 0xffff0000, v20
  v_lshlrev_b32 v33, 16, v21
  v_and_b32 v37, 0xffff0000, v21
  s_waitcnt lgkmcnt(4)
  v_lshlrev_b32 v34, 16, v22
  v_and_b32 v38, 0xffff0000, v22
  v_lshlrev_b32 v35, 16, v23
  v_and_b32 v39, 0xffff0000, v23
  v_add_f32 v44, v44, v32
  v_add_f32 v45, v45, v33
  v_add_f32 v46, v46, v34
  v_add_f32 v47, v47, v35
  v_add_f32 v44, v44, v36
  v_add_f32 v45, v45, v37
  v_add_f32 v46, v46, v38
  v_add_f32 v47, v47, v39
  s_waitcnt lgkmcnt(3)
  v_lshlrev_b32 v32, 16, v24
  v_and_b32 v36, 0xffff0000, v24
  v_lshlrev_b32 v33, 16, v25
  v_and_b32 v37, 0xffff0000, v25
  s_waitcnt lgkmcnt(2)
  v_lshlrev_b32 v34, 16, v26
  v_and_b32 v38, 0xffff0000, v26
  v_lshlrev_b32 v35, 16, v27
  v_and_b32 v39, 0xffff0000, v27
  v_add_f32 v48, v48, v32
  v_add_f32 v49, v49, v33
  v_add_f32 v50, v50, v34
  v_add_f32 v51, v51, v35
  v_add_f32 v48, v48, v36
  v_add_f32 v49, v49, v37
  v_add_f32 v50, v50, v38
  v_add_f32 v51, v51, v39
  s_waitcnt lgkmcnt(1)
  v_lshlrev_b32 v32, 16, v28
  v_and_b32 v36, 0xffff0000, v28
  v_lshlrev_b32 v33, 16, v29
  v_and_b32 v37, 0xffff0000, v29
  s_waitcnt lgkmcnt(0)
  v_lshlrev_b32 v34, 16, v30
  v_and_b32 v38, 0xffff0000, v30
  v_lshlrev_b32 v35, 16, v31
  v_and_b32 v39, 0xffff0000, v31
  v_add_f32 v52, v52, v32
  v_add_f32 v53, v53, v33
  v_add_f32 v54, v54, v34
  v_add_f32 v55, v55, v35
  v_add_f32 v52, v52, v36
  v_add_f32 v53, v53, v37
  v_add_f32 v54, v54, v38
  v_add_f32 v55, v55, v39
  s_lshl_b32 s54, s38, 2
  s_add_u32 s54, s54, s52
  s_and_b32 s54, s54, 31
  s_mul_i32 s54, s54, 49152
  s_mul_i32 s53, s52, 3072
  s_add_u32 m0, s53, 0
  s_nop 0
  buffer_load_dwordx4 v10, s[8:11], s54 offen lds
  s_add_u32 m0, s53, 1024
  s_nop 0
  buffer_load_dwordx4 v11, s[8:11], s54 offen lds
  s_add_u32 m0, s53, 2048
  s_nop 0
  buffer_load_dwordx4 v12, s[8:11], s54 offen lds
  s_add_u32 s52, s52, 4
  s_waitcnt vmcnt(9)
  s_barrier
  ds_read_b64_tr_b16 v[20:21], v17 offset:0
  ds_read_b64_tr_b16 v[22:23], v17 offset:1536
  ds_read_b64_tr_b16 v[24:25], v17 offset:64
  ds_read_b64_tr_b16 v[26:27], v17 offset:1600
  ds_read_b64_tr_b16 v[28:29], v17 offset:128
  ds_read_b64_tr_b16 v[30:31], v17 offset:1664
  s_waitcnt lgkmcnt(5)
  v_lshlrev_b32 v32, 16, v20
  v_and_b32 v36, 0xffff0000, v20
  v_lshlrev_b32 v33, 16, v21
  v_and_b32 v37, 0xffff0000, v21
  s_waitcnt lgkmcnt(4)
  v_lshlrev_b32 v34, 16, v22
  v_and_b32 v38, 0xffff0000, v22
  v_lshlrev_b32 v35, 16, v23
  v_and_b32 v39, 0xffff0000, v23
  v_add_f32 v44, v44, v32
  v_add_f32 v45, v45, v33
  v_add_f32 v46, v46, v34
  v_add_f32 v47, v47, v35
  v_add_f32 v44, v44, v36
  v_add_f32 v45, v45, v37
  v_add_f32 v46, v46, v38
  v_add_f32 v47, v47, v39
  s_waitcnt lgkmcnt(3)
  v_lshlrev_b32 v32, 16, v24
  v_and_b32 v36, 0xffff0000, v24
  v_lshlrev_b32 v33, 16, v25
  v_and_b32 v37, 0xffff0000, v25
  s_waitcnt lgkmcnt(2)
  v_lshlrev_b32 v34, 16, v26
  v_and_b32 v38, 0xffff0000, v26
  v_lshlrev_b32 v35, 16, v27
  v_and_b32 v39, 0xffff0000, v27
  v_add_f32 v48, v48, v32
  v_add_f32 v49, v49, v33
  v_add_f32 v50, v50, v34
  v_add_f32 v51, v51, v35
  v_add_f32 v48, v48, v36
  v_add_f32 v49, v49, v37
  v_add_f32 v50, v50, v38
  v_add_f32 v51, v51, v39
  s_waitcnt lgkmcnt(1)
  v_lshlrev_b32 v32, 16, v28
  v_and_b32 v36, 0xffff0000, v28
  v_lshlrev_b32 v33, 16, v29
  v_and_b32 v37, 0xffff0000, v29
  s_waitcnt lgkmcnt(0)
  v_lshlrev_b32 v34, 16, v30
  v_and_b32 v38, 0xffff0000, v30
  v_lshlrev_b32 v35, 16, v31
  v_and_b32 v39, 0xffff0000, v31
  v_add_f32 v52, v52, v32
  v_add_f32 v53, v53, v33
  v_add_f32 v54, v54, v34
  v_add_f32 v55, v55, v35
  v_add_f32 v52, v52, v36
  v_add_f32 v53, v53, v37
  v_add_f32 v54, v54, v38
  v_add_f32 v55, v55, v39
  s_waitcnt vmcnt(6)
  s_barrier
  s_mov_b32 s39, 0
  s_mov_b32 s66, 0
  s_mul_i32 s50, s40, 5
  s_mul_i32 s51, s39, 11796480
  s_mul_i32 s50, s50, s51
  s_add_u32 s50, s50, 10485760
  s_add_u32 s50, s50, s51
  s_mov_b32 s62, s50
  s_add_u32 s50, s50, s51
  s_mov_b32 s63, s50
  s_add_u32 s50, s50, s51
  s_mov_b32 s64, s50
  s_add_u32 s50, s50, s51
  s_mov_b32 s69, s50
  v_mbcnt_lo_u32_b32 v96, -1, 0
  v_mbcnt_hi_u32_b32 v96, -1, v96
  v_lshlrev_b32 v95, 4, v96
  v_mov_b32 v94, 0xdddddddd
  s_lshr_b32 s51, s36, 2
  s_lshl_b32 s50, s51, 12
  s_add_u32 s50, s50, 30720
  s_mul_i32 s51, s51, 4096
  s_add_u32 s51, s51, 38912
  v_add_u32 v92, s50, v95
  v_and_b32 v4, 31, v96
  v_lshrrev_b32 v5, 5, v96
  v_lshlrev_b32 v5, 8, v5
  v_lshl_add_u32 v5, v4, 4, v5
  v_cmp_eq_u32 vcc, 16, v4
  v_add_u32 v93, s51, v5
  v_mov_b32 v5, 0x3f803f80
  v_cndmask_b32 v76, 0, v5, vcc
  v_cndmask_b32 v77, 0, v5, vcc
  v_cndmask_b32 v78, 0, v5, vcc
  v_cndmask_b32 v79, 0, v5, vcc
  v_cndmask_b32 v80, 0, v5, vcc
  v_cndmask_b32 v81, 0, v5, vcc
  v_cndmask_b32 v82, 0, v5, vcc
  v_cndmask_b32 v83, 0, v5, vcc
  s_mov_b32 s98, 0xffff
  s_mov_b32 s99, 0xffff
  s_bfe_u32 s45, s36, 0x10001
  s_lshl_b32 s46, s37, 1
  s_add_u32 s45, s45, s46
  s_mul_i32 s45, s45, 737280
  s_lshl_b32 s47, s36, 10
  s_add_u32 s67, s47, 47104
  s_and_b32 s50, s37, 1
  s_lshl_b32 s50, s50, 3
  s_lshr_b32 s51, s38, 2
  s_add_u32 s50, s50, s51
  s_lshl_b32 s50, s50, 9
  s_add_u32 s50, s50, 8192
  s_lshl_b32 s51, s66, 3
  s_or_b32 s51, s51, s37
  v_and_b32 v5, 31, v96
  v_lshrrev_b32 v4, 2, v5
  v_cmp_eq_u32 vcc, s51, v4
  v_xor_b32 v4, 4, v5
  s_nop 0
  v_cndmask_b32 v4, v5, v4, vcc
  v_and_b32 v5, 3, v4
  v_lshrrev_b32 v4, 2, v4
  v_lshl_add_u32 v5, v5, 2, s50
  v_lshl_add_u32 v99, v4, 6, v5
  v_mbcnt_lo_u32_b32 v97, -1, 0
  v_mbcnt_hi_u32_b32 v97, -1, v97
  v_lshrrev_b32 v13, 3, v97
  v_and_b32 v14, 7, v97
  v_lshlrev_b32 v15, 1, v13
  v_and_b32 v15, 4, v15
  v_xor_b32 v14, v14, v15
  v_mul_u32_u24 v13, 3584, v13
  v_lshl_add_u32 v97, v14, 4, v13
  v_mbcnt_lo_u32_b32 v98, -1, 0
  v_mbcnt_hi_u32_b32 v98, -1, v98
  v_lshrrev_b32 v13, 3, v98
  v_and_b32 v14, 7, v98
  v_lshlrev_b32 v15, 1, v13
  v_and_b32 v15, 4, v15
  v_xor_b32 v14, v14, v15
  v_mul_u32_u24 v13, 1024, v13
  v_lshl_add_u32 v98, v14, 4, v13
  s_lshl_b32 s44, s38, 16
  s_add_u32 s44, s44, s60
  s_add_u32 s44, s44, s47
  s_and_b32 s54, s38, 15
  s_min_u32 s54, s54, 13
  s_lshl_b32 s54, s54, 8
  s_and_b32 s55, s38, 7
  s_lshl_b32 s55, s55, 7
  s_mov_b32 s71, 0
  s_lshl_b32 s92, s37, 13
  s_lshl_b32 s93, s36, 10
  s_lshl_b32 s94, s36, 13
  s_add_u32 s94, s94, s55
  s_add_u32 s95, s93, 81920
  s_add_u32 s96, s36, 50
  s_mul_i32 s96, s96, 28672
  s_add_u32 s96, s96, s54
  s_add_u32 s96, s96, 128
  s_and_b32 s50, s36, 1
  s_mul_i32 s50, s50, 896
  s_bfe_u32 s51, s36, 0x10001
  s_lshl_b32 s51, s51, 3
  s_add_u32 s50, s50, s51
  s_add_u32 s50, s50, 688
  s_lshl_b32 s50, s50, 10
  s_add_u32 s97, s50, s55
  s_and_b32 s52, s36, 3
  v_mov_b32 v87, 0x7f000000
  s_lshr_b32 s50, s38, 4
  s_mul_i32 s50, s50, 88
  s_mul_i32 s51, s52, 22
  s_add_u32 s50, s50, s51
  v_add_u32 v85, s50, v96
  v_cmp_gt_u32 vcc, 0, v85
  v_add_u32 v4, 336, v85
  s_nop 0
  v_cndmask_b32 v85, v4, v85, vcc
  v_mul_u32_u24 v85, 3584, v85
  v_add_u32 v85, s54, v85
  v_cmp_gt_u32 vcc, 22, v96
  v_mov_b32 v4, 0x7f000000
  s_nop 0
  v_cndmask_b32 v85, v4, v85, vcc
  s_lshr_b32 s50, s38, 3
  s_mul_i32 s50, s50, 192
  s_mul_i32 s51, s52, 48
  s_add_u32 s50, s50, s51
  v_add_u32 v86, s50, v96
  v_cmp_gt_u32 vcc, 384, v86
  v_add_u32 v4, 64, v86
  s_nop 0
  v_cndmask_b32 v86, v4, v86, vcc
  v_and_b32 v4, 0xffc0, v86
  v_add_u32 v86, v4, v86
  v_mul_u32_u24 v86, 1024, v86
  v_add_u32 v86, s55, v86
  v_cmp_gt_u32 vcc, 48, v96
  v_mov_b32 v4, 0x7f000000
  s_nop 0
  v_cndmask_b32 v86, v4, v86, vcc
  s_lshr_b32 s50, s38, 4
  s_lshl_b32 s51, s37, 1
  s_add_u32 s50, s50, s51
  s_mul_i32 s50, s50, 737280
  s_and_b32 s51, s38, 15
  s_mul_i32 s51, s51, 46080
  s_add_u32 s50, s50, s51
  s_mul_i32 s51, s52, 11520
  s_add_u32 s50, s50, s51
  s_add_u32 s50, s50, 10485760
  s_lshl_b32 s51, s66, 30
  s_add_u32 s50, s50, s51
  v_lshl_add_u32 v84, v96, 8, s50
  v_cmp_gt_u32 vcc, 45, v96
  v_mov_b32 v4, 0x7f000000
  s_nop 0
  v_cndmask_b32 v84, v4, v84, vcc
  s_lshl_b32 s46, s37, 1
  s_mul_i32 s46, s46, 737280
  s_mul_i32 s50, s52, 114688
  s_add_u32 s46, s46, s50
  s_lshl_b32 s50, s38, 10
  s_add_u32 s46, s46, s50
  s_add_u32 s46, s46, s61
  v_mbcnt_lo_u32_b32 v88, -1, 0
  v_mbcnt_hi_u32_b32 v88, -1, v88
  s_lshl_b32 s50, s37, 10
  s_and_b32 s51, s36, 3
  s_lshl_b32 s51, s51, 7
  s_add_u32 s50, s50, s51
  s_lshr_b32 s51, s38, 2
  s_lshl_b32 s51, s51, 3
  s_add_u32 s50, s50, s51
  v_bfe_u32 v4, v88, 1, 1
  v_and_b32 v88, 1, v88
  v_lshl_add_u32 v88, v88, 2, s50
  v_lshl_add_u32 v88, v4, 6, v88
  ds_read_b64_tr_b16 v[20:21], v17 offset:12288
  ds_read_b64_tr_b16 v[22:23], v17 offset:13824
  ds_read_b64_tr_b16 v[24:25], v17 offset:12352
  ds_read_b64_tr_b16 v[26:27], v17 offset:13888
  ds_read_b64_tr_b16 v[28:29], v17 offset:12416
  ds_read_b64_tr_b16 v[30:31], v17 offset:13952
  s_waitcnt lgkmcnt(5)
  v_lshlrev_b32 v32, 16, v20
  v_and_b32 v36, 0xffff0000, v20
  v_lshlrev_b32 v33, 16, v21
  v_and_b32 v37, 0xffff0000, v21
  s_waitcnt lgkmcnt(4)
  v_lshlrev_b32 v34, 16, v22
  v_and_b32 v38, 0xffff0000, v22
  v_lshlrev_b32 v35, 16, v23
  v_and_b32 v39, 0xffff0000, v23
  v_add_f32 v44, v44, v32
  v_add_f32 v45, v45, v33
  v_add_f32 v46, v46, v34
  v_add_f32 v47, v47, v35
  v_add_f32 v44, v44, v36
  v_add_f32 v45, v45, v37
  v_add_f32 v46, v46, v38
  v_add_f32 v47, v47, v39
  s_waitcnt lgkmcnt(3)
  v_lshlrev_b32 v32, 16, v24
  v_and_b32 v36, 0xffff0000, v24
  v_lshlrev_b32 v33, 16, v25
  v_and_b32 v37, 0xffff0000, v25
  s_waitcnt lgkmcnt(2)
  v_lshlrev_b32 v34, 16, v26
  v_and_b32 v38, 0xffff0000, v26
  v_lshlrev_b32 v35, 16, v27
  v_and_b32 v39, 0xffff0000, v27
  v_add_f32 v48, v48, v32
  v_add_f32 v49, v49, v33
  v_add_f32 v50, v50, v34
  v_add_f32 v51, v51, v35
  v_add_f32 v48, v48, v36
  v_add_f32 v49, v49, v37
  v_add_f32 v50, v50, v38
  v_add_f32 v51, v51, v39
  s_waitcnt lgkmcnt(1)
  v_lshlrev_b32 v32, 16, v28
  v_and_b32 v36, 0xffff0000, v28
  v_lshlrev_b32 v33, 16, v29
  v_and_b32 v37, 0xffff0000, v29
  s_waitcnt lgkmcnt(0)
  v_lshlrev_b32 v34, 16, v30
  v_and_b32 v38, 0xffff0000, v30
  v_lshlrev_b32 v35, 16, v31
  v_and_b32 v39, 0xffff0000, v31
  v_add_f32 v52, v52, v32
  v_add_f32 v53, v53, v33
  v_add_f32 v54, v54, v34
  v_add_f32 v55, v55, v35
  v_add_f32 v52, v52, v36
  v_add_f32 v53, v53, v37
  v_add_f32 v54, v54, v38
  v_add_f32 v55, v55, v39
  s_waitcnt vmcnt(3)
  s_barrier
  ds_read_b64_tr_b16 v[20:21], v17 offset:24576
  ds_read_b64_tr_b16 v[22:23], v17 offset:26112
  ds_read_b64_tr_b16 v[24:25], v17 offset:24640
  ds_read_b64_tr_b16 v[26:27], v17 offset:26176
  ds_read_b64_tr_b16 v[28:29], v17 offset:24704
  ds_read_b64_tr_b16 v[30:31], v17 offset:26240
  s_waitcnt lgkmcnt(5)
  v_lshlrev_b32 v32, 16, v20
  v_and_b32 v36, 0xffff0000, v20
  v_lshlrev_b32 v33, 16, v21
  v_and_b32 v37, 0xffff0000, v21
  s_waitcnt lgkmcnt(4)
  v_lshlrev_b32 v34, 16, v22
  v_and_b32 v38, 0xffff0000, v22
  v_lshlrev_b32 v35, 16, v23
  v_and_b32 v39, 0xffff0000, v23
  v_add_f32 v44, v44, v32
  v_add_f32 v45, v45, v33
  v_add_f32 v46, v46, v34
  v_add_f32 v47, v47, v35
  v_add_f32 v44, v44, v36
  v_add_f32 v45, v45, v37
  v_add_f32 v46, v46, v38
  v_add_f32 v47, v47, v39
  s_waitcnt lgkmcnt(3)
  v_lshlrev_b32 v32, 16, v24
  v_and_b32 v36, 0xffff0000, v24
  v_lshlrev_b32 v33, 16, v25
  v_and_b32 v37, 0xffff0000, v25
  s_waitcnt lgkmcnt(2)
  v_lshlrev_b32 v34, 16, v26
  v_and_b32 v38, 0xffff0000, v26
  v_lshlrev_b32 v35, 16, v27
  v_and_b32 v39, 0xffff0000, v27
  v_add_f32 v48, v48, v32
  v_add_f32 v49, v49, v33
  v_add_f32 v50, v50, v34
  v_add_f32 v51, v51, v35
  v_add_f32 v48, v48, v36
  v_add_f32 v49, v49, v37
  v_add_f32 v50, v50, v38
  v_add_f32 v51, v51, v39
  s_waitcnt lgkmcnt(1)
  v_lshlrev_b32 v32, 16, v28
  v_and_b32 v36, 0xffff0000, v28
  v_lshlrev_b32 v33, 16, v29
  v_and_b32 v37, 0xffff0000, v29
  s_waitcnt lgkmcnt(0)
  v_lshlrev_b32 v34, 16, v30
  v_and_b32 v38, 0xffff0000, v30
  v_lshlrev_b32 v35, 16, v31
  v_and_b32 v39, 0xffff0000, v31
  v_add_f32 v52, v52, v32
  v_add_f32 v53, v53, v33
  v_add_f32 v54, v54, v34
  v_add_f32 v55, v55, v35
  v_add_f32 v52, v52, v36
  v_add_f32 v53, v53, v37
  v_add_f32 v54, v54, v38
  v_add_f32 v55, v55, v39
  s_waitcnt vmcnt(0)
  s_barrier
  ds_read_b64_tr_b16 v[20:21], v17 offset:36864
  ds_read_b64_tr_b16 v[22:23], v17 offset:38400
  ds_read_b64_tr_b16 v[24:25], v17 offset:36928
  ds_read_b64_tr_b16 v[26:27], v17 offset:38464
  ds_read_b64_tr_b16 v[28:29], v17 offset:36992
  ds_read_b64_tr_b16 v[30:31], v17 offset:38528
  s_waitcnt lgkmcnt(5)
  v_lshlrev_b32 v32, 16, v20
  v_and_b32 v36, 0xffff0000, v20
  v_lshlrev_b32 v33, 16, v21
  v_and_b32 v37, 0xffff0000, v21
  s_waitcnt lgkmcnt(4)
  v_lshlrev_b32 v34, 16, v22
  v_and_b32 v38, 0xffff0000, v22
  v_lshlrev_b32 v35, 16, v23
  v_and_b32 v39, 0xffff0000, v23
  v_add_f32 v44, v44, v32
  v_add_f32 v45, v45, v33
  v_add_f32 v46, v46, v34
  v_add_f32 v47, v47, v35
  v_add_f32 v44, v44, v36
  v_add_f32 v45, v45, v37
  v_add_f32 v46, v46, v38
  v_add_f32 v47, v47, v39
  s_waitcnt lgkmcnt(3)
  v_lshlrev_b32 v32, 16, v24
  v_and_b32 v36, 0xffff0000, v24
  v_lshlrev_b32 v33, 16, v25
  v_and_b32 v37, 0xffff0000, v25
  s_waitcnt lgkmcnt(2)
  v_lshlrev_b32 v34, 16, v26
  v_and_b32 v38, 0xffff0000, v26
  v_lshlrev_b32 v35, 16, v27
  v_and_b32 v39, 0xffff0000, v27
  v_add_f32 v48, v48, v32
  v_add_f32 v49, v49, v33
  v_add_f32 v50, v50, v34
  v_add_f32 v51, v51, v35
  v_add_f32 v48, v48, v36
  v_add_f32 v49, v49, v37
  v_add_f32 v50, v50, v38
  v_add_f32 v51, v51, v39
  s_waitcnt lgkmcnt(1)
  v_lshlrev_b32 v32, 16, v28
  v_and_b32 v36, 0xffff0000, v28
  v_lshlrev_b32 v33, 16, v29
  v_and_b32 v37, 0xffff0000, v29
  s_waitcnt lgkmcnt(0)
  v_lshlrev_b32 v34, 16, v30
  v_and_b32 v38, 0xffff0000, v30
  v_lshlrev_b32 v35, 16, v31
  v_and_b32 v39, 0xffff0000, v31
  v_add_f32 v52, v52, v32
  v_add_f32 v53, v53, v33
  v_add_f32 v54, v54, v34
  v_add_f32 v55, v55, v35
  v_add_f32 v52, v52, v36
  v_add_f32 v53, v53, v37
  v_add_f32 v54, v54, v38
  v_add_f32 v55, v55, v39
  s_mul_i32 s52, s36, 384
  s_add_u32 s52, s52, 145920
  v_and_b32 v9, 31, v9
  v_lshl_add_u32 v9, v9, 2, s52
  v_add_f32 v44, v44, v45
  v_add_f32 v46, v46, v47
  v_add_f32 v44, v44, v46
  v_add_f32 v48, v48, v49
  v_add_f32 v50, v50, v51
  v_add_f32 v48, v48, v50
  v_add_f32 v52, v52, v53
  v_add_f32 v54, v54, v55
  v_add_f32 v52, v52, v54
  v_mov_b32 v45, v44
  v_mov_b32 v49, v48
  v_mov_b32 v53, v52
  s_nop 0
  v_permlane32_swap_b32 v44, v45
  v_add_f32 v44, v44, v45
  ds_write_b32 v9, v44 offset:0
  v_permlane32_swap_b32 v48, v49
  v_add_f32 v48, v48, v49
  ds_write_b32 v9, v48 offset:128
  v_permlane32_swap_b32 v52, v53
  v_add_f32 v52, v52, v53
  ds_write_b32 v9, v52 offset:256
  s_waitcnt lgkmcnt(0)
  s_barrier
  s_cmp_ge_u32 s36, 5
  s_cbranch_scc1 QD_114
  v_mbcnt_lo_u32_b32 v3, -1, 0
  v_mbcnt_hi_u32_b32 v3, -1, v3
  v_lshlrev_b32 v5, 2, v3
  s_mov_b32 s50, 0x40000
POLL_119:
  global_load_dword v4, v5, s[32:33] sc1
  s_waitcnt vmcnt(0)
  v_and_b32 v6, 0xff, v4
  v_bfe_u32 v7, v4, 8, 8
  v_bfe_u32 v8, v4, 16, 8
  v_lshrrev_b32 v9, 24, v4
  v_min_u32 v10, v6, v7
  v_min3_u32 v10, v10, v8, v9
  v_cmp_eq_u32 vcc, 0, v10
  s_sub_u32 s50, s50, 1
  s_cmp_eq_u32 s50, 0
  s_cbranch_scc1 POLLX_120
  s_cbranch_vccnz POLL_119
POLLX_120:
  v_readlane_b32 s54, v4, 0
  v_readlane_b32 s55, v4, 1
  v_and_b32 v10, 1, v3
  v_cmp_eq_u32 vcc, 0, v10
  v_mov_b32 v11, s54
  v_mov_b32 v12, s55
  v_cndmask_b32 v11, v12, v11, vcc
  v_cmp_ne_u32 vcc, v11, v4
  s_mov_b32 s39, 0
  s_cmp_lg_u64 vcc, 0
  s_cselect_b32 s66, 1, 0
  s_cmp_eq_u32 s66, 0
  s_cbranch_scc1 RSF_121
  s_mov_b32 s39, 0
  s_mov_b32 s52, 0
  v_cmp_eq_u32 vcc, 1, v6
  s_nop 0
  s_bcnt1_i32_b64 s51, vcc
  s_add_u32 s52, s52, s51
  v_cmp_eq_u32 vcc, 1, v7
  s_nop 0
  s_bcnt1_i32_b64 s51, vcc
  s_add_u32 s52, s52, s51
  v_cmp_eq_u32 vcc, 1, v8
  s_nop 0
  s_bcnt1_i32_b64 s51, vcc
  s_add_u32 s52, s52, s51
  v_cmp_eq_u32 vcc, 1, v9
  s_nop 0
  s_bcnt1_i32_b64 s51, vcc
  s_add_u32 s52, s52, s51
  s_cmp_lg_u32 s52, 32
  s_cselect_b32 s51, 1, 0
  s_or_b32 s39, s39, s51
  s_mov_b32 s52, 0
  v_cmp_eq_u32 vcc, 2, v6
  s_nop 0
  s_bcnt1_i32_b64 s51, vcc
  s_add_u32 s52, s52, s51
  v_cmp_eq_u32 vcc, 2, v7
  s_nop 0
  s_bcnt1_i32_b64 s51, vcc
  s_add_u32 s52, s52, s51
  v_cmp_eq_u32 vcc, 2, v8
  s_nop 0
  s_bcnt1_i32_b64 s51, vcc
  s_add_u32 s52, s52, s51
  v_cmp_eq_u32 vcc, 2, v9
  s_nop 0
  s_bcnt1_i32_b64 s51, vcc
  s_add_u32 s52, s52, s51
  s_cmp_lg_u32 s52, 32
  s_cselect_b32 s51, 1, 0
  s_or_b32 s39, s39, s51
  s_mov_b32 s52, 0
  v_cmp_eq_u32 vcc, 3, v6
  s_nop 0
  s_bcnt1_i32_b64 s51, vcc
  s_add_u32 s52, s52, s51
  v_cmp_eq_u32 vcc, 3, v7
  s_nop 0
  s_bcnt1_i32_b64 s51, vcc
  s_add_u32 s52, s52, s51
  v_cmp_eq_u32 vcc, 3, v8
  s_nop 0
  s_bcnt1_i32_b64 s51, vcc
  s_add_u32 s52, s52, s51
  v_cmp_eq_u32 vcc, 3, v9
  s_nop 0
  s_bcnt1_i32_b64 s51, vcc
  s_add_u32 s52, s52, s51
  s_cmp_lg_u32 s52, 32
  s_cselect_b32 s51, 1, 0
  s_or_b32 s39, s39, s51
  s_mov_b32 s52, 0
  v_cmp_eq_u32 vcc, 4, v6
  s_nop 0
  s_bcnt1_i32_b64 s51, vcc
  s_add_u32 s52, s52, s51
  v_cmp_eq_u32 vcc, 4, v7
  s_nop 0
  s_bcnt1_i32_b64 s51, vcc
  s_add_u32 s52, s52, s51
  v_cmp_eq_u32 vcc, 4, v8
  s_nop 0
  s_bcnt1_i32_b64 s51, vcc
  s_add_u32 s52, s52, s51
  v_cmp_eq_u32 vcc, 4, v9
  s_nop 0
  s_bcnt1_i32_b64 s51, vcc
  s_add_u32 s52, s52, s51
  s_cmp_lg_u32 s52, 32
  s_cselect_b32 s51, 1, 0
  s_or_b32 s39, s39, s51
  s_mov_b32 s52, 0
  v_cmp_eq_u32 vcc, 5, v6
  s_nop 0
  s_bcnt1_i32_b64 s51, vcc
  s_add_u32 s52, s52, s51
  v_cmp_eq_u32 vcc, 5, v7
  s_nop 0
  s_bcnt1_i32_b64 s51, vcc
  s_add_u32 s52, s52, s51
  v_cmp_eq_u32 vcc, 5, v8
  s_nop 0
  s_bcnt1_i32_b64 s51, vcc
  s_add_u32 s52, s52, s51
  v_cmp_eq_u32 vcc, 5, v9
  s_nop 0
  s_bcnt1_i32_b64 s51, vcc
  s_add_u32 s52, s52, s51
  s_cmp_lg_u32 s52, 32
  s_cselect_b32 s51, 1, 0
  s_or_b32 s39, s39, s51
  s_mov_b32 s52, 0
  v_cmp_eq_u32 vcc, 6, v6
  s_nop 0
  s_bcnt1_i32_b64 s51, vcc
  s_add_u32 s52, s52, s51
  v_cmp_eq_u32 vcc, 6, v7
  s_nop 0
  s_bcnt1_i32_b64 s51, vcc
  s_add_u32 s52, s52, s51
  v_cmp_eq_u32 vcc, 6, v8
  s_nop 0
  s_bcnt1_i32_b64 s51, vcc
  s_add_u32 s52, s52, s51
  v_cmp_eq_u32 vcc, 6, v9
  s_nop 0
  s_bcnt1_i32_b64 s51, vcc
  s_add_u32 s52, s52, s51
  s_cmp_lg_u32 s52, 32
  s_cselect_b32 s51, 1, 0
  s_or_b32 s39, s39, s51
  s_mov_b32 s52, 0
  v_cmp_eq_u32 vcc, 7, v6
  s_nop 0
  s_bcnt1_i32_b64 s51, vcc
  s_add_u32 s52, s52, s51
  v_cmp_eq_u32 vcc, 7, v7
  s_nop 0
  s_bcnt1_i32_b64 s51, vcc
  s_add_u32 s52, s52, s51
  v_cmp_eq_u32 vcc, 7, v8
  s_nop 0
  s_bcnt1_i32_b64 s51, vcc
  s_add_u32 s52, s52, s51
  v_cmp_eq_u32 vcc, 7, v9
  s_nop 0
  s_bcnt1_i32_b64 s51, vcc
  s_add_u32 s52, s52, s51
  s_cmp_lg_u32 s52, 32
  s_cselect_b32 s51, 1, 0
  s_or_b32 s39, s39, s51
  s_mov_b32 s52, 0
  v_cmp_eq_u32 vcc, 8, v6
  s_nop 0
  s_bcnt1_i32_b64 s51, vcc
  s_add_u32 s52, s52, s51
  v_cmp_eq_u32 vcc, 8, v7
  s_nop 0
  s_bcnt1_i32_b64 s51, vcc
  s_add_u32 s52, s52, s51
  v_cmp_eq_u32 vcc, 8, v8
  s_nop 0
  s_bcnt1_i32_b64 s51, vcc
  s_add_u32 s52, s52, s51
  v_cmp_eq_u32 vcc, 8, v9
  s_nop 0
  s_bcnt1_i32_b64 s51, vcc
  s_add_u32 s52, s52, s51
  s_cmp_lg_u32 s52, 32
  s_cselect_b32 s51, 1, 0
  s_or_b32 s39, s39, s51
  s_add_u32 s53, s43, 1
  s_mov_b32 s52, 0
  v_add_u32 v10, 0, v5
  v_cmp_gt_u32 s[54:55], s2, v10
  v_cmp_eq_u32 vcc, s53, v6
  s_nop 0
  s_and_b64 vcc, vcc, s[54:55]
  s_bcnt1_i32_b64 s51, vcc
  s_add_u32 s52, s52, s51
  v_add_u32 v10, 1, v5
  v_cmp_gt_u32 s[54:55], s2, v10
  v_cmp_eq_u32 vcc, s53, v7
  s_nop 0
  s_and_b64 vcc, vcc, s[54:55]
  s_bcnt1_i32_b64 s51, vcc
  s_add_u32 s52, s52, s51
  v_add_u32 v10, 2, v5
  v_cmp_gt_u32 s[54:55], s2, v10
  v_cmp_eq_u32 vcc, s53, v8
  s_nop 0
  s_and_b64 vcc, vcc, s[54:55]
  s_bcnt1_i32_b64 s51, vcc
  s_add_u32 s52, s52, s51
  v_add_u32 v10, 3, v5
  v_cmp_gt_u32 s[54:55], s2, v10
  v_cmp_eq_u32 vcc, s53, v9
  s_nop 0
  s_and_b64 vcc, vcc, s[54:55]
  s_bcnt1_i32_b64 s51, vcc
  s_add_u32 s52, s52, s51
  s_cmp_eq_u32 s39, 0
  s_cselect_b32 s37, s43, s37
  s_cselect_b32 s38, s52, s38
RSF_121:
  s_lshl_b32 s50, s38, 8
  s_lshl_b32 s51, s39, 16
  s_or_b32 s50, s50, s51
  s_lshl_b32 s51, s66, 17
  s_or_b32 s50, s50, s51
  s_or_b32 s50, s50, s37
  v_mov_b32 v1, 163328
  v_mov_b32 v2, s50
  ds_write_b32 v1, v2
  s_waitcnt lgkmcnt(0)
  s_barrier
  s_branch QJ_116
QD_114:
  s_sub_u32 s50, s36, 5
  s_lshl_b32 s50, s50, 7
  v_mbcnt_lo_u32_b32 v9, -1, 0
  v_mbcnt_hi_u32_b32 v9, -1, v9
  v_and_b32 v9, 31, v9
  v_lshl_add_u32 v9, v9, 2, s50
  v_add_u32 v10, 147456, v9
  v_add_u32 v9, 161792, v9
  ds_read_b32 v11, v10
  ds_read_b32 v12, v10 offset:384
  ds_read_b32 v13, v10 offset:768
  ds_read_b32 v14, v10 offset:1152
  s_waitcnt lgkmcnt(2)
  v_add_f32 v11, v11, v12
  s_waitcnt lgkmcnt(0)
  v_add_f32 v13, v13, v14
  v_add_f32 v11, v11, v13
  ds_write_b32 v9, v11
  s_waitcnt lgkmcnt(0)
  s_barrier
  v_mov_b32 v2, 163328
  ds_read_b32 v2, v2
  s_waitcnt lgkmcnt(0)
  v_readfirstlane_b32 s50, v2
  s_nop 0
  s_and_b32 s37, s50, 7
  s_bfe_u32 s38, s50, 0x50008
  s_bfe_u32 s39, s50, 0x10010
  s_bfe_u32 s66, s50, 0x10011
QJ_116:
  v_mov_b32 v32, 0
  v_mov_b32 v33, 0
  v_mov_b32 v34, 0
  v_mov_b32 v35, 0
  v_mov_b32 v36, 0
  v_mov_b32 v37, 0
  v_mov_b32 v38, 0
  v_mov_b32 v39, 0
  v_mov_b32 v40, 0
  v_mov_b32 v41, 0
  v_mov_b32 v42, 0
  v_mov_b32 v43, 0
  v_mov_b32 v44, 0
  v_mov_b32 v45, 0
  v_mov_b32 v46, 0
  v_mov_b32 v47, 0
  v_mov_b32 v48, 0
  v_mov_b32 v49, 0
  v_mov_b32 v50, 0
  v_mov_b32 v51, 0
  v_mov_b32 v52, 0
  v_mov_b32 v53, 0
  v_mov_b32 v54, 0
  v_mov_b32 v55, 0
  v_mov_b32 v56, 0
  v_mov_b32 v57, 0
  v_mov_b32 v58, 0
  v_mov_b32 v59, 0
  v_mov_b32 v60, 0
  v_mov_b32 v61, 0
  v_mov_b32 v62, 0
  v_mov_b32 v63, 0
  s_cmp_eq_u32 s66, 0
  s_cbranch_scc1 QSP_122
  s_mul_i32 s50, s40, 5
  s_mul_i32 s51, s39, 11796480
  s_mul_i32 s50, s50, s51
  s_add_u32 s50, s50, 10485760
  s_add_u32 s50, s50, s51
  s_mov_b32 s62, s50
  s_add_u32 s50, s50, s51
  s_mov_b32 s63, s50
  s_add_u32 s50, s50, s51
  s_mov_b32 s64, s50
  s_add_u32 s50, s50, s51
  s_mov_b32 s69, s50
  v_mbcnt_lo_u32_b32 v96, -1, 0
  v_mbcnt_hi_u32_b32 v96, -1, v96
  v_lshlrev_b32 v95, 4, v96
  v_mov_b32 v94, 0xdddddddd
  s_lshr_b32 s51, s36, 2
  s_lshl_b32 s50, s51, 12
  s_add_u32 s50, s50, 30720
  s_mul_i32 s51, s51, 4096
  s_add_u32 s51, s51, 38912
  v_add_u32 v92, s50, v95
  v_and_b32 v4, 31, v96
  v_lshrrev_b32 v5, 5, v96
  v_lshlrev_b32 v5, 8, v5
  v_lshl_add_u32 v5, v4, 4, v5
  v_cmp_eq_u32 vcc, 16, v4
  v_add_u32 v93, s51, v5
  v_mov_b32 v5, 0x3f803f80
  v_cndmask_b32 v76, 0, v5, vcc
  v_cndmask_b32 v77, 0, v5, vcc
  v_cndmask_b32 v78, 0, v5, vcc
  v_cndmask_b32 v79, 0, v5, vcc
  v_cndmask_b32 v80, 0, v5, vcc
  v_cndmask_b32 v81, 0, v5, vcc
  v_cndmask_b32 v82, 0, v5, vcc
  v_cndmask_b32 v83, 0, v5, vcc
  s_mov_b32 s98, 0xffff
  s_mov_b32 s99, 0xffff
  s_bfe_u32 s45, s36, 0x10001
  s_lshl_b32 s46, s37, 1
  s_add_u32 s45, s45, s46
  s_mul_i32 s45, s45, 737280
  s_lshl_b32 s47, s36, 10
  s_add_u32 s67, s47, 47104
  s_and_b32 s50, s37, 1
  s_lshl_b32 s50, s50, 3
  s_lshr_b32 s51, s38, 2
  s_add_u32 s50, s50, s51
  s_lshl_b32 s50, s50, 9
  s_add_u32 s50, s50, 8192
  s_lshl_b32 s51, s66, 3
  s_or_b32 s51, s51, s37
  v_and_b32 v5, 31, v96
  v_lshrrev_b32 v4, 2, v5
  v_cmp_eq_u32 vcc, s51, v4
  v_xor_b32 v4, 4, v5
  s_nop 0
  v_cndmask_b32 v4, v5, v4, vcc
  v_and_b32 v5, 3, v4
  v_lshrrev_b32 v4, 2, v4
  v_lshl_add_u32 v5, v5, 2, s50
  v_lshl_add_u32 v99, v4, 6, v5
  v_mbcnt_lo_u32_b32 v97, -1, 0
  v_mbcnt_hi_u32_b32 v97, -1, v97
  v_lshrrev_b32 v13, 3, v97
  v_and_b32 v14, 7, v97
  v_lshlrev_b32 v15, 1, v13
  v_and_b32 v15, 4, v15
  v_xor_b32 v14, v14, v15
  v_mul_u32_u24 v13, 3584, v13
  v_lshl_add_u32 v97, v14, 4, v13
  v_mbcnt_lo_u32_b32 v98, -1, 0
  v_mbcnt_hi_u32_b32 v98, -1, v98
  v_lshrrev_b32 v13, 3, v98
  v_and_b32 v14, 7, v98
  v_lshlrev_b32 v15, 1, v13
  v_and_b32 v15, 4, v15
  v_xor_b32 v14, v14, v15
  v_mul_u32_u24 v13, 1024, v13
  v_lshl_add_u32 v98, v14, 4, v13
  s_lshl_b32 s44, s38, 16
  s_add_u32 s44, s44, s60
  s_add_u32 s44, s44, s47
  s_and_b32 s54, s38, 15
  s_min_u32 s54, s54, 13
  s_lshl_b32 s54, s54, 8
  s_and_b32 s55, s38, 7
  s_lshl_b32 s55, s55, 7
  s_mov_b32 s71, 0
  s_lshl_b32 s92, s37, 13
  s_lshl_b32 s93, s36, 10
  s_lshl_b32 s94, s36, 13
  s_add_u32 s94, s94, s55
  s_add_u32 s95, s93, 81920
  s_add_u32 s96, s36, 50
  s_mul_i32 s96, s96, 28672
  s_add_u32 s96, s96, s54
  s_add_u32 s96, s96, 128
  s_and_b32 s50, s36, 1
  s_mul_i32 s50, s50, 896
  s_bfe_u32 s51, s36, 0x10001
  s_lshl_b32 s51, s51, 3
  s_add_u32 s50, s50, s51
  s_add_u32 s50, s50, 688
  s_lshl_b32 s50, s50, 10
  s_add_u32 s97, s50, s55
  s_and_b32 s52, s36, 3
  v_mov_b32 v87, 0x7f000000
  s_lshr_b32 s50, s38, 4
  s_mul_i32 s50, s50, 88
  s_mul_i32 s51, s52, 22
  s_add_u32 s50, s50, s51
  v_add_u32 v85, s50, v96
  v_cmp_gt_u32 vcc, 0, v85
  v_add_u32 v4, 336, v85
  s_nop 0
  v_cndmask_b32 v85, v4, v85, vcc
  v_mul_u32_u24 v85, 3584, v85
  v_add_u32 v85, s54, v85
  v_cmp_gt_u32 vcc, 22, v96
  v_mov_b32 v4, 0x7f000000
  s_nop 0
  v_cndmask_b32 v85, v4, v85, vcc
  s_lshr_b32 s50, s38, 3
  s_mul_i32 s50, s50, 192
  s_mul_i32 s51, s52, 48
  s_add_u32 s50, s50, s51
  v_add_u32 v86, s50, v96
  v_cmp_gt_u32 vcc, 384, v86
  v_add_u32 v4, 64, v86
  s_nop 0
  v_cndmask_b32 v86, v4, v86, vcc
  v_and_b32 v4, 0xffc0, v86
  v_add_u32 v86, v4, v86
  v_mul_u32_u24 v86, 1024, v86
  v_add_u32 v86, s55, v86
  v_cmp_gt_u32 vcc, 48, v96
  v_mov_b32 v4, 0x7f000000
  s_nop 0
  v_cndmask_b32 v86, v4, v86, vcc
  s_lshr_b32 s50, s38, 4
  s_lshl_b32 s51, s37, 1
  s_add_u32 s50, s50, s51
  s_mul_i32 s50, s50, 737280
  s_and_b32 s51, s38, 15
  s_mul_i32 s51, s51, 46080
  s_add_u32 s50, s50, s51
  s_mul_i32 s51, s52, 11520
  s_add_u32 s50, s50, s51
  s_add_u32 s50, s50, 10485760
  s_lshl_b32 s51, s66, 30
  s_add_u32 s50, s50, s51
  v_lshl_add_u32 v84, v96, 8, s50
  v_cmp_gt_u32 vcc, 45, v96
  v_mov_b32 v4, 0x7f000000
  s_nop 0
  v_cndmask_b32 v84, v4, v84, vcc
  s_lshl_b32 s46, s37, 1
  s_mul_i32 s46, s46, 737280
  s_mul_i32 s50, s52, 114688
  s_add_u32 s46, s46, s50
  s_lshl_b32 s50, s38, 10
  s_add_u32 s46, s46, s50
  s_add_u32 s46, s46, s61
  v_mbcnt_lo_u32_b32 v88, -1, 0
  v_mbcnt_hi_u32_b32 v88, -1, v88
  s_lshl_b32 s50, s37, 10
  s_and_b32 s51, s36, 3
  s_lshl_b32 s51, s51, 7
  s_add_u32 s50, s50, s51
  s_lshr_b32 s51, s38, 2
  s_lshl_b32 s51, s51, 3
  s_add_u32 s50, s50, s51
  v_bfe_u32 v4, v88, 1, 1
  v_and_b32 v88, 1, v88
  v_lshl_add_u32 v88, v88, 2, s50
  v_lshl_add_u32 v88, v4, 6, v88
QSP_122:
L_LAYER_h:
  s_cmp_eq_u32 s66, 0
  s_cbranch_scc1 ANQ_125
  s_mov_b32 s50, 0x40000
POLL_128:
  global_load_dword v102, v99, s[34:35] sc1
  s_waitcnt vmcnt(0)
  v_cmp_gt_u32 vcc, s42, v102
  s_sub_u32 s50, s50, 1
  s_cmp_eq_u32 s50, 0
  s_cbranch_scc1 POLLX_129
  s_cbranch_vccnz POLL_128
POLLX_129:
  s_branch ANG_124
ANQ_125:
  s_add_u32 s51, s41, 1
  s_mov_b32 s50, 0x20000
  global_load_dword v8, v88, s[34:35] sc1
POLL_130:
  global_load_dword v9, v88, s[34:35] sc1
  s_waitcnt vmcnt(1)
  v_cmp_gt_u32 vcc, s51, v8
  s_nop 0
  s_cbranch_vccz POLLX_131
  global_load_dword v8, v88, s[34:35] sc1
  s_waitcnt vmcnt(1)
  v_cmp_gt_u32 vcc, s51, v9
  s_nop 0
  s_cbranch_vccz POLLX_131
  s_sub_u32 s50, s50, 1
  s_cmp_lg_u32 s50, 0
  s_cbranch_scc1 POLL_130
POLLX_131:
ANG_124:
  s_and_b32 s52, s36, 3
  s_lshl_b32 s50, s52, 10
  s_add_u32 m0, s50, 0
  s_nop 0
  buffer_load_dwordx4 v95, s[28:31], s46 offen sc1 lds
  s_add_u32 s49, s44, s92
  s_sub_u32 s49, s49, 4096
  s_add_u32 s48, s46, 32768
  s_cmp_eq_u32 s40, 0
  s_cselect_b32 s48, s49, s48
  s_add_u32 m0, s50, 30720
  s_mov_b32 s49, 2097152
  s_cmp_eq_u32 s40, 0
  s_cselect_b32 s49, s49, 32768
  buffer_load_dwordx4 v95, s[28:31], s48 offen sc1 lds
  s_add_u32 m0, s50, 38912
  s_add_u32 s48, s48, s49
  buffer_load_dwordx4 v95, s[28:31], s48 offen sc1 lds
  s_add_u32 s46, s46, 737280
  s_and_b32 s52, s36, 3
  s_lshl_b32 s50, s52, 10
  s_add_u32 m0, s50, 4096
  s_nop 0
  buffer_load_dwordx4 v95, s[28:31], s46 offen sc1 lds
  s_add_u32 s49, s44, s92
  s_sub_u32 s49, s49, 0
  s_add_u32 s48, s46, 32768
  s_cmp_eq_u32 s40, 0
  s_cselect_b32 s48, s49, s48
  s_add_u32 m0, s50, 34816
  s_mov_b32 s49, 2097152
  s_cmp_eq_u32 s40, 0
  s_cselect_b32 s49, s49, 32768
  buffer_load_dwordx4 v95, s[28:31], s48 offen sc1 lds
  s_add_u32 m0, s50, 43008
  s_add_u32 s48, s48, s49
  buffer_load_dwordx4 v95, s[28:31], s48 offen sc1 lds
  s_add_u32 s46, s46, 737280
  s_waitcnt vmcnt(0) lgkmcnt(0)
  s_barrier
  s_and_b32 s50, s36, 3
  s_lshl_b32 s50, s50, 11
  v_add_u32 v4, s50, v95
  ds_read_b128 v[64:67], v4
  ds_read_b128 v[68:71], v4 offset:1024
  s_cmp_lg_u32 s40, 0
  s_cbranch_scc1 AL1_132
  ds_read_b128 v[72:75], v92 offset:0
  s_mov_b64 exec, s[98:99]
  ds_read_b128 v[76:79], v93 offset:0
  s_mov_b64 exec, -1
  s_mov_b64 exec, s[98:99]
  ds_read_b128 v[80:83], v93 offset:512
  s_mov_b64 exec, -1
  global_load_dword v102, v99, s[34:35] sc1
  s_waitcnt lgkmcnt(2)
  v_mfma_f32_32x32x16_bf16 v[0:15], v[72:75], v[64:67], 0
  s_nop 11
  v_exp_f32 v0, v0
  v_exp_f32 v1, v1
  v_exp_f32 v2, v2
  v_exp_f32 v3, v3
  v_exp_f32 v4, v4
  v_mfma_f32_32x32x16_bf16 v[16:31], v[72:75], v[68:71], 0
  ds_read_b128 v[72:75], v92 offset:1024
  v_exp_f32 v5, v5
  v_exp_f32 v6, v6
  v_exp_f32 v7, v7
  v_exp_f32 v8, v8
  v_exp_f32 v9, v9
  s_waitcnt lgkmcnt(2)
  v_smfmac_f32_32x32x32_bf16 v[32:47], v[76:79], v[0:7], v94
  v_exp_f32 v10, v10
  v_exp_f32 v11, v11
  v_exp_f32 v12, v12
  v_exp_f32 v13, v13
  v_exp_f32 v14, v14
  v_exp_f32 v15, v15
  v_exp_f32 v16, v16
  v_exp_f32 v17, v17
  s_waitcnt lgkmcnt(1)
  v_smfmac_f32_32x32x32_bf16 v[32:47], v[80:83], v[8:15], v94
  v_exp_f32 v18, v18
  v_exp_f32 v19, v19
  v_exp_f32 v20, v20
  s_waitcnt lgkmcnt(0)
  v_mfma_f32_32x32x16_bf16 v[0:15], v[72:75], v[64:67], 0
  v_exp_f32 v21, v21
  v_exp_f32 v22, v22
  v_exp_f32 v23, v23
  v_exp_f32 v24, v24
  v_exp_f32 v25, v25
  v_smfmac_f32_32x32x32_bf16 v[48:63], v[76:79], v[16:23], v94
  s_mov_b64 exec, s[98:99]
  ds_read_b128 v[76:79], v93 offset:1024
  s_mov_b64 exec, -1
  v_exp_f32 v26, v26
  v_exp_f32 v27, v27
  v_exp_f32 v28, v28
  v_exp_f32 v29, v29
  v_exp_f32 v30, v30
  v_exp_f32 v31, v31
  v_exp_f32 v0, v0
  v_exp_f32 v1, v1
  v_smfmac_f32_32x32x32_bf16 v[48:63], v[80:83], v[24:31], v94
  s_mov_b64 exec, s[98:99]
  ds_read_b128 v[80:83], v93 offset:1536
  s_mov_b64 exec, -1
  s_cmp_lg_u32 s71, 0
  s_cbranch_scc1 APS_134
  s_waitcnt vmcnt(0)
  v_cmp_gt_u32 vcc, s42, v102
  s_nop 0
  s_cbranch_vccnz APR_135
  s_add_u32 s92, s92, 8192
  s_and_b32 s92, s92, 0xffff
  s_mov_b32 m0, s67
  s_add_u32 s48, s92, s44
  buffer_load_dwordx4 v95, s[28:31], s48 offen lds
  s_add_u32 m0, s67, 8192
  s_add_u32 s49, s48, 2097152
  buffer_load_dwordx4 v95, s[28:31], s49 offen lds
  s_add_u32 s67, s67, 16384
  s_mov_b32 s71, 1
  s_branch APS_134
APR_135:
  global_load_dword v102, v99, s[34:35] sc1
APS_134:
  v_exp_f32 v2, v2
  v_exp_f32 v3, v3
  v_exp_f32 v4, v4
  v_mfma_f32_32x32x16_bf16 v[16:31], v[72:75], v[68:71], 0
  ds_read_b128 v[72:75], v92 offset:2048
  v_exp_f32 v5, v5
  v_exp_f32 v6, v6
  v_exp_f32 v7, v7
  v_exp_f32 v8, v8
  v_exp_f32 v9, v9
  s_waitcnt lgkmcnt(2)
  v_smfmac_f32_32x32x32_bf16 v[32:47], v[76:79], v[0:7], v94
  v_exp_f32 v10, v10
  v_exp_f32 v11, v11
  v_exp_f32 v12, v12
  v_exp_f32 v13, v13
  v_exp_f32 v14, v14
  v_exp_f32 v15, v15
  v_exp_f32 v16, v16
  v_exp_f32 v17, v17
  s_waitcnt lgkmcnt(1)
  v_smfmac_f32_32x32x32_bf16 v[32:47], v[80:83], v[8:15], v94
  v_exp_f32 v18, v18
  v_exp_f32 v19, v19
  v_exp_f32 v20, v20
  s_waitcnt lgkmcnt(0)
  v_mfma_f32_32x32x16_bf16 v[0:15], v[72:75], v[64:67], 0
  v_exp_f32 v21, v21
  v_exp_f32 v22, v22
  v_exp_f32 v23, v23
  v_exp_f32 v24, v24
  v_exp_f32 v25, v25
  v_smfmac_f32_32x32x32_bf16 v[48:63], v[76:79], v[16:23], v94
  s_mov_b64 exec, s[98:99]
  ds_read_b128 v[76:79], v93 offset:2048
  s_mov_b64 exec, -1
  v_exp_f32 v26, v26
  v_exp_f32 v27, v27
  v_exp_f32 v28, v28
  v_exp_f32 v29, v29
  v_exp_f32 v30, v30
  v_exp_f32 v31, v31
  v_exp_f32 v0, v0
  v_exp_f32 v1, v1
  v_smfmac_f32_32x32x32_bf16 v[48:63], v[80:83], v[24:31], v94
  s_mov_b64 exec, s[98:99]
  ds_read_b128 v[80:83], v93 offset:2560
  s_mov_b64 exec, -1
  s_cmp_lg_u32 s71, 0
  s_cbranch_scc1 APS_136
  s_waitcnt vmcnt(0)
  v_cmp_gt_u32 vcc, s42, v102
  s_nop 0
  s_cbranch_vccnz APR_137
  s_add_u32 s92, s92, 8192
  s_and_b32 s92, s92, 0xffff
  s_mov_b32 m0, s67
  s_add_u32 s48, s92, s44
  buffer_load_dwordx4 v95, s[28:31], s48 offen lds
  s_add_u32 m0, s67, 8192
  s_add_u32 s49, s48, 2097152
  buffer_load_dwordx4 v95, s[28:31], s49 offen lds
  s_add_u32 s67, s67, 16384
  s_mov_b32 s71, 1
  s_branch APS_136
APR_137:
  global_load_dword v102, v99, s[34:35] sc1
APS_136:
  v_exp_f32 v2, v2
  v_exp_f32 v3, v3
  v_exp_f32 v4, v4
  v_mfma_f32_32x32x16_bf16 v[16:31], v[72:75], v[68:71], 0
  ds_read_b128 v[72:75], v92 offset:3072
  v_exp_f32 v5, v5
  v_exp_f32 v6, v6
  v_exp_f32 v7, v7
  v_exp_f32 v8, v8
  v_exp_f32 v9, v9
  s_waitcnt lgkmcnt(2)
  v_smfmac_f32_32x32x32_bf16 v[32:47], v[76:79], v[0:7], v94
  v_exp_f32 v10, v10
  v_exp_f32 v11, v11
  v_exp_f32 v12, v12
  v_exp_f32 v13, v13
  v_exp_f32 v14, v14
  v_exp_f32 v15, v15
  v_exp_f32 v16, v16
  v_exp_f32 v17, v17
  s_waitcnt lgkmcnt(1)
  v_smfmac_f32_32x32x32_bf16 v[32:47], v[80:83], v[8:15], v94
  v_exp_f32 v18, v18
  v_exp_f32 v19, v19
  v_exp_f32 v20, v20
  s_waitcnt lgkmcnt(0)
  v_mfma_f32_32x32x16_bf16 v[0:15], v[72:75], v[64:67], 0
  v_exp_f32 v21, v21
  v_exp_f32 v22, v22
  v_exp_f32 v23, v23
  v_exp_f32 v24, v24
  v_exp_f32 v25, v25
  v_smfmac_f32_32x32x32_bf16 v[48:63], v[76:79], v[16:23], v94
  s_mov_b64 exec, s[98:99]
  ds_read_b128 v[76:79], v93 offset:3072
  s_mov_b64 exec, -1
  v_exp_f32 v26, v26
  v_exp_f32 v27, v27
  v_exp_f32 v28, v28
  v_exp_f32 v29, v29
  v_exp_f32 v30, v30
  v_exp_f32 v31, v31
  v_exp_f32 v0, v0
  v_exp_f32 v1, v1
  v_smfmac_f32_32x32x32_bf16 v[48:63], v[80:83], v[24:31], v94
  s_mov_b64 exec, s[98:99]
  ds_read_b128 v[80:83], v93 offset:3584
  s_mov_b64 exec, -1
  s_cmp_lg_u32 s71, 0
  s_cbranch_scc1 APW_140
  s_cmp_lg_u32 s36, 4
  s_cbranch_scc1 APW_140
  s_mov_b32 s50, 0x40000
POLL_141:
  global_load_dword v102, v99, s[34:35] sc1
  s_waitcnt vmcnt(0)
  v_cmp_gt_u32 vcc, s42, v102
  s_sub_u32 s50, s50, 1
  s_cmp_eq_u32 s50, 0
  s_cbranch_scc1 POLLX_142
  s_cbranch_vccnz POLL_141
POLLX_142:
APW_140:
  s_barrier
  s_cmp_lg_u32 s71, 0
  s_cbranch_scc1 APS_138
  s_add_u32 s92, s92, 8192
  s_and_b32 s92, s92, 0xffff
  s_mov_b32 m0, s67
  s_add_u32 s48, s92, s44
  buffer_load_dwordx4 v95, s[28:31], s48 offen lds
  s_add_u32 m0, s67, 8192
  s_add_u32 s49, s48, 2097152
  buffer_load_dwordx4 v95, s[28:31], s49 offen lds
  s_add_u32 s67, s67, 16384
  s_mov_b32 s71, 1
APS_138:
  s_add_u32 s92, s92, 8192
  s_and_b32 s92, s92, 0xffff
  s_mov_b32 m0, s67
  s_add_u32 s48, s92, s44
  buffer_load_dwordx4 v95, s[28:31], s48 offen lds
  s_add_u32 m0, s67, 8192
  s_add_u32 s49, s48, 2097152
  buffer_load_dwordx4 v95, s[28:31], s49 offen lds
  s_add_u32 s67, s67, 16384
  v_exp_f32 v2, v2
  v_exp_f32 v3, v3
  v_exp_f32 v4, v4
  v_mfma_f32_32x32x16_bf16 v[16:31], v[72:75], v[68:71], 0
  v_exp_f32 v5, v5
  v_exp_f32 v6, v6
  v_exp_f32 v7, v7
  v_exp_f32 v8, v8
  v_exp_f32 v9, v9
  s_waitcnt lgkmcnt(1)
  v_smfmac_f32_32x32x32_bf16 v[32:47], v[76:79], v[0:7], v94
  v_exp_f32 v10, v10
  v_exp_f32 v11, v11
  v_exp_f32 v12, v12
  v_exp_f32 v13, v13
  v_exp_f32 v14, v14
  v_exp_f32 v15, v15
  v_exp_f32 v16, v16
  v_exp_f32 v17, v17
  s_waitcnt lgkmcnt(0)
  v_smfmac_f32_32x32x32_bf16 v[32:47], v[80:83], v[8:15], v94
  s_waitcnt vmcnt(2)
  s_barrier
  ds_read_b128 v[72:75], v92 offset:16384
  v_exp_f32 v18, v18
  v_exp_f32 v19, v19
  v_exp_f32 v20, v20
  s_waitcnt lgkmcnt(0)
  v_mfma_f32_32x32x16_bf16 v[0:15], v[72:75], v[64:67], 0
  v_exp_f32 v21, v21
  v_exp_f32 v22, v22
  v_exp_f32 v23, v23
  v_exp_f32 v24, v24
  v_exp_f32 v25, v25
  v_smfmac_f32_32x32x32_bf16 v[48:63], v[76:79], v[16:23], v94
  s_mov_b64 exec, s[98:99]
  ds_read_b128 v[76:79], v93 offset:16384
  s_mov_b64 exec, -1
  v_exp_f32 v26, v26
  v_exp_f32 v27, v27
  v_exp_f32 v28, v28
  v_exp_f32 v29, v29
  v_exp_f32 v30, v30
  v_exp_f32 v31, v31
  v_exp_f32 v0, v0
  v_exp_f32 v1, v1
  v_smfmac_f32_32x32x32_bf16 v[48:63], v[80:83], v[24:31], v94
  s_mov_b64 exec, s[98:99]
  ds_read_b128 v[80:83], v93 offset:16896
  s_mov_b64 exec, -1
  s_add_u32 s92, s92, 8192
  s_and_b32 s92, s92, 0xffff
  s_mov_b32 m0, s67
  s_add_u32 s48, s92, s44
  buffer_load_dwordx4 v95, s[28:31], s48 offen lds
  s_add_u32 m0, s67, 8192
  s_add_u32 s49, s48, 2097152
  buffer_load_dwordx4 v95, s[28:31], s49 offen lds
  s_add_u32 s67, s67, 16384
  v_exp_f32 v2, v2
  v_exp_f32 v3, v3
  v_exp_f32 v4, v4
  v_mfma_f32_32x32x16_bf16 v[16:31], v[72:75], v[68:71], 0
  ds_read_b128 v[72:75], v92 offset:17408
  v_exp_f32 v5, v5
  v_exp_f32 v6, v6
  v_exp_f32 v7, v7
  v_exp_f32 v8, v8
  v_exp_f32 v9, v9
  s_waitcnt lgkmcnt(2)
  v_smfmac_f32_32x32x32_bf16 v[32:47], v[76:79], v[0:7], v94
  v_exp_f32 v10, v10
  v_exp_f32 v11, v11
  v_exp_f32 v12, v12
  v_exp_f32 v13, v13
  v_exp_f32 v14, v14
  v_exp_f32 v15, v15
  v_exp_f32 v16, v16
  v_exp_f32 v17, v17
  s_waitcnt lgkmcnt(1)
  v_smfmac_f32_32x32x32_bf16 v[32:47], v[80:83], v[8:15], v94
  v_exp_f32 v18, v18
  v_exp_f32 v19, v19
  v_exp_f32 v20, v20
  s_waitcnt lgkmcnt(0)
  v_mfma_f32_32x32x16_bf16 v[0:15], v[72:75], v[64:67], 0
  s_lshl_b32 s50, s2, 2
  s_add_u32 s50, s50, s36
  s_sub_u32 s50, s50, 4
  s_lshl_b32 s51, s50, 9
  s_mul_i32 s50, s50, 1792
  v_lshlrev_b32 v88, 7, v96
  s_mov_b64 exec, 0x3fff
  buffer_load_dword v100, v88, s[20:23], s50 offen
  buffer_load_dword v100, v88, s[16:19], s50 offen
  s_mov_b64 exec, 15
  buffer_load_dword v100, v88, s[12:15], s51 offen
  s_mov_b64 exec, -1
  v_exp_f32 v21, v21
  v_exp_f32 v22, v22
  v_exp_f32 v23, v23
  v_exp_f32 v24, v24
  v_exp_f32 v25, v25
  v_smfmac_f32_32x32x32_bf16 v[48:63], v[76:79], v[16:23], v94
  s_mov_b64 exec, s[98:99]
  ds_read_b128 v[76:79], v93 offset:17408
  s_mov_b64 exec, -1
  v_exp_f32 v26, v26
  v_exp_f32 v27, v27
  v_exp_f32 v28, v28
  v_exp_f32 v29, v29
  v_exp_f32 v30, v30
  v_exp_f32 v31, v31
  v_exp_f32 v0, v0
  v_exp_f32 v1, v1
  v_smfmac_f32_32x32x32_bf16 v[48:63], v[80:83], v[24:31], v94
  s_mov_b64 exec, s[98:99]
  ds_read_b128 v[80:83], v93 offset:17920
  s_mov_b64 exec, -1
  v_exp_f32 v2, v2
  v_exp_f32 v3, v3
  v_exp_f32 v4, v4
  v_mfma_f32_32x32x16_bf16 v[16:31], v[72:75], v[68:71], 0
  ds_read_b128 v[72:75], v92 offset:18432
  buffer_load_dwordx4 v[104:107], v98, s[20:23], s97 offen
  s_add_u32 s97, s97, 81920
  v_exp_f32 v5, v5
  v_exp_f32 v6, v6
  v_exp_f32 v7, v7
  v_exp_f32 v8, v8
  v_exp_f32 v9, v9
  s_waitcnt lgkmcnt(2)
  v_smfmac_f32_32x32x32_bf16 v[32:47], v[76:79], v[0:7], v94
  v_exp_f32 v10, v10
  v_exp_f32 v11, v11
  v_exp_f32 v12, v12
  v_exp_f32 v13, v13
  v_exp_f32 v14, v14
  v_exp_f32 v15, v15
  v_exp_f32 v16, v16
  v_exp_f32 v17, v17
  s_waitcnt lgkmcnt(1)
  v_smfmac_f32_32x32x32_bf16 v[32:47], v[80:83], v[8:15], v94
  v_exp_f32 v18, v18
  v_exp_f32 v19, v19
  v_exp_f32 v20, v20
  s_waitcnt lgkmcnt(0)
  v_mfma_f32_32x32x16_bf16 v[0:15], v[72:75], v[64:67], 0
  buffer_load_dwordx4 v[108:111], v98, s[20:23], s97 offen
  s_add_u32 s97, s97, 16384
  v_exp_f32 v21, v21
  v_exp_f32 v22, v22
  v_exp_f32 v23, v23
  v_exp_f32 v24, v24
  v_exp_f32 v25, v25
  v_smfmac_f32_32x32x32_bf16 v[48:63], v[76:79], v[16:23], v94
  s_mov_b64 exec, s[98:99]
  ds_read_b128 v[76:79], v93 offset:18432
  s_mov_b64 exec, -1
  v_exp_f32 v26, v26
  v_exp_f32 v27, v27
  v_exp_f32 v28, v28
  v_exp_f32 v29, v29
  v_exp_f32 v30, v30
  v_exp_f32 v31, v31
  v_exp_f32 v0, v0
  v_exp_f32 v1, v1
  v_smfmac_f32_32x32x32_bf16 v[48:63], v[80:83], v[24:31], v94
  s_mov_b64 exec, s[98:99]
  ds_read_b128 v[80:83], v93 offset:18944
  s_mov_b64 exec, -1
  v_exp_f32 v2, v2
  v_exp_f32 v3, v3
  v_exp_f32 v4, v4
  v_mfma_f32_32x32x16_bf16 v[16:31], v[72:75], v[68:71], 0
  ds_read_b128 v[72:75], v92 offset:19456
  buffer_load_dwordx4 v[112:115], v98, s[20:23], s97 offen
  s_add_u32 s97, s97, 16384
  v_exp_f32 v5, v5
  v_exp_f32 v6, v6
  v_exp_f32 v7, v7
  v_exp_f32 v8, v8
  v_exp_f32 v9, v9
  s_waitcnt lgkmcnt(2)
  v_smfmac_f32_32x32x32_bf16 v[32:47], v[76:79], v[0:7], v94
  v_exp_f32 v10, v10
  v_exp_f32 v11, v11
  v_exp_f32 v12, v12
  v_exp_f32 v13, v13
  v_exp_f32 v14, v14
  v_exp_f32 v15, v15
  v_exp_f32 v16, v16
  v_exp_f32 v17, v17
  s_waitcnt lgkmcnt(1)
  v_smfmac_f32_32x32x32_bf16 v[32:47], v[80:83], v[8:15], v94
  v_exp_f32 v18, v18
  v_exp_f32 v19, v19
  v_exp_f32 v20, v20
  s_waitcnt lgkmcnt(0)
  v_mfma_f32_32x32x16_bf16 v[0:15], v[72:75], v[64:67], 0
  buffer_load_dwordx4 v[116:119], v98, s[20:23], s97 offen
  s_add_u32 s97, s97, 16384
  v_exp_f32 v21, v21
  v_exp_f32 v22, v22
  v_exp_f32 v23, v23
  v_exp_f32 v24, v24
  v_exp_f32 v25, v25
  v_smfmac_f32_32x32x32_bf16 v[48:63], v[76:79], v[16:23], v94
  s_mov_b64 exec, s[98:99]
  ds_read_b128 v[76:79], v93 offset:19456
  s_mov_b64 exec, -1
  v_exp_f32 v26, v26
  v_exp_f32 v27, v27
  v_exp_f32 v28, v28
  v_exp_f32 v29, v29
  v_exp_f32 v30, v30
  v_exp_f32 v31, v31
  v_exp_f32 v0, v0
  v_exp_f32 v1, v1
  v_smfmac_f32_32x32x32_bf16 v[48:63], v[80:83], v[24:31], v94
  s_mov_b64 exec, s[98:99]
  ds_read_b128 v[80:83], v93 offset:19968
  s_mov_b64 exec, -1
  s_waitcnt vmcnt(9)
  s_barrier
  v_exp_f32 v2, v2
  v_exp_f32 v3, v3
  v_exp_f32 v4, v4
  v_mfma_f32_32x32x16_bf16 v[16:31], v[72:75], v[68:71], 0
  ds_read_b128 v[72:75], v92 offset:32768
  buffer_load_dwordx4 v[120:123], v98, s[20:23], s97 offen
  s_add_u32 s97, s97, 4294197248
  v_exp_f32 v5, v5
  v_exp_f32 v6, v6
  v_exp_f32 v7, v7
  v_exp_f32 v8, v8
  v_exp_f32 v9, v9
  s_waitcnt lgkmcnt(2)
  v_smfmac_f32_32x32x32_bf16 v[32:47], v[76:79], v[0:7], v94
  v_exp_f32 v10, v10
  v_exp_f32 v11, v11
  v_exp_f32 v12, v12
  v_exp_f32 v13, v13
  v_exp_f32 v14, v14
  v_exp_f32 v15, v15
  v_exp_f32 v16, v16
  v_exp_f32 v17, v17
  s_waitcnt lgkmcnt(1)
  v_smfmac_f32_32x32x32_bf16 v[32:47], v[80:83], v[8:15], v94
  v_exp_f32 v18, v18
  v_exp_f32 v19, v19
  v_exp_f32 v20, v20
  s_waitcnt lgkmcnt(0)
  v_mfma_f32_32x32x16_bf16 v[0:15], v[72:75], v[64:67], 0
  buffer_load_dwordx4 v[124:127], v98, s[20:23], s97 offen
  s_add_u32 s97, s97, 16384
  v_exp_f32 v21, v21
  v_exp_f32 v22, v22
  v_exp_f32 v23, v23
  v_exp_f32 v24, v24
  v_exp_f32 v25, v25
  v_smfmac_f32_32x32x32_bf16 v[48:63], v[76:79], v[16:23], v94
  s_mov_b64 exec, s[98:99]
  ds_read_b128 v[76:79], v93 offset:32768
  s_mov_b64 exec, -1
  v_exp_f32 v26, v26
  v_exp_f32 v27, v27
  v_exp_f32 v28, v28
  v_exp_f32 v29, v29
  v_exp_f32 v30, v30
  v_exp_f32 v31, v31
  v_exp_f32 v0, v0
  v_exp_f32 v1, v1
  v_smfmac_f32_32x32x32_bf16 v[48:63], v[80:83], v[24:31], v94
  s_mov_b64 exec, s[98:99]
  ds_read_b128 v[80:83], v93 offset:33280
  s_mov_b64 exec, -1
  s_add_u32 s92, s92, 8192
  s_and_b32 s92, s92, 0xffff
  s_mov_b32 m0, s67
  s_add_u32 s48, s92, s44
  buffer_load_dwordx4 v95, s[28:31], s48 offen lds
  s_add_u32 m0, s67, 8192
  s_add_u32 s49, s48, 2097152
  buffer_load_dwordx4 v95, s[28:31], s49 offen lds
  s_add_u32 s67, s67, 16384
  v_exp_f32 v2, v2
  v_exp_f32 v3, v3
  v_exp_f32 v4, v4
  v_mfma_f32_32x32x16_bf16 v[16:31], v[72:75], v[68:71], 0
  ds_read_b128 v[72:75], v92 offset:33792
  buffer_load_dwordx4 v[128:131], v98, s[20:23], s97 offen
  s_add_u32 s97, s97, 16384
  v_exp_f32 v5, v5
  v_exp_f32 v6, v6
  v_exp_f32 v7, v7
  v_exp_f32 v8, v8
  v_exp_f32 v9, v9
  s_waitcnt lgkmcnt(2)
  v_smfmac_f32_32x32x32_bf16 v[32:47], v[76:79], v[0:7], v94
  v_exp_f32 v10, v10
  v_exp_f32 v11, v11
  v_exp_f32 v12, v12
  v_exp_f32 v13, v13
  v_exp_f32 v14, v14
  v_exp_f32 v15, v15
  v_exp_f32 v16, v16
  v_exp_f32 v17, v17
  s_waitcnt lgkmcnt(1)
  v_smfmac_f32_32x32x32_bf16 v[32:47], v[80:83], v[8:15], v94
  v_exp_f32 v18, v18
  v_exp_f32 v19, v19
  v_exp_f32 v20, v20
  s_waitcnt lgkmcnt(0)
  v_mfma_f32_32x32x16_bf16 v[0:15], v[72:75], v[64:67], 0
  buffer_load_dwordx4 v[132:135], v98, s[20:23], s97 offen
  s_add_u32 s97, s97, 16384
  buffer_load_dword v100, v84, s[28:31], 0 offen sc1
  v_exp_f32 v21, v21
  v_exp_f32 v22, v22
  v_exp_f32 v23, v23
  v_exp_f32 v24, v24
  v_exp_f32 v25, v25
  v_smfmac_f32_32x32x32_bf16 v[48:63], v[76:79], v[16:23], v94
  s_mov_b64 exec, s[98:99]
  ds_read_b128 v[76:79], v93 offset:33792
  s_mov_b64 exec, -1
  v_exp_f32 v26, v26
  v_exp_f32 v27, v27
  v_exp_f32 v28, v28
  v_exp_f32 v29, v29
  v_exp_f32 v30, v30
  v_exp_f32 v31, v31
  v_exp_f32 v0, v0
  v_exp_f32 v1, v1
  v_smfmac_f32_32x32x32_bf16 v[48:63], v[80:83], v[24:31], v94
  s_mov_b64 exec, s[98:99]
  ds_read_b128 v[80:83], v93 offset:34304
  s_mov_b64 exec, -1
  v_exp_f32 v2, v2
  v_exp_f32 v3, v3
  v_exp_f32 v4, v4
  v_mfma_f32_32x32x16_bf16 v[16:31], v[72:75], v[68:71], 0
  ds_read_b128 v[72:75], v92 offset:34816
  buffer_load_dwordx4 v[136:139], v98, s[20:23], s97 offen
  s_add_u32 s97, s97, 81920
  v_exp_f32 v5, v5
  v_exp_f32 v6, v6
  v_exp_f32 v7, v7
  v_exp_f32 v8, v8
  v_exp_f32 v9, v9
  s_waitcnt lgkmcnt(2)
  v_smfmac_f32_32x32x32_bf16 v[32:47], v[76:79], v[0:7], v94
  v_exp_f32 v10, v10
  v_exp_f32 v11, v11
  v_exp_f32 v12, v12
  v_exp_f32 v13, v13
  v_exp_f32 v14, v14
  v_exp_f32 v15, v15
  v_exp_f32 v16, v16
  v_exp_f32 v17, v17
  s_waitcnt lgkmcnt(1)
  v_smfmac_f32_32x32x32_bf16 v[32:47], v[80:83], v[8:15], v94
  v_exp_f32 v18, v18
  v_exp_f32 v19, v19
  v_exp_f32 v20, v20
  s_waitcnt lgkmcnt(0)
  v_mfma_f32_32x32x16_bf16 v[0:15], v[72:75], v[64:67], 0
  buffer_load_dwordx4 v[140:143], v98, s[20:23], s97 offen
  s_add_u32 s97, s97, 16384
  v_exp_f32 v21, v21
  v_exp_f32 v22, v22
  v_exp_f32 v23, v23
  v_exp_f32 v24, v24
  v_exp_f32 v25, v25
  v_smfmac_f32_32x32x32_bf16 v[48:63], v[76:79], v[16:23], v94
  s_mov_b64 exec, s[98:99]
  ds_read_b128 v[76:79], v93 offset:34816
  s_mov_b64 exec, -1
  v_exp_f32 v26, v26
  v_exp_f32 v27, v27
  v_exp_f32 v28, v28
  v_exp_f32 v29, v29
  v_exp_f32 v30, v30
  v_exp_f32 v31, v31
  v_exp_f32 v0, v0
  v_exp_f32 v1, v1
  v_smfmac_f32_32x32x32_bf16 v[48:63], v[80:83], v[24:31], v94
  s_mov_b64 exec, s[98:99]
  ds_read_b128 v[80:83], v93 offset:35328
  s_mov_b64 exec, -1
  v_exp_f32 v2, v2
  v_exp_f32 v3, v3
  v_exp_f32 v4, v4
  v_mfma_f32_32x32x16_bf16 v[16:31], v[72:75], v[68:71], 0
  ds_read_b128 v[72:75], v92 offset:35840
  buffer_load_dwordx4 v[144:147], v98, s[20:23], s97 offen
  s_add_u32 s97, s97, 16384
  v_exp_f32 v5, v5
  v_exp_f32 v6, v6
  v_exp_f32 v7, v7
  v_exp_f32 v8, v8
  v_exp_f32 v9, v9
  s_waitcnt lgkmcnt(2)
  v_smfmac_f32_32x32x32_bf16 v[32:47], v[76:79], v[0:7], v94
  v_exp_f32 v10, v10
  v_exp_f32 v11, v11
  v_exp_f32 v12, v12
  v_exp_f32 v13, v13
  v_exp_f32 v14, v14
  v_exp_f32 v15, v15
  v_exp_f32 v16, v16
  v_exp_f32 v17, v17
  s_waitcnt lgkmcnt(1)
  v_smfmac_f32_32x32x32_bf16 v[32:47], v[80:83], v[8:15], v94
  v_exp_f32 v18, v18
  v_exp_f32 v19, v19
  v_exp_f32 v20, v20
  s_waitcnt lgkmcnt(0)
  v_mfma_f32_32x32x16_bf16 v[0:15], v[72:75], v[64:67], 0
  buffer_load_dwordx4 v[148:151], v98, s[20:23], s97 offen
  s_add_u32 s97, s97, 16384
  v_exp_f32 v21, v21
  v_exp_f32 v22, v22
  v_exp_f32 v23, v23
  v_exp_f32 v24, v24
  v_exp_f32 v25, v25
  v_smfmac_f32_32x32x32_bf16 v[48:63], v[76:79], v[16:23], v94
  s_mov_b64 exec, s[98:99]
  ds_read_b128 v[76:79], v93 offset:35840
  s_mov_b64 exec, -1
  v_exp_f32 v26, v26
  v_exp_f32 v27, v27
  v_exp_f32 v28, v28
  v_exp_f32 v29, v29
  v_exp_f32 v30, v30
  v_exp_f32 v31, v31
  v_exp_f32 v0, v0
  v_exp_f32 v1, v1
  v_smfmac_f32_32x32x32_bf16 v[48:63], v[80:83], v[24:31], v94
  s_mov_b64 exec, s[98:99]
  ds_read_b128 v[80:83], v93 offset:36352
  s_mov_b64 exec, -1
  s_waitcnt vmcnt(18)
  s_barrier
  v_exp_f32 v2, v2
  v_exp_f32 v3, v3
  v_exp_f32 v4, v4
  v_mfma_f32_32x32x16_bf16 v[16:31], v[72:75], v[68:71], 0
  ds_read_b128 v[72:75], v92 offset:49152
  buffer_load_dwordx4 v[152:155], v98, s[20:23], s97 offen
  s_add_u32 s97, s97, 81920
  v_exp_f32 v5, v5
  v_exp_f32 v6, v6
  v_exp_f32 v7, v7
  v_exp_f32 v8, v8
  v_exp_f32 v9, v9
  s_waitcnt lgkmcnt(2)
  v_smfmac_f32_32x32x32_bf16 v[32:47], v[76:79], v[0:7], v94
  v_exp_f32 v10, v10
  v_exp_f32 v11, v11
  v_exp_f32 v12, v12
  v_exp_f32 v13, v13
  v_exp_f32 v14, v14
  v_exp_f32 v15, v15
  v_exp_f32 v16, v16
  v_exp_f32 v17, v17
  s_waitcnt lgkmcnt(1)
  v_smfmac_f32_32x32x32_bf16 v[32:47], v[80:83], v[8:15], v94
  v_exp_f32 v18, v18
  v_exp_f32 v19, v19
  v_exp_f32 v20, v20
  s_waitcnt lgkmcnt(0)
  v_mfma_f32_32x32x16_bf16 v[0:15], v[72:75], v[64:67], 0
  buffer_load_dwordx4 v[156:159], v98, s[20:23], s97 offen
  s_add_u32 s97, s97, 16384
  v_exp_f32 v21, v21
  v_exp_f32 v22, v22
  v_exp_f32 v23, v23
  v_exp_f32 v24, v24
  v_exp_f32 v25, v25
  v_smfmac_f32_32x32x32_bf16 v[48:63], v[76:79], v[16:23], v94
  s_mov_b64 exec, s[98:99]
  ds_read_b128 v[76:79], v93 offset:49152
  s_mov_b64 exec, -1
  v_exp_f32 v26, v26
  v_exp_f32 v27, v27
  v_exp_f32 v28, v28
  v_exp_f32 v29, v29
  v_exp_f32 v30, v30
  v_exp_f32 v31, v31
  v_exp_f32 v0, v0
  v_exp_f32 v1, v1
  v_smfmac_f32_32x32x32_bf16 v[48:63], v[80:83], v[24:31], v94
  s_mov_b64 exec, s[98:99]
  ds_read_b128 v[80:83], v93 offset:49664
  s_mov_b64 exec, -1
  s_add_u32 s92, s92, 8192
  s_and_b32 s92, s92, 0xffff
  s_mov_b32 m0, s67
  s_add_u32 s48, s92, s44
  buffer_load_dwordx4 v95, s[28:31], s48 offen lds
  s_add_u32 m0, s67, 8192
  s_add_u32 s49, s48, 2097152
  buffer_load_dwordx4 v95, s[28:31], s49 offen lds
  s_add_u32 s67, s67, 16384
  v_exp_f32 v2, v2
  v_exp_f32 v3, v3
  v_exp_f32 v4, v4
  v_mfma_f32_32x32x16_bf16 v[16:31], v[72:75], v[68:71], 0
  ds_read_b128 v[72:75], v92 offset:50176
  buffer_load_dwordx4 v[160:163], v98, s[20:23], s97 offen
  s_add_u32 s97, s97, 16384
  v_exp_f32 v5, v5
  v_exp_f32 v6, v6
  v_exp_f32 v7, v7
  v_exp_f32 v8, v8
  v_exp_f32 v9, v9
  s_waitcnt lgkmcnt(2)
  v_smfmac_f32_32x32x32_bf16 v[32:47], v[76:79], v[0:7], v94
  v_exp_f32 v10, v10
  v_exp_f32 v11, v11
  v_exp_f32 v12, v12
  v_exp_f32 v13, v13
  v_exp_f32 v14, v14
  v_exp_f32 v15, v15
  v_exp_f32 v16, v16
  v_exp_f32 v17, v17
  s_waitcnt lgkmcnt(1)
  v_smfmac_f32_32x32x32_bf16 v[32:47], v[80:83], v[8:15], v94
  v_exp_f32 v18, v18
  v_exp_f32 v19, v19
  v_exp_f32 v20, v20
  s_waitcnt lgkmcnt(0)
  v_mfma_f32_32x32x16_bf16 v[0:15], v[72:75], v[64:67], 0
  buffer_load_dwordx4 v[164:167], v98, s[20:23], s97 offen
  s_add_u32 s97, s97, 16384
  buffer_load_dword v100, v84, s[28:31], 0 offen offset:128 sc1
  v_exp_f32 v21, v21
  v_exp_f32 v22, v22
  v_exp_f32 v23, v23
  v_exp_f32 v24, v24
  v_exp_f32 v25, v25
  v_smfmac_f32_32x32x32_bf16 v[48:63], v[76:79], v[16:23], v94
  s_mov_b64 exec, s[98:99]
  ds_read_b128 v[76:79], v93 offset:50176
  s_mov_b64 exec, -1
  v_exp_f32 v26, v26
  v_exp_f32 v27, v27
  v_exp_f32 v28, v28
  v_exp_f32 v29, v29
  v_exp_f32 v30, v30
  v_exp_f32 v31, v31
  v_exp_f32 v0, v0
  v_exp_f32 v1, v1
  v_smfmac_f32_32x32x32_bf16 v[48:63], v[80:83], v[24:31], v94
  s_mov_b64 exec, s[98:99]
  ds_read_b128 v[80:83], v93 offset:50688
  s_mov_b64 exec, -1
  v_exp_f32 v2, v2
  v_exp_f32 v3, v3
  v_exp_f32 v4, v4
  v_mfma_f32_32x32x16_bf16 v[16:31], v[72:75], v[68:71], 0
  ds_read_b128 v[72:75], v92 offset:51200
  buffer_load_dwordx4 v[168:171], v98, s[20:23], s97 offen
  s_add_u32 s97, s97, 81920
  v_exp_f32 v5, v5
  v_exp_f32 v6, v6
  v_exp_f32 v7, v7
  v_exp_f32 v8, v8
  v_exp_f32 v9, v9
  s_waitcnt lgkmcnt(2)
  v_smfmac_f32_32x32x32_bf16 v[32:47], v[76:79], v[0:7], v94
  v_exp_f32 v10, v10
  v_exp_f32 v11, v11
  v_exp_f32 v12, v12
  v_exp_f32 v13, v13
  v_exp_f32 v14, v14
  v_exp_f32 v15, v15
  v_exp_f32 v16, v16
  v_exp_f32 v17, v17
  s_waitcnt lgkmcnt(1)
  v_smfmac_f32_32x32x32_bf16 v[32:47], v[80:83], v[8:15], v94
  v_exp_f32 v18, v18
  v_exp_f32 v19, v19
  v_exp_f32 v20, v20
  s_waitcnt lgkmcnt(0)
  v_mfma_f32_32x32x16_bf16 v[0:15], v[72:75], v[64:67], 0
  buffer_load_dwordx4 v[172:175], v98, s[20:23], s97 offen
  s_add_u32 s97, s97, 16384
  v_exp_f32 v21, v21
  v_exp_f32 v22, v22
  v_exp_f32 v23, v23
  v_exp_f32 v24, v24
  v_exp_f32 v25, v25
  v_smfmac_f32_32x32x32_bf16 v[48:63], v[76:79], v[16:23], v94
  s_mov_b64 exec, s[98:99]
  ds_read_b128 v[76:79], v93 offset:51200
  s_mov_b64 exec, -1
  v_exp_f32 v26, v26
  v_exp_f32 v27, v27
  v_exp_f32 v28, v28
  v_exp_f32 v29, v29
  v_exp_f32 v30, v30
  v_exp_f32 v31, v31
  v_exp_f32 v0, v0
  v_exp_f32 v1, v1
  v_smfmac_f32_32x32x32_bf16 v[48:63], v[80:83], v[24:31], v94
  s_mov_b64 exec, s[98:99]
  ds_read_b128 v[80:83], v93 offset:51712
  s_mov_b64 exec, -1
  v_exp_f32 v2, v2
  v_exp_f32 v3, v3
  v_exp_f32 v4, v4
  v_mfma_f32_32x32x16_bf16 v[16:31], v[72:75], v[68:71], 0
  ds_read_b128 v[72:75], v92 offset:52224
  buffer_load_dwordx4 v[176:179], v98, s[20:23], s97 offen
  s_add_u32 s97, s97, 16384
  v_exp_f32 v5, v5
  v_exp_f32 v6, v6
  v_exp_f32 v7, v7
  v_exp_f32 v8, v8
  v_exp_f32 v9, v9
  s_waitcnt lgkmcnt(2)
  v_smfmac_f32_32x32x32_bf16 v[32:47], v[76:79], v[0:7], v94
  v_exp_f32 v10, v10
  v_exp_f32 v11, v11
  v_exp_f32 v12, v12
  v_exp_f32 v13, v13
  v_exp_f32 v14, v14
  v_exp_f32 v15, v15
  v_exp_f32 v16, v16
  v_exp_f32 v17, v17
  s_waitcnt lgkmcnt(1)
  v_smfmac_f32_32x32x32_bf16 v[32:47], v[80:83], v[8:15], v94
  v_exp_f32 v18, v18
  v_exp_f32 v19, v19
  v_exp_f32 v20, v20
  s_waitcnt lgkmcnt(0)
  v_mfma_f32_32x32x16_bf16 v[0:15], v[72:75], v[64:67], 0
  buffer_load_dwordx4 v[180:183], v98, s[20:23], s97 offen
  s_add_u32 s97, s97, 16384
  v_exp_f32 v21, v21
  v_exp_f32 v22, v22
  v_exp_f32 v23, v23
  v_exp_f32 v24, v24
  v_exp_f32 v25, v25
  v_smfmac_f32_32x32x32_bf16 v[48:63], v[76:79], v[16:23], v94
  s_mov_b64 exec, s[98:99]
  ds_read_b128 v[76:79], v93 offset:52224
  s_mov_b64 exec, -1
  v_exp_f32 v26, v26
  v_exp_f32 v27, v27
  v_exp_f32 v28, v28
  v_exp_f32 v29, v29
  v_exp_f32 v30, v30
  v_exp_f32 v31, v31
  v_exp_f32 v0, v0
  v_exp_f32 v1, v1
  v_smfmac_f32_32x32x32_bf16 v[48:63], v[80:83], v[24:31], v94
  s_mov_b64 exec, s[98:99]
  ds_read_b128 v[80:83], v93 offset:52736
  s_mov_b64 exec, -1
  s_waitcnt vmcnt(18)
  s_barrier
  v_exp_f32 v2, v2
  v_exp_f32 v3, v3
  v_exp_f32 v4, v4
  v_mfma_f32_32x32x16_bf16 v[16:31], v[72:75], v[68:71], 0
  v_add_u32 v92, 65536, v92
  ds_read_b128 v[72:75], v92 offset:0
  buffer_load_dwordx4 v[184:187], v98, s[20:23], s97 offen
  s_add_u32 s97, s97, 81920
  v_exp_f32 v5, v5
  v_exp_f32 v6, v6
  v_exp_f32 v7, v7
  v_exp_f32 v8, v8
  v_exp_f32 v9, v9
  s_waitcnt lgkmcnt(2)
  v_smfmac_f32_32x32x32_bf16 v[32:47], v[76:79], v[0:7], v94
  v_exp_f32 v10, v10
  v_exp_f32 v11, v11
  v_exp_f32 v12, v12
  v_exp_f32 v13, v13
  v_exp_f32 v14, v14
  v_exp_f32 v15, v15
  v_exp_f32 v16, v16
  v_exp_f32 v17, v17
  s_waitcnt lgkmcnt(1)
  v_smfmac_f32_32x32x32_bf16 v[32:47], v[80:83], v[8:15], v94
  v_exp_f32 v18, v18
  v_exp_f32 v19, v19
  v_exp_f32 v20, v20
  s_waitcnt lgkmcnt(0)
  v_mfma_f32_32x32x16_bf16 v[0:15], v[72:75], v[64:67], 0
  s_mov_b32 m0, s93
  s_add_u32 s93, s93, 8192
  buffer_load_dwordx4 v98, s[12:15], s94 offen lds
  s_add_u32 s94, s94, 65536
  buffer_load_dwordx4 v[188:191], v98, s[20:23], s97 offen
  s_add_u32 s97, s97, 16384
  v_exp_f32 v21, v21
  v_exp_f32 v22, v22
  v_exp_f32 v23, v23
  v_exp_f32 v24, v24
  v_exp_f32 v25, v25
  v_smfmac_f32_32x32x32_bf16 v[48:63], v[76:79], v[16:23], v94
  v_add_u32 v93, 65536, v93
  s_mov_b64 exec, s[98:99]
  ds_read_b128 v[76:79], v93 offset:0
  s_mov_b64 exec, -1
  v_exp_f32 v26, v26
  v_exp_f32 v27, v27
  v_exp_f32 v28, v28
  v_exp_f32 v29, v29
  v_exp_f32 v30, v30
  v_exp_f32 v31, v31
  v_exp_f32 v0, v0
  v_exp_f32 v1, v1
  v_smfmac_f32_32x32x32_bf16 v[48:63], v[80:83], v[24:31], v94
  s_mov_b64 exec, s[98:99]
  ds_read_b128 v[80:83], v93 offset:512
  s_mov_b64 exec, -1
  s_add_u32 s92, s92, 8192
  s_and_b32 s92, s92, 0xffff
  s_mov_b32 m0, s67
  s_add_u32 s48, s92, s44
  buffer_load_dwordx4 v95, s[28:31], s48 offen lds
  s_add_u32 m0, s67, 8192
  s_add_u32 s49, s48, 2097152
  buffer_load_dwordx4 v95, s[28:31], s49 offen lds
  s_add_u32 s67, s67, 16384
  v_exp_f32 v2, v2
  v_exp_f32 v3, v3
  v_exp_f32 v4, v4
  v_mfma_f32_32x32x16_bf16 v[16:31], v[72:75], v[68:71], 0
  ds_read_b128 v[72:75], v92 offset:1024
  buffer_load_dwordx4 v[192:195], v98, s[20:23], s97 offen
  s_add_u32 s97, s97, 16384
  v_exp_f32 v5, v5
  v_exp_f32 v6, v6
  v_exp_f32 v7, v7
  v_exp_f32 v8, v8
  v_exp_f32 v9, v9
  s_waitcnt lgkmcnt(2)
  v_smfmac_f32_32x32x32_bf16 v[32:47], v[76:79], v[0:7], v94
  v_exp_f32 v10, v10
  v_exp_f32 v11, v11
  v_exp_f32 v12, v12
  v_exp_f32 v13, v13
  v_exp_f32 v14, v14
  v_exp_f32 v15, v15
  v_exp_f32 v16, v16
  v_exp_f32 v17, v17
  s_waitcnt lgkmcnt(1)
  v_smfmac_f32_32x32x32_bf16 v[32:47], v[80:83], v[8:15], v94
  v_exp_f32 v18, v18
  v_exp_f32 v19, v19
  v_exp_f32 v20, v20
  s_waitcnt lgkmcnt(0)
  v_mfma_f32_32x32x16_bf16 v[0:15], v[72:75], v[64:67], 0
  s_mov_b32 m0, s93
  s_add_u32 s93, s93, 8192
  buffer_load_dwordx4 v98, s[12:15], s94 offen lds
  s_add_u32 s94, s94, 65536
  buffer_load_dwordx4 v[196:199], v98, s[20:23], s97 offen
  s_add_u32 s97, s97, 16384
  buffer_load_dword v100, v84, s[28:31], 0 offen sc1
  v_exp_f32 v21, v21
  v_exp_f32 v22, v22
  v_exp_f32 v23, v23
  v_exp_f32 v24, v24
  v_exp_f32 v25, v25
  v_smfmac_f32_32x32x32_bf16 v[48:63], v[76:79], v[16:23], v94
  s_mov_b64 exec, s[98:99]
  ds_read_b128 v[76:79], v93 offset:1024
  s_mov_b64 exec, -1
  v_exp_f32 v26, v26
  v_exp_f32 v27, v27
  v_exp_f32 v28, v28
  v_exp_f32 v29, v29
  v_exp_f32 v30, v30
  v_exp_f32 v31, v31
  v_exp_f32 v0, v0
  v_exp_f32 v1, v1
  v_smfmac_f32_32x32x32_bf16 v[48:63], v[80:83], v[24:31], v94
  s_mov_b64 exec, s[98:99]
  ds_read_b128 v[80:83], v93 offset:1536
  s_mov_b64 exec, -1
  v_exp_f32 v2, v2
  v_exp_f32 v3, v3
  v_exp_f32 v4, v4
  v_mfma_f32_32x32x16_bf16 v[16:31], v[72:75], v[68:71], 0
  ds_read_b128 v[72:75], v92 offset:2048
  buffer_load_dwordx4 v[200:203], v98, s[20:23], s97 offen
  s_add_u32 s97, s97, 81920
  v_exp_f32 v5, v5
  v_exp_f32 v6, v6
  v_exp_f32 v7, v7
  v_exp_f32 v8, v8
  v_exp_f32 v9, v9
  s_waitcnt lgkmcnt(2)
  v_smfmac_f32_32x32x32_bf16 v[32:47], v[76:79], v[0:7], v94
  v_exp_f32 v10, v10
  v_exp_f32 v11, v11
  v_exp_f32 v12, v12
  v_exp_f32 v13, v13
  v_exp_f32 v14, v14
  v_exp_f32 v15, v15
  v_exp_f32 v16, v16
  v_exp_f32 v17, v17
  s_waitcnt lgkmcnt(1)
  v_smfmac_f32_32x32x32_bf16 v[32:47], v[80:83], v[8:15], v94
  v_exp_f32 v18, v18
  v_exp_f32 v19, v19
  v_exp_f32 v20, v20
  s_waitcnt lgkmcnt(0)
  v_mfma_f32_32x32x16_bf16 v[0:15], v[72:75], v[64:67], 0
  s_mov_b32 m0, s93
  s_add_u32 s93, s93, 8192
  buffer_load_dwordx4 v98, s[12:15], s94 offen lds
  s_add_u32 s94, s94, 65536
  buffer_load_dwordx4 v[204:207], v98, s[20:23], s97 offen
  s_add_u32 s97, s97, 16384
  v_exp_f32 v21, v21
  v_exp_f32 v22, v22
  v_exp_f32 v23, v23
  v_exp_f32 v24, v24
  v_exp_f32 v25, v25
  v_smfmac_f32_32x32x32_bf16 v[48:63], v[76:79], v[16:23], v94
  s_mov_b64 exec, s[98:99]
  ds_read_b128 v[76:79], v93 offset:2048
  s_mov_b64 exec, -1
  v_exp_f32 v26, v26
  v_exp_f32 v27, v27
  v_exp_f32 v28, v28
  v_exp_f32 v29, v29
  v_exp_f32 v30, v30
  v_exp_f32 v31, v31
  v_exp_f32 v0, v0
  v_exp_f32 v1, v1
  v_smfmac_f32_32x32x32_bf16 v[48:63], v[80:83], v[24:31], v94
  s_mov_b64 exec, s[98:99]
  ds_read_b128 v[80:83], v93 offset:2560
  s_mov_b64 exec, -1
  v_exp_f32 v2, v2
  v_exp_f32 v3, v3
  v_exp_f32 v4, v4
  v_mfma_f32_32x32x16_bf16 v[16:31], v[72:75], v[68:71], 0
  ds_read_b128 v[72:75], v92 offset:3072
  buffer_load_dwordx4 v[208:211], v98, s[20:23], s97 offen
  s_add_u32 s97, s97, 16384
  v_exp_f32 v5, v5
  v_exp_f32 v6, v6
  v_exp_f32 v7, v7
  v_exp_f32 v8, v8
  v_exp_f32 v9, v9
  s_waitcnt lgkmcnt(2)
  v_smfmac_f32_32x32x32_bf16 v[32:47], v[76:79], v[0:7], v94
  v_exp_f32 v10, v10
  v_exp_f32 v11, v11
  v_exp_f32 v12, v12
  v_exp_f32 v13, v13
  v_exp_f32 v14, v14
  v_exp_f32 v15, v15
  v_exp_f32 v16, v16
  v_exp_f32 v17, v17
  s_waitcnt lgkmcnt(1)
  v_smfmac_f32_32x32x32_bf16 v[32:47], v[80:83], v[8:15], v94
  v_exp_f32 v18, v18
  v_exp_f32 v19, v19
  v_exp_f32 v20, v20
  s_waitcnt lgkmcnt(0)
  v_mfma_f32_32x32x16_bf16 v[0:15], v[72:75], v[64:67], 0
  s_mov_b32 m0, s93
  s_add_u32 s93, s93, 8192
  buffer_load_dwordx4 v98, s[12:15], s94 offen lds
  s_add_u32 s94, s94, 65536
  buffer_load_dwordx4 v[212:215], v98, s[20:23], s97 offen
  s_add_u32 s97, s97, 16384
  v_exp_f32 v21, v21
  v_exp_f32 v22, v22
  v_exp_f32 v23, v23
  v_exp_f32 v24, v24
  v_exp_f32 v25, v25
  v_smfmac_f32_32x32x32_bf16 v[48:63], v[76:79], v[16:23], v94
  s_mov_b64 exec, s[98:99]
  ds_read_b128 v[76:79], v93 offset:3072
  s_mov_b64 exec, -1
  v_exp_f32 v26, v26
  v_exp_f32 v27, v27
  v_exp_f32 v28, v28
  v_exp_f32 v29, v29
  v_exp_f32 v30, v30
  v_exp_f32 v31, v31
  v_exp_f32 v0, v0
  v_exp_f32 v1, v1
  v_smfmac_f32_32x32x32_bf16 v[48:63], v[80:83], v[24:31], v94
  s_mov_b64 exec, s[98:99]
  ds_read_b128 v[80:83], v93 offset:3584
  s_mov_b64 exec, -1
  s_waitcnt vmcnt(22)
  s_barrier
  v_exp_f32 v2, v2
  v_exp_f32 v3, v3
  v_exp_f32 v4, v4
  v_mfma_f32_32x32x16_bf16 v[16:31], v[72:75], v[68:71], 0
  ds_read_b128 v[72:75], v92 offset:16384
  buffer_load_dwordx4 v[216:219], v98, s[20:23], s97 offen
  s_add_u32 s97, s97, 81920
  v_exp_f32 v5, v5
  v_exp_f32 v6, v6
  v_exp_f32 v7, v7
  v_exp_f32 v8, v8
  v_exp_f32 v9, v9
  s_waitcnt lgkmcnt(2)
  v_smfmac_f32_32x32x32_bf16 v[32:47], v[76:79], v[0:7], v94
  v_exp_f32 v10, v10
  v_exp_f32 v11, v11
  v_exp_f32 v12, v12
  v_exp_f32 v13, v13
  v_exp_f32 v14, v14
  v_exp_f32 v15, v15
  v_exp_f32 v16, v16
  v_exp_f32 v17, v17
  s_waitcnt lgkmcnt(1)
  v_smfmac_f32_32x32x32_bf16 v[32:47], v[80:83], v[8:15], v94
  v_exp_f32 v18, v18
  v_exp_f32 v19, v19
  v_exp_f32 v20, v20
  s_waitcnt lgkmcnt(0)
  v_mfma_f32_32x32x16_bf16 v[0:15], v[72:75], v[64:67], 0
  s_mov_b32 m0, s93
  s_add_u32 s93, s93, 8192
  buffer_load_dwordx4 v98, s[12:15], s94 offen lds
  s_add_u32 s94, s94, 65536
  s_mov_b32 m0, s95
  s_add_u32 s95, s95, 8192
  buffer_load_dwordx4 v97, s[16:19], s96 offen lds
  s_add_u32 s96, s96, 229376
  buffer_load_dwordx4 v[220:223], v98, s[20:23], s97 offen
  s_add_u32 s97, s97, 16384
  v_exp_f32 v21, v21
  v_exp_f32 v22, v22
  v_exp_f32 v23, v23
  v_exp_f32 v24, v24
  v_exp_f32 v25, v25
  v_smfmac_f32_32x32x32_bf16 v[48:63], v[76:79], v[16:23], v94
  s_mov_b64 exec, s[98:99]
  ds_read_b128 v[76:79], v93 offset:16384
  s_mov_b64 exec, -1
  v_exp_f32 v26, v26
  v_exp_f32 v27, v27
  v_exp_f32 v28, v28
  v_exp_f32 v29, v29
  v_exp_f32 v30, v30
  v_exp_f32 v31, v31
  v_exp_f32 v0, v0
  v_exp_f32 v1, v1
  v_smfmac_f32_32x32x32_bf16 v[48:63], v[80:83], v[24:31], v94
  s_mov_b64 exec, s[98:99]
  ds_read_b128 v[80:83], v93 offset:16896
  s_mov_b64 exec, -1
  s_add_u32 s92, s92, 8192
  s_and_b32 s92, s92, 0xffff
  s_mov_b32 m0, s67
  s_add_u32 s48, s92, s44
  buffer_load_dwordx4 v95, s[28:31], s48 offen lds
  s_add_u32 m0, s67, 8192
  s_add_u32 s49, s48, 2097152
  buffer_load_dwordx4 v95, s[28:31], s49 offen lds
  s_add_u32 s67, s67, 16384
  v_exp_f32 v2, v2
  v_exp_f32 v3, v3
  v_exp_f32 v4, v4
  v_mfma_f32_32x32x16_bf16 v[16:31], v[72:75], v[68:71], 0
  ds_read_b128 v[72:75], v92 offset:17408
  buffer_load_dwordx4 v[224:227], v98, s[20:23], s97 offen
  s_add_u32 s97, s97, 16384
  v_exp_f32 v5, v5
  v_exp_f32 v6, v6
  v_exp_f32 v7, v7
  v_exp_f32 v8, v8
  v_exp_f32 v9, v9
  s_waitcnt lgkmcnt(2)
  v_smfmac_f32_32x32x32_bf16 v[32:47], v[76:79], v[0:7], v94
  v_exp_f32 v10, v10
  v_exp_f32 v11, v11
  v_exp_f32 v12, v12
  v_exp_f32 v13, v13
  v_exp_f32 v14, v14
  v_exp_f32 v15, v15
  v_exp_f32 v16, v16
  v_exp_f32 v17, v17
  s_waitcnt lgkmcnt(1)
  v_smfmac_f32_32x32x32_bf16 v[32:47], v[80:83], v[8:15], v94
  v_exp_f32 v18, v18
  v_exp_f32 v19, v19
  v_exp_f32 v20, v20
  s_waitcnt lgkmcnt(0)
  v_mfma_f32_32x32x16_bf16 v[0:15], v[72:75], v[64:67], 0
  s_mov_b32 m0, s93
  s_add_u32 s93, s93, 8192
  buffer_load_dwordx4 v98, s[12:15], s94 offen lds
  s_add_u32 s94, s94, 65536
  buffer_load_dwordx4 v[228:231], v98, s[20:23], s97 offen
  s_add_u32 s97, s97, 16384
  buffer_load_dword v100, v84, s[28:31], 0 offen offset:128 sc1
  v_exp_f32 v21, v21
  v_exp_f32 v22, v22
  v_exp_f32 v23, v23
  v_exp_f32 v24, v24
  v_exp_f32 v25, v25
  v_smfmac_f32_32x32x32_bf16 v[48:63], v[76:79], v[16:23], v94
  s_mov_b64 exec, s[98:99]
  ds_read_b128 v[76:79], v93 offset:17408
  s_mov_b64 exec, -1
  v_exp_f32 v26, v26
  v_exp_f32 v27, v27
  v_exp_f32 v28, v28
  v_exp_f32 v29, v29
  v_exp_f32 v30, v30
  v_exp_f32 v31, v31
  v_exp_f32 v0, v0
  v_exp_f32 v1, v1
  v_smfmac_f32_32x32x32_bf16 v[48:63], v[80:83], v[24:31], v94
  s_mov_b64 exec, s[98:99]
  ds_read_b128 v[80:83], v93 offset:17920
  s_mov_b64 exec, -1
  v_exp_f32 v2, v2
  v_exp_f32 v3, v3
  v_exp_f32 v4, v4
  v_mfma_f32_32x32x16_bf16 v[16:31], v[72:75], v[68:71], 0
  ds_read_b128 v[72:75], v92 offset:18432
  buffer_load_dwordx4 v[232:235], v98, s[20:23], s97 offen
  s_add_u32 s97, s97, 0
  v_exp_f32 v5, v5
  v_exp_f32 v6, v6
  v_exp_f32 v7, v7
  v_exp_f32 v8, v8
  v_exp_f32 v9, v9
  s_waitcnt lgkmcnt(2)
  v_smfmac_f32_32x32x32_bf16 v[32:47], v[76:79], v[0:7], v94
  v_exp_f32 v10, v10
  v_exp_f32 v11, v11
  v_exp_f32 v12, v12
  v_exp_f32 v13, v13
  v_exp_f32 v14, v14
  v_exp_f32 v15, v15
  v_exp_f32 v16, v16
  v_exp_f32 v17, v17
  s_waitcnt lgkmcnt(1)
  v_smfmac_f32_32x32x32_bf16 v[32:47], v[80:83], v[8:15], v94
  v_exp_f32 v18, v18
  v_exp_f32 v19, v19
  v_exp_f32 v20, v20
  s_waitcnt lgkmcnt(0)
  v_mfma_f32_32x32x16_bf16 v[0:15], v[72:75], v[64:67], 0
  s_mov_b32 m0, s93
  s_add_u32 s93, s93, 8192
  buffer_load_dwordx4 v98, s[12:15], s94 offen lds
  s_add_u32 s94, s94, 65536
  v_exp_f32 v21, v21
  v_exp_f32 v22, v22
  v_exp_f32 v23, v23
  v_exp_f32 v24, v24
  v_exp_f32 v25, v25
  v_smfmac_f32_32x32x32_bf16 v[48:63], v[76:79], v[16:23], v94
  s_mov_b64 exec, s[98:99]
  ds_read_b128 v[76:79], v93 offset:18432
  s_mov_b64 exec, -1
  v_exp_f32 v26, v26
  v_exp_f32 v27, v27
  v_exp_f32 v28, v28
  v_exp_f32 v29, v29
  v_exp_f32 v30, v30
  v_exp_f32 v31, v31
  v_exp_f32 v0, v0
  v_exp_f32 v1, v1
  v_smfmac_f32_32x32x32_bf16 v[48:63], v[80:83], v[24:31], v94
  s_mov_b64 exec, s[98:99]
  ds_read_b128 v[80:83], v93 offset:18944
  s_mov_b64 exec, -1
  v_exp_f32 v2, v2
  v_exp_f32 v3, v3
  v_exp_f32 v4, v4
  v_mfma_f32_32x32x16_bf16 v[16:31], v[72:75], v[68:71], 0
  ds_read_b128 v[72:75], v92 offset:19456
  v_exp_f32 v5, v5
  v_exp_f32 v6, v6
  v_exp_f32 v7, v7
  v_exp_f32 v8, v8
  v_exp_f32 v9, v9
  s_waitcnt lgkmcnt(2)
  v_smfmac_f32_32x32x32_bf16 v[32:47], v[76:79], v[0:7], v94
  v_exp_f32 v10, v10
  v_exp_f32 v11, v11
  v_exp_f32 v12, v12
  v_exp_f32 v13, v13
  v_exp_f32 v14, v14
  v_exp_f32 v15, v15
  v_exp_f32 v16, v16
  v_exp_f32 v17, v17
  s_waitcnt lgkmcnt(1)
  v_smfmac_f32_32x32x32_bf16 v[32:47], v[80:83], v[8:15], v94
  v_exp_f32 v18, v18
  v_exp_f32 v19, v19
  v_exp_f32 v20, v20
  s_waitcnt lgkmcnt(0)
  v_mfma_f32_32x32x16_bf16 v[0:15], v[72:75], v[64:67], 0
  s_mov_b32 m0, s93
  s_add_u32 s93, s93, 8192
  buffer_load_dwordx4 v98, s[12:15], s94 offen lds
  s_add_u32 s94, s94, 65536
  v_exp_f32 v21, v21
  v_exp_f32 v22, v22
  v_exp_f32 v23, v23
  v_exp_f32 v24, v24
  v_exp_f32 v25, v25
  v_smfmac_f32_32x32x32_bf16 v[48:63], v[76:79], v[16:23], v94
  s_mov_b64 exec, s[98:99]
  ds_read_b128 v[76:79], v93 offset:19456
  s_mov_b64 exec, -1
  v_exp_f32 v26, v26
  v_exp_f32 v27, v27
  v_exp_f32 v28, v28
  v_exp_f32 v29, v29
  v_exp_f32 v30, v30
  v_exp_f32 v31, v31
  v_exp_f32 v0, v0
  v_exp_f32 v1, v1
  v_smfmac_f32_32x32x32_bf16 v[48:63], v[80:83], v[24:31], v94
  s_mov_b64 exec, s[98:99]
  ds_read_b128 v[80:83], v93 offset:19968
  s_mov_b64 exec, -1
  s_waitcnt vmcnt(23)
  s_barrier
  v_exp_f32 v2, v2
  v_exp_f32 v3, v3
  v_exp_f32 v4, v4
  v_mfma_f32_32x32x16_bf16 v[16:31], v[72:75], v[68:71], 0
  ds_read_b128 v[72:75], v92 offset:32768
  v_exp_f32 v5, v5
  v_exp_f32 v6, v6
  v_exp_f32 v7, v7
  v_exp_f32 v8, v8
  v_exp_f32 v9, v9
  s_waitcnt lgkmcnt(2)
  v_smfmac_f32_32x32x32_bf16 v[32:47], v[76:79], v[0:7], v94
  v_exp_f32 v10, v10
  v_exp_f32 v11, v11
  v_exp_f32 v12, v12
  v_exp_f32 v13, v13
  v_exp_f32 v14, v14
  v_exp_f32 v15, v15
  v_exp_f32 v16, v16
  v_exp_f32 v17, v17
  s_waitcnt lgkmcnt(1)
  v_smfmac_f32_32x32x32_bf16 v[32:47], v[80:83], v[8:15], v94
  v_exp_f32 v18, v18
  v_exp_f32 v19, v19
  v_exp_f32 v20, v20
  s_waitcnt lgkmcnt(0)
  v_mfma_f32_32x32x16_bf16 v[0:15], v[72:75], v[64:67], 0
  s_mov_b32 m0, s95
  s_add_u32 s95, s95, 8192
  s_cmp_ge_u32 s36, 6
  s_cselect_b32 s50, 1835136, 0
  s_sub_u32 s96, s96, s50
  buffer_load_dwordx4 v97, s[16:19], s96 offen lds
  s_add_u32 s96, s96, 229376
  s_mov_b32 m0, s95
  s_add_u32 s95, s95, 8192
  s_cmp_lt_u32 s36, 6
  s_cselect_b32 s50, 1835136, 0
  s_sub_u32 s96, s96, s50
  buffer_load_dwordx4 v97, s[16:19], s96 offen lds
  s_add_u32 s96, s96, 229376
  buffer_load_dword v100, v85, s[16:19], 0 offen
  v_exp_f32 v21, v21
  v_exp_f32 v22, v22
  v_exp_f32 v23, v23
  v_exp_f32 v24, v24
  v_exp_f32 v25, v25
  v_smfmac_f32_32x32x32_bf16 v[48:63], v[76:79], v[16:23], v94
  s_mov_b64 exec, s[98:99]
  ds_read_b128 v[76:79], v93 offset:32768
  s_mov_b64 exec, -1
  v_exp_f32 v26, v26
  v_exp_f32 v27, v27
  v_exp_f32 v28, v28
  v_exp_f32 v29, v29
  v_exp_f32 v30, v30
  v_exp_f32 v31, v31
  v_exp_f32 v0, v0
  v_exp_f32 v1, v1
  v_smfmac_f32_32x32x32_bf16 v[48:63], v[80:83], v[24:31], v94
  s_mov_b64 exec, s[98:99]
  ds_read_b128 v[80:83], v93 offset:33280
  s_mov_b64 exec, -1
  v_exp_f32 v2, v2
  v_exp_f32 v3, v3
  v_exp_f32 v4, v4
  v_mfma_f32_32x32x16_bf16 v[16:31], v[72:75], v[68:71], 0
  ds_read_b128 v[72:75], v92 offset:33792
  v_exp_f32 v5, v5
  v_exp_f32 v6, v6
  v_exp_f32 v7, v7
  v_exp_f32 v8, v8
  v_exp_f32 v9, v9
  s_waitcnt lgkmcnt(2)
  v_smfmac_f32_32x32x32_bf16 v[32:47], v[76:79], v[0:7], v94
  v_exp_f32 v10, v10
  v_exp_f32 v11, v11
  v_exp_f32 v12, v12
  v_exp_f32 v13, v13
  v_exp_f32 v14, v14
  v_exp_f32 v15, v15
  v_exp_f32 v16, v16
  v_exp_f32 v17, v17
  s_waitcnt lgkmcnt(1)
  v_smfmac_f32_32x32x32_bf16 v[32:47], v[80:83], v[8:15], v94
  v_exp_f32 v18, v18
  v_exp_f32 v19, v19
  v_exp_f32 v20, v20
  s_waitcnt lgkmcnt(0)
  v_mfma_f32_32x32x16_bf16 v[0:15], v[72:75], v[64:67], 0
  buffer_load_dword v100, v84, s[28:31], 0 offen sc1
  v_exp_f32 v21, v21
  v_exp_f32 v22, v22
  v_exp_f32 v23, v23
  v_exp_f32 v24, v24
  v_exp_f32 v25, v25
  v_smfmac_f32_32x32x32_bf16 v[48:63], v[76:79], v[16:23], v94
  s_mov_b64 exec, s[98:99]
  ds_read_b128 v[76:79], v93 offset:33792
  s_mov_b64 exec, -1
  v_exp_f32 v26, v26
  v_exp_f32 v27, v27
  v_exp_f32 v28, v28
  v_exp_f32 v29, v29
  v_exp_f32 v30, v30
  v_exp_f32 v31, v31
  v_exp_f32 v0, v0
  v_exp_f32 v1, v1
  v_smfmac_f32_32x32x32_bf16 v[48:63], v[80:83], v[24:31], v94
  s_mov_b64 exec, s[98:99]
  ds_read_b128 v[80:83], v93 offset:34304
  s_mov_b64 exec, -1
  v_exp_f32 v2, v2
  v_exp_f32 v3, v3
  v_exp_f32 v4, v4
  v_mfma_f32_32x32x16_bf16 v[16:31], v[72:75], v[68:71], 0
  ds_read_b128 v[72:75], v92 offset:34816
  buffer_load_dword v100, v84, s[28:31], 0 offen offset:128 sc1
  v_exp_f32 v5, v5
  v_exp_f32 v6, v6
  v_exp_f32 v7, v7
  v_exp_f32 v8, v8
  v_exp_f32 v9, v9
  s_waitcnt lgkmcnt(2)
  v_smfmac_f32_32x32x32_bf16 v[32:47], v[76:79], v[0:7], v94
  v_exp_f32 v10, v10
  v_exp_f32 v11, v11
  v_exp_f32 v12, v12
  v_exp_f32 v13, v13
  v_exp_f32 v14, v14
  v_exp_f32 v15, v15
  v_exp_f32 v16, v16
  v_exp_f32 v17, v17
  s_waitcnt lgkmcnt(1)
  v_smfmac_f32_32x32x32_bf16 v[32:47], v[80:83], v[8:15], v94
  v_exp_f32 v18, v18
  v_exp_f32 v19, v19
  v_exp_f32 v20, v20
  s_waitcnt lgkmcnt(0)
  v_mfma_f32_32x32x16_bf16 v[0:15], v[72:75], v[64:67], 0
  v_exp_f32 v21, v21
  v_exp_f32 v22, v22
  v_exp_f32 v23, v23
  v_exp_f32 v24, v24
  v_exp_f32 v25, v25
  v_smfmac_f32_32x32x32_bf16 v[48:63], v[76:79], v[16:23], v94
  s_mov_b64 exec, s[98:99]
  ds_read_b128 v[76:79], v93 offset:34816
  s_mov_b64 exec, -1
  v_exp_f32 v26, v26
  v_exp_f32 v27, v27
  v_exp_f32 v28, v28
  v_exp_f32 v29, v29
  v_exp_f32 v30, v30
  v_exp_f32 v31, v31
  v_exp_f32 v0, v0
  v_exp_f32 v1, v1
  v_smfmac_f32_32x32x32_bf16 v[48:63], v[80:83], v[24:31], v94
  s_mov_b64 exec, s[98:99]
  ds_read_b128 v[80:83], v93 offset:35328
  s_mov_b64 exec, -1
  v_exp_f32 v2, v2
  v_exp_f32 v3, v3
  v_exp_f32 v4, v4
  v_mfma_f32_32x32x16_bf16 v[16:31], v[72:75], v[68:71], 0
  ds_read_b128 v[72:75], v92 offset:35840
  buffer_load_dword v100, v86, s[20:23], 0 offen
  v_exp_f32 v5, v5
  v_exp_f32 v6, v6
  v_exp_f32 v7, v7
  v_exp_f32 v8, v8
  v_exp_f32 v9, v9
  s_waitcnt lgkmcnt(2)
  v_smfmac_f32_32x32x32_bf16 v[32:47], v[76:79], v[0:7], v94
  v_exp_f32 v10, v10
  v_exp_f32 v11, v11
  v_exp_f32 v12, v12
  v_exp_f32 v13, v13
  v_exp_f32 v14, v14
  v_exp_f32 v15, v15
  v_exp_f32 v16, v16
  v_exp_f32 v17, v17
  s_waitcnt lgkmcnt(1)
  v_smfmac_f32_32x32x32_bf16 v[32:47], v[80:83], v[8:15], v94
  v_exp_f32 v18, v18
  v_exp_f32 v19, v19
  v_exp_f32 v20, v20
  s_waitcnt lgkmcnt(0)
  v_mfma_f32_32x32x16_bf16 v[0:15], v[72:75], v[64:67], 0
  v_exp_f32 v21, v21
  v_exp_f32 v22, v22
  v_exp_f32 v23, v23
  v_exp_f32 v24, v24
  v_exp_f32 v25, v25
  v_smfmac_f32_32x32x32_bf16 v[48:63], v[76:79], v[16:23], v94
  s_mov_b64 exec, s[98:99]
  ds_read_b128 v[76:79], v93 offset:35840
  s_mov_b64 exec, -1
  v_exp_f32 v26, v26
  v_exp_f32 v27, v27
  v_exp_f32 v28, v28
  v_exp_f32 v29, v29
  v_exp_f32 v30, v30
  v_exp_f32 v31, v31
  v_exp_f32 v0, v0
  v_exp_f32 v1, v1
  v_smfmac_f32_32x32x32_bf16 v[48:63], v[80:83], v[24:31], v94
  s_mov_b64 exec, s[98:99]
  ds_read_b128 v[80:83], v93 offset:36352
  s_mov_b64 exec, -1
  s_waitcnt vmcnt(13)
  s_barrier
  v_exp_f32 v2, v2
  v_exp_f32 v3, v3
  v_exp_f32 v4, v4
  v_mfma_f32_32x32x16_bf16 v[16:31], v[72:75], v[68:71], 0
  ds_read_b128 v[72:75], v92 offset:49152
  v_exp_f32 v5, v5
  v_exp_f32 v6, v6
  v_exp_f32 v7, v7
  v_exp_f32 v8, v8
  v_exp_f32 v9, v9
  s_waitcnt lgkmcnt(2)
  v_smfmac_f32_32x32x32_bf16 v[32:47], v[76:79], v[0:7], v94
  v_exp_f32 v10, v10
  v_exp_f32 v11, v11
  v_exp_f32 v12, v12
  v_exp_f32 v13, v13
  v_exp_f32 v14, v14
  v_exp_f32 v15, v15
  v_exp_f32 v16, v16
  v_exp_f32 v17, v17
  s_waitcnt lgkmcnt(1)
  v_smfmac_f32_32x32x32_bf16 v[32:47], v[80:83], v[8:15], v94
  v_exp_f32 v18, v18
  v_exp_f32 v19, v19
  v_exp_f32 v20, v20
  s_waitcnt lgkmcnt(0)
  v_mfma_f32_32x32x16_bf16 v[0:15], v[72:75], v[64:67], 0
  s_mov_b32 m0, s95
  s_add_u32 s95, s95, 8192
  buffer_load_dwordx4 v97, s[16:19], s96 offen lds
  s_add_u32 s96, s96, 229376
  s_mov_b32 m0, s95
  s_add_u32 s95, s95, 8192
  buffer_load_dwordx4 v97, s[16:19], s96 offen lds
  s_add_u32 s96, s96, 229376
  v_exp_f32 v21, v21
  v_exp_f32 v22, v22
  v_exp_f32 v23, v23
  v_exp_f32 v24, v24
  v_exp_f32 v25, v25
  v_smfmac_f32_32x32x32_bf16 v[48:63], v[76:79], v[16:23], v94
  s_mov_b64 exec, s[98:99]
  ds_read_b128 v[76:79], v93 offset:49152
  s_mov_b64 exec, -1
  v_exp_f32 v26, v26
  v_exp_f32 v27, v27
  v_exp_f32 v28, v28
  v_exp_f32 v29, v29
  v_exp_f32 v30, v30
  v_exp_f32 v31, v31
  v_exp_f32 v0, v0
  v_exp_f32 v1, v1
  v_smfmac_f32_32x32x32_bf16 v[48:63], v[80:83], v[24:31], v94
  s_mov_b64 exec, s[98:99]
  ds_read_b128 v[80:83], v93 offset:49664
  s_mov_b64 exec, -1
  v_exp_f32 v2, v2
  v_exp_f32 v3, v3
  v_exp_f32 v4, v4
  v_mfma_f32_32x32x16_bf16 v[16:31], v[72:75], v[68:71], 0
  ds_read_b128 v[72:75], v92 offset:50176
  buffer_load_dword v100, v84, s[28:31], 0 offen sc1
  v_exp_f32 v5, v5
  v_exp_f32 v6, v6
  v_exp_f32 v7, v7
  v_exp_f32 v8, v8
  v_exp_f32 v9, v9
  s_waitcnt lgkmcnt(2)
  v_smfmac_f32_32x32x32_bf16 v[32:47], v[76:79], v[0:7], v94
  v_exp_f32 v10, v10
  v_exp_f32 v11, v11
  v_exp_f32 v12, v12
  v_exp_f32 v13, v13
  v_exp_f32 v14, v14
  v_exp_f32 v15, v15
  v_exp_f32 v16, v16
  v_exp_f32 v17, v17
  s_waitcnt lgkmcnt(1)
  v_smfmac_f32_32x32x32_bf16 v[32:47], v[80:83], v[8:15], v94
  v_exp_f32 v18, v18
  v_exp_f32 v19, v19
  v_exp_f32 v20, v20
  s_waitcnt lgkmcnt(0)
  v_mfma_f32_32x32x16_bf16 v[0:15], v[72:75], v[64:67], 0
  buffer_load_dword v100, v84, s[28:31], 0 offen offset:128 sc1
  v_exp_f32 v21, v21
  v_exp_f32 v22, v22
  v_exp_f32 v23, v23
  v_exp_f32 v24, v24
  v_exp_f32 v25, v25
  v_smfmac_f32_32x32x32_bf16 v[48:63], v[76:79], v[16:23], v94
  s_mov_b64 exec, s[98:99]
  ds_read_b128 v[76:79], v93 offset:50176
  s_mov_b64 exec, -1
  v_exp_f32 v26, v26
  v_exp_f32 v27, v27
  v_exp_f32 v28, v28
  v_exp_f32 v29, v29
  v_exp_f32 v30, v30
  v_exp_f32 v31, v31
  v_exp_f32 v0, v0
  v_exp_f32 v1, v1
  v_smfmac_f32_32x32x32_bf16 v[48:63], v[80:83], v[24:31], v94
  s_mov_b64 exec, s[98:99]
  ds_read_b128 v[80:83], v93 offset:50688
  s_mov_b64 exec, -1
  s_barrier
  v_exp_f32 v2, v2
  v_exp_f32 v3, v3
  v_exp_f32 v4, v4
  v_mfma_f32_32x32x16_bf16 v[16:31], v[72:75], v[68:71], 0
  ds_read_b128 v[72:75], v92 offset:51200
  v_exp_f32 v5, v5
  v_exp_f32 v6, v6
  v_exp_f32 v7, v7
  v_exp_f32 v8, v8
  v_exp_f32 v9, v9
  s_waitcnt lgkmcnt(2)
  v_smfmac_f32_32x32x32_bf16 v[32:47], v[76:79], v[0:7], v94
  v_exp_f32 v10, v10
  v_exp_f32 v11, v11
  v_exp_f32 v12, v12
  v_exp_f32 v13, v13
  v_exp_f32 v14, v14
  v_exp_f32 v15, v15
  v_exp_f32 v16, v16
  v_exp_f32 v17, v17
  s_waitcnt lgkmcnt(1)
  v_smfmac_f32_32x32x32_bf16 v[32:47], v[80:83], v[8:15], v94
  v_exp_f32 v18, v18
  v_exp_f32 v19, v19
  v_exp_f32 v20, v20
  s_waitcnt lgkmcnt(0)
  v_mfma_f32_32x32x16_bf16 v[0:15], v[72:75], v[64:67], 0
  s_mov_b32 m0, s95
  s_add_u32 s95, s95, 8192
  buffer_load_dwordx4 v97, s[16:19], s96 offen lds
  s_add_u32 s96, s96, 229376
  s_mov_b32 m0, s95
  s_add_u32 s95, s95, 8192
  buffer_load_dwordx4 v97, s[16:19], s96 offen lds
  s_add_u32 s96, s96, 229376
  v_exp_f32 v21, v21
  v_exp_f32 v22, v22
  v_exp_f32 v23, v23
  v_exp_f32 v24, v24
  v_exp_f32 v25, v25
  v_smfmac_f32_32x32x32_bf16 v[48:63], v[76:79], v[16:23], v94
  s_mov_b64 exec, s[98:99]
  ds_read_b128 v[76:79], v93 offset:51200
  s_mov_b64 exec, -1
  v_exp_f32 v26, v26
  v_exp_f32 v27, v27
  v_exp_f32 v28, v28
  v_exp_f32 v29, v29
  v_exp_f32 v30, v30
  v_exp_f32 v31, v31
  v_exp_f32 v0, v0
  v_exp_f32 v1, v1
  v_smfmac_f32_32x32x32_bf16 v[48:63], v[80:83], v[24:31], v94
  s_mov_b64 exec, s[98:99]
  ds_read_b128 v[80:83], v93 offset:51712
  s_mov_b64 exec, -1
  v_exp_f32 v2, v2
  v_exp_f32 v3, v3
  v_exp_f32 v4, v4
  v_mfma_f32_32x32x16_bf16 v[16:31], v[72:75], v[68:71], 0
  ds_read_b128 v[72:75], v92 offset:52224
  v_exp_f32 v5, v5
  v_exp_f32 v6, v6
  v_exp_f32 v7, v7
  v_exp_f32 v8, v8
  v_exp_f32 v9, v9
  s_waitcnt lgkmcnt(2)
  v_smfmac_f32_32x32x32_bf16 v[32:47], v[76:79], v[0:7], v94
  v_exp_f32 v10, v10
  v_exp_f32 v11, v11
  v_exp_f32 v12, v12
  v_exp_f32 v13, v13
  v_exp_f32 v14, v14
  v_exp_f32 v15, v15
  v_exp_f32 v16, v16
  v_exp_f32 v17, v17
  s_waitcnt lgkmcnt(1)
  v_smfmac_f32_32x32x32_bf16 v[32:47], v[80:83], v[8:15], v94
  v_exp_f32 v18, v18
  v_exp_f32 v19, v19
  v_exp_f32 v20, v20
  s_waitcnt lgkmcnt(0)
  v_mfma_f32_32x32x16_bf16 v[0:15], v[72:75], v[64:67], 0
  v_exp_f32 v21, v21
  v_exp_f32 v22, v22
  v_exp_f32 v23, v23
  v_exp_f32 v24, v24
  v_exp_f32 v25, v25
  v_smfmac_f32_32x32x32_bf16 v[48:63], v[76:79], v[16:23], v94
  s_mov_b64 exec, s[98:99]
  ds_read_b128 v[76:79], v93 offset:52224
  s_mov_b64 exec, -1
  v_exp_f32 v26, v26
  v_exp_f32 v27, v27
  v_exp_f32 v28, v28
  v_exp_f32 v29, v29
  v_exp_f32 v30, v30
  v_exp_f32 v31, v31
  v_exp_f32 v0, v0
  v_exp_f32 v1, v1
  v_smfmac_f32_32x32x32_bf16 v[48:63], v[80:83], v[24:31], v94
  s_mov_b64 exec, s[98:99]
  ds_read_b128 v[80:83], v93 offset:52736
  s_mov_b64 exec, -1
  v_exp_f32 v2, v2
  v_exp_f32 v3, v3
  v_exp_f32 v4, v4
  v_mfma_f32_32x32x16_bf16 v[16:31], v[72:75], v[68:71], 0
  s_lshl_b32 s50, s36, 11
  s_add_u32 s50, s50, 65536
  v_add_u32 v84, s50, v95
  s_xor_b32 s50, s50, 8192
  v_add_u32 v85, s50, v95
  s_lshl_b32 s50, s36, 8
  s_add_u32 s50, s50, 139264
  v_lshl_add_u32 v86, v96, 2, s50
  s_xor_b32 s50, s50, 1024
  v_lshl_add_u32 v87, v96, 2, s50
  s_and_b32 s46, s36, 1
  s_lshl_b32 s46, s46, 1
  s_lshr_b32 s47, s36, 2
  s_add_u32 s46, s46, s47
  s_lshl_b32 s46, s46, 15
  s_lshl_b32 s47, s38, 10
  s_add_u32 s46, s46, s47
  s_add_u32 s46, s46, s45
  s_add_u32 s46, s46, s62
  s_add_u32 s46, s46, 458752
  v_mov_b32 v88, 0x30800000
  v_mov_b32 v89, 0x5f800000
  v_mov_b32 v101, 0x207
  s_and_b32 s51, s36, 3
  s_lshl_b32 s51, s51, 1
  s_lshr_b32 s50, s36, 2
  s_add_u32 s51, s51, s50
  s_lshl_b32 s51, s51, 7
  s_lshl_b32 s50, s37, 10
  s_add_u32 s50, s50, s51
  s_lshl_b32 s51, s38, 2
  s_add_u32 s50, s50, s51
  s_add_u32 s51, s41, 2
  v_mov_b32 v90, s50
  v_mov_b32 v91, s51
  v_exp_f32 v5, v5
  v_exp_f32 v6, v6
  v_exp_f32 v7, v7
  v_exp_f32 v8, v8
  v_exp_f32 v9, v9
  s_waitcnt lgkmcnt(1)
  v_smfmac_f32_32x32x32_bf16 v[32:47], v[76:79], v[0:7], v94
  v_exp_f32 v10, v10
  v_exp_f32 v11, v11
  v_exp_f32 v12, v12
  v_exp_f32 v13, v13
  v_exp_f32 v14, v14
  v_exp_f32 v15, v15
  v_exp_f32 v16, v16
  v_exp_f32 v17, v17
  s_waitcnt lgkmcnt(0)
  v_smfmac_f32_32x32x32_bf16 v[32:47], v[80:83], v[8:15], v94
  v_exp_f32 v18, v18
  v_exp_f32 v19, v19
  v_exp_f32 v20, v20
  v_exp_f32 v21, v21
  v_exp_f32 v22, v22
  v_exp_f32 v23, v23
  v_exp_f32 v24, v24
  v_exp_f32 v25, v25
  v_smfmac_f32_32x32x32_bf16 v[48:63], v[76:79], v[16:23], v94
  v_exp_f32 v26, v26
  v_exp_f32 v27, v27
  v_exp_f32 v28, v28
  v_exp_f32 v29, v29
  v_exp_f32 v30, v30
  v_exp_f32 v31, v31
  s_nop 1
  v_smfmac_f32_32x32x32_bf16 v[48:63], v[80:83], v[24:31], v94
  s_nop 11
  ds_write_b128 v84, v[32:35]
  ds_write_b128 v84, v[36:39] offset:1024
  ds_write_b32 v86, v40
  v_mov_b32 v32, v48
  v_mov_b32 v33, v49
  v_mov_b32 v34, v50
  v_mov_b32 v35, v51
  v_mov_b32 v36, v52
  v_mov_b32 v37, v53
  v_mov_b32 v38, v54
  v_mov_b32 v39, v55
  v_mov_b32 v40, v56
  v_mov_b32 v64, v68
  v_mov_b32 v65, v69
  v_mov_b32 v66, v70
  v_mov_b32 v67, v71
  s_branch ALJ_133
AL1_132:
  ds_read_b128 v[72:75], v92 offset:0
  s_mov_b64 exec, s[98:99]
  ds_read_b128 v[76:79], v93 offset:0
  s_mov_b64 exec, -1
  s_mov_b64 exec, s[98:99]
  ds_read_b128 v[80:83], v93 offset:512
  s_mov_b64 exec, -1
  global_load_dword v102, v99, s[34:35] sc1
  s_waitcnt lgkmcnt(2)
  v_mfma_f32_32x32x16_bf16 v[0:15], v[72:75], v[64:67], 0
  s_nop 11
  v_exp_f32 v0, v0
  v_exp_f32 v1, v1
  v_exp_f32 v2, v2
  v_exp_f32 v3, v3
  v_exp_f32 v4, v4
  v_mfma_f32_32x32x16_bf16 v[16:31], v[72:75], v[68:71], 0
  ds_read_b128 v[72:75], v92 offset:1024
  v_exp_f32 v5, v5
  v_exp_f32 v6, v6
  v_exp_f32 v7, v7
  v_exp_f32 v8, v8
  v_exp_f32 v9, v9
  s_waitcnt lgkmcnt(2)
  v_smfmac_f32_32x32x32_bf16 v[32:47], v[76:79], v[0:7], v94
  v_exp_f32 v10, v10
  v_exp_f32 v11, v11
  v_exp_f32 v12, v12
  v_exp_f32 v13, v13
  v_exp_f32 v14, v14
  v_exp_f32 v15, v15
  v_exp_f32 v16, v16
  v_exp_f32 v17, v17
  s_waitcnt lgkmcnt(1)
  v_smfmac_f32_32x32x32_bf16 v[32:47], v[80:83], v[8:15], v94
  v_exp_f32 v18, v18
  v_exp_f32 v19, v19
  v_exp_f32 v20, v20
  s_waitcnt lgkmcnt(0)
  v_mfma_f32_32x32x16_bf16 v[0:15], v[72:75], v[64:67], 0
  v_exp_f32 v21, v21
  v_exp_f32 v22, v22
  v_exp_f32 v23, v23
  v_exp_f32 v24, v24
  v_exp_f32 v25, v25
  v_smfmac_f32_32x32x32_bf16 v[48:63], v[76:79], v[16:23], v94
  s_mov_b64 exec, s[98:99]
  ds_read_b128 v[76:79], v93 offset:1024
  s_mov_b64 exec, -1
  v_exp_f32 v26, v26
  v_exp_f32 v27, v27
  v_exp_f32 v28, v28
  v_exp_f32 v29, v29
  v_exp_f32 v30, v30
  v_exp_f32 v31, v31
  v_exp_f32 v0, v0
  v_exp_f32 v1, v1
  v_smfmac_f32_32x32x32_bf16 v[48:63], v[80:83], v[24:31], v94
  s_mov_b64 exec, s[98:99]
  ds_read_b128 v[80:83], v93 offset:1536
  s_mov_b64 exec, -1
  s_cmp_lg_u32 s71, 0
  s_cbranch_scc1 APS_145
  s_waitcnt vmcnt(0)
  v_cmp_gt_u32 vcc, s42, v102
  s_nop 0
  s_cbranch_vccnz APR_146
  s_add_u32 s92, s92, 8192
  s_and_b32 s92, s92, 0xffff
  s_mov_b32 m0, s67
  s_add_u32 s48, s92, s44
  buffer_load_dwordx4 v95, s[28:31], s48 offen lds
  s_add_u32 m0, s67, 8192
  s_add_u32 s49, s48, 2097152
  buffer_load_dwordx4 v95, s[28:31], s49 offen lds
  s_add_u32 s67, s67, 16384
  s_mov_b32 s71, 1
  s_branch APS_145
APR_146:
  global_load_dword v102, v99, s[34:35] sc1
APS_145:
  v_exp_f32 v2, v2
  v_exp_f32 v3, v3
  v_exp_f32 v4, v4
  v_mfma_f32_32x32x16_bf16 v[16:31], v[72:75], v[68:71], 0
  ds_read_b128 v[72:75], v92 offset:2048
  v_exp_f32 v5, v5
  v_exp_f32 v6, v6
  v_exp_f32 v7, v7
  v_exp_f32 v8, v8
  v_exp_f32 v9, v9
  s_waitcnt lgkmcnt(2)
  v_smfmac_f32_32x32x32_bf16 v[32:47], v[76:79], v[0:7], v94
  v_exp_f32 v10, v10
  v_exp_f32 v11, v11
  v_exp_f32 v12, v12
  v_exp_f32 v13, v13
  v_exp_f32 v14, v14
  v_exp_f32 v15, v15
  v_exp_f32 v16, v16
  v_exp_f32 v17, v17
  s_waitcnt lgkmcnt(1)
  v_smfmac_f32_32x32x32_bf16 v[32:47], v[80:83], v[8:15], v94
  v_exp_f32 v18, v18
  v_exp_f32 v19, v19
  v_exp_f32 v20, v20
  s_waitcnt lgkmcnt(0)
  v_mfma_f32_32x32x16_bf16 v[0:15], v[72:75], v[64:67], 0
  v_exp_f32 v21, v21
  v_exp_f32 v22, v22
  v_exp_f32 v23, v23
  v_exp_f32 v24, v24
  v_exp_f32 v25, v25
  v_smfmac_f32_32x32x32_bf16 v[48:63], v[76:79], v[16:23], v94
  s_mov_b64 exec, s[98:99]
  ds_read_b128 v[76:79], v93 offset:2048
  s_mov_b64 exec, -1
  v_exp_f32 v26, v26
  v_exp_f32 v27, v27
  v_exp_f32 v28, v28
  v_exp_f32 v29, v29
  v_exp_f32 v30, v30
  v_exp_f32 v31, v31
  v_exp_f32 v0, v0
  v_exp_f32 v1, v1
  v_smfmac_f32_32x32x32_bf16 v[48:63], v[80:83], v[24:31], v94
  s_mov_b64 exec, s[98:99]
  ds_read_b128 v[80:83], v93 offset:2560
  s_mov_b64 exec, -1
  s_cmp_lg_u32 s71, 0
  s_cbranch_scc1 APS_147
  s_waitcnt vmcnt(0)
  v_cmp_gt_u32 vcc, s42, v102
  s_nop 0
  s_cbranch_vccnz APR_148
  s_add_u32 s92, s92, 8192
  s_and_b32 s92, s92, 0xffff
  s_mov_b32 m0, s67
  s_add_u32 s48, s92, s44
  buffer_load_dwordx4 v95, s[28:31], s48 offen lds
  s_add_u32 m0, s67, 8192
  s_add_u32 s49, s48, 2097152
  buffer_load_dwordx4 v95, s[28:31], s49 offen lds
  s_add_u32 s67, s67, 16384
  s_mov_b32 s71, 1
  s_branch APS_147
APR_148:
  global_load_dword v102, v99, s[34:35] sc1
APS_147:
  v_exp_f32 v2, v2
  v_exp_f32 v3, v3
  v_exp_f32 v4, v4
  v_mfma_f32_32x32x16_bf16 v[16:31], v[72:75], v[68:71], 0
  ds_read_b128 v[72:75], v92 offset:3072
  v_exp_f32 v5, v5
  v_exp_f32 v6, v6
  v_exp_f32 v7, v7
  v_exp_f32 v8, v8
  v_exp_f32 v9, v9
  s_waitcnt lgkmcnt(2)
  v_smfmac_f32_32x32x32_bf16 v[32:47], v[76:79], v[0:7], v94
  v_exp_f32 v10, v10
  v_exp_f32 v11, v11
  v_exp_f32 v12, v12
  v_exp_f32 v13, v13
  v_exp_f32 v14, v14
  v_exp_f32 v15, v15
  v_exp_f32 v16, v16
  v_exp_f32 v17, v17
  s_waitcnt lgkmcnt(1)
  v_smfmac_f32_32x32x32_bf16 v[32:47], v[80:83], v[8:15], v94
  v_exp_f32 v18, v18
  v_exp_f32 v19, v19
  v_exp_f32 v20, v20
  s_waitcnt lgkmcnt(0)
  v_mfma_f32_32x32x16_bf16 v[0:15], v[72:75], v[64:67], 0
  v_exp_f32 v21, v21
  v_exp_f32 v22, v22
  v_exp_f32 v23, v23
  v_exp_f32 v24, v24
  v_exp_f32 v25, v25
  v_smfmac_f32_32x32x32_bf16 v[48:63], v[76:79], v[16:23], v94
  s_mov_b64 exec, s[98:99]
  ds_read_b128 v[76:79], v93 offset:3072
  s_mov_b64 exec, -1
  v_exp_f32 v26, v26
  v_exp_f32 v27, v27
  v_exp_f32 v28, v28
  v_exp_f32 v29, v29
  v_exp_f32 v30, v30
  v_exp_f32 v31, v31
  v_exp_f32 v0, v0
  v_exp_f32 v1, v1
  v_smfmac_f32_32x32x32_bf16 v[48:63], v[80:83], v[24:31], v94
  s_mov_b64 exec, s[98:99]
  ds_read_b128 v[80:83], v93 offset:3584
  s_mov_b64 exec, -1
  s_cmp_lg_u32 s71, 0
  s_cbranch_scc1 APW_151
  s_cmp_lg_u32 s36, 4
  s_cbranch_scc1 APW_151
  s_mov_b32 s50, 0x40000
POLL_152:
  global_load_dword v102, v99, s[34:35] sc1
  s_waitcnt vmcnt(0)
  v_cmp_gt_u32 vcc, s42, v102
  s_sub_u32 s50, s50, 1
  s_cmp_eq_u32 s50, 0
  s_cbranch_scc1 POLLX_153
  s_cbranch_vccnz POLL_152
POLLX_153:
APW_151:
  s_barrier
  s_cmp_lg_u32 s71, 0
  s_cbranch_scc1 APS_149
  s_add_u32 s92, s92, 8192
  s_and_b32 s92, s92, 0xffff
  s_mov_b32 m0, s67
  s_add_u32 s48, s92, s44
  buffer_load_dwordx4 v95, s[28:31], s48 offen lds
  s_add_u32 m0, s67, 8192
  s_add_u32 s49, s48, 2097152
  buffer_load_dwordx4 v95, s[28:31], s49 offen lds
  s_add_u32 s67, s67, 16384
  s_mov_b32 s71, 1
APS_149:
  s_add_u32 s92, s92, 8192
  s_and_b32 s92, s92, 0xffff
  s_mov_b32 m0, s67
  s_add_u32 s48, s92, s44
  buffer_load_dwordx4 v95, s[28:31], s48 offen lds
  s_add_u32 m0, s67, 8192
  s_add_u32 s49, s48, 2097152
  buffer_load_dwordx4 v95, s[28:31], s49 offen lds
  s_add_u32 s67, s67, 16384
  v_exp_f32 v2, v2
  v_exp_f32 v3, v3
  v_exp_f32 v4, v4
  v_mfma_f32_32x32x16_bf16 v[16:31], v[72:75], v[68:71], 0
  v_exp_f32 v5, v5
  v_exp_f32 v6, v6
  v_exp_f32 v7, v7
  v_exp_f32 v8, v8
  v_exp_f32 v9, v9
  s_waitcnt lgkmcnt(1)
  v_smfmac_f32_32x32x32_bf16 v[32:47], v[76:79], v[0:7], v94
  v_exp_f32 v10, v10
  v_exp_f32 v11, v11
  v_exp_f32 v12, v12
  v_exp_f32 v13, v13
  v_exp_f32 v14, v14
  v_exp_f32 v15, v15
  v_exp_f32 v16, v16
  v_exp_f32 v17, v17
  s_waitcnt lgkmcnt(0)
  v_smfmac_f32_32x32x32_bf16 v[32:47], v[80:83], v[8:15], v94
  s_waitcnt vmcnt(2)
  s_barrier
  ds_read_b128 v[72:75], v92 offset:16384
  v_exp_f32 v18, v18
  v_exp_f32 v19, v19
  v_exp_f32 v20, v20
  s_waitcnt lgkmcnt(0)
  v_mfma_f32_32x32x16_bf16 v[0:15], v[72:75], v[64:67], 0
  v_exp_f32 v21, v21
  v_exp_f32 v22, v22
  v_exp_f32 v23, v23
  v_exp_f32 v24, v24
  v_exp_f32 v25, v25
  v_smfmac_f32_32x32x32_bf16 v[48:63], v[76:79], v[16:23], v94
  s_mov_b64 exec, s[98:99]
  ds_read_b128 v[76:79], v93 offset:16384
  s_mov_b64 exec, -1
  v_exp_f32 v26, v26
  v_exp_f32 v27, v27
  v_exp_f32 v28, v28
  v_exp_f32 v29, v29
  v_exp_f32 v30, v30
  v_exp_f32 v31, v31
  v_exp_f32 v0, v0
  v_exp_f32 v1, v1
  v_smfmac_f32_32x32x32_bf16 v[48:63], v[80:83], v[24:31], v94
  s_mov_b64 exec, s[98:99]
  ds_read_b128 v[80:83], v93 offset:16896
  s_mov_b64 exec, -1
  s_add_u32 s92, s92, 8192
  s_and_b32 s92, s92, 0xffff
  s_mov_b32 m0, s67
  s_add_u32 s48, s92, s44
  buffer_load_dwordx4 v95, s[28:31], s48 offen lds
  s_add_u32 m0, s67, 8192
  s_add_u32 s49, s48, 2097152
  buffer_load_dwordx4 v95, s[28:31], s49 offen lds
  s_add_u32 s67, s67, 16384
  v_exp_f32 v2, v2
  v_exp_f32 v3, v3
  v_exp_f32 v4, v4
  v_mfma_f32_32x32x16_bf16 v[16:31], v[72:75], v[68:71], 0
  ds_read_b128 v[72:75], v92 offset:17408
  v_exp_f32 v5, v5
  v_exp_f32 v6, v6
  v_exp_f32 v7, v7
  v_exp_f32 v8, v8
  v_exp_f32 v9, v9
  s_waitcnt lgkmcnt(2)
  v_smfmac_f32_32x32x32_bf16 v[32:47], v[76:79], v[0:7], v94
  v_exp_f32 v10, v10
  v_exp_f32 v11, v11
  v_exp_f32 v12, v12
  v_exp_f32 v13, v13
  v_exp_f32 v14, v14
  v_exp_f32 v15, v15
  v_exp_f32 v16, v16
  v_exp_f32 v17, v17
  s_waitcnt lgkmcnt(1)
  v_smfmac_f32_32x32x32_bf16 v[32:47], v[80:83], v[8:15], v94
  v_exp_f32 v18, v18
  v_exp_f32 v19, v19
  v_exp_f32 v20, v20
  s_waitcnt lgkmcnt(0)
  v_mfma_f32_32x32x16_bf16 v[0:15], v[72:75], v[64:67], 0
  v_exp_f32 v21, v21
  v_exp_f32 v22, v22
  v_exp_f32 v23, v23
  v_exp_f32 v24, v24
  v_exp_f32 v25, v25
  v_smfmac_f32_32x32x32_bf16 v[48:63], v[76:79], v[16:23], v94
  s_mov_b64 exec, s[98:99]
  ds_read_b128 v[76:79], v93 offset:17408
  s_mov_b64 exec, -1
  v_exp_f32 v26, v26
  v_exp_f32 v27, v27
  v_exp_f32 v28, v28
  v_exp_f32 v29, v29
  v_exp_f32 v30, v30
  v_exp_f32 v31, v31
  v_exp_f32 v0, v0
  v_exp_f32 v1, v1
  v_smfmac_f32_32x32x32_bf16 v[48:63], v[80:83], v[24:31], v94
  s_mov_b64 exec, s[98:99]
  ds_read_b128 v[80:83], v93 offset:17920
  s_mov_b64 exec, -1
  v_exp_f32 v2, v2
  v_exp_f32 v3, v3
  v_exp_f32 v4, v4
  v_mfma_f32_32x32x16_bf16 v[16:31], v[72:75], v[68:71], 0
  ds_read_b128 v[72:75], v92 offset:18432
  v_exp_f32 v5, v5
  v_exp_f32 v6, v6
  v_exp_f32 v7, v7
  v_exp_f32 v8, v8
  v_exp_f32 v9, v9
  s_waitcnt lgkmcnt(2)
  v_smfmac_f32_32x32x32_bf16 v[32:47], v[76:79], v[0:7], v94
  v_exp_f32 v10, v10
  v_exp_f32 v11, v11
  v_exp_f32 v12, v12
  v_exp_f32 v13, v13
  v_exp_f32 v14, v14
  v_exp_f32 v15, v15
  v_exp_f32 v16, v16
  v_exp_f32 v17, v17
  s_waitcnt lgkmcnt(1)
  v_smfmac_f32_32x32x32_bf16 v[32:47], v[80:83], v[8:15], v94
  v_exp_f32 v18, v18
  v_exp_f32 v19, v19
  v_exp_f32 v20, v20
  s_waitcnt lgkmcnt(0)
  v_mfma_f32_32x32x16_bf16 v[0:15], v[72:75], v[64:67], 0
  v_exp_f32 v21, v21
  v_exp_f32 v22, v22
  v_exp_f32 v23, v23
  v_exp_f32 v24, v24
  v_exp_f32 v25, v25
  v_smfmac_f32_32x32x32_bf16 v[48:63], v[76:79], v[16:23], v94
  s_mov_b64 exec, s[98:99]
  ds_read_b128 v[76:79], v93 offset:18432
  s_mov_b64 exec, -1
  v_exp_f32 v26, v26
  v_exp_f32 v27, v27
  v_exp_f32 v28, v28
  v_exp_f32 v29, v29
  v_exp_f32 v30, v30
  v_exp_f32 v31, v31
  v_exp_f32 v0, v0
  v_exp_f32 v1, v1
  v_smfmac_f32_32x32x32_bf16 v[48:63], v[80:83], v[24:31], v94
  s_mov_b64 exec, s[98:99]
  ds_read_b128 v[80:83], v93 offset:18944
  s_mov_b64 exec, -1
  v_exp_f32 v2, v2
  v_exp_f32 v3, v3
  v_exp_f32 v4, v4
  v_mfma_f32_32x32x16_bf16 v[16:31], v[72:75], v[68:71], 0
  ds_read_b128 v[72:75], v92 offset:19456
  v_exp_f32 v5, v5
  v_exp_f32 v6, v6
  v_exp_f32 v7, v7
  v_exp_f32 v8, v8
  v_exp_f32 v9, v9
  s_waitcnt lgkmcnt(2)
  v_smfmac_f32_32x32x32_bf16 v[32:47], v[76:79], v[0:7], v94
  v_exp_f32 v10, v10
  v_exp_f32 v11, v11
  v_exp_f32 v12, v12
  v_exp_f32 v13, v13
  v_exp_f32 v14, v14
  v_exp_f32 v15, v15
  v_exp_f32 v16, v16
  v_exp_f32 v17, v17
  s_waitcnt lgkmcnt(1)
  v_smfmac_f32_32x32x32_bf16 v[32:47], v[80:83], v[8:15], v94
  v_exp_f32 v18, v18
  v_exp_f32 v19, v19
  v_exp_f32 v20, v20
  s_waitcnt lgkmcnt(0)
  v_mfma_f32_32x32x16_bf16 v[0:15], v[72:75], v[64:67], 0
  v_exp_f32 v21, v21
  v_exp_f32 v22, v22
  v_exp_f32 v23, v23
  v_exp_f32 v24, v24
  v_exp_f32 v25, v25
  v_smfmac_f32_32x32x32_bf16 v[48:63], v[76:79], v[16:23], v94
  s_mov_b64 exec, s[98:99]
  ds_read_b128 v[76:79], v93 offset:19456
  s_mov_b64 exec, -1
  v_exp_f32 v26, v26
  v_exp_f32 v27, v27
  v_exp_f32 v28, v28
  v_exp_f32 v29, v29
  v_exp_f32 v30, v30
  v_exp_f32 v31, v31
  v_exp_f32 v0, v0
  v_exp_f32 v1, v1
  v_smfmac_f32_32x32x32_bf16 v[48:63], v[80:83], v[24:31], v94
  s_mov_b64 exec, s[98:99]
  ds_read_b128 v[80:83], v93 offset:19968
  s_mov_b64 exec, -1
  s_waitcnt vmcnt(2)
  s_barrier
  v_exp_f32 v2, v2
  v_exp_f32 v3, v3
  v_exp_f32 v4, v4
  v_mfma_f32_32x32x16_bf16 v[16:31], v[72:75], v[68:71], 0
  ds_read_b128 v[72:75], v92 offset:32768
  v_exp_f32 v5, v5
  v_exp_f32 v6, v6
  v_exp_f32 v7, v7
  v_exp_f32 v8, v8
  v_exp_f32 v9, v9
  s_waitcnt lgkmcnt(2)
  v_smfmac_f32_32x32x32_bf16 v[32:47], v[76:79], v[0:7], v94
  v_exp_f32 v10, v10
  v_exp_f32 v11, v11
  v_exp_f32 v12, v12
  v_exp_f32 v13, v13
  v_exp_f32 v14, v14
  v_exp_f32 v15, v15
  v_exp_f32 v16, v16
  v_exp_f32 v17, v17
  s_waitcnt lgkmcnt(1)
  v_smfmac_f32_32x32x32_bf16 v[32:47], v[80:83], v[8:15], v94
  v_exp_f32 v18, v18
  v_exp_f32 v19, v19
  v_exp_f32 v20, v20
  s_waitcnt lgkmcnt(0)
  v_mfma_f32_32x32x16_bf16 v[0:15], v[72:75], v[64:67], 0
  v_exp_f32 v21, v21
  v_exp_f32 v22, v22
  v_exp_f32 v23, v23
  v_exp_f32 v24, v24
  v_exp_f32 v25, v25
  v_smfmac_f32_32x32x32_bf16 v[48:63], v[76:79], v[16:23], v94
  s_mov_b64 exec, s[98:99]
  ds_read_b128 v[76:79], v93 offset:32768
  s_mov_b64 exec, -1
  v_exp_f32 v26, v26
  v_exp_f32 v27, v27
  v_exp_f32 v28, v28
  v_exp_f32 v29, v29
  v_exp_f32 v30, v30
  v_exp_f32 v31, v31
  v_exp_f32 v0, v0
  v_exp_f32 v1, v1
  v_smfmac_f32_32x32x32_bf16 v[48:63], v[80:83], v[24:31], v94
  s_mov_b64 exec, s[98:99]
  ds_read_b128 v[80:83], v93 offset:33280
  s_mov_b64 exec, -1
  s_add_u32 s92, s92, 8192
  s_and_b32 s92, s92, 0xffff
  s_mov_b32 m0, s67
  s_add_u32 s48, s92, s44
  buffer_load_dwordx4 v95, s[28:31], s48 offen lds
  s_add_u32 m0, s67, 8192
  s_add_u32 s49, s48, 2097152
  buffer_load_dwordx4 v95, s[28:31], s49 offen lds
  s_add_u32 s67, s67, 16384
  v_exp_f32 v2, v2
  v_exp_f32 v3, v3
  v_exp_f32 v4, v4
  v_mfma_f32_32x32x16_bf16 v[16:31], v[72:75], v[68:71], 0
  ds_read_b128 v[72:75], v92 offset:33792
  v_exp_f32 v5, v5
  v_exp_f32 v6, v6
  v_exp_f32 v7, v7
  v_exp_f32 v8, v8
  v_exp_f32 v9, v9
  s_waitcnt lgkmcnt(2)
  v_smfmac_f32_32x32x32_bf16 v[32:47], v[76:79], v[0:7], v94
  v_exp_f32 v10, v10
  v_exp_f32 v11, v11
  v_exp_f32 v12, v12
  v_exp_f32 v13, v13
  v_exp_f32 v14, v14
  v_exp_f32 v15, v15
  v_exp_f32 v16, v16
  v_exp_f32 v17, v17
  s_waitcnt lgkmcnt(1)
  v_smfmac_f32_32x32x32_bf16 v[32:47], v[80:83], v[8:15], v94
  v_exp_f32 v18, v18
  v_exp_f32 v19, v19
  v_exp_f32 v20, v20
  s_waitcnt lgkmcnt(0)
  v_mfma_f32_32x32x16_bf16 v[0:15], v[72:75], v[64:67], 0
  buffer_load_dword v100, v84, s[28:31], 0 offen sc1
  v_exp_f32 v21, v21
  v_exp_f32 v22, v22
  v_exp_f32 v23, v23
  v_exp_f32 v24, v24
  v_exp_f32 v25, v25
  v_smfmac_f32_32x32x32_bf16 v[48:63], v[76:79], v[16:23], v94
  s_mov_b64 exec, s[98:99]
  ds_read_b128 v[76:79], v93 offset:33792
  s_mov_b64 exec, -1
  v_exp_f32 v26, v26
  v_exp_f32 v27, v27
  v_exp_f32 v28, v28
  v_exp_f32 v29, v29
  v_exp_f32 v30, v30
  v_exp_f32 v31, v31
  v_exp_f32 v0, v0
  v_exp_f32 v1, v1
  v_smfmac_f32_32x32x32_bf16 v[48:63], v[80:83], v[24:31], v94
  s_mov_b64 exec, s[98:99]
  ds_read_b128 v[80:83], v93 offset:34304
  s_mov_b64 exec, -1
  v_exp_f32 v2, v2
  v_exp_f32 v3, v3
  v_exp_f32 v4, v4
  v_mfma_f32_32x32x16_bf16 v[16:31], v[72:75], v[68:71], 0
  ds_read_b128 v[72:75], v92 offset:34816
  v_exp_f32 v5, v5
  v_exp_f32 v6, v6
  v_exp_f32 v7, v7
  v_exp_f32 v8, v8
  v_exp_f32 v9, v9
  s_waitcnt lgkmcnt(2)
  v_smfmac_f32_32x32x32_bf16 v[32:47], v[76:79], v[0:7], v94
  v_exp_f32 v10, v10
  v_exp_f32 v11, v11
  v_exp_f32 v12, v12
  v_exp_f32 v13, v13
  v_exp_f32 v14, v14
  v_exp_f32 v15, v15
  v_exp_f32 v16, v16
  v_exp_f32 v17, v17
  s_waitcnt lgkmcnt(1)
  v_smfmac_f32_32x32x32_bf16 v[32:47], v[80:83], v[8:15], v94
  v_exp_f32 v18, v18
  v_exp_f32 v19, v19
  v_exp_f32 v20, v20
  s_waitcnt lgkmcnt(0)
  v_mfma_f32_32x32x16_bf16 v[0:15], v[72:75], v[64:67], 0
  v_exp_f32 v21, v21
  v_exp_f32 v22, v22
  v_exp_f32 v23, v23
  v_exp_f32 v24, v24
  v_exp_f32 v25, v25
  v_smfmac_f32_32x32x32_bf16 v[48:63], v[76:79], v[16:23], v94
  s_mov_b64 exec, s[98:99]
  ds_read_b128 v[76:79], v93 offset:34816
  s_mov_b64 exec, -1
  v_exp_f32 v26, v26
  v_exp_f32 v27, v27
  v_exp_f32 v28, v28
  v_exp_f32 v29, v29
  v_exp_f32 v30, v30
  v_exp_f32 v31, v31
  v_exp_f32 v0, v0
  v_exp_f32 v1, v1
  v_smfmac_f32_32x32x32_bf16 v[48:63], v[80:83], v[24:31], v94
  s_mov_b64 exec, s[98:99]
  ds_read_b128 v[80:83], v93 offset:35328
  s_mov_b64 exec, -1
  v_exp_f32 v2, v2
  v_exp_f32 v3, v3
  v_exp_f32 v4, v4
  v_mfma_f32_32x32x16_bf16 v[16:31], v[72:75], v[68:71], 0
  ds_read_b128 v[72:75], v92 offset:35840
  v_exp_f32 v5, v5
  v_exp_f32 v6, v6
  v_exp_f32 v7, v7
  v_exp_f32 v8, v8
  v_exp_f32 v9, v9
  s_waitcnt lgkmcnt(2)
  v_smfmac_f32_32x32x32_bf16 v[32:47], v[76:79], v[0:7], v94
  v_exp_f32 v10, v10
  v_exp_f32 v11, v11
  v_exp_f32 v12, v12
  v_exp_f32 v13, v13
  v_exp_f32 v14, v14
  v_exp_f32 v15, v15
  v_exp_f32 v16, v16
  v_exp_f32 v17, v17
  s_waitcnt lgkmcnt(1)
  v_smfmac_f32_32x32x32_bf16 v[32:47], v[80:83], v[8:15], v94
  v_exp_f32 v18, v18
  v_exp_f32 v19, v19
  v_exp_f32 v20, v20
  s_waitcnt lgkmcnt(0)
  v_mfma_f32_32x32x16_bf16 v[0:15], v[72:75], v[64:67], 0
  v_exp_f32 v21, v21
  v_exp_f32 v22, v22
  v_exp_f32 v23, v23
  v_exp_f32 v24, v24
  v_exp_f32 v25, v25
  v_smfmac_f32_32x32x32_bf16 v[48:63], v[76:79], v[16:23], v94
  s_mov_b64 exec, s[98:99]
  ds_read_b128 v[76:79], v93 offset:35840
  s_mov_b64 exec, -1
  v_exp_f32 v26, v26
  v_exp_f32 v27, v27
  v_exp_f32 v28, v28
  v_exp_f32 v29, v29
  v_exp_f32 v30, v30
  v_exp_f32 v31, v31
  v_exp_f32 v0, v0
  v_exp_f32 v1, v1
  v_smfmac_f32_32x32x32_bf16 v[48:63], v[80:83], v[24:31], v94
  s_mov_b64 exec, s[98:99]
  ds_read_b128 v[80:83], v93 offset:36352
  s_mov_b64 exec, -1
  s_waitcnt vmcnt(3)
  s_barrier
  v_exp_f32 v2, v2
  v_exp_f32 v3, v3
  v_exp_f32 v4, v4
  v_mfma_f32_32x32x16_bf16 v[16:31], v[72:75], v[68:71], 0
  ds_read_b128 v[72:75], v92 offset:49152
  v_exp_f32 v5, v5
  v_exp_f32 v6, v6
  v_exp_f32 v7, v7
  v_exp_f32 v8, v8
  v_exp_f32 v9, v9
  s_waitcnt lgkmcnt(2)
  v_smfmac_f32_32x32x32_bf16 v[32:47], v[76:79], v[0:7], v94
  v_exp_f32 v10, v10
  v_exp_f32 v11, v11
  v_exp_f32 v12, v12
  v_exp_f32 v13, v13
  v_exp_f32 v14, v14
  v_exp_f32 v15, v15
  v_exp_f32 v16, v16
  v_exp_f32 v17, v17
  s_waitcnt lgkmcnt(1)
  v_smfmac_f32_32x32x32_bf16 v[32:47], v[80:83], v[8:15], v94
  v_exp_f32 v18, v18
  v_exp_f32 v19, v19
  v_exp_f32 v20, v20
  s_waitcnt lgkmcnt(0)
  v_mfma_f32_32x32x16_bf16 v[0:15], v[72:75], v[64:67], 0
  v_exp_f32 v21, v21
  v_exp_f32 v22, v22
  v_exp_f32 v23, v23
  v_exp_f32 v24, v24
  v_exp_f32 v25, v25
  v_smfmac_f32_32x32x32_bf16 v[48:63], v[76:79], v[16:23], v94
  s_mov_b64 exec, s[98:99]
  ds_read_b128 v[76:79], v93 offset:49152
  s_mov_b64 exec, -1
  v_exp_f32 v26, v26
  v_exp_f32 v27, v27
  v_exp_f32 v28, v28
  v_exp_f32 v29, v29
  v_exp_f32 v30, v30
  v_exp_f32 v31, v31
  v_exp_f32 v0, v0
  v_exp_f32 v1, v1
  v_smfmac_f32_32x32x32_bf16 v[48:63], v[80:83], v[24:31], v94
  s_mov_b64 exec, s[98:99]
  ds_read_b128 v[80:83], v93 offset:49664
  s_mov_b64 exec, -1
  s_add_u32 s92, s92, 8192
  s_and_b32 s92, s92, 0xffff
  s_mov_b32 m0, s67
  s_add_u32 s48, s92, s44
  buffer_load_dwordx4 v95, s[28:31], s48 offen lds
  s_add_u32 m0, s67, 8192
  s_add_u32 s49, s48, 2097152
  buffer_load_dwordx4 v95, s[28:31], s49 offen lds
  s_add_u32 s67, s67, 16384
  v_exp_f32 v2, v2
  v_exp_f32 v3, v3
  v_exp_f32 v4, v4
  v_mfma_f32_32x32x16_bf16 v[16:31], v[72:75], v[68:71], 0
  ds_read_b128 v[72:75], v92 offset:50176
  v_exp_f32 v5, v5
  v_exp_f32 v6, v6
  v_exp_f32 v7, v7
  v_exp_f32 v8, v8
  v_exp_f32 v9, v9
  s_waitcnt lgkmcnt(2)
  v_smfmac_f32_32x32x32_bf16 v[32:47], v[76:79], v[0:7], v94
  v_exp_f32 v10, v10
  v_exp_f32 v11, v11
  v_exp_f32 v12, v12
  v_exp_f32 v13, v13
  v_exp_f32 v14, v14
  v_exp_f32 v15, v15
  v_exp_f32 v16, v16
  v_exp_f32 v17, v17
  s_waitcnt lgkmcnt(1)
  v_smfmac_f32_32x32x32_bf16 v[32:47], v[80:83], v[8:15], v94
  v_exp_f32 v18, v18
  v_exp_f32 v19, v19
  v_exp_f32 v20, v20
  s_waitcnt lgkmcnt(0)
  v_mfma_f32_32x32x16_bf16 v[0:15], v[72:75], v[64:67], 0
  buffer_load_dword v100, v84, s[28:31], 0 offen offset:128 sc1
  v_exp_f32 v21, v21
  v_exp_f32 v22, v22
  v_exp_f32 v23, v23
  v_exp_f32 v24, v24
  v_exp_f32 v25, v25
  v_smfmac_f32_32x32x32_bf16 v[48:63], v[76:79], v[16:23], v94
  s_mov_b64 exec, s[98:99]
  ds_read_b128 v[76:79], v93 offset:50176
  s_mov_b64 exec, -1
  v_exp_f32 v26, v26
  v_exp_f32 v27, v27
  v_exp_f32 v28, v28
  v_exp_f32 v29, v29
  v_exp_f32 v30, v30
  v_exp_f32 v31, v31
  v_exp_f32 v0, v0
  v_exp_f32 v1, v1
  v_smfmac_f32_32x32x32_bf16 v[48:63], v[80:83], v[24:31], v94
  s_mov_b64 exec, s[98:99]
  ds_read_b128 v[80:83], v93 offset:50688
  s_mov_b64 exec, -1
  v_exp_f32 v2, v2
  v_exp_f32 v3, v3
  v_exp_f32 v4, v4
  v_mfma_f32_32x32x16_bf16 v[16:31], v[72:75], v[68:71], 0
  ds_read_b128 v[72:75], v92 offset:51200
  v_exp_f32 v5, v5
  v_exp_f32 v6, v6
  v_exp_f32 v7, v7
  v_exp_f32 v8, v8
  v_exp_f32 v9, v9
  s_waitcnt lgkmcnt(2)
  v_smfmac_f32_32x32x32_bf16 v[32:47], v[76:79], v[0:7], v94
  v_exp_f32 v10, v10
  v_exp_f32 v11, v11
  v_exp_f32 v12, v12
  v_exp_f32 v13, v13
  v_exp_f32 v14, v14
  v_exp_f32 v15, v15
  v_exp_f32 v16, v16
  v_exp_f32 v17, v17
  s_waitcnt lgkmcnt(1)
  v_smfmac_f32_32x32x32_bf16 v[32:47], v[80:83], v[8:15], v94
  v_exp_f32 v18, v18
  v_exp_f32 v19, v19
  v_exp_f32 v20, v20
  s_waitcnt lgkmcnt(0)
  v_mfma_f32_32x32x16_bf16 v[0:15], v[72:75], v[64:67], 0
  v_exp_f32 v21, v21
  v_exp_f32 v22, v22
  v_exp_f32 v23, v23
  v_exp_f32 v24, v24
  v_exp_f32 v25, v25
  v_smfmac_f32_32x32x32_bf16 v[48:63], v[76:79], v[16:23], v94
  s_mov_b64 exec, s[98:99]
  ds_read_b128 v[76:79], v93 offset:51200
  s_mov_b64 exec, -1
  v_exp_f32 v26, v26
  v_exp_f32 v27, v27
  v_exp_f32 v28, v28
  v_exp_f32 v29, v29
  v_exp_f32 v30, v30
  v_exp_f32 v31, v31
  v_exp_f32 v0, v0
  v_exp_f32 v1, v1
  v_smfmac_f32_32x32x32_bf16 v[48:63], v[80:83], v[24:31], v94
  s_mov_b64 exec, s[98:99]
  ds_read_b128 v[80:83], v93 offset:51712
  s_mov_b64 exec, -1
  v_exp_f32 v2, v2
  v_exp_f32 v3, v3
  v_exp_f32 v4, v4
  v_mfma_f32_32x32x16_bf16 v[16:31], v[72:75], v[68:71], 0
  ds_read_b128 v[72:75], v92 offset:52224
  v_exp_f32 v5, v5
  v_exp_f32 v6, v6
  v_exp_f32 v7, v7
  v_exp_f32 v8, v8
  v_exp_f32 v9, v9
  s_waitcnt lgkmcnt(2)
  v_smfmac_f32_32x32x32_bf16 v[32:47], v[76:79], v[0:7], v94
  v_exp_f32 v10, v10
  v_exp_f32 v11, v11
  v_exp_f32 v12, v12
  v_exp_f32 v13, v13
  v_exp_f32 v14, v14
  v_exp_f32 v15, v15
  v_exp_f32 v16, v16
  v_exp_f32 v17, v17
  s_waitcnt lgkmcnt(1)
  v_smfmac_f32_32x32x32_bf16 v[32:47], v[80:83], v[8:15], v94
  v_exp_f32 v18, v18
  v_exp_f32 v19, v19
  v_exp_f32 v20, v20
  s_waitcnt lgkmcnt(0)
  v_mfma_f32_32x32x16_bf16 v[0:15], v[72:75], v[64:67], 0
  v_exp_f32 v21, v21
  v_exp_f32 v22, v22
  v_exp_f32 v23, v23
  v_exp_f32 v24, v24
  v_exp_f32 v25, v25
  v_smfmac_f32_32x32x32_bf16 v[48:63], v[76:79], v[16:23], v94
  s_mov_b64 exec, s[98:99]
  ds_read_b128 v[76:79], v93 offset:52224
  s_mov_b64 exec, -1
  v_exp_f32 v26, v26
  v_exp_f32 v27, v27
  v_exp_f32 v28, v28
  v_exp_f32 v29, v29
  v_exp_f32 v30, v30
  v_exp_f32 v31, v31
  v_exp_f32 v0, v0
  v_exp_f32 v1, v1
  v_smfmac_f32_32x32x32_bf16 v[48:63], v[80:83], v[24:31], v94
  s_mov_b64 exec, s[98:99]
  ds_read_b128 v[80:83], v93 offset:52736
  s_mov_b64 exec, -1
  s_waitcnt vmcnt(4)
  s_barrier
  v_exp_f32 v2, v2
  v_exp_f32 v3, v3
  v_exp_f32 v4, v4
  v_mfma_f32_32x32x16_bf16 v[16:31], v[72:75], v[68:71], 0
  v_add_u32 v92, 65536, v92
  ds_read_b128 v[72:75], v92 offset:0
  v_exp_f32 v5, v5
  v_exp_f32 v6, v6
  v_exp_f32 v7, v7
  v_exp_f32 v8, v8
  v_exp_f32 v9, v9
  s_waitcnt lgkmcnt(2)
  v_smfmac_f32_32x32x32_bf16 v[32:47], v[76:79], v[0:7], v94
  v_exp_f32 v10, v10
  v_exp_f32 v11, v11
  v_exp_f32 v12, v12
  v_exp_f32 v13, v13
  v_exp_f32 v14, v14
  v_exp_f32 v15, v15
  v_exp_f32 v16, v16
  v_exp_f32 v17, v17
  s_waitcnt lgkmcnt(1)
  v_smfmac_f32_32x32x32_bf16 v[32:47], v[80:83], v[8:15], v94
  v_exp_f32 v18, v18
  v_exp_f32 v19, v19
  v_exp_f32 v20, v20
  s_waitcnt lgkmcnt(0)
  v_mfma_f32_32x32x16_bf16 v[0:15], v[72:75], v[64:67], 0
  s_mov_b32 m0, s93
  s_add_u32 s93, s93, 8192
  buffer_load_dwordx4 v98, s[12:15], s94 offen lds
  s_add_u32 s94, s94, 65536
  v_exp_f32 v21, v21
  v_exp_f32 v22, v22
  v_exp_f32 v23, v23
  v_exp_f32 v24, v24
  v_exp_f32 v25, v25
  v_smfmac_f32_32x32x32_bf16 v[48:63], v[76:79], v[16:23], v94
  v_add_u32 v93, 65536, v93
  s_mov_b64 exec, s[98:99]
  ds_read_b128 v[76:79], v93 offset:0
  s_mov_b64 exec, -1
  v_exp_f32 v26, v26
  v_exp_f32 v27, v27
  v_exp_f32 v28, v28
  v_exp_f32 v29, v29
  v_exp_f32 v30, v30
  v_exp_f32 v31, v31
  v_exp_f32 v0, v0
  v_exp_f32 v1, v1
  v_smfmac_f32_32x32x32_bf16 v[48:63], v[80:83], v[24:31], v94
  s_mov_b64 exec, s[98:99]
  ds_read_b128 v[80:83], v93 offset:512
  s_mov_b64 exec, -1
  s_add_u32 s92, s92, 8192
  s_and_b32 s92, s92, 0xffff
  s_mov_b32 m0, s67
  s_add_u32 s48, s92, s44
  buffer_load_dwordx4 v95, s[28:31], s48 offen lds
  s_add_u32 m0, s67, 8192
  s_add_u32 s49, s48, 2097152
  buffer_load_dwordx4 v95, s[28:31], s49 offen lds
  s_add_u32 s67, s67, 16384
  v_exp_f32 v2, v2
  v_exp_f32 v3, v3
  v_exp_f32 v4, v4
  v_mfma_f32_32x32x16_bf16 v[16:31], v[72:75], v[68:71], 0
  ds_read_b128 v[72:75], v92 offset:1024
  v_exp_f32 v5, v5
  v_exp_f32 v6, v6
  v_exp_f32 v7, v7
  v_exp_f32 v8, v8
  v_exp_f32 v9, v9
  s_waitcnt lgkmcnt(2)
  v_smfmac_f32_32x32x32_bf16 v[32:47], v[76:79], v[0:7], v94
  v_exp_f32 v10, v10
  v_exp_f32 v11, v11
  v_exp_f32 v12, v12
  v_exp_f32 v13, v13
  v_exp_f32 v14, v14
  v_exp_f32 v15, v15
  v_exp_f32 v16, v16
  v_exp_f32 v17, v17
  s_waitcnt lgkmcnt(1)
  v_smfmac_f32_32x32x32_bf16 v[32:47], v[80:83], v[8:15], v94
  v_exp_f32 v18, v18
  v_exp_f32 v19, v19
  v_exp_f32 v20, v20
  s_waitcnt lgkmcnt(0)
  v_mfma_f32_32x32x16_bf16 v[0:15], v[72:75], v[64:67], 0
  s_mov_b32 m0, s93
  s_add_u32 s93, s93, 8192
  buffer_load_dwordx4 v98, s[12:15], s94 offen lds
  s_add_u32 s94, s94, 65536
  buffer_load_dword v100, v84, s[28:31], 0 offen sc1
  v_exp_f32 v21, v21
  v_exp_f32 v22, v22
  v_exp_f32 v23, v23
  v_exp_f32 v24, v24
  v_exp_f32 v25, v25
  v_smfmac_f32_32x32x32_bf16 v[48:63], v[76:79], v[16:23], v94
  s_mov_b64 exec, s[98:99]
  ds_read_b128 v[76:79], v93 offset:1024
  s_mov_b64 exec, -1
  v_exp_f32 v26, v26
  v_exp_f32 v27, v27
  v_exp_f32 v28, v28
  v_exp_f32 v29, v29
  v_exp_f32 v30, v30
  v_exp_f32 v31, v31
  v_exp_f32 v0, v0
  v_exp_f32 v1, v1
  v_smfmac_f32_32x32x32_bf16 v[48:63], v[80:83], v[24:31], v94
  s_mov_b64 exec, s[98:99]
  ds_read_b128 v[80:83], v93 offset:1536
  s_mov_b64 exec, -1
  v_exp_f32 v2, v2
  v_exp_f32 v3, v3
  v_exp_f32 v4, v4
  v_mfma_f32_32x32x16_bf16 v[16:31], v[72:75], v[68:71], 0
  ds_read_b128 v[72:75], v92 offset:2048
  v_exp_f32 v5, v5
  v_exp_f32 v6, v6
  v_exp_f32 v7, v7
  v_exp_f32 v8, v8
  v_exp_f32 v9, v9
  s_waitcnt lgkmcnt(2)
  v_smfmac_f32_32x32x32_bf16 v[32:47], v[76:79], v[0:7], v94
  v_exp_f32 v10, v10
  v_exp_f32 v11, v11
  v_exp_f32 v12, v12
  v_exp_f32 v13, v13
  v_exp_f32 v14, v14
  v_exp_f32 v15, v15
  v_exp_f32 v16, v16
  v_exp_f32 v17, v17
  s_waitcnt lgkmcnt(1)
  v_smfmac_f32_32x32x32_bf16 v[32:47], v[80:83], v[8:15], v94
  v_exp_f32 v18, v18
  v_exp_f32 v19, v19
  v_exp_f32 v20, v20
  s_waitcnt lgkmcnt(0)
  v_mfma_f32_32x32x16_bf16 v[0:15], v[72:75], v[64:67], 0
  s_mov_b32 m0, s93
  s_add_u32 s93, s93, 8192
  buffer_load_dwordx4 v98, s[12:15], s94 offen lds
  s_add_u32 s94, s94, 65536
  v_exp_f32 v21, v21
  v_exp_f32 v22, v22
  v_exp_f32 v23, v23
  v_exp_f32 v24, v24
  v_exp_f32 v25, v25
  v_smfmac_f32_32x32x32_bf16 v[48:63], v[76:79], v[16:23], v94
  s_mov_b64 exec, s[98:99]
  ds_read_b128 v[76:79], v93 offset:2048
  s_mov_b64 exec, -1
  v_exp_f32 v26, v26
  v_exp_f32 v27, v27
  v_exp_f32 v28, v28
  v_exp_f32 v29, v29
  v_exp_f32 v30, v30
  v_exp_f32 v31, v31
  v_exp_f32 v0, v0
  v_exp_f32 v1, v1
  v_smfmac_f32_32x32x32_bf16 v[48:63], v[80:83], v[24:31], v94
  s_mov_b64 exec, s[98:99]
  ds_read_b128 v[80:83], v93 offset:2560
  s_mov_b64 exec, -1
  v_exp_f32 v2, v2
  v_exp_f32 v3, v3
  v_exp_f32 v4, v4
  v_mfma_f32_32x32x16_bf16 v[16:31], v[72:75], v[68:71], 0
  ds_read_b128 v[72:75], v92 offset:3072
  v_exp_f32 v5, v5
  v_exp_f32 v6, v6
  v_exp_f32 v7, v7
  v_exp_f32 v8, v8
  v_exp_f32 v9, v9
  s_waitcnt lgkmcnt(2)
  v_smfmac_f32_32x32x32_bf16 v[32:47], v[76:79], v[0:7], v94
  v_exp_f32 v10, v10
  v_exp_f32 v11, v11
  v_exp_f32 v12, v12
  v_exp_f32 v13, v13
  v_exp_f32 v14, v14
  v_exp_f32 v15, v15
  v_exp_f32 v16, v16
  v_exp_f32 v17, v17
  s_waitcnt lgkmcnt(1)
  v_smfmac_f32_32x32x32_bf16 v[32:47], v[80:83], v[8:15], v94
  v_exp_f32 v18, v18
  v_exp_f32 v19, v19
  v_exp_f32 v20, v20
  s_waitcnt lgkmcnt(0)
  v_mfma_f32_32x32x16_bf16 v[0:15], v[72:75], v[64:67], 0
  s_mov_b32 m0, s93
  s_add_u32 s93, s93, 8192
  buffer_load_dwordx4 v98, s[12:15], s94 offen lds
  s_add_u32 s94, s94, 65536
  v_exp_f32 v21, v21
  v_exp_f32 v22, v22
  v_exp_f32 v23, v23
  v_exp_f32 v24, v24
  v_exp_f32 v25, v25
  v_smfmac_f32_32x32x32_bf16 v[48:63], v[76:79], v[16:23], v94
  s_mov_b64 exec, s[98:99]
  ds_read_b128 v[76:79], v93 offset:3072
  s_mov_b64 exec, -1
  v_exp_f32 v26, v26
  v_exp_f32 v27, v27
  v_exp_f32 v28, v28
  v_exp_f32 v29, v29
  v_exp_f32 v30, v30
  v_exp_f32 v31, v31
  v_exp_f32 v0, v0
  v_exp_f32 v1, v1
  v_smfmac_f32_32x32x32_bf16 v[48:63], v[80:83], v[24:31], v94
  s_mov_b64 exec, s[98:99]
  ds_read_b128 v[80:83], v93 offset:3584
  s_mov_b64 exec, -1
  s_waitcnt vmcnt(8)
  s_barrier
  v_exp_f32 v2, v2
  v_exp_f32 v3, v3
  v_exp_f32 v4, v4
  v_mfma_f32_32x32x16_bf16 v[16:31], v[72:75], v[68:71], 0
  ds_read_b128 v[72:75], v92 offset:16384
  v_exp_f32 v5, v5
  v_exp_f32 v6, v6
  v_exp_f32 v7, v7
  v_exp_f32 v8, v8
  v_exp_f32 v9, v9
  s_waitcnt lgkmcnt(2)
  v_smfmac_f32_32x32x32_bf16 v[32:47], v[76:79], v[0:7], v94
  v_exp_f32 v10, v10
  v_exp_f32 v11, v11
  v_exp_f32 v12, v12
  v_exp_f32 v13, v13
  v_exp_f32 v14, v14
  v_exp_f32 v15, v15
  v_exp_f32 v16, v16
  v_exp_f32 v17, v17
  s_waitcnt lgkmcnt(1)
  v_smfmac_f32_32x32x32_bf16 v[32:47], v[80:83], v[8:15], v94
  v_exp_f32 v18, v18
  v_exp_f32 v19, v19
  v_exp_f32 v20, v20
  s_waitcnt lgkmcnt(0)
  v_mfma_f32_32x32x16_bf16 v[0:15], v[72:75], v[64:67], 0
  s_mov_b32 m0, s93
  s_add_u32 s93, s93, 8192
  buffer_load_dwordx4 v98, s[12:15], s94 offen lds
  s_add_u32 s94, s94, 65536
  s_mov_b32 m0, s95
  s_add_u32 s95, s95, 8192
  buffer_load_dwordx4 v97, s[16:19], s96 offen lds
  s_add_u32 s96, s96, 229376
  v_exp_f32 v21, v21
  v_exp_f32 v22, v22
  v_exp_f32 v23, v23
  v_exp_f32 v24, v24
  v_exp_f32 v25, v25
  v_smfmac_f32_32x32x32_bf16 v[48:63], v[76:79], v[16:23], v94
  s_mov_b64 exec, s[98:99]
  ds_read_b128 v[76:79], v93 offset:16384
  s_mov_b64 exec, -1
  v_exp_f32 v26, v26
  v_exp_f32 v27, v27
  v_exp_f32 v28, v28
  v_exp_f32 v29, v29
  v_exp_f32 v30, v30
  v_exp_f32 v31, v31
  v_exp_f32 v0, v0
  v_exp_f32 v1, v1
  v_smfmac_f32_32x32x32_bf16 v[48:63], v[80:83], v[24:31], v94
  s_mov_b64 exec, s[98:99]
  ds_read_b128 v[80:83], v93 offset:16896
  s_mov_b64 exec, -1
  s_add_u32 s92, s92, 8192
  s_and_b32 s92, s92, 0xffff
  s_mov_b32 m0, s67
  s_add_u32 s48, s92, s44
  buffer_load_dwordx4 v95, s[28:31], s48 offen lds
  s_add_u32 m0, s67, 8192
  s_add_u32 s49, s48, 2097152
  buffer_load_dwordx4 v95, s[28:31], s49 offen lds
  s_add_u32 s67, s67, 16384
  v_exp_f32 v2, v2
  v_exp_f32 v3, v3
  v_exp_f32 v4, v4
  v_mfma_f32_32x32x16_bf16 v[16:31], v[72:75], v[68:71], 0
  ds_read_b128 v[72:75], v92 offset:17408
  v_exp_f32 v5, v5
  v_exp_f32 v6, v6
  v_exp_f32 v7, v7
  v_exp_f32 v8, v8
  v_exp_f32 v9, v9
  s_waitcnt lgkmcnt(2)
  v_smfmac_f32_32x32x32_bf16 v[32:47], v[76:79], v[0:7], v94
  v_exp_f32 v10, v10
  v_exp_f32 v11, v11
  v_exp_f32 v12, v12
  v_exp_f32 v13, v13
  v_exp_f32 v14, v14
  v_exp_f32 v15, v15
  v_exp_f32 v16, v16
  v_exp_f32 v17, v17
  s_waitcnt lgkmcnt(1)
  v_smfmac_f32_32x32x32_bf16 v[32:47], v[80:83], v[8:15], v94
  v_exp_f32 v18, v18
  v_exp_f32 v19, v19
  v_exp_f32 v20, v20
  s_waitcnt lgkmcnt(0)
  v_mfma_f32_32x32x16_bf16 v[0:15], v[72:75], v[64:67], 0
  s_mov_b32 m0, s93
  s_add_u32 s93, s93, 8192
  buffer_load_dwordx4 v98, s[12:15], s94 offen lds
  s_add_u32 s94, s94, 65536
  buffer_load_dword v100, v84, s[28:31], 0 offen offset:128 sc1
  v_exp_f32 v21, v21
  v_exp_f32 v22, v22
  v_exp_f32 v23, v23
  v_exp_f32 v24, v24
  v_exp_f32 v25, v25
  v_smfmac_f32_32x32x32_bf16 v[48:63], v[76:79], v[16:23], v94
  s_mov_b64 exec, s[98:99]
  ds_read_b128 v[76:79], v93 offset:17408
  s_mov_b64 exec, -1
  v_exp_f32 v26, v26
  v_exp_f32 v27, v27
  v_exp_f32 v28, v28
  v_exp_f32 v29, v29
  v_exp_f32 v30, v30
  v_exp_f32 v31, v31
  v_exp_f32 v0, v0
  v_exp_f32 v1, v1
  v_smfmac_f32_32x32x32_bf16 v[48:63], v[80:83], v[24:31], v94
  s_mov_b64 exec, s[98:99]
  ds_read_b128 v[80:83], v93 offset:17920
  s_mov_b64 exec, -1
  v_exp_f32 v2, v2
  v_exp_f32 v3, v3
  v_exp_f32 v4, v4
  v_mfma_f32_32x32x16_bf16 v[16:31], v[72:75], v[68:71], 0
  ds_read_b128 v[72:75], v92 offset:18432
  v_exp_f32 v5, v5
  v_exp_f32 v6, v6
  v_exp_f32 v7, v7
  v_exp_f32 v8, v8
  v_exp_f32 v9, v9
  s_waitcnt lgkmcnt(2)
  v_smfmac_f32_32x32x32_bf16 v[32:47], v[76:79], v[0:7], v94
  v_exp_f32 v10, v10
  v_exp_f32 v11, v11
  v_exp_f32 v12, v12
  v_exp_f32 v13, v13
  v_exp_f32 v14, v14
  v_exp_f32 v15, v15
  v_exp_f32 v16, v16
  v_exp_f32 v17, v17
  s_waitcnt lgkmcnt(1)
  v_smfmac_f32_32x32x32_bf16 v[32:47], v[80:83], v[8:15], v94
  v_exp_f32 v18, v18
  v_exp_f32 v19, v19
  v_exp_f32 v20, v20
  s_waitcnt lgkmcnt(0)
  v_mfma_f32_32x32x16_bf16 v[0:15], v[72:75], v[64:67], 0
  s_mov_b32 m0, s93
  s_add_u32 s93, s93, 8192
  buffer_load_dwordx4 v98, s[12:15], s94 offen lds
  s_add_u32 s94, s94, 65536
  v_exp_f32 v21, v21
  v_exp_f32 v22, v22
  v_exp_f32 v23, v23
  v_exp_f32 v24, v24
  v_exp_f32 v25, v25
  v_smfmac_f32_32x32x32_bf16 v[48:63], v[76:79], v[16:23], v94
  s_mov_b64 exec, s[98:99]
  ds_read_b128 v[76:79], v93 offset:18432
  s_mov_b64 exec, -1
  v_exp_f32 v26, v26
  v_exp_f32 v27, v27
  v_exp_f32 v28, v28
  v_exp_f32 v29, v29
  v_exp_f32 v30, v30
  v_exp_f32 v31, v31
  v_exp_f32 v0, v0
  v_exp_f32 v1, v1
  v_smfmac_f32_32x32x32_bf16 v[48:63], v[80:83], v[24:31], v94
  s_mov_b64 exec, s[98:99]
  ds_read_b128 v[80:83], v93 offset:18944
  s_mov_b64 exec, -1
  v_exp_f32 v2, v2
  v_exp_f32 v3, v3
  v_exp_f32 v4, v4
  v_mfma_f32_32x32x16_bf16 v[16:31], v[72:75], v[68:71], 0
  ds_read_b128 v[72:75], v92 offset:19456
  v_exp_f32 v5, v5
  v_exp_f32 v6, v6
  v_exp_f32 v7, v7
  v_exp_f32 v8, v8
  v_exp_f32 v9, v9
  s_waitcnt lgkmcnt(2)
  v_smfmac_f32_32x32x32_bf16 v[32:47], v[76:79], v[0:7], v94
  v_exp_f32 v10, v10
  v_exp_f32 v11, v11
  v_exp_f32 v12, v12
  v_exp_f32 v13, v13
  v_exp_f32 v14, v14
  v_exp_f32 v15, v15
  v_exp_f32 v16, v16
  v_exp_f32 v17, v17
  s_waitcnt lgkmcnt(1)
  v_smfmac_f32_32x32x32_bf16 v[32:47], v[80:83], v[8:15], v94
  v_exp_f32 v18, v18
  v_exp_f32 v19, v19
  v_exp_f32 v20, v20
  s_waitcnt lgkmcnt(0)
  v_mfma_f32_32x32x16_bf16 v[0:15], v[72:75], v[64:67], 0
  s_mov_b32 m0, s93
  s_add_u32 s93, s93, 8192
  buffer_load_dwordx4 v98, s[12:15], s94 offen lds
  s_add_u32 s94, s94, 65536
  v_exp_f32 v21, v21
  v_exp_f32 v22, v22
  v_exp_f32 v23, v23
  v_exp_f32 v24, v24
  v_exp_f32 v25, v25
  v_smfmac_f32_32x32x32_bf16 v[48:63], v[76:79], v[16:23], v94
  s_mov_b64 exec, s[98:99]
  ds_read_b128 v[76:79], v93 offset:19456
  s_mov_b64 exec, -1
  v_exp_f32 v26, v26
  v_exp_f32 v27, v27
  v_exp_f32 v28, v28
  v_exp_f32 v29, v29
  v_exp_f32 v30, v30
  v_exp_f32 v31, v31
  v_exp_f32 v0, v0
  v_exp_f32 v1, v1
  v_smfmac_f32_32x32x32_bf16 v[48:63], v[80:83], v[24:31], v94
  s_mov_b64 exec, s[98:99]
  ds_read_b128 v[80:83], v93 offset:19968
  s_mov_b64 exec, -1
  s_waitcnt vmcnt(12)
  s_barrier
  v_exp_f32 v2, v2
  v_exp_f32 v3, v3
  v_exp_f32 v4, v4
  v_mfma_f32_32x32x16_bf16 v[16:31], v[72:75], v[68:71], 0
  ds_read_b128 v[72:75], v92 offset:32768
  v_exp_f32 v5, v5
  v_exp_f32 v6, v6
  v_exp_f32 v7, v7
  v_exp_f32 v8, v8
  v_exp_f32 v9, v9
  s_waitcnt lgkmcnt(2)
  v_smfmac_f32_32x32x32_bf16 v[32:47], v[76:79], v[0:7], v94
  v_exp_f32 v10, v10
  v_exp_f32 v11, v11
  v_exp_f32 v12, v12
  v_exp_f32 v13, v13
  v_exp_f32 v14, v14
  v_exp_f32 v15, v15
  v_exp_f32 v16, v16
  v_exp_f32 v17, v17
  s_waitcnt lgkmcnt(1)
  v_smfmac_f32_32x32x32_bf16 v[32:47], v[80:83], v[8:15], v94
  v_exp_f32 v18, v18
  v_exp_f32 v19, v19
  v_exp_f32 v20, v20
  s_waitcnt lgkmcnt(0)
  v_mfma_f32_32x32x16_bf16 v[0:15], v[72:75], v[64:67], 0
  s_mov_b32 m0, s95
  s_add_u32 s95, s95, 8192
  s_cmp_ge_u32 s36, 6
  s_cselect_b32 s50, 1835136, 0
  s_sub_u32 s96, s96, s50
  buffer_load_dwordx4 v97, s[16:19], s96 offen lds
  s_add_u32 s96, s96, 229376
  s_mov_b32 m0, s95
  s_add_u32 s95, s95, 8192
  s_cmp_lt_u32 s36, 6
  s_cselect_b32 s50, 1835136, 0
  s_sub_u32 s96, s96, s50
  buffer_load_dwordx4 v97, s[16:19], s96 offen lds
  s_add_u32 s96, s96, 229376
  buffer_load_dword v100, v85, s[16:19], 0 offen
  v_exp_f32 v21, v21
  v_exp_f32 v22, v22
  v_exp_f32 v23, v23
  v_exp_f32 v24, v24
  v_exp_f32 v25, v25
  v_smfmac_f32_32x32x32_bf16 v[48:63], v[76:79], v[16:23], v94
  s_mov_b64 exec, s[98:99]
  ds_read_b128 v[76:79], v93 offset:32768
  s_mov_b64 exec, -1
  v_exp_f32 v26, v26
  v_exp_f32 v27, v27
  v_exp_f32 v28, v28
  v_exp_f32 v29, v29
  v_exp_f32 v30, v30
  v_exp_f32 v31, v31
  v_exp_f32 v0, v0
  v_exp_f32 v1, v1
  v_smfmac_f32_32x32x32_bf16 v[48:63], v[80:83], v[24:31], v94
  s_mov_b64 exec, s[98:99]
  ds_read_b128 v[80:83], v93 offset:33280
  s_mov_b64 exec, -1
  v_exp_f32 v2, v2
  v_exp_f32 v3, v3
  v_exp_f32 v4, v4
  v_mfma_f32_32x32x16_bf16 v[16:31], v[72:75], v[68:71], 0
  ds_read_b128 v[72:75], v92 offset:33792
  v_exp_f32 v5, v5
  v_exp_f32 v6, v6
  v_exp_f32 v7, v7
  v_exp_f32 v8, v8
  v_exp_f32 v9, v9
  s_waitcnt lgkmcnt(2)
  v_smfmac_f32_32x32x32_bf16 v[32:47], v[76:79], v[0:7], v94
  v_exp_f32 v10, v10
  v_exp_f32 v11, v11
  v_exp_f32 v12, v12
  v_exp_f32 v13, v13
  v_exp_f32 v14, v14
  v_exp_f32 v15, v15
  v_exp_f32 v16, v16
  v_exp_f32 v17, v17
  s_waitcnt lgkmcnt(1)
  v_smfmac_f32_32x32x32_bf16 v[32:47], v[80:83], v[8:15], v94
  v_exp_f32 v18, v18
  v_exp_f32 v19, v19
  v_exp_f32 v20, v20
  s_waitcnt lgkmcnt(0)
  v_mfma_f32_32x32x16_bf16 v[0:15], v[72:75], v[64:67], 0
  buffer_load_dword v100, v84, s[28:31], 0 offen sc1
  v_exp_f32 v21, v21
  v_exp_f32 v22, v22
  v_exp_f32 v23, v23
  v_exp_f32 v24, v24
  v_exp_f32 v25, v25
  v_smfmac_f32_32x32x32_bf16 v[48:63], v[76:79], v[16:23], v94
  s_mov_b64 exec, s[98:99]
  ds_read_b128 v[76:79], v93 offset:33792
  s_mov_b64 exec, -1
  v_exp_f32 v26, v26
  v_exp_f32 v27, v27
  v_exp_f32 v28, v28
  v_exp_f32 v29, v29
  v_exp_f32 v30, v30
  v_exp_f32 v31, v31
  v_exp_f32 v0, v0
  v_exp_f32 v1, v1
  v_smfmac_f32_32x32x32_bf16 v[48:63], v[80:83], v[24:31], v94
  s_mov_b64 exec, s[98:99]
  ds_read_b128 v[80:83], v93 offset:34304
  s_mov_b64 exec, -1
  v_exp_f32 v2, v2
  v_exp_f32 v3, v3
  v_exp_f32 v4, v4
  v_mfma_f32_32x32x16_bf16 v[16:31], v[72:75], v[68:71], 0
  ds_read_b128 v[72:75], v92 offset:34816
  buffer_load_dword v100, v84, s[28:31], 0 offen offset:128 sc1
  v_exp_f32 v5, v5
  v_exp_f32 v6, v6
  v_exp_f32 v7, v7
  v_exp_f32 v8, v8
  v_exp_f32 v9, v9
  s_waitcnt lgkmcnt(2)
  v_smfmac_f32_32x32x32_bf16 v[32:47], v[76:79], v[0:7], v94
  v_exp_f32 v10, v10
  v_exp_f32 v11, v11
  v_exp_f32 v12, v12
  v_exp_f32 v13, v13
  v_exp_f32 v14, v14
  v_exp_f32 v15, v15
  v_exp_f32 v16, v16
  v_exp_f32 v17, v17
  s_waitcnt lgkmcnt(1)
  v_smfmac_f32_32x32x32_bf16 v[32:47], v[80:83], v[8:15], v94
  v_exp_f32 v18, v18
  v_exp_f32 v19, v19
  v_exp_f32 v20, v20
  s_waitcnt lgkmcnt(0)
  v_mfma_f32_32x32x16_bf16 v[0:15], v[72:75], v[64:67], 0
  v_exp_f32 v21, v21
  v_exp_f32 v22, v22
  v_exp_f32 v23, v23
  v_exp_f32 v24, v24
  v_exp_f32 v25, v25
  v_smfmac_f32_32x32x32_bf16 v[48:63], v[76:79], v[16:23], v94
  s_mov_b64 exec, s[98:99]
  ds_read_b128 v[76:79], v93 offset:34816
  s_mov_b64 exec, -1
  v_exp_f32 v26, v26
  v_exp_f32 v27, v27
  v_exp_f32 v28, v28
  v_exp_f32 v29, v29
  v_exp_f32 v30, v30
  v_exp_f32 v31, v31
  v_exp_f32 v0, v0
  v_exp_f32 v1, v1
  v_smfmac_f32_32x32x32_bf16 v[48:63], v[80:83], v[24:31], v94
  s_mov_b64 exec, s[98:99]
  ds_read_b128 v[80:83], v93 offset:35328
  s_mov_b64 exec, -1
  v_exp_f32 v2, v2
  v_exp_f32 v3, v3
  v_exp_f32 v4, v4
  v_mfma_f32_32x32x16_bf16 v[16:31], v[72:75], v[68:71], 0
  ds_read_b128 v[72:75], v92 offset:35840
  buffer_load_dword v100, v86, s[20:23], 0 offen
  v_exp_f32 v5, v5
  v_exp_f32 v6, v6
  v_exp_f32 v7, v7
  v_exp_f32 v8, v8
  v_exp_f32 v9, v9
  s_waitcnt lgkmcnt(2)
  v_smfmac_f32_32x32x32_bf16 v[32:47], v[76:79], v[0:7], v94
  v_exp_f32 v10, v10
  v_exp_f32 v11, v11
  v_exp_f32 v12, v12
  v_exp_f32 v13, v13
  v_exp_f32 v14, v14
  v_exp_f32 v15, v15
  v_exp_f32 v16, v16
  v_exp_f32 v17, v17
  s_waitcnt lgkmcnt(1)
  v_smfmac_f32_32x32x32_bf16 v[32:47], v[80:83], v[8:15], v94
  v_exp_f32 v18, v18
  v_exp_f32 v19, v19
  v_exp_f32 v20, v20
  s_waitcnt lgkmcnt(0)
  v_mfma_f32_32x32x16_bf16 v[0:15], v[72:75], v[64:67], 0
  v_exp_f32 v21, v21
  v_exp_f32 v22, v22
  v_exp_f32 v23, v23
  v_exp_f32 v24, v24
  v_exp_f32 v25, v25
  v_smfmac_f32_32x32x32_bf16 v[48:63], v[76:79], v[16:23], v94
  s_mov_b64 exec, s[98:99]
  ds_read_b128 v[76:79], v93 offset:35840
  s_mov_b64 exec, -1
  v_exp_f32 v26, v26
  v_exp_f32 v27, v27
  v_exp_f32 v28, v28
  v_exp_f32 v29, v29
  v_exp_f32 v30, v30
  v_exp_f32 v31, v31
  v_exp_f32 v0, v0
  v_exp_f32 v1, v1
  v_smfmac_f32_32x32x32_bf16 v[48:63], v[80:83], v[24:31], v94
  s_mov_b64 exec, s[98:99]
  ds_read_b128 v[80:83], v93 offset:36352
  s_mov_b64 exec, -1
  s_waitcnt vmcnt(10)
  s_barrier
  v_exp_f32 v2, v2
  v_exp_f32 v3, v3
  v_exp_f32 v4, v4
  v_mfma_f32_32x32x16_bf16 v[16:31], v[72:75], v[68:71], 0
  ds_read_b128 v[72:75], v92 offset:49152
  v_exp_f32 v5, v5
  v_exp_f32 v6, v6
  v_exp_f32 v7, v7
  v_exp_f32 v8, v8
  v_exp_f32 v9, v9
  s_waitcnt lgkmcnt(2)
  v_smfmac_f32_32x32x32_bf16 v[32:47], v[76:79], v[0:7], v94
  v_exp_f32 v10, v10
  v_exp_f32 v11, v11
  v_exp_f32 v12, v12
  v_exp_f32 v13, v13
  v_exp_f32 v14, v14
  v_exp_f32 v15, v15
  v_exp_f32 v16, v16
  v_exp_f32 v17, v17
  s_waitcnt lgkmcnt(1)
  v_smfmac_f32_32x32x32_bf16 v[32:47], v[80:83], v[8:15], v94
  v_exp_f32 v18, v18
  v_exp_f32 v19, v19
  v_exp_f32 v20, v20
  s_waitcnt lgkmcnt(0)
  v_mfma_f32_32x32x16_bf16 v[0:15], v[72:75], v[64:67], 0
  s_mov_b32 m0, s95
  s_add_u32 s95, s95, 8192
  buffer_load_dwordx4 v97, s[16:19], s96 offen lds
  s_add_u32 s96, s96, 229376
  s_mov_b32 m0, s95
  s_add_u32 s95, s95, 8192
  buffer_load_dwordx4 v97, s[16:19], s96 offen lds
  s_add_u32 s96, s96, 229376
  v_exp_f32 v21, v21
  v_exp_f32 v22, v22
  v_exp_f32 v23, v23
  v_exp_f32 v24, v24
  v_exp_f32 v25, v25
  v_smfmac_f32_32x32x32_bf16 v[48:63], v[76:79], v[16:23], v94
  s_mov_b64 exec, s[98:99]
  ds_read_b128 v[76:79], v93 offset:49152
  s_mov_b64 exec, -1
  v_exp_f32 v26, v26
  v_exp_f32 v27, v27
  v_exp_f32 v28, v28
  v_exp_f32 v29, v29
  v_exp_f32 v30, v30
  v_exp_f32 v31, v31
  v_exp_f32 v0, v0
  v_exp_f32 v1, v1
  v_smfmac_f32_32x32x32_bf16 v[48:63], v[80:83], v[24:31], v94
  s_mov_b64 exec, s[98:99]
  ds_read_b128 v[80:83], v93 offset:49664
  s_mov_b64 exec, -1
  v_exp_f32 v2, v2
  v_exp_f32 v3, v3
  v_exp_f32 v4, v4
  v_mfma_f32_32x32x16_bf16 v[16:31], v[72:75], v[68:71], 0
  ds_read_b128 v[72:75], v92 offset:50176
  buffer_load_dword v100, v84, s[28:31], 0 offen sc1
  v_exp_f32 v5, v5
  v_exp_f32 v6, v6
  v_exp_f32 v7, v7
  v_exp_f32 v8, v8
  v_exp_f32 v9, v9
  s_waitcnt lgkmcnt(2)
  v_smfmac_f32_32x32x32_bf16 v[32:47], v[76:79], v[0:7], v94
  v_exp_f32 v10, v10
  v_exp_f32 v11, v11
  v_exp_f32 v12, v12
  v_exp_f32 v13, v13
  v_exp_f32 v14, v14
  v_exp_f32 v15, v15
  v_exp_f32 v16, v16
  v_exp_f32 v17, v17
  s_waitcnt lgkmcnt(1)
  v_smfmac_f32_32x32x32_bf16 v[32:47], v[80:83], v[8:15], v94
  v_exp_f32 v18, v18
  v_exp_f32 v19, v19
  v_exp_f32 v20, v20
  s_waitcnt lgkmcnt(0)
  v_mfma_f32_32x32x16_bf16 v[0:15], v[72:75], v[64:67], 0
  buffer_load_dword v100, v84, s[28:31], 0 offen offset:128 sc1
  v_exp_f32 v21, v21
  v_exp_f32 v22, v22
  v_exp_f32 v23, v23
  v_exp_f32 v24, v24
  v_exp_f32 v25, v25
  v_smfmac_f32_32x32x32_bf16 v[48:63], v[76:79], v[16:23], v94
  s_mov_b64 exec, s[98:99]
  ds_read_b128 v[76:79], v93 offset:50176
  s_mov_b64 exec, -1
  v_exp_f32 v26, v26
  v_exp_f32 v27, v27
  v_exp_f32 v28, v28
  v_exp_f32 v29, v29
  v_exp_f32 v30, v30
  v_exp_f32 v31, v31
  v_exp_f32 v0, v0
  v_exp_f32 v1, v1
  v_smfmac_f32_32x32x32_bf16 v[48:63], v[80:83], v[24:31], v94
  s_mov_b64 exec, s[98:99]
  ds_read_b128 v[80:83], v93 offset:50688
  s_mov_b64 exec, -1
  s_barrier
  v_exp_f32 v2, v2
  v_exp_f32 v3, v3
  v_exp_f32 v4, v4
  v_mfma_f32_32x32x16_bf16 v[16:31], v[72:75], v[68:71], 0
  ds_read_b128 v[72:75], v92 offset:51200
  v_exp_f32 v5, v5
  v_exp_f32 v6, v6
  v_exp_f32 v7, v7
  v_exp_f32 v8, v8
  v_exp_f32 v9, v9
  s_waitcnt lgkmcnt(2)
  v_smfmac_f32_32x32x32_bf16 v[32:47], v[76:79], v[0:7], v94
  v_exp_f32 v10, v10
  v_exp_f32 v11, v11
  v_exp_f32 v12, v12
  v_exp_f32 v13, v13
  v_exp_f32 v14, v14
  v_exp_f32 v15, v15
  v_exp_f32 v16, v16
  v_exp_f32 v17, v17
  s_waitcnt lgkmcnt(1)
  v_smfmac_f32_32x32x32_bf16 v[32:47], v[80:83], v[8:15], v94
  v_exp_f32 v18, v18
  v_exp_f32 v19, v19
  v_exp_f32 v20, v20
  s_waitcnt lgkmcnt(0)
  v_mfma_f32_32x32x16_bf16 v[0:15], v[72:75], v[64:67], 0
  s_mov_b32 m0, s95
  s_add_u32 s95, s95, 8192
  buffer_load_dwordx4 v97, s[16:19], s96 offen lds
  s_add_u32 s96, s96, 229376
  s_mov_b32 m0, s95
  s_add_u32 s95, s95, 8192
  buffer_load_dwordx4 v97, s[16:19], s96 offen lds
  s_add_u32 s96, s96, 229376
  v_exp_f32 v21, v21
  v_exp_f32 v22, v22
  v_exp_f32 v23, v23
  v_exp_f32 v24, v24
  v_exp_f32 v25, v25
  v_smfmac_f32_32x32x32_bf16 v[48:63], v[76:79], v[16:23], v94
  s_mov_b64 exec, s[98:99]
  ds_read_b128 v[76:79], v93 offset:51200
  s_mov_b64 exec, -1
  v_exp_f32 v26, v26
  v_exp_f32 v27, v27
  v_exp_f32 v28, v28
  v_exp_f32 v29, v29
  v_exp_f32 v30, v30
  v_exp_f32 v31, v31
  v_exp_f32 v0, v0
  v_exp_f32 v1, v1
  v_smfmac_f32_32x32x32_bf16 v[48:63], v[80:83], v[24:31], v94
  s_mov_b64 exec, s[98:99]
  ds_read_b128 v[80:83], v93 offset:51712
  s_mov_b64 exec, -1
  v_exp_f32 v2, v2
  v_exp_f32 v3, v3
  v_exp_f32 v4, v4
  v_mfma_f32_32x32x16_bf16 v[16:31], v[72:75], v[68:71], 0
  ds_read_b128 v[72:75], v92 offset:52224
  v_exp_f32 v5, v5
  v_exp_f32 v6, v6
  v_exp_f32 v7, v7
  v_exp_f32 v8, v8
  v_exp_f32 v9, v9
  s_waitcnt lgkmcnt(2)
  v_smfmac_f32_32x32x32_bf16 v[32:47], v[76:79], v[0:7], v94
  v_exp_f32 v10, v10
  v_exp_f32 v11, v11
  v_exp_f32 v12, v12
  v_exp_f32 v13, v13
  v_exp_f32 v14, v14
  v_exp_f32 v15, v15
  v_exp_f32 v16, v16
  v_exp_f32 v17, v17
  s_waitcnt lgkmcnt(1)
  v_smfmac_f32_32x32x32_bf16 v[32:47], v[80:83], v[8:15], v94
  v_exp_f32 v18, v18
  v_exp_f32 v19, v19
  v_exp_f32 v20, v20
  s_waitcnt lgkmcnt(0)
  v_mfma_f32_32x32x16_bf16 v[0:15], v[72:75], v[64:67], 0
  v_exp_f32 v21, v21
  v_exp_f32 v22, v22
  v_exp_f32 v23, v23
  v_exp_f32 v24, v24
  v_exp_f32 v25, v25
  v_smfmac_f32_32x32x32_bf16 v[48:63], v[76:79], v[16:23], v94
  s_mov_b64 exec, s[98:99]
  ds_read_b128 v[76:79], v93 offset:52224
  s_mov_b64 exec, -1
  v_exp_f32 v26, v26
  v_exp_f32 v27, v27
  v_exp_f32 v28, v28
  v_exp_f32 v29, v29
  v_exp_f32 v30, v30
  v_exp_f32 v31, v31
  v_exp_f32 v0, v0
  v_exp_f32 v1, v1
  v_smfmac_f32_32x32x32_bf16 v[48:63], v[80:83], v[24:31], v94
  s_mov_b64 exec, s[98:99]
  ds_read_b128 v[80:83], v93 offset:52736
  s_mov_b64 exec, -1
  v_exp_f32 v2, v2
  v_exp_f32 v3, v3
  v_exp_f32 v4, v4
  v_mfma_f32_32x32x16_bf16 v[16:31], v[72:75], v[68:71], 0
  s_lshl_b32 s50, s36, 11
  s_add_u32 s50, s50, 65536
  v_add_u32 v84, s50, v95
  s_xor_b32 s50, s50, 8192
  v_add_u32 v85, s50, v95
  s_lshl_b32 s50, s36, 8
  s_add_u32 s50, s50, 139264
  v_lshl_add_u32 v86, v96, 2, s50
  s_xor_b32 s50, s50, 1024
  v_lshl_add_u32 v87, v96, 2, s50
  s_and_b32 s46, s36, 1
  s_lshl_b32 s46, s46, 1
  s_lshr_b32 s47, s36, 2
  s_add_u32 s46, s46, s47
  s_lshl_b32 s46, s46, 15
  s_lshl_b32 s47, s38, 10
  s_add_u32 s46, s46, s47
  s_add_u32 s46, s46, s45
  s_add_u32 s46, s46, s62
  s_add_u32 s46, s46, 458752
  v_mov_b32 v88, 0x30800000
  v_mov_b32 v89, 0x5f800000
  v_mov_b32 v101, 0x207
  s_and_b32 s51, s36, 3
  s_lshl_b32 s51, s51, 1
  s_lshr_b32 s50, s36, 2
  s_add_u32 s51, s51, s50
  s_lshl_b32 s51, s51, 7
  s_lshl_b32 s50, s37, 10
  s_add_u32 s50, s50, s51
  s_lshl_b32 s51, s38, 2
  s_add_u32 s50, s50, s51
  s_add_u32 s51, s41, 2
  v_mov_b32 v90, s50
  v_mov_b32 v91, s51
  v_exp_f32 v5, v5
  v_exp_f32 v6, v6
  v_exp_f32 v7, v7
  v_exp_f32 v8, v8
  v_exp_f32 v9, v9
  s_waitcnt lgkmcnt(1)
  v_smfmac_f32_32x32x32_bf16 v[32:47], v[76:79], v[0:7], v94
  v_exp_f32 v10, v10
  v_exp_f32 v11, v11
  v_exp_f32 v12, v12
  v_exp_f32 v13, v13
  v_exp_f32 v14, v14
  v_exp_f32 v15, v15
  v_exp_f32 v16, v16
  v_exp_f32 v17, v17
  s_waitcnt lgkmcnt(0)
  v_smfmac_f32_32x32x32_bf16 v[32:47], v[80:83], v[8:15], v94
  v_exp_f32 v18, v18
  v_exp_f32 v19, v19
  v_exp_f32 v20, v20
  v_exp_f32 v21, v21
  v_exp_f32 v22, v22
  v_exp_f32 v23, v23
  v_exp_f32 v24, v24
  v_exp_f32 v25, v25
  v_smfmac_f32_32x32x32_bf16 v[48:63], v[76:79], v[16:23], v94
  v_exp_f32 v26, v26
  v_exp_f32 v27, v27
  v_exp_f32 v28, v28
  v_exp_f32 v29, v29
  v_exp_f32 v30, v30
  v_exp_f32 v31, v31
  s_nop 1
  v_smfmac_f32_32x32x32_bf16 v[48:63], v[80:83], v[24:31], v94
  s_nop 11
  ds_write_b128 v84, v[32:35]
  ds_write_b128 v84, v[36:39] offset:1024
  ds_write_b32 v86, v40
  v_mov_b32 v32, v48
  v_mov_b32 v33, v49
  v_mov_b32 v34, v50
  v_mov_b32 v35, v51
  v_mov_b32 v36, v52
  v_mov_b32 v37, v53
  v_mov_b32 v38, v54
  v_mov_b32 v39, v55
  v_mov_b32 v40, v56
  v_mov_b32 v64, v68
  v_mov_b32 v65, v69
  v_mov_b32 v66, v70
  v_mov_b32 v67, v71
ALJ_133:
  s_waitcnt lgkmcnt(0)
  s_barrier
  ds_read_b128 v[4:7], v85
  ds_read_b128 v[8:11], v85 offset:1024
  ds_read_b32 v12, v87
  s_waitcnt lgkmcnt(2)
  v_add_f32 v32, v32, v4
  v_add_f32 v33, v33, v5
  v_add_f32 v34, v34, v6
  v_add_f32 v35, v35, v7
  s_waitcnt lgkmcnt(1)
  v_add_f32 v36, v36, v8
  v_add_f32 v37, v37, v9
  v_add_f32 v38, v38, v10
  v_add_f32 v39, v39, v11
  s_waitcnt lgkmcnt(0)
  v_add_f32 v40, v40, v12
  v_mov_b32 v41, v40
  s_nop 1
  v_permlane32_swap_b32 v40, v41
  v_cmp_nle_f32 s[50:51], v88, v40
  v_cmp_nge_f32 vcc, v89, v40
  s_nop 0
  s_or_b64 s[50:51], s[50:51], vcc
  v_add_f32 v4, abs(v32), abs(v33)
  v_add_f32 v5, abs(v34), abs(v35)
  v_add_f32 v6, abs(v36), abs(v37)
  v_add_f32 v7, abs(v38), abs(v39)
  v_add_f32 v4, v4, v5
  v_add_f32 v6, v6, v7
  v_add_f32 v4, v4, v6
  v_cmp_class_f32 vcc, v4, v101
  s_nop 0
  s_or_b64 s[50:51], s[50:51], vcc
  s_cmp_lg_u64 s[50:51], 0
  s_cbranch_scc1 ASLW_157
ANRM_156:
  v_rcp_f32 v0, v40
  s_nop 0
  v_mul_f32 v32, v0, v32
  v_mul_f32 v33, v0, v33
  v_mul_f32 v34, v0, v34
  v_mul_f32 v35, v0, v35
  v_mul_f32 v36, v0, v36
  v_mul_f32 v37, v0, v37
  v_mul_f32 v38, v0, v38
  v_mul_f32 v39, v0, v39
  v_cvt_pk_bf16_f32 v32, v32, v33
  v_cvt_pk_bf16_f32 v33, v34, v35
  v_cvt_pk_bf16_f32 v34, v36, v37
  v_cvt_pk_bf16_f32 v35, v38, v39
  s_cmp_lg_u32 s39, 0
  s_cbranch_scc1 STS_158
  buffer_store_dwordx4 v[32:35], v95, s[28:31], s46 offen
STD_159:
  s_waitcnt vmcnt(0)
  s_mov_b64 exec, 1
  s_cmp_lg_u32 s39, 0
  s_cbranch_scc1 STS_160
  global_store_dword v90, v91, s[34:35]
STD_161:
  s_mov_b64 exec, -1
  s_barrier
  s_cmp_lg_u32 s40, 0
  s_cbranch_scc1 CW_167
  v_mbcnt_lo_u32_b32 v9, -1, 0
  v_mbcnt_hi_u32_b32 v9, -1, v9
  v_bfe_u32 v13, v9, 2, 2
  v_bfe_u32 v14, v9, 4, 1
  v_lshlrev_b32 v14, 5, v14
  v_and_b32 v15, 3, v9
  v_lshl_add_u32 v14, v15, 3, v14
  v_lshrrev_b32 v15, 5, v9
  s_and_b32 s51, s36, 1
  v_lshl_add_u32 v52, v15, 2, v13
  v_lshlrev_b32 v52, 7, v52
  v_add_u32 v52, v52, v14
  v_lshrrev_b32 v53, 1, v13
  v_xor_b32 v53, s51, v53
  v_lshl_add_u32 v52, v53, 6, v52
  v_xor_b32 v53, 64, v52
  s_cmp_lt_u32 s36, 6
  s_cselect_b32 s51, 65536, 0
  s_add_u32 s51, s51, 30720
  v_add_u32 v52, s51, v52
  v_add_u32 v53, 32768, v52
  v_mov_b32 v44, 0
  v_mov_b32 v45, 0
  v_mov_b32 v46, 0
  v_mov_b32 v47, 0
  v_mov_b32 v48, 0
  v_mov_b32 v49, 0
  v_mov_b32 v50, 0
  v_mov_b32 v51, 0
  s_cmp_ge_u32 s36, 6
  s_cbranch_scc1 CW_168
  ds_read_b64_tr_b16 v[20:21], v52 offset:0
  ds_read_b64_tr_b16 v[22:23], v52 offset:1024
  ds_read_b64_tr_b16 v[24:25], v52 offset:2048
  ds_read_b64_tr_b16 v[26:27], v52 offset:3072
  ds_read_b64_tr_b16 v[28:29], v52 offset:4096
  ds_read_b64_tr_b16 v[30:31], v52 offset:5120
  ds_read_b64_tr_b16 v[32:33], v52 offset:6144
  ds_read_b64_tr_b16 v[34:35], v52 offset:7168
  ds_read_b64_tr_b16 v[36:37], v52 offset:8192
  ds_read_b64_tr_b16 v[38:39], v52 offset:9216
  s_waitcnt lgkmcnt(9)
  v_dot2c_f32_bf16 v44, 0x3f803f80, v20
  v_dot2c_f32_bf16 v45, 0x3f803f80, v21
  s_waitcnt lgkmcnt(8)
  v_dot2c_f32_bf16 v46, 0x3f803f80, v22
  v_dot2c_f32_bf16 v47, 0x3f803f80, v23
  ds_read_b64_tr_b16 v[20:21], v52 offset:10240
  ds_read_b64_tr_b16 v[22:23], v52 offset:11264
  s_waitcnt lgkmcnt(9)
  v_dot2c_f32_bf16 v48, 0x3f803f80, v24
  v_dot2c_f32_bf16 v49, 0x3f803f80, v25
  s_waitcnt lgkmcnt(8)
  v_dot2c_f32_bf16 v50, 0x3f803f80, v26
  v_dot2c_f32_bf16 v51, 0x3f803f80, v27
  ds_read_b64_tr_b16 v[24:25], v52 offset:12288
  ds_read_b64_tr_b16 v[26:27], v52 offset:13312
  s_waitcnt lgkmcnt(9)
  v_dot2c_f32_bf16 v44, 0x3f803f80, v28
  v_dot2c_f32_bf16 v45, 0x3f803f80, v29
  s_waitcnt lgkmcnt(8)
  v_dot2c_f32_bf16 v46, 0x3f803f80, v30
  v_dot2c_f32_bf16 v47, 0x3f803f80, v31
  ds_read_b64_tr_b16 v[28:29], v52 offset:14336
  ds_read_b64_tr_b16 v[30:31], v52 offset:15360
  s_waitcnt lgkmcnt(9)
  v_dot2c_f32_bf16 v48, 0x3f803f80, v32
  v_dot2c_f32_bf16 v49, 0x3f803f80, v33
  s_waitcnt lgkmcnt(8)
  v_dot2c_f32_bf16 v50, 0x3f803f80, v34
  v_dot2c_f32_bf16 v51, 0x3f803f80, v35
  ds_read_b64_tr_b16 v[32:33], v52 offset:16384
  ds_read_b64_tr_b16 v[34:35], v52 offset:17408
  s_waitcnt lgkmcnt(9)
  v_dot2c_f32_bf16 v44, 0x3f803f80, v36
  v_dot2c_f32_bf16 v45, 0x3f803f80, v37
  s_waitcnt lgkmcnt(8)
  v_dot2c_f32_bf16 v46, 0x3f803f80, v38
  v_dot2c_f32_bf16 v47, 0x3f803f80, v39
  ds_read_b64_tr_b16 v[36:37], v52 offset:18432
  ds_read_b64_tr_b16 v[38:39], v52 offset:19456
  s_waitcnt lgkmcnt(9)
  v_dot2c_f32_bf16 v48, 0x3f803f80, v20
  v_dot2c_f32_bf16 v49, 0x3f803f80, v21
  s_waitcnt lgkmcnt(8)
  v_dot2c_f32_bf16 v50, 0x3f803f80, v22
  v_dot2c_f32_bf16 v51, 0x3f803f80, v23
  ds_read_b64_tr_b16 v[20:21], v52 offset:20480
  ds_read_b64_tr_b16 v[22:23], v52 offset:21504
  s_waitcnt lgkmcnt(9)
  v_dot2c_f32_bf16 v44, 0x3f803f80, v24
  v_dot2c_f32_bf16 v45, 0x3f803f80, v25
  s_waitcnt lgkmcnt(8)
  v_dot2c_f32_bf16 v46, 0x3f803f80, v26
  v_dot2c_f32_bf16 v47, 0x3f803f80, v27
  ds_read_b64_tr_b16 v[24:25], v52 offset:22528
  ds_read_b64_tr_b16 v[26:27], v52 offset:23552
  s_waitcnt lgkmcnt(9)
  v_dot2c_f32_bf16 v48, 0x3f803f80, v28
  v_dot2c_f32_bf16 v49, 0x3f803f80, v29
  s_waitcnt lgkmcnt(8)
  v_dot2c_f32_bf16 v50, 0x3f803f80, v30
  v_dot2c_f32_bf16 v51, 0x3f803f80, v31
  ds_read_b64_tr_b16 v[28:29], v52 offset:24576
  ds_read_b64_tr_b16 v[30:31], v52 offset:25600
  s_waitcnt lgkmcnt(9)
  v_dot2c_f32_bf16 v44, 0x3f803f80, v32
  v_dot2c_f32_bf16 v45, 0x3f803f80, v33
  s_waitcnt lgkmcnt(8)
  v_dot2c_f32_bf16 v46, 0x3f803f80, v34
  v_dot2c_f32_bf16 v47, 0x3f803f80, v35
  ds_read_b64_tr_b16 v[32:33], v52 offset:26624
  ds_read_b64_tr_b16 v[34:35], v52 offset:27648
  s_waitcnt lgkmcnt(9)
  v_dot2c_f32_bf16 v48, 0x3f803f80, v36
  v_dot2c_f32_bf16 v49, 0x3f803f80, v37
  s_waitcnt lgkmcnt(8)
  v_dot2c_f32_bf16 v50, 0x3f803f80, v38
  v_dot2c_f32_bf16 v51, 0x3f803f80, v39
  ds_read_b64_tr_b16 v[36:37], v52 offset:28672
  ds_read_b64_tr_b16 v[38:39], v52 offset:29696
  s_waitcnt lgkmcnt(9)
  v_dot2c_f32_bf16 v44, 0x3f803f80, v20
  v_dot2c_f32_bf16 v45, 0x3f803f80, v21
  s_waitcnt lgkmcnt(8)
  v_dot2c_f32_bf16 v46, 0x3f803f80, v22
  v_dot2c_f32_bf16 v47, 0x3f803f80, v23
  ds_read_b64_tr_b16 v[20:21], v52 offset:30720
  ds_read_b64_tr_b16 v[22:23], v52 offset:31744
  s_waitcnt lgkmcnt(9)
  v_dot2c_f32_bf16 v48, 0x3f803f80, v24
  v_dot2c_f32_bf16 v49, 0x3f803f80, v25
  s_waitcnt lgkmcnt(8)
  v_dot2c_f32_bf16 v50, 0x3f803f80, v26
  v_dot2c_f32_bf16 v51, 0x3f803f80, v27
  ds_read_b64_tr_b16 v[24:25], v53 offset:0
  ds_read_b64_tr_b16 v[26:27], v53 offset:1024
  s_waitcnt lgkmcnt(9)
  v_dot2c_f32_bf16 v44, 0x3f803f80, v28
  v_dot2c_f32_bf16 v45, 0x3f803f80, v29
  s_waitcnt lgkmcnt(8)
  v_dot2c_f32_bf16 v46, 0x3f803f80, v30
  v_dot2c_f32_bf16 v47, 0x3f803f80, v31
  ds_read_b64_tr_b16 v[28:29], v53 offset:2048
  ds_read_b64_tr_b16 v[30:31], v53 offset:3072
  s_waitcnt lgkmcnt(9)
  v_dot2c_f32_bf16 v48, 0x3f803f80, v32
  v_dot2c_f32_bf16 v49, 0x3f803f80, v33
  s_waitcnt lgkmcnt(8)
  v_dot2c_f32_bf16 v50, 0x3f803f80, v34
  v_dot2c_f32_bf16 v51, 0x3f803f80, v35
  ds_read_b64_tr_b16 v[32:33], v53 offset:4096
  ds_read_b64_tr_b16 v[34:35], v53 offset:5120
  s_waitcnt lgkmcnt(9)
  v_dot2c_f32_bf16 v44, 0x3f803f80, v36
  v_dot2c_f32_bf16 v45, 0x3f803f80, v37
  s_waitcnt lgkmcnt(8)
  v_dot2c_f32_bf16 v46, 0x3f803f80, v38
  v_dot2c_f32_bf16 v47, 0x3f803f80, v39
  ds_read_b64_tr_b16 v[36:37], v53 offset:6144
  ds_read_b64_tr_b16 v[38:39], v53 offset:7168
  s_waitcnt lgkmcnt(9)
  v_dot2c_f32_bf16 v48, 0x3f803f80, v20
  v_dot2c_f32_bf16 v49, 0x3f803f80, v21
  s_waitcnt lgkmcnt(8)
  v_dot2c_f32_bf16 v50, 0x3f803f80, v22
  v_dot2c_f32_bf16 v51, 0x3f803f80, v23
  ds_read_b64_tr_b16 v[20:21], v53 offset:8192
  ds_read_b64_tr_b16 v[22:23], v53 offset:9216
  s_waitcnt lgkmcnt(9)
  v_dot2c_f32_bf16 v44, 0x3f803f80, v24
  v_dot2c_f32_bf16 v45, 0x3f803f80, v25
  s_waitcnt lgkmcnt(8)
  v_dot2c_f32_bf16 v46, 0x3f803f80, v26
  v_dot2c_f32_bf16 v47, 0x3f803f80, v27
  s_waitcnt lgkmcnt(7)
  v_dot2c_f32_bf16 v48, 0x3f803f80, v28
  v_dot2c_f32_bf16 v49, 0x3f803f80, v29
  s_waitcnt lgkmcnt(6)
  v_dot2c_f32_bf16 v50, 0x3f803f80, v30
  v_dot2c_f32_bf16 v51, 0x3f803f80, v31
  s_waitcnt lgkmcnt(5)
  v_dot2c_f32_bf16 v44, 0x3f803f80, v32
  v_dot2c_f32_bf16 v45, 0x3f803f80, v33
  s_waitcnt lgkmcnt(4)
  v_dot2c_f32_bf16 v46, 0x3f803f80, v34
  v_dot2c_f32_bf16 v47, 0x3f803f80, v35
  s_waitcnt lgkmcnt(3)
  v_dot2c_f32_bf16 v48, 0x3f803f80, v36
  v_dot2c_f32_bf16 v49, 0x3f803f80, v37
  s_waitcnt lgkmcnt(2)
  v_dot2c_f32_bf16 v50, 0x3f803f80, v38
  v_dot2c_f32_bf16 v51, 0x3f803f80, v39
  s_waitcnt lgkmcnt(1)
  v_dot2c_f32_bf16 v44, 0x3f803f80, v20
  v_dot2c_f32_bf16 v45, 0x3f803f80, v21
  s_waitcnt lgkmcnt(0)
  v_dot2c_f32_bf16 v46, 0x3f803f80, v22
  v_dot2c_f32_bf16 v47, 0x3f803f80, v23
  s_branch CW_169
CW_168:
  ds_read_b64_tr_b16 v[20:21], v53 offset:18432
  ds_read_b64_tr_b16 v[22:23], v53 offset:19456
  ds_read_b64_tr_b16 v[24:25], v53 offset:20480
  ds_read_b64_tr_b16 v[26:27], v53 offset:21504
  ds_read_b64_tr_b16 v[28:29], v53 offset:22528
  ds_read_b64_tr_b16 v[30:31], v53 offset:23552
  ds_read_b64_tr_b16 v[32:33], v53 offset:24576
  ds_read_b64_tr_b16 v[34:35], v53 offset:25600
  ds_read_b64_tr_b16 v[36:37], v53 offset:26624
  ds_read_b64_tr_b16 v[38:39], v53 offset:27648
  s_waitcnt lgkmcnt(9)
  v_dot2c_f32_bf16 v44, 0x3f803f80, v20
  v_dot2c_f32_bf16 v45, 0x3f803f80, v21
  s_waitcnt lgkmcnt(8)
  v_dot2c_f32_bf16 v46, 0x3f803f80, v22
  v_dot2c_f32_bf16 v47, 0x3f803f80, v23
  ds_read_b64_tr_b16 v[20:21], v53 offset:28672
  ds_read_b64_tr_b16 v[22:23], v53 offset:29696
  s_waitcnt lgkmcnt(9)
  v_dot2c_f32_bf16 v48, 0x3f803f80, v24
  v_dot2c_f32_bf16 v49, 0x3f803f80, v25
  s_waitcnt lgkmcnt(8)
  v_dot2c_f32_bf16 v50, 0x3f803f80, v26
  v_dot2c_f32_bf16 v51, 0x3f803f80, v27
  ds_read_b64_tr_b16 v[24:25], v53 offset:30720
  ds_read_b64_tr_b16 v[26:27], v53 offset:31744
  s_waitcnt lgkmcnt(9)
  v_dot2c_f32_bf16 v44, 0x3f803f80, v28
  v_dot2c_f32_bf16 v45, 0x3f803f80, v29
  s_waitcnt lgkmcnt(8)
  v_dot2c_f32_bf16 v46, 0x3f803f80, v30
  v_dot2c_f32_bf16 v47, 0x3f803f80, v31
  s_waitcnt lgkmcnt(7)
  v_dot2c_f32_bf16 v48, 0x3f803f80, v32
  v_dot2c_f32_bf16 v49, 0x3f803f80, v33
  s_waitcnt lgkmcnt(6)
  v_dot2c_f32_bf16 v50, 0x3f803f80, v34
  v_dot2c_f32_bf16 v51, 0x3f803f80, v35
  s_waitcnt lgkmcnt(5)
  v_dot2c_f32_bf16 v44, 0x3f803f80, v36
  v_dot2c_f32_bf16 v45, 0x3f803f80, v37
  s_waitcnt lgkmcnt(4)
  v_dot2c_f32_bf16 v46, 0x3f803f80, v38
  v_dot2c_f32_bf16 v47, 0x3f803f80, v39
  s_waitcnt lgkmcnt(3)
  v_dot2c_f32_bf16 v48, 0x3f803f80, v20
  v_dot2c_f32_bf16 v49, 0x3f803f80, v21
  s_waitcnt lgkmcnt(2)
  v_dot2c_f32_bf16 v50, 0x3f803f80, v22
  v_dot2c_f32_bf16 v51, 0x3f803f80, v23
  s_waitcnt lgkmcnt(1)
  v_dot2c_f32_bf16 v44, 0x3f803f80, v24
  v_dot2c_f32_bf16 v45, 0x3f803f80, v25
  s_waitcnt lgkmcnt(0)
  v_dot2c_f32_bf16 v46, 0x3f803f80, v26
  v_dot2c_f32_bf16 v47, 0x3f803f80, v27
CW_169:
CW_167:
  s_barrier
  s_cmp_eq_u32 s36, 4
  s_cbranch_scc1 OD_165
  v_mbcnt_lo_u32_b32 v9, -1, 0
  v_mbcnt_hi_u32_b32 v9, -1, v9
  v_lshrrev_b32 v13, 3, v9
  v_and_b32 v14, 7, v9
  v_lshlrev_b32 v15, 1, v13
  v_and_b32 v15, 4, v15
  v_xor_b32 v14, v14, v15
  v_mul_u32_u24 v13, 3584, v13
  v_lshl_add_u32 v9, v14, 4, v13
  s_and_b32 s55, s38, 15
  s_min_u32 s55, s55, 13
  s_lshl_b32 s55, s55, 8
  s_add_u32 s56, s36, 101
  s_mov_b32 s52, s56
  s_cmp_ge_u32 s52, 128
  s_cbranch_scc1 DX_172
DL_171:
  s_lshl_b32 s53, s52, 10
  s_add_u32 m0, s53, 30720
  s_and_b32 s53, s52, 63
  s_mul_i32 s53, s53, 28672
  s_add_u32 s53, s53, s55
  s_cmp_lt_u32 s52, 64
  s_cselect_b32 s51, 128, 0
  s_add_u32 s53, s53, s51
  buffer_load_dwordx4 v9, s[16:19], s53 offen lds
  s_add_u32 s52, s52, 3
  s_cmp_lt_u32 s52, 128
  s_cbranch_scc1 DL_171
DX_172:
OD_165:
  s_cmp_lg_u32 s40, 0
  s_cbranch_scc1 ON_170
  s_and_b32 s50, s38, 15
  s_lshr_b32 s51, s50, 1
  s_and_b32 s50, s50, 1
  s_lshl_b32 s53, s50, 10
  s_lshl_b32 s54, s51, 7
  s_add_u32 s53, s53, s54
  s_lshl_b32 s55, s50, 6
  s_add_u32 s54, s54, s55
  s_add_u32 s54, s54, 2048
  v_mbcnt_lo_u32_b32 v13, -1, 0
  v_mbcnt_hi_u32_b32 v13, -1, v13
  s_lshr_b32 s50, s38, 4
  s_cmp_eq_u32 s50, 0
  s_cselect_b32 s53, s53, s54
  s_sub_u32 s50, s36, 4
  s_mul_i32 s50, s50, 40
  s_add_u32 s50, s50, 0
  v_add_u32 v13, s50, v13
  v_mul_u32_u24 v13, 3072, v13
  s_mov_b32 exec_lo, 0xffffffff
  s_mov_b32 exec_hi, 0xff
  buffer_load_dword v40, v13, s[8:11], s53 offen
  s_mov_b64 exec, -1
ON_170:
  s_barrier
  s_waitcnt vmcnt(0)
  s_barrier
  s_barrier
  s_cmp_lg_u32 s40, 0
  s_cbranch_scc1 CW_179
  s_cmp_ge_u32 s36, 6
  s_cbranch_scc1 CW_180
  ds_read_b64_tr_b16 v[20:21], v53 offset:10240
  ds_read_b64_tr_b16 v[22:23], v53 offset:11264
  ds_read_b64_tr_b16 v[24:25], v53 offset:12288
  ds_read_b64_tr_b16 v[26:27], v53 offset:13312
  ds_read_b64_tr_b16 v[28:29], v53 offset:14336
  ds_read_b64_tr_b16 v[30:31], v53 offset:15360
  ds_read_b64_tr_b16 v[32:33], v53 offset:16384
  ds_read_b64_tr_b16 v[34:35], v53 offset:17408
  ds_read_b64_tr_b16 v[36:37], v53 offset:18432
  ds_read_b64_tr_b16 v[38:39], v53 offset:19456
  s_waitcnt lgkmcnt(9)
  v_dot2c_f32_bf16 v44, 0x3f803f80, v20
  v_dot2c_f32_bf16 v45, 0x3f803f80, v21
  s_waitcnt lgkmcnt(8)
  v_dot2c_f32_bf16 v46, 0x3f803f80, v22
  v_dot2c_f32_bf16 v47, 0x3f803f80, v23
  ds_read_b64_tr_b16 v[20:21], v53 offset:20480
  ds_read_b64_tr_b16 v[22:23], v53 offset:21504
  s_waitcnt lgkmcnt(9)
  v_dot2c_f32_bf16 v48, 0x3f803f80, v24
  v_dot2c_f32_bf16 v49, 0x3f803f80, v25
  s_waitcnt lgkmcnt(8)
  v_dot2c_f32_bf16 v50, 0x3f803f80, v26
  v_dot2c_f32_bf16 v51, 0x3f803f80, v27
  ds_read_b64_tr_b16 v[24:25], v53 offset:22528
  ds_read_b64_tr_b16 v[26:27], v53 offset:23552
  s_waitcnt lgkmcnt(9)
  v_dot2c_f32_bf16 v44, 0x3f803f80, v28
  v_dot2c_f32_bf16 v45, 0x3f803f80, v29
  s_waitcnt lgkmcnt(8)
  v_dot2c_f32_bf16 v46, 0x3f803f80, v30
  v_dot2c_f32_bf16 v47, 0x3f803f80, v31
  ds_read_b64_tr_b16 v[28:29], v53 offset:24576
  ds_read_b64_tr_b16 v[30:31], v53 offset:25600
  s_waitcnt lgkmcnt(9)
  v_dot2c_f32_bf16 v48, 0x3f803f80, v32
  v_dot2c_f32_bf16 v49, 0x3f803f80, v33
  s_waitcnt lgkmcnt(8)
  v_dot2c_f32_bf16 v50, 0x3f803f80, v34
  v_dot2c_f32_bf16 v51, 0x3f803f80, v35
  ds_read_b64_tr_b16 v[32:33], v53 offset:26624
  ds_read_b64_tr_b16 v[34:35], v53 offset:27648
  s_waitcnt lgkmcnt(9)
  v_dot2c_f32_bf16 v44, 0x3f803f80, v36
  v_dot2c_f32_bf16 v45, 0x3f803f80, v37
  s_waitcnt lgkmcnt(8)
  v_dot2c_f32_bf16 v46, 0x3f803f80, v38
  v_dot2c_f32_bf16 v47, 0x3f803f80, v39
  ds_read_b64_tr_b16 v[36:37], v53 offset:28672
  ds_read_b64_tr_b16 v[38:39], v53 offset:29696
  s_waitcnt lgkmcnt(9)
  v_dot2c_f32_bf16 v48, 0x3f803f80, v20
  v_dot2c_f32_bf16 v49, 0x3f803f80, v21
  s_waitcnt lgkmcnt(8)
  v_dot2c_f32_bf16 v50, 0x3f803f80, v22
  v_dot2c_f32_bf16 v51, 0x3f803f80, v23
  ds_read_b64_tr_b16 v[20:21], v53 offset:30720
  ds_read_b64_tr_b16 v[22:23], v53 offset:31744
  s_waitcnt lgkmcnt(9)
  v_dot2c_f32_bf16 v44, 0x3f803f80, v24
  v_dot2c_f32_bf16 v45, 0x3f803f80, v25
  s_waitcnt lgkmcnt(8)
  v_dot2c_f32_bf16 v46, 0x3f803f80, v26
  v_dot2c_f32_bf16 v47, 0x3f803f80, v27
  s_waitcnt lgkmcnt(7)
  v_dot2c_f32_bf16 v48, 0x3f803f80, v28
  v_dot2c_f32_bf16 v49, 0x3f803f80, v29
  s_waitcnt lgkmcnt(6)
  v_dot2c_f32_bf16 v50, 0x3f803f80, v30
  v_dot2c_f32_bf16 v51, 0x3f803f80, v31
  s_waitcnt lgkmcnt(5)
  v_dot2c_f32_bf16 v44, 0x3f803f80, v32
  v_dot2c_f32_bf16 v45, 0x3f803f80, v33
  s_waitcnt lgkmcnt(4)
  v_dot2c_f32_bf16 v46, 0x3f803f80, v34
  v_dot2c_f32_bf16 v47, 0x3f803f80, v35
  s_waitcnt lgkmcnt(3)
  v_dot2c_f32_bf16 v48, 0x3f803f80, v36
  v_dot2c_f32_bf16 v49, 0x3f803f80, v37
  s_waitcnt lgkmcnt(2)
  v_dot2c_f32_bf16 v50, 0x3f803f80, v38
  v_dot2c_f32_bf16 v51, 0x3f803f80, v39
  s_waitcnt lgkmcnt(1)
  v_dot2c_f32_bf16 v44, 0x3f803f80, v20
  v_dot2c_f32_bf16 v45, 0x3f803f80, v21
  s_waitcnt lgkmcnt(0)
  v_dot2c_f32_bf16 v46, 0x3f803f80, v22
  v_dot2c_f32_bf16 v47, 0x3f803f80, v23
  s_branch CW_181
CW_180:
  ds_read_b64_tr_b16 v[20:21], v52 offset:0
  ds_read_b64_tr_b16 v[22:23], v52 offset:1024
  ds_read_b64_tr_b16 v[24:25], v52 offset:2048
  ds_read_b64_tr_b16 v[26:27], v52 offset:3072
  ds_read_b64_tr_b16 v[28:29], v52 offset:4096
  ds_read_b64_tr_b16 v[30:31], v52 offset:5120
  ds_read_b64_tr_b16 v[32:33], v52 offset:6144
  ds_read_b64_tr_b16 v[34:35], v52 offset:7168
  ds_read_b64_tr_b16 v[36:37], v52 offset:8192
  ds_read_b64_tr_b16 v[38:39], v52 offset:9216
  s_waitcnt lgkmcnt(9)
  v_dot2c_f32_bf16 v44, 0x3f803f80, v20
  v_dot2c_f32_bf16 v45, 0x3f803f80, v21
  s_waitcnt lgkmcnt(8)
  v_dot2c_f32_bf16 v46, 0x3f803f80, v22
  v_dot2c_f32_bf16 v47, 0x3f803f80, v23
  ds_read_b64_tr_b16 v[20:21], v52 offset:10240
  ds_read_b64_tr_b16 v[22:23], v52 offset:11264
  s_waitcnt lgkmcnt(9)
  v_dot2c_f32_bf16 v48, 0x3f803f80, v24
  v_dot2c_f32_bf16 v49, 0x3f803f80, v25
  s_waitcnt lgkmcnt(8)
  v_dot2c_f32_bf16 v50, 0x3f803f80, v26
  v_dot2c_f32_bf16 v51, 0x3f803f80, v27
  ds_read_b64_tr_b16 v[24:25], v52 offset:12288
  ds_read_b64_tr_b16 v[26:27], v52 offset:13312
  s_waitcnt lgkmcnt(9)
  v_dot2c_f32_bf16 v44, 0x3f803f80, v28
  v_dot2c_f32_bf16 v45, 0x3f803f80, v29
  s_waitcnt lgkmcnt(8)
  v_dot2c_f32_bf16 v46, 0x3f803f80, v30
  v_dot2c_f32_bf16 v47, 0x3f803f80, v31
  ds_read_b64_tr_b16 v[28:29], v52 offset:14336
  ds_read_b64_tr_b16 v[30:31], v52 offset:15360
  s_waitcnt lgkmcnt(9)
  v_dot2c_f32_bf16 v48, 0x3f803f80, v32
  v_dot2c_f32_bf16 v49, 0x3f803f80, v33
  s_waitcnt lgkmcnt(8)
  v_dot2c_f32_bf16 v50, 0x3f803f80, v34
  v_dot2c_f32_bf16 v51, 0x3f803f80, v35
  ds_read_b64_tr_b16 v[32:33], v52 offset:16384
  ds_read_b64_tr_b16 v[34:35], v52 offset:17408
  s_waitcnt lgkmcnt(9)
  v_dot2c_f32_bf16 v44, 0x3f803f80, v36
  v_dot2c_f32_bf16 v45, 0x3f803f80, v37
  s_waitcnt lgkmcnt(8)
  v_dot2c_f32_bf16 v46, 0x3f803f80, v38
  v_dot2c_f32_bf16 v47, 0x3f803f80, v39
  ds_read_b64_tr_b16 v[36:37], v52 offset:18432
  ds_read_b64_tr_b16 v[38:39], v52 offset:19456
  s_waitcnt lgkmcnt(9)
  v_dot2c_f32_bf16 v48, 0x3f803f80, v20
  v_dot2c_f32_bf16 v49, 0x3f803f80, v21
  s_waitcnt lgkmcnt(8)
  v_dot2c_f32_bf16 v50, 0x3f803f80, v22
  v_dot2c_f32_bf16 v51, 0x3f803f80, v23
  ds_read_b64_tr_b16 v[20:21], v52 offset:20480
  ds_read_b64_tr_b16 v[22:23], v52 offset:21504
  s_waitcnt lgkmcnt(9)
  v_dot2c_f32_bf16 v44, 0x3f803f80, v24
  v_dot2c_f32_bf16 v45, 0x3f803f80, v25
  s_waitcnt lgkmcnt(8)
  v_dot2c_f32_bf16 v46, 0x3f803f80, v26
  v_dot2c_f32_bf16 v47, 0x3f803f80, v27
  ds_read_b64_tr_b16 v[24:25], v52 offset:22528
  ds_read_b64_tr_b16 v[26:27], v52 offset:23552
  s_waitcnt lgkmcnt(9)
  v_dot2c_f32_bf16 v48, 0x3f803f80, v28
  v_dot2c_f32_bf16 v49, 0x3f803f80, v29
  s_waitcnt lgkmcnt(8)
  v_dot2c_f32_bf16 v50, 0x3f803f80, v30
  v_dot2c_f32_bf16 v51, 0x3f803f80, v31
  ds_read_b64_tr_b16 v[28:29], v52 offset:24576
  ds_read_b64_tr_b16 v[30:31], v52 offset:25600
  s_waitcnt lgkmcnt(9)
  v_dot2c_f32_bf16 v44, 0x3f803f80, v32
  v_dot2c_f32_bf16 v45, 0x3f803f80, v33
  s_waitcnt lgkmcnt(8)
  v_dot2c_f32_bf16 v46, 0x3f803f80, v34
  v_dot2c_f32_bf16 v47, 0x3f803f80, v35
  ds_read_b64_tr_b16 v[32:33], v52 offset:26624
  ds_read_b64_tr_b16 v[34:35], v52 offset:27648
  s_waitcnt lgkmcnt(9)
  v_dot2c_f32_bf16 v48, 0x3f803f80, v36
  v_dot2c_f32_bf16 v49, 0x3f803f80, v37
  s_waitcnt lgkmcnt(8)
  v_dot2c_f32_bf16 v50, 0x3f803f80, v38
  v_dot2c_f32_bf16 v51, 0x3f803f80, v39
  ds_read_b64_tr_b16 v[36:37], v52 offset:28672
  ds_read_b64_tr_b16 v[38:39], v52 offset:29696
  s_waitcnt lgkmcnt(9)
  v_dot2c_f32_bf16 v44, 0x3f803f80, v20
  v_dot2c_f32_bf16 v45, 0x3f803f80, v21
  s_waitcnt lgkmcnt(8)
  v_dot2c_f32_bf16 v46, 0x3f803f80, v22
  v_dot2c_f32_bf16 v47, 0x3f803f80, v23
  ds_read_b64_tr_b16 v[20:21], v52 offset:30720
  ds_read_b64_tr_b16 v[22:23], v52 offset:31744
  s_waitcnt lgkmcnt(9)
  v_dot2c_f32_bf16 v48, 0x3f803f80, v24
  v_dot2c_f32_bf16 v49, 0x3f803f80, v25
  s_waitcnt lgkmcnt(8)
  v_dot2c_f32_bf16 v50, 0x3f803f80, v26
  v_dot2c_f32_bf16 v51, 0x3f803f80, v27
  ds_read_b64_tr_b16 v[24:25], v53 offset:0
  ds_read_b64_tr_b16 v[26:27], v53 offset:1024
  s_waitcnt lgkmcnt(9)
  v_dot2c_f32_bf16 v44, 0x3f803f80, v28
  v_dot2c_f32_bf16 v45, 0x3f803f80, v29
  s_waitcnt lgkmcnt(8)
  v_dot2c_f32_bf16 v46, 0x3f803f80, v30
  v_dot2c_f32_bf16 v47, 0x3f803f80, v31
  ds_read_b64_tr_b16 v[28:29], v53 offset:2048
  ds_read_b64_tr_b16 v[30:31], v53 offset:3072
  s_waitcnt lgkmcnt(9)
  v_dot2c_f32_bf16 v48, 0x3f803f80, v32
  v_dot2c_f32_bf16 v49, 0x3f803f80, v33
  s_waitcnt lgkmcnt(8)
  v_dot2c_f32_bf16 v50, 0x3f803f80, v34
  v_dot2c_f32_bf16 v51, 0x3f803f80, v35
  ds_read_b64_tr_b16 v[32:33], v53 offset:4096
  ds_read_b64_tr_b16 v[34:35], v53 offset:5120
  s_waitcnt lgkmcnt(9)
  v_dot2c_f32_bf16 v44, 0x3f803f80, v36
  v_dot2c_f32_bf16 v45, 0x3f803f80, v37
  s_waitcnt lgkmcnt(8)
  v_dot2c_f32_bf16 v46, 0x3f803f80, v38
  v_dot2c_f32_bf16 v47, 0x3f803f80, v39
  ds_read_b64_tr_b16 v[36:37], v53 offset:6144
  ds_read_b64_tr_b16 v[38:39], v53 offset:7168
  s_waitcnt lgkmcnt(9)
  v_dot2c_f32_bf16 v48, 0x3f803f80, v20
  v_dot2c_f32_bf16 v49, 0x3f803f80, v21
  s_waitcnt lgkmcnt(8)
  v_dot2c_f32_bf16 v50, 0x3f803f80, v22
  v_dot2c_f32_bf16 v51, 0x3f803f80, v23
  ds_read_b64_tr_b16 v[20:21], v53 offset:8192
  ds_read_b64_tr_b16 v[22:23], v53 offset:9216
  s_waitcnt lgkmcnt(9)
  v_dot2c_f32_bf16 v44, 0x3f803f80, v24
  v_dot2c_f32_bf16 v45, 0x3f803f80, v25
  s_waitcnt lgkmcnt(8)
  v_dot2c_f32_bf16 v46, 0x3f803f80, v26
  v_dot2c_f32_bf16 v47, 0x3f803f80, v27
  ds_read_b64_tr_b16 v[24:25], v53 offset:10240
  ds_read_b64_tr_b16 v[26:27], v53 offset:11264
  s_waitcnt lgkmcnt(9)
  v_dot2c_f32_bf16 v48, 0x3f803f80, v28
  v_dot2c_f32_bf16 v49, 0x3f803f80, v29
  s_waitcnt lgkmcnt(8)
  v_dot2c_f32_bf16 v50, 0x3f803f80, v30
  v_dot2c_f32_bf16 v51, 0x3f803f80, v31
  ds_read_b64_tr_b16 v[28:29], v53 offset:12288
  ds_read_b64_tr_b16 v[30:31], v53 offset:13312
  s_waitcnt lgkmcnt(9)
  v_dot2c_f32_bf16 v44, 0x3f803f80, v32
  v_dot2c_f32_bf16 v45, 0x3f803f80, v33
  s_waitcnt lgkmcnt(8)
  v_dot2c_f32_bf16 v46, 0x3f803f80, v34
  v_dot2c_f32_bf16 v47, 0x3f803f80, v35
  ds_read_b64_tr_b16 v[32:33], v53 offset:14336
  ds_read_b64_tr_b16 v[34:35], v53 offset:15360
  s_waitcnt lgkmcnt(9)
  v_dot2c_f32_bf16 v48, 0x3f803f80, v36
  v_dot2c_f32_bf16 v49, 0x3f803f80, v37
  s_waitcnt lgkmcnt(8)
  v_dot2c_f32_bf16 v50, 0x3f803f80, v38
  v_dot2c_f32_bf16 v51, 0x3f803f80, v39
  ds_read_b64_tr_b16 v[36:37], v53 offset:16384
  ds_read_b64_tr_b16 v[38:39], v53 offset:17408
  s_waitcnt lgkmcnt(9)
  v_dot2c_f32_bf16 v44, 0x3f803f80, v20
  v_dot2c_f32_bf16 v45, 0x3f803f80, v21
  s_waitcnt lgkmcnt(8)
  v_dot2c_f32_bf16 v46, 0x3f803f80, v22
  v_dot2c_f32_bf16 v47, 0x3f803f80, v23
  s_waitcnt lgkmcnt(7)
  v_dot2c_f32_bf16 v48, 0x3f803f80, v24
  v_dot2c_f32_bf16 v49, 0x3f803f80, v25
  s_waitcnt lgkmcnt(6)
  v_dot2c_f32_bf16 v50, 0x3f803f80, v26
  v_dot2c_f32_bf16 v51, 0x3f803f80, v27
  s_waitcnt lgkmcnt(5)
  v_dot2c_f32_bf16 v44, 0x3f803f80, v28
  v_dot2c_f32_bf16 v45, 0x3f803f80, v29
  s_waitcnt lgkmcnt(4)
  v_dot2c_f32_bf16 v46, 0x3f803f80, v30
  v_dot2c_f32_bf16 v47, 0x3f803f80, v31
  s_waitcnt lgkmcnt(3)
  v_dot2c_f32_bf16 v48, 0x3f803f80, v32
  v_dot2c_f32_bf16 v49, 0x3f803f80, v33
  s_waitcnt lgkmcnt(2)
  v_dot2c_f32_bf16 v50, 0x3f803f80, v34
  v_dot2c_f32_bf16 v51, 0x3f803f80, v35
  s_waitcnt lgkmcnt(1)
  v_dot2c_f32_bf16 v44, 0x3f803f80, v36
  v_dot2c_f32_bf16 v45, 0x3f803f80, v37
  s_waitcnt lgkmcnt(0)
  v_dot2c_f32_bf16 v46, 0x3f803f80, v38
  v_dot2c_f32_bf16 v47, 0x3f803f80, v39
CW_181:
  s_sub_u32 s50, s36, 4
  s_nop 2
  v_add_f32 v44, v44, v48
  v_add_f32 v45, v45, v49
  v_add_f32 v46, v46, v50
  v_add_f32 v47, v47, v51
  v_add_f32 v44, v44, v46
  v_add_f32 v45, v45, v47
  v_add_f32 v44, v44, v45
  v_mbcnt_lo_u32_b32 v9, -1, 0
  v_mbcnt_hi_u32_b32 v9, -1, v9
  v_mov_b32 v45, v44
  s_nop 1
  v_permlane32_swap_b32 v44, v45
  v_add_f32 v44, v44, v45
  v_and_b32 v9, 31, v9
  s_lshl_b32 s50, s50, 7
  s_add_u32 s50, s50, 162304
  v_lshl_add_u32 v9, v9, 2, s50
  ds_write_b32 v9, v44
  s_waitcnt lgkmcnt(0)
CW_179:
  s_barrier
  s_cmp_lg_u32 s40, 0
  s_cbranch_scc1 UC_178
  v_mbcnt_lo_u32_b32 v9, -1, 0
  v_mbcnt_hi_u32_b32 v9, -1, v9
  s_and_b32 s50, s38, 15
  s_lshr_b32 s51, s50, 1
  s_and_b32 s50, s50, 1
  s_lshl_b32 s53, s50, 10
  s_lshl_b32 s54, s51, 7
  s_add_u32 s53, s53, s54
  s_lshl_b32 s55, s50, 6
  s_add_u32 s54, s54, s55
  s_add_u32 s54, s54, 2048
  s_sub_u32 s54, s54, 128
  v_add_u32 v13, 0, v9
  v_mul_u32_u24 v14, 171, v13
  v_lshrrev_b32 v14, 11, v14
  v_mul_u32_u24 v15, 12, v14
  v_sub_u32 v15, v13, v15
  v_mov_b32 v16, s53
  v_mov_b32 v17, s54
  v_cmp_gt_u32 vcc, 8, v15
  s_nop 1
  v_cndmask_b32 v16, v17, v16, vcc
  v_lshl_add_u32 v16, v15, 4, v16
  v_mul_u32_u24 v14, 3072, v14
  v_add_u32 v10, v14, v16
  v_add_u32 v13, 64, v9
  v_mul_u32_u24 v14, 171, v13
  v_lshrrev_b32 v14, 11, v14
  v_mul_u32_u24 v15, 12, v14
  v_sub_u32 v15, v13, v15
  v_mov_b32 v16, s53
  v_mov_b32 v17, s54
  v_cmp_gt_u32 vcc, 8, v15
  s_nop 1
  v_cndmask_b32 v16, v17, v16, vcc
  v_lshl_add_u32 v16, v15, 4, v16
  v_mul_u32_u24 v14, 3072, v14
  v_add_u32 v11, v14, v16
  v_add_u32 v13, 128, v9
  v_mul_u32_u24 v14, 171, v13
  v_lshrrev_b32 v14, 11, v14
  v_mul_u32_u24 v15, 12, v14
  v_sub_u32 v15, v13, v15
  v_mov_b32 v16, s53
  v_mov_b32 v17, s54
  v_cmp_gt_u32 vcc, 8, v15
  s_nop 1
  v_cndmask_b32 v16, v17, v16, vcc
  v_lshl_add_u32 v16, v15, 4, v16
  v_mul_u32_u24 v14, 3072, v14
  v_add_u32 v12, v14, v16
  s_add_u32 s52, s36, -4
  s_cmp_ge_u32 s52, 10
  s_cselect_b32 s53, 11, 0
  s_add_u32 s52, s52, s53
  s_mul_i32 s54, s52, 49152
  buffer_load_dwordx4 v[44:47], v10, s[8:11], s54 offen
  buffer_load_dwordx4 v[48:51], v11, s[8:11], s54 offen
  buffer_load_dwordx4 v[52:55], v12, s[8:11], s54 offen
  s_add_u32 s52, s36, 0
  s_cmp_ge_u32 s52, 10
  s_cselect_b32 s53, 11, 0
  s_add_u32 s52, s52, s53
  s_mul_i32 s54, s52, 49152
  buffer_load_dwordx4 v[56:59], v10, s[8:11], s54 offen
  buffer_load_dwordx4 v[60:63], v11, s[8:11], s54 offen
  buffer_load_dwordx4 v[64:67], v12, s[8:11], s54 offen
  s_add_u32 s52, s36, 4
  s_cmp_ge_u32 s52, 10
  s_cselect_b32 s53, 11, 0
  s_add_u32 s52, s52, s53
  s_mul_i32 s54, s52, 49152
  buffer_load_dwordx4 v[68:71], v10, s[8:11], s54 offen
  buffer_load_dwordx4 v[72:75], v11, s[8:11], s54 offen
  buffer_load_dwordx4 v[76:79], v12, s[8:11], s54 offen
  s_add_u32 s52, s36, 8
  s_cmp_ge_u32 s52, 10
  s_cselect_b32 s53, 11, 0
  s_add_u32 s52, s52, s53
  s_mul_i32 s54, s52, 49152
  buffer_load_dwordx4 v[80:83], v10, s[8:11], s54 offen
  buffer_load_dwordx4 v[84:87], v11, s[8:11], s54 offen
  buffer_load_dwordx4 v[88:91], v12, s[8:11], s54 offen
  s_cmp_lg_u32 s36, 4
  s_cbranch_scc1 QL_186
  s_mov_b32 s52, 31
  s_mul_i32 s54, s52, 49152
  buffer_load_dwordx4 v[92:95], v10, s[8:11], s54 offen
  buffer_load_dwordx4 v[96:99], v11, s[8:11], s54 offen
  buffer_load_dwordx4 v[100:103], v12, s[8:11], s54 offen
QL_186:
UC_178:
  s_cmp_eq_u32 s36, 4
  s_cbranch_scc1 UJ_176
  s_and_b32 s50, s38, 15
  s_cmp_lt_u32 s50, 14
  s_cbranch_scc1 UXI_187
  v_mbcnt_lo_u32_b32 v9, -1, 0
  v_mbcnt_hi_u32_b32 v9, -1, v9
  v_lshrrev_b32 v13, 3, v9
  v_and_b32 v14, 7, v9
  v_lshlrev_b32 v15, 1, v13
  v_and_b32 v15, 4, v15
  v_xor_b32 v14, v14, v15
  v_mul_u32_u24 v13, 1024, v13
  v_lshl_add_u32 v9, v14, 4, v13
  s_and_b32 s55, s38, 7
  s_lshl_b32 s55, s55, 7
  s_sub_u32 s56, s36, 5
  s_mov_b32 s52, s56
  s_cmp_ge_u32 s52, 28
  s_cbranch_scc1 DX_189
DL_188:
  s_lshl_b32 m0, s52, 10
  s_cmp_ge_u32 s52, 14
  s_cselect_b32 s50, 1, 0
  s_mul_i32 s53, s50, 14
  s_sub_u32 s53, s52, s53
  s_lshr_b32 s51, s53, 3
  s_lshl_b32 s51, s51, 3
  s_add_u32 s51, s51, s53
  s_lshl_b32 s54, s51, 13
  s_add_u32 s54, s54, s55
  s_mul_i32 s51, s50, 917504
  s_add_u32 s54, s54, s51
  buffer_load_dwordx4 v9, s[20:23], s54 offen lds
  s_add_u32 s52, s52, 3
  s_cmp_lt_u32 s52, 28
  s_cbranch_scc1 DL_188
DX_189:
UXI_187:
  v_mbcnt_lo_u32_b32 v9, -1, 0
  v_mbcnt_hi_u32_b32 v9, -1, v9
  v_lshrrev_b32 v13, 3, v9
  v_and_b32 v14, 7, v9
  v_lshlrev_b32 v15, 1, v13
  v_and_b32 v15, 4, v15
  v_xor_b32 v14, v14, v15
  v_mul_u32_u24 v13, 1024, v13
  v_lshl_add_u32 v9, v14, 4, v13
  s_and_b32 s55, s38, 7
  s_lshl_b32 s55, s55, 7
  s_sub_u32 s56, s36, 5
  s_mov_b32 s52, s56
  s_cmp_ge_u32 s52, 64
  s_cbranch_scc1 DX_191
DL_190:
  s_lshl_b32 s53, s52, 10
  s_add_u32 m0, s53, 96256
  s_lshr_b32 s50, s52, 5
  s_and_b32 s53, s52, 31
  s_add_u32 s53, s53, 14
  s_lshr_b32 s51, s53, 3
  s_lshl_b32 s51, s51, 3
  s_add_u32 s51, s51, s53
  s_lshl_b32 s54, s51, 13
  s_add_u32 s54, s54, s55
  s_mul_i32 s51, s50, 917504
  s_add_u32 s54, s54, s51
  buffer_load_dwordx4 v9, s[20:23], s54 offen lds
  s_add_u32 s52, s52, 3
  s_cmp_lt_u32 s52, 64
  s_cbranch_scc1 DL_190
DX_191:
UJ_176:
  s_barrier
  v_mbcnt_lo_u32_b32 v9, -1, 0
  v_mbcnt_hi_u32_b32 v9, -1, v9
  s_and_b32 s50, s36, 1
  s_bfe_u32 s51, s36, 0x10001
  s_lshl_b32 s51, s51, 10
  v_lshl_add_u32 v9, v9, 4, s51
  s_lshl_b32 s50, s50, 15
  s_add_u32 s50, s50, 30720
  v_add_u32 v10, s50, v9
  ds_write_b128 v10, v[104:107] offset:0
  ds_write_b128 v10, v[108:111] offset:2048
  ds_write_b128 v10, v[112:115] offset:4096
  ds_write_b128 v10, v[116:119] offset:6144
  ds_write_b128 v10, v[120:123] offset:8192
  ds_write_b128 v10, v[124:127] offset:10240
  ds_write_b128 v10, v[128:131] offset:12288
  ds_write_b128 v10, v[132:135] offset:14336
  ds_write_b128 v10, v[136:139] offset:16384
  ds_write_b128 v10, v[140:143] offset:18432
  ds_write_b128 v10, v[144:147] offset:20480
  ds_write_b128 v10, v[148:151] offset:22528
  ds_write_b128 v10, v[152:155] offset:24576
  ds_write_b128 v10, v[156:159] offset:26624
  ds_write_b128 v10, v[160:163] offset:28672
  ds_write_b128 v10, v[164:167] offset:30720
  s_waitcnt lgkmcnt(0)
  s_waitcnt vmcnt(0)
  s_barrier
  s_barrier
  v_mbcnt_lo_u32_b32 v9, -1, 0
  v_mbcnt_hi_u32_b32 v9, -1, v9
  s_and_b32 s50, s36, 1
  s_bfe_u32 s51, s36, 0x10001
  s_lshl_b32 s51, s51, 10
  v_lshl_add_u32 v9, v9, 4, s51
  s_mul_i32 s51, s50, 14336
  v_add_u32 v10, s51, v9
  s_lshl_b32 s50, s50, 15
  s_add_u32 s50, s50, 96256
  v_add_u32 v11, s50, v9
  ds_write_b128 v10, v[168:171] offset:0
  ds_write_b128 v10, v[172:175] offset:2048
  ds_write_b128 v10, v[176:179] offset:4096
  ds_write_b128 v10, v[180:183] offset:6144
  ds_write_b128 v10, v[184:187] offset:8192
  ds_write_b128 v10, v[188:191] offset:10240
  ds_write_b128 v10, v[192:195] offset:12288
  ds_write_b128 v11, v[196:199] offset:0
  ds_write_b128 v11, v[200:203] offset:2048
  ds_write_b128 v11, v[204:207] offset:4096
  ds_write_b128 v11, v[208:211] offset:6144
  ds_write_b128 v11, v[212:215] offset:8192
  ds_write_b128 v11, v[216:219] offset:10240
  ds_write_b128 v11, v[220:223] offset:12288
  ds_write_b128 v11, v[224:227] offset:14336
  ds_write_b128 v11, v[228:231] offset:16384
  ds_write_b128 v11, v[232:235] offset:18432
  s_waitcnt lgkmcnt(0)
  s_barrier
  s_cmp_lg_u32 s40, 0
  s_cbranch_scc1 L_END
  v_mbcnt_lo_u32_b32 v9, -1, 0
  v_mbcnt_hi_u32_b32 v9, -1, v9
  s_and_b32 s50, s38, 15
  s_lshr_b32 s51, s50, 1
  s_and_b32 s50, s50, 1
  s_lshl_b32 s53, s50, 10
  s_lshl_b32 s54, s51, 7
  s_add_u32 s53, s53, s54
  s_lshl_b32 s55, s50, 6
  s_add_u32 s54, s54, s55
  s_add_u32 s54, s54, 2048
  s_sub_u32 s54, s54, 128
  v_add_u32 v13, 0, v9
  v_mul_u32_u24 v14, 171, v13
  v_lshrrev_b32 v14, 11, v14
  v_mul_u32_u24 v15, 12, v14
  v_sub_u32 v15, v13, v15
  v_mov_b32 v16, s53
  v_mov_b32 v17, s54
  v_cmp_gt_u32 vcc, 8, v15
  s_nop 1
  v_cndmask_b32 v16, v17, v16, vcc
  v_lshl_add_u32 v16, v15, 4, v16
  v_mul_u32_u24 v14, 3072, v14
  v_add_u32 v10, v14, v16
  v_add_u32 v13, 64, v9
  v_mul_u32_u24 v14, 171, v13
  v_lshrrev_b32 v14, 11, v14
  v_mul_u32_u24 v15, 12, v14
  v_sub_u32 v15, v13, v15
  v_mov_b32 v16, s53
  v_mov_b32 v17, s54
  v_cmp_gt_u32 vcc, 8, v15
  s_nop 1
  v_cndmask_b32 v16, v17, v16, vcc
  v_lshl_add_u32 v16, v15, 4, v16
  v_mul_u32_u24 v14, 3072, v14
  v_add_u32 v11, v14, v16
  v_add_u32 v13, 128, v9
  v_mul_u32_u24 v14, 171, v13
  v_lshrrev_b32 v14, 11, v14
  v_mul_u32_u24 v15, 12, v14
  v_sub_u32 v15, v13, v15
  v_mov_b32 v16, s53
  v_mov_b32 v17, s54
  v_cmp_gt_u32 vcc, 8, v15
  s_nop 1
  v_cndmask_b32 v16, v17, v16, vcc
  v_lshl_add_u32 v16, v15, 4, v16
  v_mul_u32_u24 v14, 3072, v14
  v_add_u32 v12, v14, v16
  s_barrier
  s_cmp_lg_u32 s40, 0
  s_cbranch_scc1 TN_195
  s_add_u32 s56, s36, 6
  s_mov_b32 s52, s56
  s_cmp_ge_u32 s52, 25
  s_cbranch_scc1 DX_198
DL_197:
  s_cmp_ge_u32 s52, 21
  s_cselect_b32 s50, 6, 0
  s_add_u32 s50, s50, s52
  s_mul_i32 s53, s50, 3072
  s_mul_i32 s54, s50, 49152
  s_add_u32 m0, s53, 0
  s_nop 0
  buffer_load_dwordx4 v10, s[8:11], s54 offen lds
  s_add_u32 m0, s53, 1024
  s_nop 0
  buffer_load_dwordx4 v11, s[8:11], s54 offen lds
  s_add_u32 m0, s53, 2048
  s_nop 0
  buffer_load_dwordx4 v12, s[8:11], s54 offen lds
  s_add_u32 s52, s52, 4
  s_cmp_lt_u32 s52, 25
  s_cbranch_scc1 DL_197
DX_198:
TN_195:
  s_barrier
  s_cmp_lg_u32 s40, 0
  s_cbranch_scc1 TN_199
  v_mbcnt_lo_u32_b32 v9, -1, 0
  v_mbcnt_hi_u32_b32 v9, -1, v9
  v_lshlrev_b32 v9, 4, v9
  s_add_u32 s52, s36, -4
  s_cmp_ge_u32 s52, 10
  s_cselect_b32 s53, 11, 0
  s_add_u32 s52, s52, s53
  s_mul_i32 s53, s52, 3072
  v_add_u32 v10, s53, v9
  ds_write_b128 v10, v[44:47] offset:0
  ds_write_b128 v10, v[48:51] offset:1024
  ds_write_b128 v10, v[52:55] offset:2048
  s_add_u32 s52, s36, 0
  s_cmp_ge_u32 s52, 10
  s_cselect_b32 s53, 11, 0
  s_add_u32 s52, s52, s53
  s_mul_i32 s53, s52, 3072
  v_add_u32 v10, s53, v9
  ds_write_b128 v10, v[56:59] offset:0
  ds_write_b128 v10, v[60:63] offset:1024
  ds_write_b128 v10, v[64:67] offset:2048
TN_199:
  s_barrier
  s_cmp_lg_u32 s40, 0
  s_cbranch_scc1 L_END
  s_mov_b32 s41, 6
  s_mov_b32 s40, 1
  s_andn2_b32 s90, s66, s39
  s_mov_b32 s66, s39
  s_mov_b32 s91, s39
  s_mov_b32 s60, 6291456
  s_mul_i32 s61, s39, 58982400
  s_add_u32 s61, s61, 10485760
  s_mov_b32 s65, s38
  s_mov_b32 s70, s37
  s_add_u32 s42, s40, 1
  s_add_u32 s52, s36, 4
  s_cmp_ge_u32 s52, 10
  s_cselect_b32 s53, 11, 0
  s_add_u32 s52, s52, s53
  s_mul_i32 s53, s52, 3072
  v_add_u32 v10, s53, v9
  ds_write_b128 v10, v[68:71] offset:0
  ds_write_b128 v10, v[72:75] offset:1024
  ds_write_b128 v10, v[76:79] offset:2048
  s_add_u32 s52, s36, 8
  s_cmp_ge_u32 s52, 10
  s_cselect_b32 s53, 11, 0
  s_add_u32 s52, s52, s53
  s_mul_i32 s53, s52, 3072
  v_add_u32 v10, s53, v9
  ds_write_b128 v10, v[80:83] offset:0
  ds_write_b128 v10, v[84:87] offset:1024
  ds_write_b128 v10, v[88:91] offset:2048
  s_cmp_lg_u32 s36, 4
  s_cbranch_scc1 QL_208
  s_mov_b32 s52, 31
  s_mul_i32 s53, s52, 3072
  v_add_u32 v10, s53, v9
  ds_write_b128 v10, v[92:95] offset:0
  ds_write_b128 v10, v[96:99] offset:1024
  ds_write_b128 v10, v[100:103] offset:2048
QL_208:
  s_waitcnt vmcnt(0) lgkmcnt(0)
  s_barrier
  s_cmp_ge_u32 s36, 5
  s_cbranch_scc1 QD_203
  s_cmp_eq_u32 s90, 0
  s_cbranch_scc1 DYN_209
  s_barrier
DYN_209:
  s_branch QJ_205
QD_203:
  s_cmp_eq_u32 s90, 0
  s_cbranch_scc1 DYN_210
  v_mbcnt_lo_u32_b32 v9, -1, 0
  v_mbcnt_hi_u32_b32 v9, -1, v9
  v_bfe_u32 v13, v9, 2, 2
  v_bfe_u32 v14, v9, 4, 1
  v_lshlrev_b32 v14, 5, v14
  v_and_b32 v15, 3, v9
  v_lshl_add_u32 v14, v15, 3, v14
  v_lshrrev_b32 v15, 5, v9
  s_sub_u32 s50, s36, 5
  s_lshl_b32 s51, s50, 6
  v_lshl_add_u32 v16, v15, 2, v13
  v_mul_u32_u24 v16, 192, v16
  v_add3_u32 v16, v16, v14, s51
  v_add_u32 v17, 49152, v16
  v_mov_b32 v44, 0
  v_mov_b32 v45, 0
  v_mov_b32 v46, 0
  v_mov_b32 v47, 0
  v_mov_b32 v48, 0
  v_mov_b32 v49, 0
  v_mov_b32 v50, 0
  v_mov_b32 v51, 0
  ds_read_b64_tr_b16 v[20:21], v16 offset:0
  ds_read_b64_tr_b16 v[22:23], v16 offset:1536
  ds_read_b64_tr_b16 v[24:25], v16 offset:3072
  ds_read_b64_tr_b16 v[26:27], v16 offset:4608
  ds_read_b64_tr_b16 v[28:29], v16 offset:6144
  ds_read_b64_tr_b16 v[30:31], v16 offset:7680
  ds_read_b64_tr_b16 v[32:33], v16 offset:9216
  ds_read_b64_tr_b16 v[34:35], v16 offset:10752
  ds_read_b64_tr_b16 v[36:37], v16 offset:12288
  ds_read_b64_tr_b16 v[38:39], v16 offset:13824
  s_waitcnt lgkmcnt(9)
  v_dot2c_f32_bf16 v44, 0x3f803f80, v20
  v_dot2c_f32_bf16 v45, 0x3f803f80, v21
  s_waitcnt lgkmcnt(8)
  v_dot2c_f32_bf16 v46, 0x3f803f80, v22
  v_dot2c_f32_bf16 v47, 0x3f803f80, v23
  ds_read_b64_tr_b16 v[20:21], v16 offset:15360
  ds_read_b64_tr_b16 v[22:23], v16 offset:16896
  s_waitcnt lgkmcnt(9)
  v_dot2c_f32_bf16 v48, 0x3f803f80, v24
  v_dot2c_f32_bf16 v49, 0x3f803f80, v25
  s_waitcnt lgkmcnt(8)
  v_dot2c_f32_bf16 v50, 0x3f803f80, v26
  v_dot2c_f32_bf16 v51, 0x3f803f80, v27
  ds_read_b64_tr_b16 v[24:25], v16 offset:18432
  ds_read_b64_tr_b16 v[26:27], v16 offset:19968
  s_waitcnt lgkmcnt(9)
  v_dot2c_f32_bf16 v44, 0x3f803f80, v28
  v_dot2c_f32_bf16 v45, 0x3f803f80, v29
  s_waitcnt lgkmcnt(8)
  v_dot2c_f32_bf16 v46, 0x3f803f80, v30
  v_dot2c_f32_bf16 v47, 0x3f803f80, v31
  ds_read_b64_tr_b16 v[28:29], v16 offset:21504
  ds_read_b64_tr_b16 v[30:31], v16 offset:23040
  s_waitcnt lgkmcnt(9)
  v_dot2c_f32_bf16 v48, 0x3f803f80, v32
  v_dot2c_f32_bf16 v49, 0x3f803f80, v33
  s_waitcnt lgkmcnt(8)
  v_dot2c_f32_bf16 v50, 0x3f803f80, v34
  v_dot2c_f32_bf16 v51, 0x3f803f80, v35
  ds_read_b64_tr_b16 v[32:33], v16 offset:24576
  ds_read_b64_tr_b16 v[34:35], v16 offset:26112
  s_waitcnt lgkmcnt(9)
  v_dot2c_f32_bf16 v44, 0x3f803f80, v36
  v_dot2c_f32_bf16 v45, 0x3f803f80, v37
  s_waitcnt lgkmcnt(8)
  v_dot2c_f32_bf16 v46, 0x3f803f80, v38
  v_dot2c_f32_bf16 v47, 0x3f803f80, v39
  ds_read_b64_tr_b16 v[36:37], v16 offset:27648
  ds_read_b64_tr_b16 v[38:39], v16 offset:29184
  s_waitcnt lgkmcnt(9)
  v_dot2c_f32_bf16 v48, 0x3f803f80, v20
  v_dot2c_f32_bf16 v49, 0x3f803f80, v21
  s_waitcnt lgkmcnt(8)
  v_dot2c_f32_bf16 v50, 0x3f803f80, v22
  v_dot2c_f32_bf16 v51, 0x3f803f80, v23
  ds_read_b64_tr_b16 v[20:21], v16 offset:30720
  ds_read_b64_tr_b16 v[22:23], v16 offset:32256
  s_waitcnt lgkmcnt(9)
  v_dot2c_f32_bf16 v44, 0x3f803f80, v24
  v_dot2c_f32_bf16 v45, 0x3f803f80, v25
  s_waitcnt lgkmcnt(8)
  v_dot2c_f32_bf16 v46, 0x3f803f80, v26
  v_dot2c_f32_bf16 v47, 0x3f803f80, v27
  ds_read_b64_tr_b16 v[24:25], v16 offset:33792
  ds_read_b64_tr_b16 v[26:27], v16 offset:35328
  s_waitcnt lgkmcnt(9)
  v_dot2c_f32_bf16 v48, 0x3f803f80, v28
  v_dot2c_f32_bf16 v49, 0x3f803f80, v29
  s_waitcnt lgkmcnt(8)
  v_dot2c_f32_bf16 v50, 0x3f803f80, v30
  v_dot2c_f32_bf16 v51, 0x3f803f80, v31
  ds_read_b64_tr_b16 v[28:29], v16 offset:36864
  ds_read_b64_tr_b16 v[30:31], v16 offset:38400
  s_waitcnt lgkmcnt(9)
  v_dot2c_f32_bf16 v44, 0x3f803f80, v32
  v_dot2c_f32_bf16 v45, 0x3f803f80, v33
  s_waitcnt lgkmcnt(8)
  v_dot2c_f32_bf16 v46, 0x3f803f80, v34
  v_dot2c_f32_bf16 v47, 0x3f803f80, v35
  ds_read_b64_tr_b16 v[32:33], v16 offset:39936
  ds_read_b64_tr_b16 v[34:35], v16 offset:41472
  s_waitcnt lgkmcnt(9)
  v_dot2c_f32_bf16 v48, 0x3f803f80, v36
  v_dot2c_f32_bf16 v49, 0x3f803f80, v37
  s_waitcnt lgkmcnt(8)
  v_dot2c_f32_bf16 v50, 0x3f803f80, v38
  v_dot2c_f32_bf16 v51, 0x3f803f80, v39
  ds_read_b64_tr_b16 v[36:37], v16 offset:43008
  ds_read_b64_tr_b16 v[38:39], v16 offset:44544
  s_waitcnt lgkmcnt(9)
  v_dot2c_f32_bf16 v44, 0x3f803f80, v20
  v_dot2c_f32_bf16 v45, 0x3f803f80, v21
  s_waitcnt lgkmcnt(8)
  v_dot2c_f32_bf16 v46, 0x3f803f80, v22
  v_dot2c_f32_bf16 v47, 0x3f803f80, v23
  ds_read_b64_tr_b16 v[20:21], v16 offset:46080
  ds_read_b64_tr_b16 v[22:23], v16 offset:47616
  s_waitcnt lgkmcnt(9)
  v_dot2c_f32_bf16 v48, 0x3f803f80, v24
  v_dot2c_f32_bf16 v49, 0x3f803f80, v25
  s_waitcnt lgkmcnt(8)
  v_dot2c_f32_bf16 v50, 0x3f803f80, v26
  v_dot2c_f32_bf16 v51, 0x3f803f80, v27
  ds_read_b64_tr_b16 v[24:25], v17 offset:0
  ds_read_b64_tr_b16 v[26:27], v17 offset:1536
  s_waitcnt lgkmcnt(9)
  v_dot2c_f32_bf16 v44, 0x3f803f80, v28
  v_dot2c_f32_bf16 v45, 0x3f803f80, v29
  s_waitcnt lgkmcnt(8)
  v_dot2c_f32_bf16 v46, 0x3f803f80, v30
  v_dot2c_f32_bf16 v47, 0x3f803f80, v31
  ds_read_b64_tr_b16 v[28:29], v17 offset:3072
  ds_read_b64_tr_b16 v[30:31], v17 offset:4608
  s_waitcnt lgkmcnt(9)
  v_dot2c_f32_bf16 v48, 0x3f803f80, v32
  v_dot2c_f32_bf16 v49, 0x3f803f80, v33
  s_waitcnt lgkmcnt(8)
  v_dot2c_f32_bf16 v50, 0x3f803f80, v34
  v_dot2c_f32_bf16 v51, 0x3f803f80, v35
  ds_read_b64_tr_b16 v[32:33], v17 offset:6144
  ds_read_b64_tr_b16 v[34:35], v17 offset:7680
  s_waitcnt lgkmcnt(9)
  v_dot2c_f32_bf16 v44, 0x3f803f80, v36
  v_dot2c_f32_bf16 v45, 0x3f803f80, v37
  s_waitcnt lgkmcnt(8)
  v_dot2c_f32_bf16 v46, 0x3f803f80, v38
  v_dot2c_f32_bf16 v47, 0x3f803f80, v39
  ds_read_b64_tr_b16 v[36:37], v17 offset:9216
  ds_read_b64_tr_b16 v[38:39], v17 offset:10752
  s_waitcnt lgkmcnt(9)
  v_dot2c_f32_bf16 v48, 0x3f803f80, v20
  v_dot2c_f32_bf16 v49, 0x3f803f80, v21
  s_waitcnt lgkmcnt(8)
  v_dot2c_f32_bf16 v50, 0x3f803f80, v22
  v_dot2c_f32_bf16 v51, 0x3f803f80, v23
  ds_read_b64_tr_b16 v[20:21], v17 offset:12288
  ds_read_b64_tr_b16 v[22:23], v17 offset:13824
  s_waitcnt lgkmcnt(9)
  v_dot2c_f32_bf16 v44, 0x3f803f80, v24
  v_dot2c_f32_bf16 v45, 0x3f803f80, v25
  s_waitcnt lgkmcnt(8)
  v_dot2c_f32_bf16 v46, 0x3f803f80, v26
  v_dot2c_f32_bf16 v47, 0x3f803f80, v27
  ds_read_b64_tr_b16 v[24:25], v17 offset:15360
  ds_read_b64_tr_b16 v[26:27], v17 offset:16896
  s_waitcnt lgkmcnt(9)
  v_dot2c_f32_bf16 v48, 0x3f803f80, v28
  v_dot2c_f32_bf16 v49, 0x3f803f80, v29
  s_waitcnt lgkmcnt(8)
  v_dot2c_f32_bf16 v50, 0x3f803f80, v30
  v_dot2c_f32_bf16 v51, 0x3f803f80, v31
  ds_read_b64_tr_b16 v[28:29], v17 offset:18432
  ds_read_b64_tr_b16 v[30:31], v17 offset:19968
  s_waitcnt lgkmcnt(9)
  v_dot2c_f32_bf16 v44, 0x3f803f80, v32
  v_dot2c_f32_bf16 v45, 0x3f803f80, v33
  s_waitcnt lgkmcnt(8)
  v_dot2c_f32_bf16 v46, 0x3f803f80, v34
  v_dot2c_f32_bf16 v47, 0x3f803f80, v35
  ds_read_b64_tr_b16 v[32:33], v17 offset:21504
  ds_read_b64_tr_b16 v[34:35], v17 offset:23040
  s_waitcnt lgkmcnt(9)
  v_dot2c_f32_bf16 v48, 0x3f803f80, v36
  v_dot2c_f32_bf16 v49, 0x3f803f80, v37
  s_waitcnt lgkmcnt(8)
  v_dot2c_f32_bf16 v50, 0x3f803f80, v38
  v_dot2c_f32_bf16 v51, 0x3f803f80, v39
  ds_read_b64_tr_b16 v[36:37], v17 offset:24576
  ds_read_b64_tr_b16 v[38:39], v17 offset:26112
  s_waitcnt lgkmcnt(9)
  v_dot2c_f32_bf16 v44, 0x3f803f80, v20
  v_dot2c_f32_bf16 v45, 0x3f803f80, v21
  s_waitcnt lgkmcnt(8)
  v_dot2c_f32_bf16 v46, 0x3f803f80, v22
  v_dot2c_f32_bf16 v47, 0x3f803f80, v23
  ds_read_b64_tr_b16 v[20:21], v17 offset:27648
  ds_read_b64_tr_b16 v[22:23], v17 offset:29184
  s_waitcnt lgkmcnt(9)
  v_dot2c_f32_bf16 v48, 0x3f803f80, v24
  v_dot2c_f32_bf16 v49, 0x3f803f80, v25
  s_waitcnt lgkmcnt(8)
  v_dot2c_f32_bf16 v50, 0x3f803f80, v26
  v_dot2c_f32_bf16 v51, 0x3f803f80, v27
  ds_read_b64_tr_b16 v[24:25], v17 offset:30720
  ds_read_b64_tr_b16 v[26:27], v17 offset:32256
  s_waitcnt lgkmcnt(9)
  v_dot2c_f32_bf16 v44, 0x3f803f80, v28
  v_dot2c_f32_bf16 v45, 0x3f803f80, v29
  s_waitcnt lgkmcnt(8)
  v_dot2c_f32_bf16 v46, 0x3f803f80, v30
  v_dot2c_f32_bf16 v47, 0x3f803f80, v31
  ds_read_b64_tr_b16 v[28:29], v17 offset:33792
  ds_read_b64_tr_b16 v[30:31], v17 offset:35328
  s_waitcnt lgkmcnt(9)
  v_dot2c_f32_bf16 v48, 0x3f803f80, v32
  v_dot2c_f32_bf16 v49, 0x3f803f80, v33
  s_waitcnt lgkmcnt(8)
  v_dot2c_f32_bf16 v50, 0x3f803f80, v34
  v_dot2c_f32_bf16 v51, 0x3f803f80, v35
  ds_read_b64_tr_b16 v[32:33], v17 offset:36864
  ds_read_b64_tr_b16 v[34:35], v17 offset:38400
  s_waitcnt lgkmcnt(9)
  v_dot2c_f32_bf16 v44, 0x3f803f80, v36
  v_dot2c_f32_bf16 v45, 0x3f803f80, v37
  s_waitcnt lgkmcnt(8)
  v_dot2c_f32_bf16 v46, 0x3f803f80, v38
  v_dot2c_f32_bf16 v47, 0x3f803f80, v39
  ds_read_b64_tr_b16 v[36:37], v17 offset:39936
  ds_read_b64_tr_b16 v[38:39], v17 offset:41472
  s_waitcnt lgkmcnt(9)
  v_dot2c_f32_bf16 v48, 0x3f803f80, v20
  v_dot2c_f32_bf16 v49, 0x3f803f80, v21
  s_waitcnt lgkmcnt(8)
  v_dot2c_f32_bf16 v50, 0x3f803f80, v22
  v_dot2c_f32_bf16 v51, 0x3f803f80, v23
  ds_read_b64_tr_b16 v[20:21], v17 offset:43008
  ds_read_b64_tr_b16 v[22:23], v17 offset:44544
  s_waitcnt lgkmcnt(9)
  v_dot2c_f32_bf16 v44, 0x3f803f80, v24
  v_dot2c_f32_bf16 v45, 0x3f803f80, v25
  s_waitcnt lgkmcnt(8)
  v_dot2c_f32_bf16 v46, 0x3f803f80, v26
  v_dot2c_f32_bf16 v47, 0x3f803f80, v27
  ds_read_b64_tr_b16 v[24:25], v17 offset:46080
  ds_read_b64_tr_b16 v[26:27], v17 offset:47616
  s_waitcnt lgkmcnt(9)
  v_dot2c_f32_bf16 v48, 0x3f803f80, v28
  v_dot2c_f32_bf16 v49, 0x3f803f80, v29
  s_waitcnt lgkmcnt(8)
  v_dot2c_f32_bf16 v50, 0x3f803f80, v30
  v_dot2c_f32_bf16 v51, 0x3f803f80, v31
  s_waitcnt lgkmcnt(7)
  v_dot2c_f32_bf16 v44, 0x3f803f80, v32
  v_dot2c_f32_bf16 v45, 0x3f803f80, v33
  s_waitcnt lgkmcnt(6)
  v_dot2c_f32_bf16 v46, 0x3f803f80, v34
  v_dot2c_f32_bf16 v47, 0x3f803f80, v35
  s_waitcnt lgkmcnt(5)
  v_dot2c_f32_bf16 v48, 0x3f803f80, v36
  v_dot2c_f32_bf16 v49, 0x3f803f80, v37
  s_waitcnt lgkmcnt(4)
  v_dot2c_f32_bf16 v50, 0x3f803f80, v38
  v_dot2c_f32_bf16 v51, 0x3f803f80, v39
  s_waitcnt lgkmcnt(3)
  v_dot2c_f32_bf16 v44, 0x3f803f80, v20
  v_dot2c_f32_bf16 v45, 0x3f803f80, v21
  s_waitcnt lgkmcnt(2)
  v_dot2c_f32_bf16 v46, 0x3f803f80, v22
  v_dot2c_f32_bf16 v47, 0x3f803f80, v23
  s_waitcnt lgkmcnt(1)
  v_dot2c_f32_bf16 v48, 0x3f803f80, v24
  v_dot2c_f32_bf16 v49, 0x3f803f80, v25
  s_waitcnt lgkmcnt(0)
  v_dot2c_f32_bf16 v50, 0x3f803f80, v26
  v_dot2c_f32_bf16 v51, 0x3f803f80, v27
  s_nop 2
  v_add_f32 v44, v44, v48
  v_add_f32 v45, v45, v49
  v_add_f32 v46, v46, v50
  v_add_f32 v47, v47, v51
  v_add_f32 v44, v44, v46
  v_add_f32 v45, v45, v47
  v_add_f32 v44, v44, v45
  v_mbcnt_lo_u32_b32 v9, -1, 0
  v_mbcnt_hi_u32_b32 v9, -1, v9
  v_mov_b32 v45, v44
  s_nop 1
  v_permlane32_swap_b32 v44, v45
  v_add_f32 v44, v44, v45
  v_and_b32 v9, 31, v9
  s_lshl_b32 s50, s50, 7
  s_add_u32 s50, s50, 161792
  v_lshl_add_u32 v9, v9, 2, s50
  ds_write_b32 v9, v44
  s_waitcnt lgkmcnt(0)
  s_barrier
DYN_210:
QJ_205:
  s_mul_i32 s50, s40, 5
  s_mul_i32 s51, s39, 11796480
  s_mul_i32 s50, s50, s51
  s_add_u32 s50, s50, 10485760
  s_add_u32 s50, s50, s51
  s_mov_b32 s62, s50
  s_add_u32 s50, s50, s51
  s_mov_b32 s63, s50
  s_add_u32 s50, s50, s51
  s_mov_b32 s64, s50
  s_add_u32 s50, s50, s51
  s_mov_b32 s69, s50
  v_mbcnt_lo_u32_b32 v96, -1, 0
  v_mbcnt_hi_u32_b32 v96, -1, v96
  v_lshlrev_b32 v95, 4, v96
  v_mov_b32 v94, 0xdddddddd
  s_lshr_b32 s51, s36, 2
  s_lshl_b32 s50, s51, 12
  s_add_u32 s50, s50, 30720
  s_mul_i32 s51, s51, 4096
  s_add_u32 s51, s51, 38912
  v_add_u32 v92, s50, v95
  v_and_b32 v4, 31, v96
  v_lshrrev_b32 v5, 5, v96
  v_lshlrev_b32 v5, 8, v5
  v_lshl_add_u32 v5, v4, 4, v5
  v_cmp_eq_u32 vcc, 16, v4
  v_add_u32 v93, s51, v5
  v_mov_b32 v5, 0x3f803f80
  v_cndmask_b32 v76, 0, v5, vcc
  v_cndmask_b32 v77, 0, v5, vcc
  v_cndmask_b32 v78, 0, v5, vcc
  v_cndmask_b32 v79, 0, v5, vcc
  v_cndmask_b32 v80, 0, v5, vcc
  v_cndmask_b32 v81, 0, v5, vcc
  v_cndmask_b32 v82, 0, v5, vcc
  v_cndmask_b32 v83, 0, v5, vcc
  s_mov_b32 s98, 0xffff
  s_mov_b32 s99, 0xffff
  v_mov_b32 v32, 0
  v_mov_b32 v33, 0
  v_mov_b32 v34, 0
  v_mov_b32 v35, 0
  v_mov_b32 v36, 0
  v_mov_b32 v37, 0
  v_mov_b32 v38, 0
  v_mov_b32 v39, 0
  v_mov_b32 v40, 0
  v_mov_b32 v41, 0
  v_mov_b32 v42, 0
  v_mov_b32 v43, 0
  v_mov_b32 v44, 0
  v_mov_b32 v45, 0
  v_mov_b32 v46, 0
  v_mov_b32 v47, 0
  v_mov_b32 v48, 0
  v_mov_b32 v49, 0
  v_mov_b32 v50, 0
  v_mov_b32 v51, 0
  v_mov_b32 v52, 0
  v_mov_b32 v53, 0
  v_mov_b32 v54, 0
  v_mov_b32 v55, 0
  v_mov_b32 v56, 0
  v_mov_b32 v57, 0
  v_mov_b32 v58, 0
  v_mov_b32 v59, 0
  v_mov_b32 v60, 0
  v_mov_b32 v61, 0
  v_mov_b32 v62, 0
  v_mov_b32 v63, 0
  s_bfe_u32 s45, s36, 0x10001
  s_lshl_b32 s46, s37, 1
  s_add_u32 s45, s45, s46
  s_mul_i32 s45, s45, 737280
  s_lshl_b32 s47, s36, 10
  s_add_u32 s67, s47, 47104
  s_and_b32 s50, s37, 1
  s_lshl_b32 s50, s50, 3
  s_lshr_b32 s51, s38, 2
  s_add_u32 s50, s50, s51
  s_lshl_b32 s50, s50, 9
  s_add_u32 s50, s50, 8192
  s_lshl_b32 s51, s66, 3
  s_or_b32 s51, s51, s37
  v_and_b32 v5, 31, v96
  v_lshrrev_b32 v4, 2, v5
  v_cmp_eq_u32 vcc, s51, v4
  v_xor_b32 v4, 4, v5
  s_nop 0
  v_cndmask_b32 v4, v5, v4, vcc
  v_and_b32 v5, 3, v4
  v_lshrrev_b32 v4, 2, v4
  v_lshl_add_u32 v5, v5, 2, s50
  v_lshl_add_u32 v99, v4, 6, v5
  v_mbcnt_lo_u32_b32 v97, -1, 0
  v_mbcnt_hi_u32_b32 v97, -1, v97
  v_lshrrev_b32 v13, 3, v97
  v_and_b32 v14, 7, v97
  v_lshlrev_b32 v15, 1, v13
  v_and_b32 v15, 4, v15
  v_xor_b32 v14, v14, v15
  v_mul_u32_u24 v13, 3584, v13
  v_lshl_add_u32 v97, v14, 4, v13
  v_mbcnt_lo_u32_b32 v98, -1, 0
  v_mbcnt_hi_u32_b32 v98, -1, v98
  v_lshrrev_b32 v13, 3, v98
  v_and_b32 v14, 7, v98
  v_lshlrev_b32 v15, 1, v13
  v_and_b32 v15, 4, v15
  v_xor_b32 v14, v14, v15
  v_mul_u32_u24 v13, 1024, v13
  v_lshl_add_u32 v98, v14, 4, v13
  s_lshl_b32 s44, s38, 16
  s_add_u32 s44, s44, s60
  s_add_u32 s44, s44, s47
  s_and_b32 s54, s38, 15
  s_min_u32 s54, s54, 13
  s_lshl_b32 s54, s54, 8
  s_and_b32 s55, s38, 7
  s_lshl_b32 s55, s55, 7
  s_mov_b32 s71, 0
  s_lshl_b32 s92, s37, 13
  s_lshl_b32 s93, s36, 10
  s_lshl_b32 s94, s36, 13
  s_add_u32 s94, s94, s55
  s_add_u32 s95, s93, 81920
  s_add_u32 s96, s36, 50
  s_mul_i32 s96, s96, 28672
  s_add_u32 s96, s96, s54
  s_add_u32 s96, s96, 128
  s_and_b32 s50, s36, 1
  s_mul_i32 s50, s50, 896
  s_bfe_u32 s51, s36, 0x10001
  s_lshl_b32 s51, s51, 3
  s_add_u32 s50, s50, s51
  s_add_u32 s50, s50, 688
  s_lshl_b32 s50, s50, 10
  s_add_u32 s97, s50, s55
  s_and_b32 s52, s36, 3
  v_mov_b32 v87, 0x7f000000
  s_lshr_b32 s50, s38, 4
  s_mul_i32 s50, s50, 88
  s_mul_i32 s51, s52, 22
  s_add_u32 s50, s50, s51
  v_add_u32 v85, s50, v96
  v_cmp_gt_u32 vcc, 0, v85
  v_add_u32 v4, 336, v85
  s_nop 0
  v_cndmask_b32 v85, v4, v85, vcc
  v_mul_u32_u24 v85, 3584, v85
  v_add_u32 v85, s54, v85
  v_cmp_gt_u32 vcc, 22, v96
  v_mov_b32 v4, 0x7f000000
  s_nop 0
  v_cndmask_b32 v85, v4, v85, vcc
  s_lshr_b32 s50, s38, 3
  s_mul_i32 s50, s50, 192
  s_mul_i32 s51, s52, 48
  s_add_u32 s50, s50, s51
  v_add_u32 v86, s50, v96
  v_cmp_gt_u32 vcc, 384, v86
  v_add_u32 v4, 64, v86
  s_nop 0
  v_cndmask_b32 v86, v4, v86, vcc
  v_and_b32 v4, 0xffc0, v86
  v_add_u32 v86, v4, v86
  v_mul_u32_u24 v86, 1024, v86
  v_add_u32 v86, s55, v86
  v_cmp_gt_u32 vcc, 48, v96
  v_mov_b32 v4, 0x7f000000
  s_nop 0
  v_cndmask_b32 v86, v4, v86, vcc
  s_lshr_b32 s50, s38, 4
  s_lshl_b32 s51, s37, 1
  s_add_u32 s50, s50, s51
  s_mul_i32 s50, s50, 737280
  s_and_b32 s51, s38, 15
  s_mul_i32 s51, s51, 46080
  s_add_u32 s50, s50, s51
  s_mul_i32 s51, s52, 11520
  s_add_u32 s50, s50, s51
  s_add_u32 s50, s50, 10485760
  s_lshl_b32 s51, s66, 30
  s_add_u32 s50, s50, s51
  v_lshl_add_u32 v84, v96, 8, s50
  v_cmp_gt_u32 vcc, 45, v96
  v_mov_b32 v4, 0x7f000000
  s_nop 0
  v_cndmask_b32 v84, v4, v84, vcc
  s_lshl_b32 s46, s37, 1
  s_mul_i32 s46, s46, 737280
  s_mul_i32 s50, s52, 114688
  s_add_u32 s46, s46, s50
  s_lshl_b32 s50, s38, 10
  s_add_u32 s46, s46, s50
  s_add_u32 s46, s46, s61
  v_mbcnt_lo_u32_b32 v88, -1, 0
  v_mbcnt_hi_u32_b32 v88, -1, v88
  s_lshl_b32 s50, s37, 10
  s_and_b32 s51, s36, 3
  s_lshl_b32 s51, s51, 7
  s_add_u32 s50, s50, s51
  s_lshr_b32 s51, s38, 2
  s_lshl_b32 s51, s51, 3
  s_add_u32 s50, s50, s51
  v_bfe_u32 v4, v88, 1, 1
  v_and_b32 v88, 1, v88
  v_lshl_add_u32 v88, v88, 2, s50
  v_lshl_add_u32 v88, v4, 6, v88
  s_barrier
  s_branch L_LAYER_h
ASLW_25:
  s_lshl_b32 s44, s38, 16
  s_add_u32 s44, s44, s60
  v_and_b32 v4, 31, v96
  v_lshrrev_b32 v5, 5, v96
  v_lshlrev_b32 v5, 8, v5
  v_lshl_add_u32 v93, v4, 4, v5
  v_cmp_eq_u32 vcc, 16, v4
  v_mov_b32 v5, 0x3f803f80
  s_nop 0
  v_cndmask_b32 v5, 0, v5, vcc
  v_mov_b32 v76, v5
  v_mov_b32 v77, v5
  v_mov_b32 v78, v5
  v_mov_b32 v79, v5
  v_mov_b32 v80, v5
  v_mov_b32 v81, v5
  v_mov_b32 v82, v5
  v_mov_b32 v83, v5
  v_mov_b32 v32, 0
  v_mov_b32 v33, 0
  v_mov_b32 v34, 0
  v_mov_b32 v35, 0
  v_mov_b32 v36, 0
  v_mov_b32 v37, 0
  v_mov_b32 v38, 0
  v_mov_b32 v39, 0
  v_mov_b32 v40, 0
  v_mov_b32 v41, 0
  v_mov_b32 v42, 0
  v_mov_b32 v43, 0
  v_mov_b32 v44, 0
  v_mov_b32 v45, 0
  v_mov_b32 v46, 0
  v_mov_b32 v47, 0
  v_mov_b32 v48, 0xff800000
  s_mov_b32 s50, 0
  s_mov_b32 s48, s44
AMX_30:
  buffer_load_dwordx4 v[72:75], v95, s[28:31], s48 offen
  s_add_u32 s48, s48, 1024
  s_add_u32 s50, s50, 1
  s_waitcnt vmcnt(0)
  v_mfma_f32_32x32x16_bf16 v[0:15], v[72:75], v[64:67], 0
  s_nop 12
  v_max3_f32 v48, v48, v0, v1
  v_max3_f32 v48, v48, v2, v3
  v_max3_f32 v48, v48, v4, v5
  v_max3_f32 v48, v48, v6, v7
  v_max3_f32 v48, v48, v8, v9
  v_max3_f32 v48, v48, v10, v11
  v_max3_f32 v48, v48, v12, v13
  v_max3_f32 v48, v48, v14, v15
  s_cmp_lt_u32 s50, 64
  s_cbranch_scc1 AMX_30
  v_mov_b32 v49, v48
  s_nop 1
  v_permlane32_swap_b32 v48, v49
  v_max_f32 v48, v48, v49
  v_sub_f32 v48, 0, v48
  v_mov_b32 v49, v48
  v_mov_b32 v50, v48
  v_mov_b32 v51, v48
  v_mov_b32 v52, v48
  v_mov_b32 v53, v48
  v_mov_b32 v54, v48
  v_mov_b32 v55, v48
  v_mov_b32 v56, v48
  v_mov_b32 v57, v48
  v_mov_b32 v58, v48
  v_mov_b32 v59, v48
  v_mov_b32 v60, v48
  v_mov_b32 v61, v48
  v_mov_b32 v62, v48
  v_mov_b32 v63, v48
  s_mov_b32 s50, 0
  s_mov_b32 s48, s44
AMX_31:
  buffer_load_dwordx4 v[72:75], v95, s[28:31], s48 offen
  s_add_u32 s49, s48, 2097152
  s_mov_b32 exec_lo, 0xffff
  s_mov_b32 exec_hi, 0xffff
  buffer_load_dwordx4 v[76:79], v93, s[28:31], s49 offen
  buffer_load_dwordx4 v[80:83], v93, s[28:31], s49 offen offset:512
  s_mov_b64 exec, -1
  s_add_u32 s48, s48, 1024
  s_add_u32 s50, s50, 1
  s_waitcnt vmcnt(0)
  v_mfma_f32_32x32x16_bf16 v[0:15], v[72:75], v[64:67], v[48:63]
  s_nop 12
  v_exp_f32 v0, v0
  v_exp_f32 v1, v1
  v_exp_f32 v2, v2
  v_exp_f32 v3, v3
  v_exp_f32 v4, v4
  v_exp_f32 v5, v5
  v_exp_f32 v6, v6
  v_exp_f32 v7, v7
  v_exp_f32 v8, v8
  v_exp_f32 v9, v9
  v_exp_f32 v10, v10
  v_exp_f32 v11, v11
  v_exp_f32 v12, v12
  v_exp_f32 v13, v13
  v_exp_f32 v14, v14
  v_exp_f32 v15, v15
  s_nop 1
  v_smfmac_f32_32x32x32_bf16 v[32:47], v[76:79], v[0:7], v94
  v_smfmac_f32_32x32x32_bf16 v[32:47], v[80:83], v[8:15], v94
  s_cmp_lt_u32 s50, 64
  s_cbranch_scc1 AMX_31
  s_nop 12
  v_mov_b32 v41, v40
  s_nop 1
  v_permlane32_swap_b32 v40, v41
  s_branch ANRM_24
ASLW_157:
  s_lshl_b32 s44, s38, 16
  s_add_u32 s44, s44, s60
  v_and_b32 v4, 31, v96
  v_lshrrev_b32 v5, 5, v96
  v_lshlrev_b32 v5, 8, v5
  v_lshl_add_u32 v93, v4, 4, v5
  v_cmp_eq_u32 vcc, 16, v4
  v_mov_b32 v5, 0x3f803f80
  s_nop 0
  v_cndmask_b32 v5, 0, v5, vcc
  v_mov_b32 v76, v5
  v_mov_b32 v77, v5
  v_mov_b32 v78, v5
  v_mov_b32 v79, v5
  v_mov_b32 v80, v5
  v_mov_b32 v81, v5
  v_mov_b32 v82, v5
  v_mov_b32 v83, v5
  v_mov_b32 v32, 0
  v_mov_b32 v33, 0
  v_mov_b32 v34, 0
  v_mov_b32 v35, 0
  v_mov_b32 v36, 0
  v_mov_b32 v37, 0
  v_mov_b32 v38, 0
  v_mov_b32 v39, 0
  v_mov_b32 v40, 0
  v_mov_b32 v41, 0
  v_mov_b32 v42, 0
  v_mov_b32 v43, 0
  v_mov_b32 v44, 0
  v_mov_b32 v45, 0
  v_mov_b32 v46, 0
  v_mov_b32 v47, 0
  v_mov_b32 v48, 0xff800000
  s_mov_b32 s50, 0
  s_mov_b32 s48, s44
AMX_162:
  buffer_load_dwordx4 v[72:75], v95, s[28:31], s48 offen
  s_add_u32 s48, s48, 1024
  s_add_u32 s50, s50, 1
  s_waitcnt vmcnt(0)
  v_mfma_f32_32x32x16_bf16 v[0:15], v[72:75], v[64:67], 0
  s_nop 12
  v_max3_f32 v48, v48, v0, v1
  v_max3_f32 v48, v48, v2, v3
  v_max3_f32 v48, v48, v4, v5
  v_max3_f32 v48, v48, v6, v7
  v_max3_f32 v48, v48, v8, v9
  v_max3_f32 v48, v48, v10, v11
  v_max3_f32 v48, v48, v12, v13
  v_max3_f32 v48, v48, v14, v15
  s_cmp_lt_u32 s50, 64
  s_cbranch_scc1 AMX_162
  v_mov_b32 v49, v48
  s_nop 1
  v_permlane32_swap_b32 v48, v49
  v_max_f32 v48, v48, v49
  v_sub_f32 v48, 0, v48
  v_mov_b32 v49, v48
  v_mov_b32 v50, v48
  v_mov_b32 v51, v48
  v_mov_b32 v52, v48
  v_mov_b32 v53, v48
  v_mov_b32 v54, v48
  v_mov_b32 v55, v48
  v_mov_b32 v56, v48
  v_mov_b32 v57, v48
  v_mov_b32 v58, v48
  v_mov_b32 v59, v48
  v_mov_b32 v60, v48
  v_mov_b32 v61, v48
  v_mov_b32 v62, v48
  v_mov_b32 v63, v48
  s_mov_b32 s50, 0
  s_mov_b32 s48, s44
AMX_163:
  buffer_load_dwordx4 v[72:75], v95, s[28:31], s48 offen
  s_add_u32 s49, s48, 2097152
  s_mov_b32 exec_lo, 0xffff
  s_mov_b32 exec_hi, 0xffff
  buffer_load_dwordx4 v[76:79], v93, s[28:31], s49 offen
  buffer_load_dwordx4 v[80:83], v93, s[28:31], s49 offen offset:512
  s_mov_b64 exec, -1
  s_add_u32 s48, s48, 1024
  s_add_u32 s50, s50, 1
  s_waitcnt vmcnt(0)
  v_mfma_f32_32x32x16_bf16 v[0:15], v[72:75], v[64:67], v[48:63]
  s_nop 12
  v_exp_f32 v0, v0
  v_exp_f32 v1, v1
  v_exp_f32 v2, v2
  v_exp_f32 v3, v3
  v_exp_f32 v4, v4
  v_exp_f32 v5, v5
  v_exp_f32 v6, v6
  v_exp_f32 v7, v7
  v_exp_f32 v8, v8
  v_exp_f32 v9, v9
  v_exp_f32 v10, v10
  v_exp_f32 v11, v11
  v_exp_f32 v12, v12
  v_exp_f32 v13, v13
  v_exp_f32 v14, v14
  v_exp_f32 v15, v15
  s_nop 1
  v_smfmac_f32_32x32x32_bf16 v[32:47], v[76:79], v[0:7], v94
  v_smfmac_f32_32x32x32_bf16 v[32:47], v[80:83], v[8:15], v94
  s_cmp_lt_u32 s50, 64
  s_cbranch_scc1 AMX_163
  s_nop 12
  v_mov_b32 v41, v40
  s_nop 1
  v_permlane32_swap_b32 v40, v41
  s_branch ANRM_156
STS_7:
  global_store_dword v236, v237, s[34:35] sc1
  s_branch STD_8
STS_26:
  buffer_store_dwordx4 v[32:35], v95, s[28:31], s46 offen sc1
  s_branch STD_27
STS_28:
  global_store_dword v90, v91, s[34:35] sc1
  s_branch STD_29
STS_37:
  buffer_store_dwordx4 v[248:251], v216, s[28:31], s46 offen sc1
  buffer_store_dwordx4 v[252:255], v216, s[28:31], s46 offen offset:1024 sc1
  s_branch STD_38
STS_39:
  buffer_store_dword v224, v216, s[28:31], s49 offen sc1
  s_branch STD_40
STS_43:
  global_store_dword v226, v227, s[34:35] sc1
  s_branch STD_44
STS_56:
  buffer_store_dwordx4 v[128:131], v245, s[28:31], s46 offen offset:0 sc1
  buffer_store_dwordx4 v[136:139], v245, s[28:31], s46 offen offset:1024 sc1
  s_branch STD_57
STS_58:
  buffer_store_dwordx4 v[144:147], v245, s[28:31], s46 offen offset:2048 sc1
  buffer_store_dwordx4 v[152:155], v245, s[28:31], s46 offen offset:3072 sc1
  s_branch STD_59
STS_60:
  buffer_store_dwordx4 v[160:163], v245, s[28:31], s48 offen offset:0 sc1
  buffer_store_dwordx4 v[168:171], v245, s[28:31], s48 offen offset:1024 sc1
  s_branch STD_61
STS_64:
  global_store_dword v192, v193, s[34:35] sc1
  s_branch STD_65
STS_66:
  buffer_store_dwordx4 v[176:179], v245, s[28:31], s48 offen offset:2048 sc1
  buffer_store_dwordx4 v[184:187], v245, s[28:31], s48 offen offset:3072 sc1
  s_branch STD_67
STS_78:
  global_store_dword v224, v225, s[34:35] sc1
  s_branch STD_79
STS_85:
  buffer_store_dwordx4 v[248:251], v216, s[28:31], s46 offen sc1
  buffer_store_dwordx4 v[252:255], v216, s[28:31], s46 offen offset:1024 sc1
  s_branch STD_86
STS_87:
  buffer_store_dword v224, v216, s[28:31], s49 offen sc1
  s_branch STD_88
STS_91:
  global_store_dword v226, v227, s[34:35] sc1
  s_branch STD_92
STS_100:
  buffer_store_dwordx4 v[160:163], v245, s[28:31], s46 offen offset:0 sc1
  buffer_store_dwordx4 v[168:171], v245, s[28:31], s46 offen offset:512 sc1
  s_branch STD_101
STS_102:
  buffer_store_dwordx4 v[128:131], v214, s[28:31], s45 offen offset:0 sc1
  buffer_store_dwordx4 v[136:139], v214, s[28:31], s45 offen offset:1024 sc1
  s_branch STD_103
STS_107:
  buffer_store_dwordx4 v[144:147], v214, s[28:31], s45 offen offset:2048 sc1
  buffer_store_dwordx4 v[152:155], v214, s[28:31], s45 offen offset:3072 sc1
  s_branch STD_108
STS_109:
  global_store_dword v236, v237, s[34:35] sc1
  s_branch STD_110
STS_158:
  buffer_store_dwordx4 v[32:35], v95, s[28:31], s46 offen sc1
  s_branch STD_159
STS_160:
  global_store_dword v90, v91, s[34:35] sc1
  s_branch STD_161
L_END:
  s_endpgm
.section .rodata,"a"
.p2align 6
.amdhsa_kernel interleave_layers__mha_block__dense_activation_silu__prompt_kernel
  .amdhsa_next_free_vgpr 256
  .amdhsa_next_free_sgpr 100
  .amdhsa_accum_offset 256
  .amdhsa_group_segment_fixed_size 0
  .amdhsa_kernarg_size 72
  .amdhsa_user_sgpr_count 2
  .amdhsa_user_sgpr_kernarg_segment_ptr 1
  .amdhsa_system_sgpr_workgroup_id_x 1
.end_amdhsa_kernel
```
